```python
import torch

def _softmax(x, axis=-1):
    return torch.softmax(x, dim=axis)
def _gelu(x):
    return torch.nn.functional.gelu(x, approximate="tanh")
def _silu(x):
    return torch.nn.functional.silu(x)
def _sigmoid(x):
    return torch.sigmoid(x)
def _layernorm(x, axis=-1, eps=1e-5):
    m = x.mean(dim=axis, keepdim=True)
    v = x.var(dim=axis, keepdim=True, unbiased=False)
    return (x - m) / torch.sqrt(v + eps)
def _scatter_add(tgt, idx, src, axis=0):
    return tgt.clone().index_add_(axis, idx, src)
def _segment_sum(src, seg, n):
    out = torch.zeros((n,) + src.shape[1:], dtype=src.dtype)
    return out.index_add_(0, seg, src)
def _pad(x, pw):
    flat = tuple(v for pair in reversed(pw) for v in pair)
    return torch.nn.functional.pad(x, flat)

kernel_name = 'gated_mix__compressed_kv_cla__linear_kernel_hedgehog__prompt'

def setup_inputs():

    _w = (lambda a: (lambda t: t.to(torch.bfloat16) if t.is_floating_point() else t)(torch.as_tensor(a)))
    def _A_setup():
        B, H, Sq, Sk, D, M = 1, 32, 2048, 2048, 128, 512
        Dc = 4 * D
        return {
            "x": _w((lambda *s: torch.randn(*s, dtype=torch.bfloat16) * 0.05)(B, Sq, M)),
            "c_kv": _w((lambda *s: torch.randn(*s, dtype=torch.bfloat16) * 0.8)(B, Sk, Dc)),
            "w_q": _w((lambda *s: torch.randn(*s, dtype=torch.bfloat16) * 6.4)(M, H, D) * (M ** -0.5)),
            "w_uk": _w((lambda *s: torch.randn(*s, dtype=torch.bfloat16) * 6.4)(Dc, H, D) * (Dc ** -0.5)),
            "w_uv": _w((lambda *s: torch.randn(*s, dtype=torch.bfloat16) * 0.8)(Dc, H, D) * (Dc ** -0.5)),
            "w_o": _w((lambda *s: torch.randn(*s, dtype=torch.bfloat16) * 0.8)(H, D, M) * ((H * D) ** -0.5)),
        }
    _A_in = _A_setup()

    def _B_setup():
        B, S, D, H = 1, 2048, 512, 32
        Dh = D // H
        return {
            "x": _w((lambda *s: torch.randn(*s, dtype=torch.bfloat16) * 0.05)(B, S, D)),
            "wqkv": _w((lambda *s: torch.randn(*s, dtype=torch.bfloat16) * 1.6)(D, 3 * D)),
            "w_phi": _w((lambda *s: torch.randn(*s, dtype=torch.bfloat16) * 1.6)(H, Dh, Dh) * (Dh ** -0.5)),
            "wo": _w((lambda *s: torch.randn(*s, dtype=torch.bfloat16) * 0.05)(D, D)),
        }
    _B_in = _B_setup()

    return {
        "A_x": _A_in["x"],
        "A_c_kv": _A_in["c_kv"],
        "A_w_q": _A_in["w_q"],
        "A_w_uk": _A_in["w_uk"],
        "A_w_uv": _A_in["w_uv"],
        "A_w_o": _A_in["w_o"],
        "B_x": _B_in["x"],
        "B_wqkv": _B_in["wqkv"],
        "B_w_phi": _B_in["w_phi"],
        "B_wo": _B_in["wo"],
        "gate_w": _w((lambda *s: torch.randn(*s, dtype=torch.bfloat16) * 0.05)(512) * 16.0),
    }

def reference(A_x, A_c_kv, A_w_q, A_w_uk, A_w_uv, A_w_o, B_x, B_wqkv, B_w_phi, B_wo, gate_w):
    def _A_ref(x, c_kv, w_q, w_uk, w_uv, w_o):
        B, Sq, M = x.shape[0], x.shape[1], x.shape[2]
        Sk = c_kv.shape[1]
        H, D = w_q.shape[1], w_q.shape[2]
        q = torch.einsum("bqm,mhd->bhqd", x, w_q)
        k = torch.einsum("bkc,chd->bhkd", c_kv, w_uk)
        v = torch.einsum("bkc,chd->bhkd", c_kv, w_uv)
        scores = torch.einsum("bhqd,bhkd->bhqk", q, k) * (D ** -0.5)
        off = Sk - Sq
        qi = torch.arange(Sq)[:, None]
        kj = torch.arange(Sk)[None, :]
        cmask = kj <= (qi + off)
        scores = torch.where(cmask[None, None], scores, -1e9)
        p = _softmax(scores, axis=-1)
        ctx = torch.einsum("bhqk,bhkd->bhqd", p, v)
        return torch.einsum("bhqd,hdm->bqm", ctx, w_o)

    def _B_ref(x, wqkv, w_phi, wo):
        B, S, D = x.shape
        H = 32; Dh = D // H
        qkv = (lambda x, *d: x.permute(*d))((x @ wqkv).reshape(B, S, 3, H, Dh), 2, 0, 3, 1, 4)
        q, k, v = qkv[0], qkv[1], qkv[2]
        pq = torch.einsum("bhsd,hdf->bhsf", q, w_phi)
        pk = torch.einsum("bhsd,hdf->bhsf", k, w_phi)
        phi_q = torch.concatenate([_softmax(pq, axis=-1), _softmax(-pq, axis=-1)], axis=-1)
        phi_k = torch.concatenate([_softmax(pk, axis=-1), _softmax(-pk, axis=-1)], axis=-1)
        kv = torch.einsum("bhsf,bhsd->bhfd", phi_k, v)
        z  = torch.einsum("bhsf->bhf", phi_k)
        num = torch.einsum("bhqf,bhfd->bhqd", phi_q, kv)
        den = torch.einsum("bhqf,bhf->bhq", phi_q, z)[..., None] + 1e-6
        o = num / den
        return (lambda x, *d: x.permute(*d))(o, 0, 2, 1, 3).reshape(B, S, D) @ wo

    x = A_x
    g = _sigmoid((x * gate_w).sum(-1, keepdims=True))
    a = _A_ref(x, A_c_kv, A_w_q, A_w_uk, A_w_uv, A_w_o)
    b = _B_ref(x, B_wqkv, B_w_phi, B_wo)
    return g * a + (1 - g) * b
```

```asm
; @launch kernel=proj_kernel grid=(256,1,1) block=(512,1,1) lds=131072
; @launch kernel=attn_kernel grid=(256,1,1) block=(512,1,1) lds=131072
.amdgcn_target "amdgcn-amd-amdhsa--gfx950"
.text
.globl proj_kernel
.p2align 8
.type proj_kernel,@function
proj_kernel:
    s_cmp_ge_u32 s2, 256
    s_cbranch_scc1 K1_EXIT
    s_load_dwordx4 s[36:39], s[0:1], 0
    s_load_dwordx4 s[40:43], s[0:1], 16
    s_load_dwordx2 s[44:45], s[0:1], 32
    s_load_dwordx4 s[48:51], s[0:1], 56
    s_load_dwordx2 s[46:47], s[0:1], 104
    s_load_dwordx2 s[58:59], s[0:1], 80
    v_lshrrev_b32 v1, 6, v0
    v_and_b32 v19, 63, v0
    v_readfirstlane_b32 s20, v1
    v_lshlrev_b32 v18, 4, v19
    s_waitcnt lgkmcnt(0)
    s_mov_b32 s16, s46
    s_and_b32 s17, s47, 0xffff
    s_mov_b32 s18, 268435456
    s_mov_b32 s19, 0x00020000
    s_mov_b32 s52, s50
    s_and_b32 s53, s51, 0xffff
    s_mov_b32 s54, 16384
    s_mov_b32 s55, 0x00020000
    s_mov_b32 s64, s58
    s_and_b32 s65, s59, 0xffff
    s_mov_b32 s66, 1024
    s_mov_b32 s67, 0x00020000
    s_bfe_u32 s29, s2, 0x30003
    s_cmp_lt_u32 s2, 64
    s_cbranch_scc1 K1_BMODE
    s_mov_b32 s21, 0
    s_sub_u32 s30, s2, 64
    s_and_b32 s31, s30, 7
    s_lshr_b32 s32, s30, 3
    s_and_b32 s22, s32, 3
    s_lshr_b32 s32, s32, 2
    s_mul_i32 s31, s31, 6
    s_add_u32 s32, s32, s31
    s_lshr_b32 s24, s32, 4
    s_and_b32 s23, s32, 15
    s_cmp_eq_u32 s24, 0
    s_cselect_b32 s30, s36, s38
    s_cselect_b32 s31, s37, s39
    s_mov_b32 s8, s30
    s_and_b32 s9, s31, 0xffff
    s_mov_b32 s10, 2097152
    s_mov_b32 s11, 0x00020000
    s_cmp_eq_u32 s24, 0
    s_cselect_b32 s30, s40, s42
    s_cselect_b32 s31, s41, s43
    s_cmp_eq_u32 s24, 2
    s_cselect_b32 s30, s44, s30
    s_cselect_b32 s31, s45, s31
    s_cselect_b32 s26, 1, 0
    s_mov_b32 s12, s30
    s_and_b32 s13, s31, 0xffff
    s_mov_b32 s14, 4194304
    s_mov_b32 s15, 0x00020000
    s_mov_b32 s25, 524288
    s_mov_b32 s34, 8192
    s_lshl_b32 s35, s23, 9
    s_branch K1_COMMON
K1_BMODE:
    s_mov_b32 s21, 1
    s_and_b32 s22, s2, 7
    s_lshr_b32 s23, s2, 3
    s_mov_b32 s24, 3
    s_mov_b32 s8, s36
    s_and_b32 s9, s37, 0xffff
    s_mov_b32 s10, 2097152
    s_mov_b32 s11, 0x00020000
    s_mov_b32 s12, s48
    s_and_b32 s13, s49, 0xffff
    s_mov_b32 s14, 1572864
    s_mov_b32 s15, 0x00020000
    s_mov_b32 s25, 196608
    s_mov_b32 s34, 3072
    s_lshl_b32 s35, s23, 7
    s_lshr_b32 s30, s20, 1
    s_cmp_eq_u32 s30, 1
    s_cselect_b32 s26, 1, 0
K1_COMMON:
    v_lshrrev_b32 v20, 3, v19
    v_lshrrev_b32 v21, 4, v19
    v_and_b32 v22, 7, v19
    s_lshl_b32 s30, s22, 8
    s_lshl_b32 s31, s20, 5
    s_add_u32 s30, s30, s31
    v_add_u32 v23, 0, v21
    v_and_b32 v23, 7, v23
    v_xor_b32 v23, v23, v22
    v_add_u32 v24, s30, v20
    v_add_u32 v24, 0, v24
    v_lshlrev_b32 v24, 10, v24
    v_lshl_add_u32 v4, v23, 4, v24
    v_add_u32 v23, 4, v21
    v_and_b32 v23, 7, v23
    v_xor_b32 v23, v23, v22
    v_add_u32 v24, s30, v20
    v_add_u32 v24, 8, v24
    v_lshlrev_b32 v24, 10, v24
    v_lshl_add_u32 v5, v23, 4, v24
    v_add_u32 v23, 8, v21
    v_and_b32 v23, 7, v23
    v_xor_b32 v23, v23, v22
    v_add_u32 v24, s30, v20
    v_add_u32 v24, 16, v24
    v_lshlrev_b32 v24, 10, v24
    v_lshl_add_u32 v6, v23, 4, v24
    v_add_u32 v23, 12, v21
    v_and_b32 v23, 7, v23
    v_xor_b32 v23, v23, v22
    v_add_u32 v24, s30, v20
    v_add_u32 v24, 24, v24
    v_lshlrev_b32 v24, 10, v24
    v_lshl_add_u32 v7, v23, 4, v24
    v_lshrrev_b32 v20, 5, v19
    v_bfe_u32 v21, v19, 2, 3
    v_and_b32 v22, 3, v19
    s_lshl_b32 s31, s20, 3
    v_add_u32 v23, 0, v20
    v_and_b32 v24, 3, v23
    v_xor_b32 v24, v24, v21
    v_add_u32 v23, s31, v23
    v_mul_lo_u32 v23, v23, s34
    s_cmp_eq_u32 s21, 1
    s_cbranch_scc1 K1_WCOLB0
    v_lshlrev_b32 v25, 6, v24
    s_branch K1_WCOLD0
K1_WCOLB0:
    v_lshrrev_b32 v26, 1, v24
    v_add_u32 v25, 1, v26
    v_cmp_gt_u32 vcc, 2, v26
    s_nop 1
    v_cndmask_b32 v25, 0, v25, vcc
    v_lshlrev_b32 v25, 10, v25
    v_and_b32 v26, 1, v24
    v_lshl_add_u32 v25, v26, 6, v25
K1_WCOLD0:
    v_lshl_add_u32 v25, v22, 4, v25
    v_add3_u32 v8, v23, v25, s35
    v_add_u32 v23, 2, v20
    v_and_b32 v24, 3, v23
    v_xor_b32 v24, v24, v21
    v_add_u32 v23, s31, v23
    v_mul_lo_u32 v23, v23, s34
    s_cmp_eq_u32 s21, 1
    s_cbranch_scc1 K1_WCOLB1
    v_lshlrev_b32 v25, 6, v24
    s_branch K1_WCOLD1
K1_WCOLB1:
    v_lshrrev_b32 v26, 1, v24
    v_add_u32 v25, 1, v26
    v_cmp_gt_u32 vcc, 2, v26
    s_nop 1
    v_cndmask_b32 v25, 0, v25, vcc
    v_lshlrev_b32 v25, 10, v25
    v_and_b32 v26, 1, v24
    v_lshl_add_u32 v25, v26, 6, v25
K1_WCOLD1:
    v_lshl_add_u32 v25, v22, 4, v25
    v_add3_u32 v9, v23, v25, s35
    v_add_u32 v23, 4, v20
    v_and_b32 v24, 3, v23
    v_xor_b32 v24, v24, v21
    v_add_u32 v23, s31, v23
    v_mul_lo_u32 v23, v23, s34
    s_cmp_eq_u32 s21, 1
    s_cbranch_scc1 K1_WCOLB2
    v_lshlrev_b32 v25, 6, v24
    s_branch K1_WCOLD2
K1_WCOLB2:
    v_lshrrev_b32 v26, 1, v24
    v_add_u32 v25, 1, v26
    v_cmp_gt_u32 vcc, 2, v26
    s_nop 1
    v_cndmask_b32 v25, 0, v25, vcc
    v_lshlrev_b32 v25, 10, v25
    v_and_b32 v26, 1, v24
    v_lshl_add_u32 v25, v26, 6, v25
K1_WCOLD2:
    v_lshl_add_u32 v25, v22, 4, v25
    v_add3_u32 v10, v23, v25, s35
    v_add_u32 v23, 6, v20
    v_and_b32 v24, 3, v23
    v_xor_b32 v24, v24, v21
    v_add_u32 v23, s31, v23
    v_mul_lo_u32 v23, v23, s34
    s_cmp_eq_u32 s21, 1
    s_cbranch_scc1 K1_WCOLB3
    v_lshlrev_b32 v25, 6, v24
    s_branch K1_WCOLD3
K1_WCOLB3:
    v_lshrrev_b32 v26, 1, v24
    v_add_u32 v25, 1, v26
    v_cmp_gt_u32 vcc, 2, v26
    s_nop 1
    v_cndmask_b32 v25, 0, v25, vcc
    v_lshlrev_b32 v25, 10, v25
    v_and_b32 v26, 1, v24
    v_lshl_add_u32 v25, v26, 6, v25
K1_WCOLD3:
    v_lshl_add_u32 v25, v22, 4, v25
    v_add3_u32 v11, v23, v25, s35
    s_lshl_b32 s27, s20, 12
    s_add_u32 s28, s27, 65536
    v_and_b32 v20, 31, v19
    v_lshrrev_b32 v21, 5, v19
    v_bfe_u32 v22, v19, 1, 3
    v_xor_b32 v21, v21, v22
    s_and_b32 s30, s20, 1
    s_lshl_b32 s30, s30, 14
    v_lshlrev_b32 v20, 7, v20
    v_add_u32 v20, s30, v20
    v_xor_b32 v23, 0, v21
    v_lshl_add_u32 v12, v23, 4, v20
    v_xor_b32 v23, 2, v21
    v_lshl_add_u32 v13, v23, 4, v20
    v_xor_b32 v23, 4, v21
    v_lshl_add_u32 v14, v23, 4, v20
    v_xor_b32 v23, 6, v21
    v_lshl_add_u32 v15, v23, 4, v20
    v_lshrrev_b32 v20, 5, v19
    v_bfe_u32 v21, v19, 2, 2
    v_lshl_add_u32 v20, v20, 3, v21
    v_lshlrev_b32 v20, 9, v20
    v_bfe_u32 v22, v19, 4, 1
    v_lshl_add_u32 v20, v22, 5, v20
    v_and_b32 v22, 3, v19
    v_lshl_add_u32 v20, v22, 3, v20
    v_add_u32 v20, 0x10000, v20
    s_lshr_b32 s30, s20, 1
    s_lshl_b32 s30, s30, 1
    s_add_u32 s31, s30, 0
    v_xor_b32 v23, s31, v21
    v_lshl_add_u32 v16, v23, 6, v20
    s_add_u32 s31, s30, 1
    v_xor_b32 v23, s31, v21
    v_lshl_add_u32 v17, v23, 6, v20
    s_cmp_eq_u32 s21, 0
    s_cbranch_scc1 K1_NOPHI
    v_lshrrev_b32 v20, 5, v19
    v_lshlrev_b32 v20, 7, v20
    v_and_b32 v21, 15, v19
    v_lshl_add_u32 v20, v21, 1, v20
    s_lshl_b32 s35, s23, 11
    buffer_load_ushort v28, v20, s[52:55], s35 offen offset:0
    buffer_load_ushort v29, v20, s[52:55], s35 offen offset:32
    buffer_load_ushort v30, v20, s[52:55], s35 offen offset:64
    buffer_load_ushort v31, v20, s[52:55], s35 offen offset:96
    buffer_load_ushort v32, v20, s[52:55], s35 offen offset:256
    buffer_load_ushort v33, v20, s[52:55], s35 offen offset:288
    buffer_load_ushort v34, v20, s[52:55], s35 offen offset:320
    buffer_load_ushort v35, v20, s[52:55], s35 offen offset:352
    buffer_load_ushort v36, v20, s[52:55], s35 offen offset:512
    buffer_load_ushort v37, v20, s[52:55], s35 offen offset:544
    buffer_load_ushort v38, v20, s[52:55], s35 offen offset:576
    buffer_load_ushort v39, v20, s[52:55], s35 offen offset:608
    buffer_load_ushort v40, v20, s[52:55], s35 offen offset:768
    buffer_load_ushort v41, v20, s[52:55], s35 offen offset:800
    buffer_load_ushort v42, v20, s[52:55], s35 offen offset:832
    buffer_load_ushort v43, v20, s[52:55], s35 offen offset:864
    buffer_load_ushort v44, v20, s[52:55], s35 offen offset:1024
    buffer_load_ushort v45, v20, s[52:55], s35 offen offset:1056
    buffer_load_ushort v46, v20, s[52:55], s35 offen offset:1088
    buffer_load_ushort v47, v20, s[52:55], s35 offen offset:1120
    buffer_load_ushort v48, v20, s[52:55], s35 offen offset:1280
    buffer_load_ushort v49, v20, s[52:55], s35 offen offset:1312
    buffer_load_ushort v50, v20, s[52:55], s35 offen offset:1344
    buffer_load_ushort v51, v20, s[52:55], s35 offen offset:1376
    buffer_load_ushort v52, v20, s[52:55], s35 offen offset:1536
    buffer_load_ushort v53, v20, s[52:55], s35 offen offset:1568
    buffer_load_ushort v54, v20, s[52:55], s35 offen offset:1600
    buffer_load_ushort v55, v20, s[52:55], s35 offen offset:1632
    buffer_load_ushort v56, v20, s[52:55], s35 offen offset:1792
    buffer_load_ushort v57, v20, s[52:55], s35 offen offset:1824
    buffer_load_ushort v58, v20, s[52:55], s35 offen offset:1856
    buffer_load_ushort v59, v20, s[52:55], s35 offen offset:1888
    s_branch K1_NOCT
K1_NOPHI:
    s_cmp_ge_u32 s2, 128
    s_cbranch_scc1 K1_NOCT
    s_mov_b32 s84, s38
    s_and_b32 s85, s39, 0xffff
    s_mov_b32 s86, 2097152
    s_mov_b32 s87, 0x00020000
    v_lshrrev_b32 v20, 4, v0
    v_and_b32 v21, 15, v0
    v_lshlrev_b32 v20, 10, v20
    v_lshl_add_u32 v20, v21, 6, v20
    s_sub_u32 s30, s2, 64
    s_lshl_b32 s30, s30, 15
    buffer_load_dword v26, v20, s[84:87], s30 offen
K1_NOCT:
    s_mov_b32 s56, 0
    s_mov_b32 s57, 1048576
    s_add_u32 s31, s29, 0
    s_and_b32 s31, s31, 7
    s_lshl_b32 s30, s31, 7
    s_mul_i32 s31, s25, s31
    s_add_u32 m0, s27, 0
    s_nop 0
    buffer_load_dwordx4 v4, s[8:11], s30 offen lds
    s_add_u32 m0, s27, 1024
    s_nop 0
    buffer_load_dwordx4 v5, s[8:11], s30 offen lds
    s_add_u32 m0, s27, 2048
    s_nop 0
    buffer_load_dwordx4 v6, s[8:11], s30 offen lds
    s_add_u32 m0, s27, 3072
    s_nop 0
    buffer_load_dwordx4 v7, s[8:11], s30 offen lds
    s_add_u32 m0, s28, 0
    s_nop 0
    buffer_load_dwordx4 v8, s[12:15], s31 offen lds
    s_add_u32 m0, s28, 1024
    s_nop 0
    buffer_load_dwordx4 v9, s[12:15], s31 offen lds
    s_add_u32 m0, s28, 2048
    s_nop 0
    buffer_load_dwordx4 v10, s[12:15], s31 offen lds
    s_add_u32 m0, s28, 3072
    s_nop 0
    buffer_load_dwordx4 v11, s[12:15], s31 offen lds
    s_add_u32 s30, s29, 1
    s_and_b32 s30, s30, 7
    s_lshl_b32 s30, s30, 7
    s_add_u32 s30, s30, s56
    s_add_u32 m0, s27, 32768
    s_nop 0
    buffer_load_dwordx4 v4, s[8:11], s30 offen lds
    s_add_u32 m0, s27, 33792
    s_nop 0
    buffer_load_dwordx4 v5, s[8:11], s30 offen lds
    s_add_u32 m0, s27, 34816
    s_nop 0
    buffer_load_dwordx4 v6, s[8:11], s30 offen lds
    s_add_u32 m0, s27, 35840
    s_nop 0
    buffer_load_dwordx4 v7, s[8:11], s30 offen lds
    s_cmp_eq_u32 s21, 0
    s_cselect_b64 vcc, -1, 0
    s_waitcnt vmcnt(4)
    s_barrier
    ds_read_b128 v[64:67], v12 offset:0
    ds_read_b128 v[68:71], v12 offset:4096
    ds_read_b128 v[72:75], v12 offset:8192
    ds_read_b128 v[76:79], v12 offset:12288
    ds_read_b64_tr_b16 v[80:81], v16 offset:0
    ds_read_b64_tr_b16 v[82:83], v16 offset:2048
    ds_read_b64_tr_b16 v[84:85], v17 offset:0
    ds_read_b64_tr_b16 v[86:87], v17 offset:2048
K1_AGAIN:
    s_cmp_eq_u32 s26, 1
    s_cbranch_scc1 K1_LOOPN
K1_LOOPT:
    ds_read_b128 v[88:91], v13 offset:0
    ds_read_b128 v[92:95], v13 offset:4096
    ds_read_b128 v[96:99], v13 offset:8192
    ds_read_b128 v[100:103], v13 offset:12288
    ds_read_b64_tr_b16 v[104:105], v16 offset:8192
    ds_read_b64_tr_b16 v[106:107], v16 offset:10240
    ds_read_b64_tr_b16 v[108:109], v17 offset:8192
    ds_read_b64_tr_b16 v[110:111], v17 offset:10240
    s_waitcnt lgkmcnt(8)
    s_add_u32 s31, s29, 1
    s_and_b32 s31, s31, 7
    s_mul_i32 s31, s25, s31
    v_mfma_f32_32x32x16_bf16 v[128:143], v[80:83], v[64:67], 0
    v_mfma_f32_32x32x16_bf16 v[144:159], v[84:87], v[64:67], 0
    s_add_u32 m0, s28, 32768
    s_nop 0
    buffer_load_dwordx4 v8, s[12:15], s31 offen lds
    v_mfma_f32_32x32x16_bf16 v[160:175], v[80:83], v[68:71], 0
    v_mfma_f32_32x32x16_bf16 v[176:191], v[84:87], v[68:71], 0
    s_add_u32 m0, s28, 33792
    s_nop 0
    buffer_load_dwordx4 v9, s[12:15], s31 offen lds
    v_mfma_f32_32x32x16_bf16 v[192:207], v[80:83], v[72:75], 0
    v_mfma_f32_32x32x16_bf16 v[208:223], v[84:87], v[72:75], 0
    s_add_u32 m0, s28, 34816
    s_nop 0
    buffer_load_dwordx4 v10, s[12:15], s31 offen lds
    v_mfma_f32_32x32x16_bf16 v[224:239], v[80:83], v[76:79], 0
    v_mfma_f32_32x32x16_bf16 v[240:255], v[84:87], v[76:79], 0
    s_add_u32 m0, s28, 35840
    s_nop 0
    buffer_load_dwordx4 v11, s[12:15], s31 offen lds
    ds_read_b128 v[64:67], v14 offset:0
    ds_read_b128 v[68:71], v14 offset:4096
    ds_read_b128 v[72:75], v14 offset:8192
    ds_read_b128 v[76:79], v14 offset:12288
    ds_read_b64_tr_b16 v[80:81], v16 offset:16384
    ds_read_b64_tr_b16 v[82:83], v16 offset:18432
    ds_read_b64_tr_b16 v[84:85], v17 offset:16384
    ds_read_b64_tr_b16 v[86:87], v17 offset:18432
    s_waitcnt lgkmcnt(8)
    v_mfma_f32_32x32x16_bf16 v[128:143], v[104:107], v[88:91], v[128:143]
    v_mfma_f32_32x32x16_bf16 v[144:159], v[108:111], v[88:91], v[144:159]
    v_mfma_f32_32x32x16_bf16 v[160:175], v[104:107], v[92:95], v[160:175]
    v_mfma_f32_32x32x16_bf16 v[176:191], v[108:111], v[92:95], v[176:191]
    v_mfma_f32_32x32x16_bf16 v[192:207], v[104:107], v[96:99], v[192:207]
    v_mfma_f32_32x32x16_bf16 v[208:223], v[108:111], v[96:99], v[208:223]
    v_mfma_f32_32x32x16_bf16 v[224:239], v[104:107], v[100:103], v[224:239]
    v_mfma_f32_32x32x16_bf16 v[240:255], v[108:111], v[100:103], v[240:255]
    ds_read_b128 v[88:91], v15 offset:0
    ds_read_b128 v[92:95], v15 offset:4096
    ds_read_b128 v[96:99], v15 offset:8192
    ds_read_b128 v[100:103], v15 offset:12288
    ds_read_b64_tr_b16 v[104:105], v16 offset:24576
    ds_read_b64_tr_b16 v[106:107], v16 offset:26624
    ds_read_b64_tr_b16 v[108:109], v17 offset:24576
    ds_read_b64_tr_b16 v[110:111], v17 offset:26624
    s_waitcnt lgkmcnt(8)
    v_mfma_f32_32x32x16_bf16 v[128:143], v[80:83], v[64:67], v[128:143]
    v_mfma_f32_32x32x16_bf16 v[144:159], v[84:87], v[64:67], v[144:159]
    v_mfma_f32_32x32x16_bf16 v[160:175], v[80:83], v[68:71], v[160:175]
    v_mfma_f32_32x32x16_bf16 v[176:191], v[84:87], v[68:71], v[176:191]
    v_mfma_f32_32x32x16_bf16 v[192:207], v[80:83], v[72:75], v[192:207]
    v_mfma_f32_32x32x16_bf16 v[208:223], v[84:87], v[72:75], v[208:223]
    v_mfma_f32_32x32x16_bf16 v[224:239], v[80:83], v[76:79], v[224:239]
    v_mfma_f32_32x32x16_bf16 v[240:255], v[84:87], v[76:79], v[240:255]
    s_waitcnt vmcnt(0) lgkmcnt(0)
    s_barrier
    ds_read_b128 v[64:67], v12 offset:32768
    ds_read_b128 v[68:71], v12 offset:36864
    ds_read_b128 v[72:75], v12 offset:40960
    ds_read_b128 v[76:79], v12 offset:45056
    ds_read_b64_tr_b16 v[80:81], v16 offset:32768
    ds_read_b64_tr_b16 v[82:83], v16 offset:34816
    ds_read_b64_tr_b16 v[84:85], v17 offset:32768
    ds_read_b64_tr_b16 v[86:87], v17 offset:34816
    s_add_u32 s30, s29, 2
    s_and_b32 s30, s30, 7
    s_lshl_b32 s30, s30, 7
    s_add_u32 s30, s30, s56
    v_mfma_f32_32x32x16_bf16 v[128:143], v[104:107], v[88:91], v[128:143]
    v_mfma_f32_32x32x16_bf16 v[144:159], v[108:111], v[88:91], v[144:159]
    s_add_u32 m0, s27, 0
    s_nop 0
    buffer_load_dwordx4 v4, s[8:11], s30 offen lds
    v_mfma_f32_32x32x16_bf16 v[160:175], v[104:107], v[92:95], v[160:175]
    v_mfma_f32_32x32x16_bf16 v[176:191], v[108:111], v[92:95], v[176:191]
    s_add_u32 m0, s27, 1024
    s_nop 0
    buffer_load_dwordx4 v5, s[8:11], s30 offen lds
    v_mfma_f32_32x32x16_bf16 v[192:207], v[104:107], v[96:99], v[192:207]
    v_mfma_f32_32x32x16_bf16 v[208:223], v[108:111], v[96:99], v[208:223]
    s_add_u32 m0, s27, 2048
    s_nop 0
    buffer_load_dwordx4 v6, s[8:11], s30 offen lds
    v_mfma_f32_32x32x16_bf16 v[224:239], v[104:107], v[100:103], v[224:239]
    v_mfma_f32_32x32x16_bf16 v[240:255], v[108:111], v[100:103], v[240:255]
    s_add_u32 m0, s27, 3072
    s_nop 0
    buffer_load_dwordx4 v7, s[8:11], s30 offen lds
    ds_read_b128 v[88:91], v13 offset:32768
    ds_read_b128 v[92:95], v13 offset:36864
    ds_read_b128 v[96:99], v13 offset:40960
    ds_read_b128 v[100:103], v13 offset:45056
    ds_read_b64_tr_b16 v[104:105], v16 offset:40960
    ds_read_b64_tr_b16 v[106:107], v16 offset:43008
    ds_read_b64_tr_b16 v[108:109], v17 offset:40960
    ds_read_b64_tr_b16 v[110:111], v17 offset:43008
    s_waitcnt lgkmcnt(8)
    s_add_u32 s31, s29, 2
    s_and_b32 s31, s31, 7
    s_mul_i32 s31, s25, s31
    v_mfma_f32_32x32x16_bf16 v[128:143], v[80:83], v[64:67], v[128:143]
    v_mfma_f32_32x32x16_bf16 v[144:159], v[84:87], v[64:67], v[144:159]
    s_add_u32 m0, s28, 0
    s_nop 0
    buffer_load_dwordx4 v8, s[12:15], s31 offen lds
    v_mfma_f32_32x32x16_bf16 v[160:175], v[80:83], v[68:71], v[160:175]
    v_mfma_f32_32x32x16_bf16 v[176:191], v[84:87], v[68:71], v[176:191]
    s_add_u32 m0, s28, 1024
    s_nop 0
    buffer_load_dwordx4 v9, s[12:15], s31 offen lds
    v_mfma_f32_32x32x16_bf16 v[192:207], v[80:83], v[72:75], v[192:207]
    v_mfma_f32_32x32x16_bf16 v[208:223], v[84:87], v[72:75], v[208:223]
    s_add_u32 m0, s28, 2048
    s_nop 0
    buffer_load_dwordx4 v10, s[12:15], s31 offen lds
    v_mfma_f32_32x32x16_bf16 v[224:239], v[80:83], v[76:79], v[224:239]
    v_mfma_f32_32x32x16_bf16 v[240:255], v[84:87], v[76:79], v[240:255]
    s_add_u32 m0, s28, 3072
    s_nop 0
    buffer_load_dwordx4 v11, s[12:15], s31 offen lds
    ds_read_b128 v[64:67], v14 offset:32768
    ds_read_b128 v[68:71], v14 offset:36864
    ds_read_b128 v[72:75], v14 offset:40960
    ds_read_b128 v[76:79], v14 offset:45056
    ds_read_b64_tr_b16 v[80:81], v16 offset:49152
    ds_read_b64_tr_b16 v[82:83], v16 offset:51200
    ds_read_b64_tr_b16 v[84:85], v17 offset:49152
    ds_read_b64_tr_b16 v[86:87], v17 offset:51200
    s_waitcnt lgkmcnt(8)
    v_mfma_f32_32x32x16_bf16 v[128:143], v[104:107], v[88:91], v[128:143]
    v_mfma_f32_32x32x16_bf16 v[144:159], v[108:111], v[88:91], v[144:159]
    v_mfma_f32_32x32x16_bf16 v[160:175], v[104:107], v[92:95], v[160:175]
    v_mfma_f32_32x32x16_bf16 v[176:191], v[108:111], v[92:95], v[176:191]
    v_mfma_f32_32x32x16_bf16 v[192:207], v[104:107], v[96:99], v[192:207]
    v_mfma_f32_32x32x16_bf16 v[208:223], v[108:111], v[96:99], v[208:223]
    v_mfma_f32_32x32x16_bf16 v[224:239], v[104:107], v[100:103], v[224:239]
    v_mfma_f32_32x32x16_bf16 v[240:255], v[108:111], v[100:103], v[240:255]
    ds_read_b128 v[88:91], v15 offset:32768
    ds_read_b128 v[92:95], v15 offset:36864
    ds_read_b128 v[96:99], v15 offset:40960
    ds_read_b128 v[100:103], v15 offset:45056
    ds_read_b64_tr_b16 v[104:105], v16 offset:57344
    ds_read_b64_tr_b16 v[106:107], v16 offset:59392
    ds_read_b64_tr_b16 v[108:109], v17 offset:57344
    ds_read_b64_tr_b16 v[110:111], v17 offset:59392
    s_waitcnt lgkmcnt(8)
    v_mfma_f32_32x32x16_bf16 v[128:143], v[80:83], v[64:67], v[128:143]
    v_mfma_f32_32x32x16_bf16 v[144:159], v[84:87], v[64:67], v[144:159]
    v_mfma_f32_32x32x16_bf16 v[160:175], v[80:83], v[68:71], v[160:175]
    v_mfma_f32_32x32x16_bf16 v[176:191], v[84:87], v[68:71], v[176:191]
    v_mfma_f32_32x32x16_bf16 v[192:207], v[80:83], v[72:75], v[192:207]
    v_mfma_f32_32x32x16_bf16 v[208:223], v[84:87], v[72:75], v[208:223]
    v_mfma_f32_32x32x16_bf16 v[224:239], v[80:83], v[76:79], v[224:239]
    v_mfma_f32_32x32x16_bf16 v[240:255], v[84:87], v[76:79], v[240:255]
    s_waitcnt vmcnt(0) lgkmcnt(0)
    s_barrier
    ds_read_b128 v[64:67], v12 offset:0
    ds_read_b128 v[68:71], v12 offset:4096
    ds_read_b128 v[72:75], v12 offset:8192
    ds_read_b128 v[76:79], v12 offset:12288
    ds_read_b64_tr_b16 v[80:81], v16 offset:0
    ds_read_b64_tr_b16 v[82:83], v16 offset:2048
    ds_read_b64_tr_b16 v[84:85], v17 offset:0
    ds_read_b64_tr_b16 v[86:87], v17 offset:2048
    s_add_u32 s30, s29, 3
    s_and_b32 s30, s30, 7
    s_lshl_b32 s30, s30, 7
    s_add_u32 s30, s30, s56
    v_mfma_f32_32x32x16_bf16 v[128:143], v[104:107], v[88:91], v[128:143]
    v_mfma_f32_32x32x16_bf16 v[144:159], v[108:111], v[88:91], v[144:159]
    s_add_u32 m0, s27, 32768
    s_nop 0
    buffer_load_dwordx4 v4, s[8:11], s30 offen lds
    v_mfma_f32_32x32x16_bf16 v[160:175], v[104:107], v[92:95], v[160:175]
    v_mfma_f32_32x32x16_bf16 v[176:191], v[108:111], v[92:95], v[176:191]
    s_add_u32 m0, s27, 33792
    s_nop 0
    buffer_load_dwordx4 v5, s[8:11], s30 offen lds
    v_mfma_f32_32x32x16_bf16 v[192:207], v[104:107], v[96:99], v[192:207]
    v_mfma_f32_32x32x16_bf16 v[208:223], v[108:111], v[96:99], v[208:223]
    s_add_u32 m0, s27, 34816
    s_nop 0
    buffer_load_dwordx4 v6, s[8:11], s30 offen lds
    v_mfma_f32_32x32x16_bf16 v[224:239], v[104:107], v[100:103], v[224:239]
    v_mfma_f32_32x32x16_bf16 v[240:255], v[108:111], v[100:103], v[240:255]
    s_add_u32 m0, s27, 35840
    s_nop 0
    buffer_load_dwordx4 v7, s[8:11], s30 offen lds
    ds_read_b128 v[88:91], v13 offset:0
    ds_read_b128 v[92:95], v13 offset:4096
    ds_read_b128 v[96:99], v13 offset:8192
    ds_read_b128 v[100:103], v13 offset:12288
    ds_read_b64_tr_b16 v[104:105], v16 offset:8192
    ds_read_b64_tr_b16 v[106:107], v16 offset:10240
    ds_read_b64_tr_b16 v[108:109], v17 offset:8192
    ds_read_b64_tr_b16 v[110:111], v17 offset:10240
    s_waitcnt lgkmcnt(8)
    s_add_u32 s31, s29, 3
    s_and_b32 s31, s31, 7
    s_mul_i32 s31, s25, s31
    v_mfma_f32_32x32x16_bf16 v[128:143], v[80:83], v[64:67], v[128:143]
    v_mfma_f32_32x32x16_bf16 v[144:159], v[84:87], v[64:67], v[144:159]
    s_add_u32 m0, s28, 32768
    s_nop 0
    buffer_load_dwordx4 v8, s[12:15], s31 offen lds
    v_mfma_f32_32x32x16_bf16 v[160:175], v[80:83], v[68:71], v[160:175]
    v_mfma_f32_32x32x16_bf16 v[176:191], v[84:87], v[68:71], v[176:191]
    s_add_u32 m0, s28, 33792
    s_nop 0
    buffer_load_dwordx4 v9, s[12:15], s31 offen lds
    v_mfma_f32_32x32x16_bf16 v[192:207], v[80:83], v[72:75], v[192:207]
    v_mfma_f32_32x32x16_bf16 v[208:223], v[84:87], v[72:75], v[208:223]
    s_add_u32 m0, s28, 34816
    s_nop 0
    buffer_load_dwordx4 v10, s[12:15], s31 offen lds
    v_mfma_f32_32x32x16_bf16 v[224:239], v[80:83], v[76:79], v[224:239]
    v_mfma_f32_32x32x16_bf16 v[240:255], v[84:87], v[76:79], v[240:255]
    s_add_u32 m0, s28, 35840
    s_nop 0
    buffer_load_dwordx4 v11, s[12:15], s31 offen lds
    ds_read_b128 v[64:67], v14 offset:0
    ds_read_b128 v[68:71], v14 offset:4096
    ds_read_b128 v[72:75], v14 offset:8192
    ds_read_b128 v[76:79], v14 offset:12288
    ds_read_b64_tr_b16 v[80:81], v16 offset:16384
    ds_read_b64_tr_b16 v[82:83], v16 offset:18432
    ds_read_b64_tr_b16 v[84:85], v17 offset:16384
    ds_read_b64_tr_b16 v[86:87], v17 offset:18432
    s_waitcnt lgkmcnt(8)
    v_mfma_f32_32x32x16_bf16 v[128:143], v[104:107], v[88:91], v[128:143]
    v_mfma_f32_32x32x16_bf16 v[144:159], v[108:111], v[88:91], v[144:159]
    v_mfma_f32_32x32x16_bf16 v[160:175], v[104:107], v[92:95], v[160:175]
    v_mfma_f32_32x32x16_bf16 v[176:191], v[108:111], v[92:95], v[176:191]
    v_mfma_f32_32x32x16_bf16 v[192:207], v[104:107], v[96:99], v[192:207]
    v_mfma_f32_32x32x16_bf16 v[208:223], v[108:111], v[96:99], v[208:223]
    v_mfma_f32_32x32x16_bf16 v[224:239], v[104:107], v[100:103], v[224:239]
    v_mfma_f32_32x32x16_bf16 v[240:255], v[108:111], v[100:103], v[240:255]
    ds_read_b128 v[88:91], v15 offset:0
    ds_read_b128 v[92:95], v15 offset:4096
    ds_read_b128 v[96:99], v15 offset:8192
    ds_read_b128 v[100:103], v15 offset:12288
    ds_read_b64_tr_b16 v[104:105], v16 offset:24576
    ds_read_b64_tr_b16 v[106:107], v16 offset:26624
    ds_read_b64_tr_b16 v[108:109], v17 offset:24576
    ds_read_b64_tr_b16 v[110:111], v17 offset:26624
    s_waitcnt lgkmcnt(8)
    v_mfma_f32_32x32x16_bf16 v[128:143], v[80:83], v[64:67], v[128:143]
    v_mfma_f32_32x32x16_bf16 v[144:159], v[84:87], v[64:67], v[144:159]
    v_mfma_f32_32x32x16_bf16 v[160:175], v[80:83], v[68:71], v[160:175]
    v_mfma_f32_32x32x16_bf16 v[176:191], v[84:87], v[68:71], v[176:191]
    v_mfma_f32_32x32x16_bf16 v[192:207], v[80:83], v[72:75], v[192:207]
    v_mfma_f32_32x32x16_bf16 v[208:223], v[84:87], v[72:75], v[208:223]
    v_mfma_f32_32x32x16_bf16 v[224:239], v[80:83], v[76:79], v[224:239]
    v_mfma_f32_32x32x16_bf16 v[240:255], v[84:87], v[76:79], v[240:255]
    s_waitcnt vmcnt(0) lgkmcnt(0)
    s_barrier
    ds_read_b128 v[64:67], v12 offset:32768
    ds_read_b128 v[68:71], v12 offset:36864
    ds_read_b128 v[72:75], v12 offset:40960
    ds_read_b128 v[76:79], v12 offset:45056
    ds_read_b64_tr_b16 v[80:81], v16 offset:32768
    ds_read_b64_tr_b16 v[82:83], v16 offset:34816
    ds_read_b64_tr_b16 v[84:85], v17 offset:32768
    ds_read_b64_tr_b16 v[86:87], v17 offset:34816
    s_add_u32 s30, s29, 4
    s_and_b32 s30, s30, 7
    s_lshl_b32 s30, s30, 7
    s_add_u32 s30, s30, s56
    v_mfma_f32_32x32x16_bf16 v[128:143], v[104:107], v[88:91], v[128:143]
    v_mfma_f32_32x32x16_bf16 v[144:159], v[108:111], v[88:91], v[144:159]
    s_add_u32 m0, s27, 0
    s_nop 0
    buffer_load_dwordx4 v4, s[8:11], s30 offen lds
    v_mfma_f32_32x32x16_bf16 v[160:175], v[104:107], v[92:95], v[160:175]
    v_mfma_f32_32x32x16_bf16 v[176:191], v[108:111], v[92:95], v[176:191]
    s_add_u32 m0, s27, 1024
    s_nop 0
    buffer_load_dwordx4 v5, s[8:11], s30 offen lds
    v_mfma_f32_32x32x16_bf16 v[192:207], v[104:107], v[96:99], v[192:207]
    v_mfma_f32_32x32x16_bf16 v[208:223], v[108:111], v[96:99], v[208:223]
    s_add_u32 m0, s27, 2048
    s_nop 0
    buffer_load_dwordx4 v6, s[8:11], s30 offen lds
    v_mfma_f32_32x32x16_bf16 v[224:239], v[104:107], v[100:103], v[224:239]
    v_mfma_f32_32x32x16_bf16 v[240:255], v[108:111], v[100:103], v[240:255]
    s_add_u32 m0, s27, 3072
    s_nop 0
    buffer_load_dwordx4 v7, s[8:11], s30 offen lds
    ds_read_b128 v[88:91], v13 offset:32768
    ds_read_b128 v[92:95], v13 offset:36864
    ds_read_b128 v[96:99], v13 offset:40960
    ds_read_b128 v[100:103], v13 offset:45056
    ds_read_b64_tr_b16 v[104:105], v16 offset:40960
    ds_read_b64_tr_b16 v[106:107], v16 offset:43008
    ds_read_b64_tr_b16 v[108:109], v17 offset:40960
    ds_read_b64_tr_b16 v[110:111], v17 offset:43008
    s_waitcnt lgkmcnt(8)
    s_add_u32 s31, s29, 4
    s_and_b32 s31, s31, 7
    s_mul_i32 s31, s25, s31
    v_mfma_f32_32x32x16_bf16 v[128:143], v[80:83], v[64:67], v[128:143]
    v_mfma_f32_32x32x16_bf16 v[144:159], v[84:87], v[64:67], v[144:159]
    s_add_u32 m0, s28, 0
    s_nop 0
    buffer_load_dwordx4 v8, s[12:15], s31 offen lds
    v_mfma_f32_32x32x16_bf16 v[160:175], v[80:83], v[68:71], v[160:175]
    v_mfma_f32_32x32x16_bf16 v[176:191], v[84:87], v[68:71], v[176:191]
    s_add_u32 m0, s28, 1024
    s_nop 0
    buffer_load_dwordx4 v9, s[12:15], s31 offen lds
    v_mfma_f32_32x32x16_bf16 v[192:207], v[80:83], v[72:75], v[192:207]
    v_mfma_f32_32x32x16_bf16 v[208:223], v[84:87], v[72:75], v[208:223]
    s_add_u32 m0, s28, 2048
    s_nop 0
    buffer_load_dwordx4 v10, s[12:15], s31 offen lds
    v_mfma_f32_32x32x16_bf16 v[224:239], v[80:83], v[76:79], v[224:239]
    v_mfma_f32_32x32x16_bf16 v[240:255], v[84:87], v[76:79], v[240:255]
    s_add_u32 m0, s28, 3072
    s_nop 0
    buffer_load_dwordx4 v11, s[12:15], s31 offen lds
    ds_read_b128 v[64:67], v14 offset:32768
    ds_read_b128 v[68:71], v14 offset:36864
    ds_read_b128 v[72:75], v14 offset:40960
    ds_read_b128 v[76:79], v14 offset:45056
    ds_read_b64_tr_b16 v[80:81], v16 offset:49152
    ds_read_b64_tr_b16 v[82:83], v16 offset:51200
    ds_read_b64_tr_b16 v[84:85], v17 offset:49152
    ds_read_b64_tr_b16 v[86:87], v17 offset:51200
    s_waitcnt lgkmcnt(8)
    v_mfma_f32_32x32x16_bf16 v[128:143], v[104:107], v[88:91], v[128:143]
    v_mfma_f32_32x32x16_bf16 v[144:159], v[108:111], v[88:91], v[144:159]
    v_mfma_f32_32x32x16_bf16 v[160:175], v[104:107], v[92:95], v[160:175]
    v_mfma_f32_32x32x16_bf16 v[176:191], v[108:111], v[92:95], v[176:191]
    v_mfma_f32_32x32x16_bf16 v[192:207], v[104:107], v[96:99], v[192:207]
    v_mfma_f32_32x32x16_bf16 v[208:223], v[108:111], v[96:99], v[208:223]
    v_mfma_f32_32x32x16_bf16 v[224:239], v[104:107], v[100:103], v[224:239]
    v_mfma_f32_32x32x16_bf16 v[240:255], v[108:111], v[100:103], v[240:255]
    ds_read_b128 v[88:91], v15 offset:32768
    ds_read_b128 v[92:95], v15 offset:36864
    ds_read_b128 v[96:99], v15 offset:40960
    ds_read_b128 v[100:103], v15 offset:45056
    ds_read_b64_tr_b16 v[104:105], v16 offset:57344
    ds_read_b64_tr_b16 v[106:107], v16 offset:59392
    ds_read_b64_tr_b16 v[108:109], v17 offset:57344
    ds_read_b64_tr_b16 v[110:111], v17 offset:59392
    s_waitcnt lgkmcnt(8)
    v_mfma_f32_32x32x16_bf16 v[128:143], v[80:83], v[64:67], v[128:143]
    v_mfma_f32_32x32x16_bf16 v[144:159], v[84:87], v[64:67], v[144:159]
    v_mfma_f32_32x32x16_bf16 v[160:175], v[80:83], v[68:71], v[160:175]
    v_mfma_f32_32x32x16_bf16 v[176:191], v[84:87], v[68:71], v[176:191]
    v_mfma_f32_32x32x16_bf16 v[192:207], v[80:83], v[72:75], v[192:207]
    v_mfma_f32_32x32x16_bf16 v[208:223], v[84:87], v[72:75], v[208:223]
    v_mfma_f32_32x32x16_bf16 v[224:239], v[80:83], v[76:79], v[224:239]
    v_mfma_f32_32x32x16_bf16 v[240:255], v[84:87], v[76:79], v[240:255]
    s_waitcnt vmcnt(0) lgkmcnt(0)
    s_barrier
    ds_read_b128 v[64:67], v12 offset:0
    ds_read_b128 v[68:71], v12 offset:4096
    ds_read_b128 v[72:75], v12 offset:8192
    ds_read_b128 v[76:79], v12 offset:12288
    ds_read_b64_tr_b16 v[80:81], v16 offset:0
    ds_read_b64_tr_b16 v[82:83], v16 offset:2048
    ds_read_b64_tr_b16 v[84:85], v17 offset:0
    ds_read_b64_tr_b16 v[86:87], v17 offset:2048
    s_add_u32 s30, s29, 5
    s_and_b32 s30, s30, 7
    s_lshl_b32 s30, s30, 7
    s_add_u32 s30, s30, s56
    v_mfma_f32_32x32x16_bf16 v[128:143], v[104:107], v[88:91], v[128:143]
    v_mfma_f32_32x32x16_bf16 v[144:159], v[108:111], v[88:91], v[144:159]
    s_add_u32 m0, s27, 32768
    s_nop 0
    buffer_load_dwordx4 v4, s[8:11], s30 offen lds
    v_mfma_f32_32x32x16_bf16 v[160:175], v[104:107], v[92:95], v[160:175]
    v_mfma_f32_32x32x16_bf16 v[176:191], v[108:111], v[92:95], v[176:191]
    s_add_u32 m0, s27, 33792
    s_nop 0
    buffer_load_dwordx4 v5, s[8:11], s30 offen lds
    v_mfma_f32_32x32x16_bf16 v[192:207], v[104:107], v[96:99], v[192:207]
    v_mfma_f32_32x32x16_bf16 v[208:223], v[108:111], v[96:99], v[208:223]
    s_add_u32 m0, s27, 34816
    s_nop 0
    buffer_load_dwordx4 v6, s[8:11], s30 offen lds
    v_mfma_f32_32x32x16_bf16 v[224:239], v[104:107], v[100:103], v[224:239]
    v_mfma_f32_32x32x16_bf16 v[240:255], v[108:111], v[100:103], v[240:255]
    s_add_u32 m0, s27, 35840
    s_nop 0
    buffer_load_dwordx4 v7, s[8:11], s30 offen lds
    ds_read_b128 v[88:91], v13 offset:0
    ds_read_b128 v[92:95], v13 offset:4096
    ds_read_b128 v[96:99], v13 offset:8192
    ds_read_b128 v[100:103], v13 offset:12288
    ds_read_b64_tr_b16 v[104:105], v16 offset:8192
    ds_read_b64_tr_b16 v[106:107], v16 offset:10240
    ds_read_b64_tr_b16 v[108:109], v17 offset:8192
    ds_read_b64_tr_b16 v[110:111], v17 offset:10240
    s_waitcnt lgkmcnt(8)
    s_add_u32 s31, s29, 5
    s_and_b32 s31, s31, 7
    s_mul_i32 s31, s25, s31
    v_mfma_f32_32x32x16_bf16 v[128:143], v[80:83], v[64:67], v[128:143]
    v_mfma_f32_32x32x16_bf16 v[144:159], v[84:87], v[64:67], v[144:159]
    s_add_u32 m0, s28, 32768
    s_nop 0
    buffer_load_dwordx4 v8, s[12:15], s31 offen lds
    v_mfma_f32_32x32x16_bf16 v[160:175], v[80:83], v[68:71], v[160:175]
    v_mfma_f32_32x32x16_bf16 v[176:191], v[84:87], v[68:71], v[176:191]
    s_add_u32 m0, s28, 33792
    s_nop 0
    buffer_load_dwordx4 v9, s[12:15], s31 offen lds
    v_mfma_f32_32x32x16_bf16 v[192:207], v[80:83], v[72:75], v[192:207]
    v_mfma_f32_32x32x16_bf16 v[208:223], v[84:87], v[72:75], v[208:223]
    s_add_u32 m0, s28, 34816
    s_nop 0
    buffer_load_dwordx4 v10, s[12:15], s31 offen lds
    v_mfma_f32_32x32x16_bf16 v[224:239], v[80:83], v[76:79], v[224:239]
    v_mfma_f32_32x32x16_bf16 v[240:255], v[84:87], v[76:79], v[240:255]
    s_add_u32 m0, s28, 35840
    s_nop 0
    buffer_load_dwordx4 v11, s[12:15], s31 offen lds
    ds_read_b128 v[64:67], v14 offset:0
    ds_read_b128 v[68:71], v14 offset:4096
    ds_read_b128 v[72:75], v14 offset:8192
    ds_read_b128 v[76:79], v14 offset:12288
    ds_read_b64_tr_b16 v[80:81], v16 offset:16384
    ds_read_b64_tr_b16 v[82:83], v16 offset:18432
    ds_read_b64_tr_b16 v[84:85], v17 offset:16384
    ds_read_b64_tr_b16 v[86:87], v17 offset:18432
    s_waitcnt lgkmcnt(8)
    v_mfma_f32_32x32x16_bf16 v[128:143], v[104:107], v[88:91], v[128:143]
    v_mfma_f32_32x32x16_bf16 v[144:159], v[108:111], v[88:91], v[144:159]
    v_mfma_f32_32x32x16_bf16 v[160:175], v[104:107], v[92:95], v[160:175]
    v_mfma_f32_32x32x16_bf16 v[176:191], v[108:111], v[92:95], v[176:191]
    v_mfma_f32_32x32x16_bf16 v[192:207], v[104:107], v[96:99], v[192:207]
    v_mfma_f32_32x32x16_bf16 v[208:223], v[108:111], v[96:99], v[208:223]
    v_mfma_f32_32x32x16_bf16 v[224:239], v[104:107], v[100:103], v[224:239]
    v_mfma_f32_32x32x16_bf16 v[240:255], v[108:111], v[100:103], v[240:255]
    ds_read_b128 v[88:91], v15 offset:0
    ds_read_b128 v[92:95], v15 offset:4096
    ds_read_b128 v[96:99], v15 offset:8192
    ds_read_b128 v[100:103], v15 offset:12288
    ds_read_b64_tr_b16 v[104:105], v16 offset:24576
    ds_read_b64_tr_b16 v[106:107], v16 offset:26624
    ds_read_b64_tr_b16 v[108:109], v17 offset:24576
    ds_read_b64_tr_b16 v[110:111], v17 offset:26624
    s_waitcnt lgkmcnt(8)
    v_mfma_f32_32x32x16_bf16 v[128:143], v[80:83], v[64:67], v[128:143]
    v_mfma_f32_32x32x16_bf16 v[144:159], v[84:87], v[64:67], v[144:159]
    v_mfma_f32_32x32x16_bf16 v[160:175], v[80:83], v[68:71], v[160:175]
    v_mfma_f32_32x32x16_bf16 v[176:191], v[84:87], v[68:71], v[176:191]
    v_mfma_f32_32x32x16_bf16 v[192:207], v[80:83], v[72:75], v[192:207]
    v_mfma_f32_32x32x16_bf16 v[208:223], v[84:87], v[72:75], v[208:223]
    v_mfma_f32_32x32x16_bf16 v[224:239], v[80:83], v[76:79], v[224:239]
    v_mfma_f32_32x32x16_bf16 v[240:255], v[84:87], v[76:79], v[240:255]
    s_waitcnt vmcnt(0) lgkmcnt(0)
    s_barrier
    ds_read_b128 v[64:67], v12 offset:32768
    ds_read_b128 v[68:71], v12 offset:36864
    ds_read_b128 v[72:75], v12 offset:40960
    ds_read_b128 v[76:79], v12 offset:45056
    ds_read_b64_tr_b16 v[80:81], v16 offset:32768
    ds_read_b64_tr_b16 v[82:83], v16 offset:34816
    ds_read_b64_tr_b16 v[84:85], v17 offset:32768
    ds_read_b64_tr_b16 v[86:87], v17 offset:34816
    s_add_u32 s30, s29, 6
    s_and_b32 s30, s30, 7
    s_lshl_b32 s30, s30, 7
    s_add_u32 s30, s30, s56
    v_mfma_f32_32x32x16_bf16 v[128:143], v[104:107], v[88:91], v[128:143]
    v_mfma_f32_32x32x16_bf16 v[144:159], v[108:111], v[88:91], v[144:159]
    s_add_u32 m0, s27, 0
    s_nop 0
    buffer_load_dwordx4 v4, s[8:11], s30 offen lds
    v_mfma_f32_32x32x16_bf16 v[160:175], v[104:107], v[92:95], v[160:175]
    v_mfma_f32_32x32x16_bf16 v[176:191], v[108:111], v[92:95], v[176:191]
    s_add_u32 m0, s27, 1024
    s_nop 0
    buffer_load_dwordx4 v5, s[8:11], s30 offen lds
    v_mfma_f32_32x32x16_bf16 v[192:207], v[104:107], v[96:99], v[192:207]
    v_mfma_f32_32x32x16_bf16 v[208:223], v[108:111], v[96:99], v[208:223]
    s_add_u32 m0, s27, 2048
    s_nop 0
    buffer_load_dwordx4 v6, s[8:11], s30 offen lds
    v_mfma_f32_32x32x16_bf16 v[224:239], v[104:107], v[100:103], v[224:239]
    v_mfma_f32_32x32x16_bf16 v[240:255], v[108:111], v[100:103], v[240:255]
    s_add_u32 m0, s27, 3072
    s_nop 0
    buffer_load_dwordx4 v7, s[8:11], s30 offen lds
    ds_read_b128 v[88:91], v13 offset:32768
    ds_read_b128 v[92:95], v13 offset:36864
    ds_read_b128 v[96:99], v13 offset:40960
    ds_read_b128 v[100:103], v13 offset:45056
    ds_read_b64_tr_b16 v[104:105], v16 offset:40960
    ds_read_b64_tr_b16 v[106:107], v16 offset:43008
    ds_read_b64_tr_b16 v[108:109], v17 offset:40960
    ds_read_b64_tr_b16 v[110:111], v17 offset:43008
    s_waitcnt lgkmcnt(8)
    s_add_u32 s31, s29, 6
    s_and_b32 s31, s31, 7
    s_mul_i32 s31, s25, s31
    v_mfma_f32_32x32x16_bf16 v[128:143], v[80:83], v[64:67], v[128:143]
    v_mfma_f32_32x32x16_bf16 v[144:159], v[84:87], v[64:67], v[144:159]
    s_add_u32 m0, s28, 0
    s_nop 0
    buffer_load_dwordx4 v8, s[12:15], s31 offen lds
    v_mfma_f32_32x32x16_bf16 v[160:175], v[80:83], v[68:71], v[160:175]
    v_mfma_f32_32x32x16_bf16 v[176:191], v[84:87], v[68:71], v[176:191]
    s_add_u32 m0, s28, 1024
    s_nop 0
    buffer_load_dwordx4 v9, s[12:15], s31 offen lds
    v_mfma_f32_32x32x16_bf16 v[192:207], v[80:83], v[72:75], v[192:207]
    v_mfma_f32_32x32x16_bf16 v[208:223], v[84:87], v[72:75], v[208:223]
    s_add_u32 m0, s28, 2048
    s_nop 0
    buffer_load_dwordx4 v10, s[12:15], s31 offen lds
    v_mfma_f32_32x32x16_bf16 v[224:239], v[80:83], v[76:79], v[224:239]
    v_mfma_f32_32x32x16_bf16 v[240:255], v[84:87], v[76:79], v[240:255]
    s_add_u32 m0, s28, 3072
    s_nop 0
    buffer_load_dwordx4 v11, s[12:15], s31 offen lds
    ds_read_b128 v[64:67], v14 offset:32768
    ds_read_b128 v[68:71], v14 offset:36864
    ds_read_b128 v[72:75], v14 offset:40960
    ds_read_b128 v[76:79], v14 offset:45056
    ds_read_b64_tr_b16 v[80:81], v16 offset:49152
    ds_read_b64_tr_b16 v[82:83], v16 offset:51200
    ds_read_b64_tr_b16 v[84:85], v17 offset:49152
    ds_read_b64_tr_b16 v[86:87], v17 offset:51200
    s_waitcnt lgkmcnt(8)
    v_mfma_f32_32x32x16_bf16 v[128:143], v[104:107], v[88:91], v[128:143]
    v_mfma_f32_32x32x16_bf16 v[144:159], v[108:111], v[88:91], v[144:159]
    v_mfma_f32_32x32x16_bf16 v[160:175], v[104:107], v[92:95], v[160:175]
    v_mfma_f32_32x32x16_bf16 v[176:191], v[108:111], v[92:95], v[176:191]
    v_mfma_f32_32x32x16_bf16 v[192:207], v[104:107], v[96:99], v[192:207]
    v_mfma_f32_32x32x16_bf16 v[208:223], v[108:111], v[96:99], v[208:223]
    v_mfma_f32_32x32x16_bf16 v[224:239], v[104:107], v[100:103], v[224:239]
    v_mfma_f32_32x32x16_bf16 v[240:255], v[108:111], v[100:103], v[240:255]
    ds_read_b128 v[88:91], v15 offset:32768
    ds_read_b128 v[92:95], v15 offset:36864
    ds_read_b128 v[96:99], v15 offset:40960
    ds_read_b128 v[100:103], v15 offset:45056
    ds_read_b64_tr_b16 v[104:105], v16 offset:57344
    ds_read_b64_tr_b16 v[106:107], v16 offset:59392
    ds_read_b64_tr_b16 v[108:109], v17 offset:57344
    ds_read_b64_tr_b16 v[110:111], v17 offset:59392
    s_waitcnt lgkmcnt(8)
    v_mfma_f32_32x32x16_bf16 v[128:143], v[80:83], v[64:67], v[128:143]
    v_mfma_f32_32x32x16_bf16 v[144:159], v[84:87], v[64:67], v[144:159]
    v_mfma_f32_32x32x16_bf16 v[160:175], v[80:83], v[68:71], v[160:175]
    v_mfma_f32_32x32x16_bf16 v[176:191], v[84:87], v[68:71], v[176:191]
    v_mfma_f32_32x32x16_bf16 v[192:207], v[80:83], v[72:75], v[192:207]
    v_mfma_f32_32x32x16_bf16 v[208:223], v[84:87], v[72:75], v[208:223]
    v_mfma_f32_32x32x16_bf16 v[224:239], v[80:83], v[76:79], v[224:239]
    v_mfma_f32_32x32x16_bf16 v[240:255], v[84:87], v[76:79], v[240:255]
    s_waitcnt vmcnt(0) lgkmcnt(0)
    s_barrier
    ds_read_b128 v[64:67], v12 offset:0
    ds_read_b128 v[68:71], v12 offset:4096
    ds_read_b128 v[72:75], v12 offset:8192
    ds_read_b128 v[76:79], v12 offset:12288
    ds_read_b64_tr_b16 v[80:81], v16 offset:0
    ds_read_b64_tr_b16 v[82:83], v16 offset:2048
    ds_read_b64_tr_b16 v[84:85], v17 offset:0
    ds_read_b64_tr_b16 v[86:87], v17 offset:2048
    s_add_u32 s30, s29, 7
    s_and_b32 s30, s30, 7
    s_lshl_b32 s30, s30, 7
    s_add_u32 s30, s30, s56
    v_mfma_f32_32x32x16_bf16 v[128:143], v[104:107], v[88:91], v[128:143]
    v_mfma_f32_32x32x16_bf16 v[144:159], v[108:111], v[88:91], v[144:159]
    s_add_u32 m0, s27, 32768
    s_nop 0
    buffer_load_dwordx4 v4, s[8:11], s30 offen lds
    v_mfma_f32_32x32x16_bf16 v[160:175], v[104:107], v[92:95], v[160:175]
    v_mfma_f32_32x32x16_bf16 v[176:191], v[108:111], v[92:95], v[176:191]
    s_add_u32 m0, s27, 33792
    s_nop 0
    buffer_load_dwordx4 v5, s[8:11], s30 offen lds
    v_mfma_f32_32x32x16_bf16 v[192:207], v[104:107], v[96:99], v[192:207]
    v_mfma_f32_32x32x16_bf16 v[208:223], v[108:111], v[96:99], v[208:223]
    s_add_u32 m0, s27, 34816
    s_nop 0
    buffer_load_dwordx4 v6, s[8:11], s30 offen lds
    v_mfma_f32_32x32x16_bf16 v[224:239], v[104:107], v[100:103], v[224:239]
    v_mfma_f32_32x32x16_bf16 v[240:255], v[108:111], v[100:103], v[240:255]
    s_add_u32 m0, s27, 35840
    s_nop 0
    buffer_load_dwordx4 v7, s[8:11], s30 offen lds
    ds_read_b128 v[88:91], v13 offset:0
    ds_read_b128 v[92:95], v13 offset:4096
    ds_read_b128 v[96:99], v13 offset:8192
    ds_read_b128 v[100:103], v13 offset:12288
    ds_read_b64_tr_b16 v[104:105], v16 offset:8192
    ds_read_b64_tr_b16 v[106:107], v16 offset:10240
    ds_read_b64_tr_b16 v[108:109], v17 offset:8192
    ds_read_b64_tr_b16 v[110:111], v17 offset:10240
    s_waitcnt lgkmcnt(8)
    s_add_u32 s31, s29, 7
    s_and_b32 s31, s31, 7
    s_mul_i32 s31, s25, s31
    v_mfma_f32_32x32x16_bf16 v[128:143], v[80:83], v[64:67], v[128:143]
    v_mfma_f32_32x32x16_bf16 v[144:159], v[84:87], v[64:67], v[144:159]
    s_add_u32 m0, s28, 32768
    s_nop 0
    buffer_load_dwordx4 v8, s[12:15], s31 offen lds
    v_mfma_f32_32x32x16_bf16 v[160:175], v[80:83], v[68:71], v[160:175]
    v_mfma_f32_32x32x16_bf16 v[176:191], v[84:87], v[68:71], v[176:191]
    s_add_u32 m0, s28, 33792
    s_nop 0
    buffer_load_dwordx4 v9, s[12:15], s31 offen lds
    v_mfma_f32_32x32x16_bf16 v[192:207], v[80:83], v[72:75], v[192:207]
    v_mfma_f32_32x32x16_bf16 v[208:223], v[84:87], v[72:75], v[208:223]
    s_add_u32 m0, s28, 34816
    s_nop 0
    buffer_load_dwordx4 v10, s[12:15], s31 offen lds
    v_mfma_f32_32x32x16_bf16 v[224:239], v[80:83], v[76:79], v[224:239]
    v_mfma_f32_32x32x16_bf16 v[240:255], v[84:87], v[76:79], v[240:255]
    s_add_u32 m0, s28, 35840
    s_nop 0
    buffer_load_dwordx4 v11, s[12:15], s31 offen lds
    ds_read_b128 v[64:67], v14 offset:0
    ds_read_b128 v[68:71], v14 offset:4096
    ds_read_b128 v[72:75], v14 offset:8192
    ds_read_b128 v[76:79], v14 offset:12288
    ds_read_b64_tr_b16 v[80:81], v16 offset:16384
    ds_read_b64_tr_b16 v[82:83], v16 offset:18432
    ds_read_b64_tr_b16 v[84:85], v17 offset:16384
    ds_read_b64_tr_b16 v[86:87], v17 offset:18432
    s_waitcnt lgkmcnt(8)
    v_mfma_f32_32x32x16_bf16 v[128:143], v[104:107], v[88:91], v[128:143]
    v_mfma_f32_32x32x16_bf16 v[144:159], v[108:111], v[88:91], v[144:159]
    v_mfma_f32_32x32x16_bf16 v[160:175], v[104:107], v[92:95], v[160:175]
    v_mfma_f32_32x32x16_bf16 v[176:191], v[108:111], v[92:95], v[176:191]
    v_mfma_f32_32x32x16_bf16 v[192:207], v[104:107], v[96:99], v[192:207]
    v_mfma_f32_32x32x16_bf16 v[208:223], v[108:111], v[96:99], v[208:223]
    v_mfma_f32_32x32x16_bf16 v[224:239], v[104:107], v[100:103], v[224:239]
    v_mfma_f32_32x32x16_bf16 v[240:255], v[108:111], v[100:103], v[240:255]
    ds_read_b128 v[88:91], v15 offset:0
    ds_read_b128 v[92:95], v15 offset:4096
    ds_read_b128 v[96:99], v15 offset:8192
    ds_read_b128 v[100:103], v15 offset:12288
    ds_read_b64_tr_b16 v[104:105], v16 offset:24576
    ds_read_b64_tr_b16 v[106:107], v16 offset:26624
    ds_read_b64_tr_b16 v[108:109], v17 offset:24576
    ds_read_b64_tr_b16 v[110:111], v17 offset:26624
    s_waitcnt lgkmcnt(8)
    v_mfma_f32_32x32x16_bf16 v[128:143], v[80:83], v[64:67], v[128:143]
    v_mfma_f32_32x32x16_bf16 v[144:159], v[84:87], v[64:67], v[144:159]
    v_mfma_f32_32x32x16_bf16 v[160:175], v[80:83], v[68:71], v[160:175]
    v_mfma_f32_32x32x16_bf16 v[176:191], v[84:87], v[68:71], v[176:191]
    v_mfma_f32_32x32x16_bf16 v[192:207], v[80:83], v[72:75], v[192:207]
    v_mfma_f32_32x32x16_bf16 v[208:223], v[84:87], v[72:75], v[208:223]
    v_mfma_f32_32x32x16_bf16 v[224:239], v[80:83], v[76:79], v[224:239]
    v_mfma_f32_32x32x16_bf16 v[240:255], v[84:87], v[76:79], v[240:255]
    s_waitcnt vmcnt(0) lgkmcnt(0)
    s_barrier
    ds_read_b128 v[64:67], v12 offset:32768
    ds_read_b128 v[68:71], v12 offset:36864
    ds_read_b128 v[72:75], v12 offset:40960
    ds_read_b128 v[76:79], v12 offset:45056
    ds_read_b64_tr_b16 v[80:81], v16 offset:32768
    ds_read_b64_tr_b16 v[82:83], v16 offset:34816
    ds_read_b64_tr_b16 v[84:85], v17 offset:32768
    ds_read_b64_tr_b16 v[86:87], v17 offset:34816
    s_add_u32 s30, s29, 0
    s_and_b32 s30, s30, 7
    s_lshl_b32 s30, s30, 7
    s_add_u32 s30, s30, s57
    v_mfma_f32_32x32x16_bf16 v[128:143], v[104:107], v[88:91], v[128:143]
    v_mfma_f32_32x32x16_bf16 v[144:159], v[108:111], v[88:91], v[144:159]
    s_cbranch_vccz K1_SKT6_0
    s_add_u32 m0, s27, 0
    s_nop 0
    buffer_load_dwordx4 v4, s[8:11], s30 offen lds
K1_SKT6_0:
    v_mfma_f32_32x32x16_bf16 v[160:175], v[104:107], v[92:95], v[160:175]
    v_mfma_f32_32x32x16_bf16 v[176:191], v[108:111], v[92:95], v[176:191]
    s_cbranch_vccz K1_SKT6_1
    s_add_u32 m0, s27, 1024
    s_nop 0
    buffer_load_dwordx4 v5, s[8:11], s30 offen lds
K1_SKT6_1:
    v_mfma_f32_32x32x16_bf16 v[192:207], v[104:107], v[96:99], v[192:207]
    v_mfma_f32_32x32x16_bf16 v[208:223], v[108:111], v[96:99], v[208:223]
    s_cbranch_vccz K1_SKT6_2
    s_add_u32 m0, s27, 2048
    s_nop 0
    buffer_load_dwordx4 v6, s[8:11], s30 offen lds
K1_SKT6_2:
    v_mfma_f32_32x32x16_bf16 v[224:239], v[104:107], v[100:103], v[224:239]
    v_mfma_f32_32x32x16_bf16 v[240:255], v[108:111], v[100:103], v[240:255]
    s_cbranch_vccz K1_SKT6_3
    s_add_u32 m0, s27, 3072
    s_nop 0
    buffer_load_dwordx4 v7, s[8:11], s30 offen lds
K1_SKT6_3:
    ds_read_b128 v[88:91], v13 offset:32768
    ds_read_b128 v[92:95], v13 offset:36864
    ds_read_b128 v[96:99], v13 offset:40960
    ds_read_b128 v[100:103], v13 offset:45056
    ds_read_b64_tr_b16 v[104:105], v16 offset:40960
    ds_read_b64_tr_b16 v[106:107], v16 offset:43008
    ds_read_b64_tr_b16 v[108:109], v17 offset:40960
    ds_read_b64_tr_b16 v[110:111], v17 offset:43008
    s_waitcnt lgkmcnt(8)
    s_add_u32 s31, s29, 0
    s_and_b32 s31, s31, 7
    s_mul_i32 s31, s25, s31
    v_mfma_f32_32x32x16_bf16 v[128:143], v[80:83], v[64:67], v[128:143]
    v_mfma_f32_32x32x16_bf16 v[144:159], v[84:87], v[64:67], v[144:159]
    s_cbranch_vccz K1_SKT7_4
    s_add_u32 m0, s28, 0
    s_nop 0
    buffer_load_dwordx4 v8, s[12:15], s31 offen lds
K1_SKT7_4:
    v_mfma_f32_32x32x16_bf16 v[160:175], v[80:83], v[68:71], v[160:175]
    v_mfma_f32_32x32x16_bf16 v[176:191], v[84:87], v[68:71], v[176:191]
    s_cbranch_vccz K1_SKT7_5
    s_add_u32 m0, s28, 1024
    s_nop 0
    buffer_load_dwordx4 v9, s[12:15], s31 offen lds
K1_SKT7_5:
    v_mfma_f32_32x32x16_bf16 v[192:207], v[80:83], v[72:75], v[192:207]
    v_mfma_f32_32x32x16_bf16 v[208:223], v[84:87], v[72:75], v[208:223]
    s_cbranch_vccz K1_SKT7_6
    s_add_u32 m0, s28, 2048
    s_nop 0
    buffer_load_dwordx4 v10, s[12:15], s31 offen lds
K1_SKT7_6:
    v_mfma_f32_32x32x16_bf16 v[224:239], v[80:83], v[76:79], v[224:239]
    v_mfma_f32_32x32x16_bf16 v[240:255], v[84:87], v[76:79], v[240:255]
    s_cbranch_vccz K1_SKT7_7
    s_add_u32 m0, s28, 3072
    s_nop 0
    buffer_load_dwordx4 v11, s[12:15], s31 offen lds
K1_SKT7_7:
    ds_read_b128 v[64:67], v14 offset:32768
    ds_read_b128 v[68:71], v14 offset:36864
    ds_read_b128 v[72:75], v14 offset:40960
    ds_read_b128 v[76:79], v14 offset:45056
    ds_read_b64_tr_b16 v[80:81], v16 offset:49152
    ds_read_b64_tr_b16 v[82:83], v16 offset:51200
    ds_read_b64_tr_b16 v[84:85], v17 offset:49152
    ds_read_b64_tr_b16 v[86:87], v17 offset:51200
    s_waitcnt lgkmcnt(8)
    v_mfma_f32_32x32x16_bf16 v[128:143], v[104:107], v[88:91], v[128:143]
    v_mfma_f32_32x32x16_bf16 v[144:159], v[108:111], v[88:91], v[144:159]
    v_mfma_f32_32x32x16_bf16 v[160:175], v[104:107], v[92:95], v[160:175]
    v_mfma_f32_32x32x16_bf16 v[176:191], v[108:111], v[92:95], v[176:191]
    v_mfma_f32_32x32x16_bf16 v[192:207], v[104:107], v[96:99], v[192:207]
    v_mfma_f32_32x32x16_bf16 v[208:223], v[108:111], v[96:99], v[208:223]
    v_mfma_f32_32x32x16_bf16 v[224:239], v[104:107], v[100:103], v[224:239]
    v_mfma_f32_32x32x16_bf16 v[240:255], v[108:111], v[100:103], v[240:255]
    ds_read_b128 v[88:91], v15 offset:32768
    ds_read_b128 v[92:95], v15 offset:36864
    ds_read_b128 v[96:99], v15 offset:40960
    ds_read_b128 v[100:103], v15 offset:45056
    ds_read_b64_tr_b16 v[104:105], v16 offset:57344
    ds_read_b64_tr_b16 v[106:107], v16 offset:59392
    ds_read_b64_tr_b16 v[108:109], v17 offset:57344
    ds_read_b64_tr_b16 v[110:111], v17 offset:59392
    s_waitcnt lgkmcnt(8)
    v_mfma_f32_32x32x16_bf16 v[128:143], v[80:83], v[64:67], v[128:143]
    v_mfma_f32_32x32x16_bf16 v[144:159], v[84:87], v[64:67], v[144:159]
    v_mfma_f32_32x32x16_bf16 v[160:175], v[80:83], v[68:71], v[160:175]
    v_mfma_f32_32x32x16_bf16 v[176:191], v[84:87], v[68:71], v[176:191]
    v_mfma_f32_32x32x16_bf16 v[192:207], v[80:83], v[72:75], v[192:207]
    v_mfma_f32_32x32x16_bf16 v[208:223], v[84:87], v[72:75], v[208:223]
    v_mfma_f32_32x32x16_bf16 v[224:239], v[80:83], v[76:79], v[224:239]
    v_mfma_f32_32x32x16_bf16 v[240:255], v[84:87], v[76:79], v[240:255]
    s_waitcnt vmcnt(0) lgkmcnt(0)
    s_barrier
    ds_read_b128 v[64:67], v12 offset:0
    ds_read_b128 v[68:71], v12 offset:4096
    ds_read_b128 v[72:75], v12 offset:8192
    ds_read_b128 v[76:79], v12 offset:12288
    ds_read_b64_tr_b16 v[80:81], v16 offset:0
    ds_read_b64_tr_b16 v[82:83], v16 offset:2048
    ds_read_b64_tr_b16 v[84:85], v17 offset:0
    ds_read_b64_tr_b16 v[86:87], v17 offset:2048
    s_add_u32 s30, s29, 1
    s_and_b32 s30, s30, 7
    s_lshl_b32 s30, s30, 7
    s_add_u32 s30, s30, s57
    v_mfma_f32_32x32x16_bf16 v[128:143], v[104:107], v[88:91], v[128:143]
    v_mfma_f32_32x32x16_bf16 v[144:159], v[108:111], v[88:91], v[144:159]
    s_cbranch_vccz K1_SKT7_0
    s_add_u32 m0, s27, 32768
    s_nop 0
    buffer_load_dwordx4 v4, s[8:11], s30 offen lds
K1_SKT7_0:
    v_mfma_f32_32x32x16_bf16 v[160:175], v[104:107], v[92:95], v[160:175]
    v_mfma_f32_32x32x16_bf16 v[176:191], v[108:111], v[92:95], v[176:191]
    s_cbranch_vccz K1_SKT7_1
    s_add_u32 m0, s27, 33792
    s_nop 0
    buffer_load_dwordx4 v5, s[8:11], s30 offen lds
K1_SKT7_1:
    v_mfma_f32_32x32x16_bf16 v[192:207], v[104:107], v[96:99], v[192:207]
    v_mfma_f32_32x32x16_bf16 v[208:223], v[108:111], v[96:99], v[208:223]
    s_cbranch_vccz K1_SKT7_2
    s_add_u32 m0, s27, 34816
    s_nop 0
    buffer_load_dwordx4 v6, s[8:11], s30 offen lds
K1_SKT7_2:
    v_mfma_f32_32x32x16_bf16 v[224:239], v[104:107], v[100:103], v[224:239]
    v_mfma_f32_32x32x16_bf16 v[240:255], v[108:111], v[100:103], v[240:255]
    s_cbranch_vccz K1_SKT7_3
    s_add_u32 m0, s27, 35840
    s_nop 0
    buffer_load_dwordx4 v7, s[8:11], s30 offen lds
K1_SKT7_3:
    s_branch K1_EPI
K1_LOOPN:
    ds_read_b128 v[88:91], v13 offset:0
    ds_read_b128 v[92:95], v13 offset:4096
    ds_read_b128 v[96:99], v13 offset:8192
    ds_read_b128 v[100:103], v13 offset:12288
    ds_read_b64_tr_b16 v[104:105], v16 offset:8192
    ds_read_b64_tr_b16 v[106:107], v16 offset:10240
    ds_read_b64_tr_b16 v[108:109], v17 offset:8192
    ds_read_b64_tr_b16 v[110:111], v17 offset:10240
    s_waitcnt lgkmcnt(8)
    s_add_u32 s31, s29, 1
    s_and_b32 s31, s31, 7
    s_mul_i32 s31, s25, s31
    v_mfma_f32_32x32x16_bf16 v[128:143], v[64:67], v[80:83], 0
    v_mfma_f32_32x32x16_bf16 v[144:159], v[64:67], v[84:87], 0
    s_add_u32 m0, s28, 32768
    s_nop 0
    buffer_load_dwordx4 v8, s[12:15], s31 offen lds
    v_mfma_f32_32x32x16_bf16 v[160:175], v[68:71], v[80:83], 0
    v_mfma_f32_32x32x16_bf16 v[176:191], v[68:71], v[84:87], 0
    s_add_u32 m0, s28, 33792
    s_nop 0
    buffer_load_dwordx4 v9, s[12:15], s31 offen lds
    v_mfma_f32_32x32x16_bf16 v[192:207], v[72:75], v[80:83], 0
    v_mfma_f32_32x32x16_bf16 v[208:223], v[72:75], v[84:87], 0
    s_add_u32 m0, s28, 34816
    s_nop 0
    buffer_load_dwordx4 v10, s[12:15], s31 offen lds
    v_mfma_f32_32x32x16_bf16 v[224:239], v[76:79], v[80:83], 0
    v_mfma_f32_32x32x16_bf16 v[240:255], v[76:79], v[84:87], 0
    s_add_u32 m0, s28, 35840
    s_nop 0
    buffer_load_dwordx4 v11, s[12:15], s31 offen lds
    ds_read_b128 v[64:67], v14 offset:0
    ds_read_b128 v[68:71], v14 offset:4096
    ds_read_b128 v[72:75], v14 offset:8192
    ds_read_b128 v[76:79], v14 offset:12288
    ds_read_b64_tr_b16 v[80:81], v16 offset:16384
    ds_read_b64_tr_b16 v[82:83], v16 offset:18432
    ds_read_b64_tr_b16 v[84:85], v17 offset:16384
    ds_read_b64_tr_b16 v[86:87], v17 offset:18432
    s_waitcnt lgkmcnt(8)
    v_mfma_f32_32x32x16_bf16 v[128:143], v[88:91], v[104:107], v[128:143]
    v_mfma_f32_32x32x16_bf16 v[144:159], v[88:91], v[108:111], v[144:159]
    v_mfma_f32_32x32x16_bf16 v[160:175], v[92:95], v[104:107], v[160:175]
    v_mfma_f32_32x32x16_bf16 v[176:191], v[92:95], v[108:111], v[176:191]
    v_mfma_f32_32x32x16_bf16 v[192:207], v[96:99], v[104:107], v[192:207]
    v_mfma_f32_32x32x16_bf16 v[208:223], v[96:99], v[108:111], v[208:223]
    v_mfma_f32_32x32x16_bf16 v[224:239], v[100:103], v[104:107], v[224:239]
    v_mfma_f32_32x32x16_bf16 v[240:255], v[100:103], v[108:111], v[240:255]
    ds_read_b128 v[88:91], v15 offset:0
    ds_read_b128 v[92:95], v15 offset:4096
    ds_read_b128 v[96:99], v15 offset:8192
    ds_read_b128 v[100:103], v15 offset:12288
    ds_read_b64_tr_b16 v[104:105], v16 offset:24576
    ds_read_b64_tr_b16 v[106:107], v16 offset:26624
    ds_read_b64_tr_b16 v[108:109], v17 offset:24576
    ds_read_b64_tr_b16 v[110:111], v17 offset:26624
    s_waitcnt lgkmcnt(8)
    v_mfma_f32_32x32x16_bf16 v[128:143], v[64:67], v[80:83], v[128:143]
    v_mfma_f32_32x32x16_bf16 v[144:159], v[64:67], v[84:87], v[144:159]
    v_mfma_f32_32x32x16_bf16 v[160:175], v[68:71], v[80:83], v[160:175]
    v_mfma_f32_32x32x16_bf16 v[176:191], v[68:71], v[84:87], v[176:191]
    v_mfma_f32_32x32x16_bf16 v[192:207], v[72:75], v[80:83], v[192:207]
    v_mfma_f32_32x32x16_bf16 v[208:223], v[72:75], v[84:87], v[208:223]
    v_mfma_f32_32x32x16_bf16 v[224:239], v[76:79], v[80:83], v[224:239]
    v_mfma_f32_32x32x16_bf16 v[240:255], v[76:79], v[84:87], v[240:255]
    s_waitcnt vmcnt(0) lgkmcnt(0)
    s_barrier
    ds_read_b128 v[64:67], v12 offset:32768
    ds_read_b128 v[68:71], v12 offset:36864
    ds_read_b128 v[72:75], v12 offset:40960
    ds_read_b128 v[76:79], v12 offset:45056
    ds_read_b64_tr_b16 v[80:81], v16 offset:32768
    ds_read_b64_tr_b16 v[82:83], v16 offset:34816
    ds_read_b64_tr_b16 v[84:85], v17 offset:32768
    ds_read_b64_tr_b16 v[86:87], v17 offset:34816
    s_add_u32 s30, s29, 2
    s_and_b32 s30, s30, 7
    s_lshl_b32 s30, s30, 7
    s_add_u32 s30, s30, s56
    v_mfma_f32_32x32x16_bf16 v[128:143], v[88:91], v[104:107], v[128:143]
    v_mfma_f32_32x32x16_bf16 v[144:159], v[88:91], v[108:111], v[144:159]
    s_add_u32 m0, s27, 0
    s_nop 0
    buffer_load_dwordx4 v4, s[8:11], s30 offen lds
    v_mfma_f32_32x32x16_bf16 v[160:175], v[92:95], v[104:107], v[160:175]
    v_mfma_f32_32x32x16_bf16 v[176:191], v[92:95], v[108:111], v[176:191]
    s_add_u32 m0, s27, 1024
    s_nop 0
    buffer_load_dwordx4 v5, s[8:11], s30 offen lds
    v_mfma_f32_32x32x16_bf16 v[192:207], v[96:99], v[104:107], v[192:207]
    v_mfma_f32_32x32x16_bf16 v[208:223], v[96:99], v[108:111], v[208:223]
    s_add_u32 m0, s27, 2048
    s_nop 0
    buffer_load_dwordx4 v6, s[8:11], s30 offen lds
    v_mfma_f32_32x32x16_bf16 v[224:239], v[100:103], v[104:107], v[224:239]
    v_mfma_f32_32x32x16_bf16 v[240:255], v[100:103], v[108:111], v[240:255]
    s_add_u32 m0, s27, 3072
    s_nop 0
    buffer_load_dwordx4 v7, s[8:11], s30 offen lds
    ds_read_b128 v[88:91], v13 offset:32768
    ds_read_b128 v[92:95], v13 offset:36864
    ds_read_b128 v[96:99], v13 offset:40960
    ds_read_b128 v[100:103], v13 offset:45056
    ds_read_b64_tr_b16 v[104:105], v16 offset:40960
    ds_read_b64_tr_b16 v[106:107], v16 offset:43008
    ds_read_b64_tr_b16 v[108:109], v17 offset:40960
    ds_read_b64_tr_b16 v[110:111], v17 offset:43008
    s_waitcnt lgkmcnt(8)
    s_add_u32 s31, s29, 2
    s_and_b32 s31, s31, 7
    s_mul_i32 s31, s25, s31
    v_mfma_f32_32x32x16_bf16 v[128:143], v[64:67], v[80:83], v[128:143]
    v_mfma_f32_32x32x16_bf16 v[144:159], v[64:67], v[84:87], v[144:159]
    s_add_u32 m0, s28, 0
    s_nop 0
    buffer_load_dwordx4 v8, s[12:15], s31 offen lds
    v_mfma_f32_32x32x16_bf16 v[160:175], v[68:71], v[80:83], v[160:175]
    v_mfma_f32_32x32x16_bf16 v[176:191], v[68:71], v[84:87], v[176:191]
    s_add_u32 m0, s28, 1024
    s_nop 0
    buffer_load_dwordx4 v9, s[12:15], s31 offen lds
    v_mfma_f32_32x32x16_bf16 v[192:207], v[72:75], v[80:83], v[192:207]
    v_mfma_f32_32x32x16_bf16 v[208:223], v[72:75], v[84:87], v[208:223]
    s_add_u32 m0, s28, 2048
    s_nop 0
    buffer_load_dwordx4 v10, s[12:15], s31 offen lds
    v_mfma_f32_32x32x16_bf16 v[224:239], v[76:79], v[80:83], v[224:239]
    v_mfma_f32_32x32x16_bf16 v[240:255], v[76:79], v[84:87], v[240:255]
    s_add_u32 m0, s28, 3072
    s_nop 0
    buffer_load_dwordx4 v11, s[12:15], s31 offen lds
    ds_read_b128 v[64:67], v14 offset:32768
    ds_read_b128 v[68:71], v14 offset:36864
    ds_read_b128 v[72:75], v14 offset:40960
    ds_read_b128 v[76:79], v14 offset:45056
    ds_read_b64_tr_b16 v[80:81], v16 offset:49152
    ds_read_b64_tr_b16 v[82:83], v16 offset:51200
    ds_read_b64_tr_b16 v[84:85], v17 offset:49152
    ds_read_b64_tr_b16 v[86:87], v17 offset:51200
    s_waitcnt lgkmcnt(8)
    v_mfma_f32_32x32x16_bf16 v[128:143], v[88:91], v[104:107], v[128:143]
    v_mfma_f32_32x32x16_bf16 v[144:159], v[88:91], v[108:111], v[144:159]
    v_mfma_f32_32x32x16_bf16 v[160:175], v[92:95], v[104:107], v[160:175]
    v_mfma_f32_32x32x16_bf16 v[176:191], v[92:95], v[108:111], v[176:191]
    v_mfma_f32_32x32x16_bf16 v[192:207], v[96:99], v[104:107], v[192:207]
    v_mfma_f32_32x32x16_bf16 v[208:223], v[96:99], v[108:111], v[208:223]
    v_mfma_f32_32x32x16_bf16 v[224:239], v[100:103], v[104:107], v[224:239]
    v_mfma_f32_32x32x16_bf16 v[240:255], v[100:103], v[108:111], v[240:255]
    ds_read_b128 v[88:91], v15 offset:32768
    ds_read_b128 v[92:95], v15 offset:36864
    ds_read_b128 v[96:99], v15 offset:40960
    ds_read_b128 v[100:103], v15 offset:45056
    ds_read_b64_tr_b16 v[104:105], v16 offset:57344
    ds_read_b64_tr_b16 v[106:107], v16 offset:59392
    ds_read_b64_tr_b16 v[108:109], v17 offset:57344
    ds_read_b64_tr_b16 v[110:111], v17 offset:59392
    s_waitcnt lgkmcnt(8)
    v_mfma_f32_32x32x16_bf16 v[128:143], v[64:67], v[80:83], v[128:143]
    v_mfma_f32_32x32x16_bf16 v[144:159], v[64:67], v[84:87], v[144:159]
    v_mfma_f32_32x32x16_bf16 v[160:175], v[68:71], v[80:83], v[160:175]
    v_mfma_f32_32x32x16_bf16 v[176:191], v[68:71], v[84:87], v[176:191]
    v_mfma_f32_32x32x16_bf16 v[192:207], v[72:75], v[80:83], v[192:207]
    v_mfma_f32_32x32x16_bf16 v[208:223], v[72:75], v[84:87], v[208:223]
    v_mfma_f32_32x32x16_bf16 v[224:239], v[76:79], v[80:83], v[224:239]
    v_mfma_f32_32x32x16_bf16 v[240:255], v[76:79], v[84:87], v[240:255]
    s_waitcnt vmcnt(0) lgkmcnt(0)
    s_barrier
    ds_read_b128 v[64:67], v12 offset:0
    ds_read_b128 v[68:71], v12 offset:4096
    ds_read_b128 v[72:75], v12 offset:8192
    ds_read_b128 v[76:79], v12 offset:12288
    ds_read_b64_tr_b16 v[80:81], v16 offset:0
    ds_read_b64_tr_b16 v[82:83], v16 offset:2048
    ds_read_b64_tr_b16 v[84:85], v17 offset:0
    ds_read_b64_tr_b16 v[86:87], v17 offset:2048
    s_add_u32 s30, s29, 3
    s_and_b32 s30, s30, 7
    s_lshl_b32 s30, s30, 7
    s_add_u32 s30, s30, s56
    v_mfma_f32_32x32x16_bf16 v[128:143], v[88:91], v[104:107], v[128:143]
    v_mfma_f32_32x32x16_bf16 v[144:159], v[88:91], v[108:111], v[144:159]
    s_add_u32 m0, s27, 32768
    s_nop 0
    buffer_load_dwordx4 v4, s[8:11], s30 offen lds
    v_mfma_f32_32x32x16_bf16 v[160:175], v[92:95], v[104:107], v[160:175]
    v_mfma_f32_32x32x16_bf16 v[176:191], v[92:95], v[108:111], v[176:191]
    s_add_u32 m0, s27, 33792
    s_nop 0
    buffer_load_dwordx4 v5, s[8:11], s30 offen lds
    v_mfma_f32_32x32x16_bf16 v[192:207], v[96:99], v[104:107], v[192:207]
    v_mfma_f32_32x32x16_bf16 v[208:223], v[96:99], v[108:111], v[208:223]
    s_add_u32 m0, s27, 34816
    s_nop 0
    buffer_load_dwordx4 v6, s[8:11], s30 offen lds
    v_mfma_f32_32x32x16_bf16 v[224:239], v[100:103], v[104:107], v[224:239]
    v_mfma_f32_32x32x16_bf16 v[240:255], v[100:103], v[108:111], v[240:255]
    s_add_u32 m0, s27, 35840
    s_nop 0
    buffer_load_dwordx4 v7, s[8:11], s30 offen lds
    ds_read_b128 v[88:91], v13 offset:0
    ds_read_b128 v[92:95], v13 offset:4096
    ds_read_b128 v[96:99], v13 offset:8192
    ds_read_b128 v[100:103], v13 offset:12288
    ds_read_b64_tr_b16 v[104:105], v16 offset:8192
    ds_read_b64_tr_b16 v[106:107], v16 offset:10240
    ds_read_b64_tr_b16 v[108:109], v17 offset:8192
    ds_read_b64_tr_b16 v[110:111], v17 offset:10240
    s_waitcnt lgkmcnt(8)
    s_add_u32 s31, s29, 3
    s_and_b32 s31, s31, 7
    s_mul_i32 s31, s25, s31
    v_mfma_f32_32x32x16_bf16 v[128:143], v[64:67], v[80:83], v[128:143]
    v_mfma_f32_32x32x16_bf16 v[144:159], v[64:67], v[84:87], v[144:159]
    s_add_u32 m0, s28, 32768
    s_nop 0
    buffer_load_dwordx4 v8, s[12:15], s31 offen lds
    v_mfma_f32_32x32x16_bf16 v[160:175], v[68:71], v[80:83], v[160:175]
    v_mfma_f32_32x32x16_bf16 v[176:191], v[68:71], v[84:87], v[176:191]
    s_add_u32 m0, s28, 33792
    s_nop 0
    buffer_load_dwordx4 v9, s[12:15], s31 offen lds
    v_mfma_f32_32x32x16_bf16 v[192:207], v[72:75], v[80:83], v[192:207]
    v_mfma_f32_32x32x16_bf16 v[208:223], v[72:75], v[84:87], v[208:223]
    s_add_u32 m0, s28, 34816
    s_nop 0
    buffer_load_dwordx4 v10, s[12:15], s31 offen lds
    v_mfma_f32_32x32x16_bf16 v[224:239], v[76:79], v[80:83], v[224:239]
    v_mfma_f32_32x32x16_bf16 v[240:255], v[76:79], v[84:87], v[240:255]
    s_add_u32 m0, s28, 35840
    s_nop 0
    buffer_load_dwordx4 v11, s[12:15], s31 offen lds
    ds_read_b128 v[64:67], v14 offset:0
    ds_read_b128 v[68:71], v14 offset:4096
    ds_read_b128 v[72:75], v14 offset:8192
    ds_read_b128 v[76:79], v14 offset:12288
    ds_read_b64_tr_b16 v[80:81], v16 offset:16384
    ds_read_b64_tr_b16 v[82:83], v16 offset:18432
    ds_read_b64_tr_b16 v[84:85], v17 offset:16384
    ds_read_b64_tr_b16 v[86:87], v17 offset:18432
    s_waitcnt lgkmcnt(8)
    v_mfma_f32_32x32x16_bf16 v[128:143], v[88:91], v[104:107], v[128:143]
    v_mfma_f32_32x32x16_bf16 v[144:159], v[88:91], v[108:111], v[144:159]
    v_mfma_f32_32x32x16_bf16 v[160:175], v[92:95], v[104:107], v[160:175]
    v_mfma_f32_32x32x16_bf16 v[176:191], v[92:95], v[108:111], v[176:191]
    v_mfma_f32_32x32x16_bf16 v[192:207], v[96:99], v[104:107], v[192:207]
    v_mfma_f32_32x32x16_bf16 v[208:223], v[96:99], v[108:111], v[208:223]
    v_mfma_f32_32x32x16_bf16 v[224:239], v[100:103], v[104:107], v[224:239]
    v_mfma_f32_32x32x16_bf16 v[240:255], v[100:103], v[108:111], v[240:255]
    ds_read_b128 v[88:91], v15 offset:0
    ds_read_b128 v[92:95], v15 offset:4096
    ds_read_b128 v[96:99], v15 offset:8192
    ds_read_b128 v[100:103], v15 offset:12288
    ds_read_b64_tr_b16 v[104:105], v16 offset:24576
    ds_read_b64_tr_b16 v[106:107], v16 offset:26624
    ds_read_b64_tr_b16 v[108:109], v17 offset:24576
    ds_read_b64_tr_b16 v[110:111], v17 offset:26624
    s_waitcnt lgkmcnt(8)
    v_mfma_f32_32x32x16_bf16 v[128:143], v[64:67], v[80:83], v[128:143]
    v_mfma_f32_32x32x16_bf16 v[144:159], v[64:67], v[84:87], v[144:159]
    v_mfma_f32_32x32x16_bf16 v[160:175], v[68:71], v[80:83], v[160:175]
    v_mfma_f32_32x32x16_bf16 v[176:191], v[68:71], v[84:87], v[176:191]
    v_mfma_f32_32x32x16_bf16 v[192:207], v[72:75], v[80:83], v[192:207]
    v_mfma_f32_32x32x16_bf16 v[208:223], v[72:75], v[84:87], v[208:223]
    v_mfma_f32_32x32x16_bf16 v[224:239], v[76:79], v[80:83], v[224:239]
    v_mfma_f32_32x32x16_bf16 v[240:255], v[76:79], v[84:87], v[240:255]
    s_waitcnt vmcnt(0) lgkmcnt(0)
    s_barrier
    ds_read_b128 v[64:67], v12 offset:32768
    ds_read_b128 v[68:71], v12 offset:36864
    ds_read_b128 v[72:75], v12 offset:40960
    ds_read_b128 v[76:79], v12 offset:45056
    ds_read_b64_tr_b16 v[80:81], v16 offset:32768
    ds_read_b64_tr_b16 v[82:83], v16 offset:34816
    ds_read_b64_tr_b16 v[84:85], v17 offset:32768
    ds_read_b64_tr_b16 v[86:87], v17 offset:34816
    s_add_u32 s30, s29, 4
    s_and_b32 s30, s30, 7
    s_lshl_b32 s30, s30, 7
    s_add_u32 s30, s30, s56
    v_mfma_f32_32x32x16_bf16 v[128:143], v[88:91], v[104:107], v[128:143]
    v_mfma_f32_32x32x16_bf16 v[144:159], v[88:91], v[108:111], v[144:159]
    s_add_u32 m0, s27, 0
    s_nop 0
    buffer_load_dwordx4 v4, s[8:11], s30 offen lds
    v_mfma_f32_32x32x16_bf16 v[160:175], v[92:95], v[104:107], v[160:175]
    v_mfma_f32_32x32x16_bf16 v[176:191], v[92:95], v[108:111], v[176:191]
    s_add_u32 m0, s27, 1024
    s_nop 0
    buffer_load_dwordx4 v5, s[8:11], s30 offen lds
    v_mfma_f32_32x32x16_bf16 v[192:207], v[96:99], v[104:107], v[192:207]
    v_mfma_f32_32x32x16_bf16 v[208:223], v[96:99], v[108:111], v[208:223]
    s_add_u32 m0, s27, 2048
    s_nop 0
    buffer_load_dwordx4 v6, s[8:11], s30 offen lds
    v_mfma_f32_32x32x16_bf16 v[224:239], v[100:103], v[104:107], v[224:239]
    v_mfma_f32_32x32x16_bf16 v[240:255], v[100:103], v[108:111], v[240:255]
    s_add_u32 m0, s27, 3072
    s_nop 0
    buffer_load_dwordx4 v7, s[8:11], s30 offen lds
    ds_read_b128 v[88:91], v13 offset:32768
    ds_read_b128 v[92:95], v13 offset:36864
    ds_read_b128 v[96:99], v13 offset:40960
    ds_read_b128 v[100:103], v13 offset:45056
    ds_read_b64_tr_b16 v[104:105], v16 offset:40960
    ds_read_b64_tr_b16 v[106:107], v16 offset:43008
    ds_read_b64_tr_b16 v[108:109], v17 offset:40960
    ds_read_b64_tr_b16 v[110:111], v17 offset:43008
    s_waitcnt lgkmcnt(8)
    s_add_u32 s31, s29, 4
    s_and_b32 s31, s31, 7
    s_mul_i32 s31, s25, s31
    v_mfma_f32_32x32x16_bf16 v[128:143], v[64:67], v[80:83], v[128:143]
    v_mfma_f32_32x32x16_bf16 v[144:159], v[64:67], v[84:87], v[144:159]
    s_add_u32 m0, s28, 0
    s_nop 0
    buffer_load_dwordx4 v8, s[12:15], s31 offen lds
    v_mfma_f32_32x32x16_bf16 v[160:175], v[68:71], v[80:83], v[160:175]
    v_mfma_f32_32x32x16_bf16 v[176:191], v[68:71], v[84:87], v[176:191]
    s_add_u32 m0, s28, 1024
    s_nop 0
    buffer_load_dwordx4 v9, s[12:15], s31 offen lds
    v_mfma_f32_32x32x16_bf16 v[192:207], v[72:75], v[80:83], v[192:207]
    v_mfma_f32_32x32x16_bf16 v[208:223], v[72:75], v[84:87], v[208:223]
    s_add_u32 m0, s28, 2048
    s_nop 0
    buffer_load_dwordx4 v10, s[12:15], s31 offen lds
    v_mfma_f32_32x32x16_bf16 v[224:239], v[76:79], v[80:83], v[224:239]
    v_mfma_f32_32x32x16_bf16 v[240:255], v[76:79], v[84:87], v[240:255]
    s_add_u32 m0, s28, 3072
    s_nop 0
    buffer_load_dwordx4 v11, s[12:15], s31 offen lds
    ds_read_b128 v[64:67], v14 offset:32768
    ds_read_b128 v[68:71], v14 offset:36864
    ds_read_b128 v[72:75], v14 offset:40960
    ds_read_b128 v[76:79], v14 offset:45056
    ds_read_b64_tr_b16 v[80:81], v16 offset:49152
    ds_read_b64_tr_b16 v[82:83], v16 offset:51200
    ds_read_b64_tr_b16 v[84:85], v17 offset:49152
    ds_read_b64_tr_b16 v[86:87], v17 offset:51200
    s_waitcnt lgkmcnt(8)
    v_mfma_f32_32x32x16_bf16 v[128:143], v[88:91], v[104:107], v[128:143]
    v_mfma_f32_32x32x16_bf16 v[144:159], v[88:91], v[108:111], v[144:159]
    v_mfma_f32_32x32x16_bf16 v[160:175], v[92:95], v[104:107], v[160:175]
    v_mfma_f32_32x32x16_bf16 v[176:191], v[92:95], v[108:111], v[176:191]
    v_mfma_f32_32x32x16_bf16 v[192:207], v[96:99], v[104:107], v[192:207]
    v_mfma_f32_32x32x16_bf16 v[208:223], v[96:99], v[108:111], v[208:223]
    v_mfma_f32_32x32x16_bf16 v[224:239], v[100:103], v[104:107], v[224:239]
    v_mfma_f32_32x32x16_bf16 v[240:255], v[100:103], v[108:111], v[240:255]
    ds_read_b128 v[88:91], v15 offset:32768
    ds_read_b128 v[92:95], v15 offset:36864
    ds_read_b128 v[96:99], v15 offset:40960
    ds_read_b128 v[100:103], v15 offset:45056
    ds_read_b64_tr_b16 v[104:105], v16 offset:57344
    ds_read_b64_tr_b16 v[106:107], v16 offset:59392
    ds_read_b64_tr_b16 v[108:109], v17 offset:57344
    ds_read_b64_tr_b16 v[110:111], v17 offset:59392
    s_waitcnt lgkmcnt(8)
    v_mfma_f32_32x32x16_bf16 v[128:143], v[64:67], v[80:83], v[128:143]
    v_mfma_f32_32x32x16_bf16 v[144:159], v[64:67], v[84:87], v[144:159]
    v_mfma_f32_32x32x16_bf16 v[160:175], v[68:71], v[80:83], v[160:175]
    v_mfma_f32_32x32x16_bf16 v[176:191], v[68:71], v[84:87], v[176:191]
    v_mfma_f32_32x32x16_bf16 v[192:207], v[72:75], v[80:83], v[192:207]
    v_mfma_f32_32x32x16_bf16 v[208:223], v[72:75], v[84:87], v[208:223]
    v_mfma_f32_32x32x16_bf16 v[224:239], v[76:79], v[80:83], v[224:239]
    v_mfma_f32_32x32x16_bf16 v[240:255], v[76:79], v[84:87], v[240:255]
    s_waitcnt vmcnt(0) lgkmcnt(0)
    s_barrier
    ds_read_b128 v[64:67], v12 offset:0
    ds_read_b128 v[68:71], v12 offset:4096
    ds_read_b128 v[72:75], v12 offset:8192
    ds_read_b128 v[76:79], v12 offset:12288
    ds_read_b64_tr_b16 v[80:81], v16 offset:0
    ds_read_b64_tr_b16 v[82:83], v16 offset:2048
    ds_read_b64_tr_b16 v[84:85], v17 offset:0
    ds_read_b64_tr_b16 v[86:87], v17 offset:2048
    s_add_u32 s30, s29, 5
    s_and_b32 s30, s30, 7
    s_lshl_b32 s30, s30, 7
    s_add_u32 s30, s30, s56
    v_mfma_f32_32x32x16_bf16 v[128:143], v[88:91], v[104:107], v[128:143]
    v_mfma_f32_32x32x16_bf16 v[144:159], v[88:91], v[108:111], v[144:159]
    s_add_u32 m0, s27, 32768
    s_nop 0
    buffer_load_dwordx4 v4, s[8:11], s30 offen lds
    v_mfma_f32_32x32x16_bf16 v[160:175], v[92:95], v[104:107], v[160:175]
    v_mfma_f32_32x32x16_bf16 v[176:191], v[92:95], v[108:111], v[176:191]
    s_add_u32 m0, s27, 33792
    s_nop 0
    buffer_load_dwordx4 v5, s[8:11], s30 offen lds
    v_mfma_f32_32x32x16_bf16 v[192:207], v[96:99], v[104:107], v[192:207]
    v_mfma_f32_32x32x16_bf16 v[208:223], v[96:99], v[108:111], v[208:223]
    s_add_u32 m0, s27, 34816
    s_nop 0
    buffer_load_dwordx4 v6, s[8:11], s30 offen lds
    v_mfma_f32_32x32x16_bf16 v[224:239], v[100:103], v[104:107], v[224:239]
    v_mfma_f32_32x32x16_bf16 v[240:255], v[100:103], v[108:111], v[240:255]
    s_add_u32 m0, s27, 35840
    s_nop 0
    buffer_load_dwordx4 v7, s[8:11], s30 offen lds
    ds_read_b128 v[88:91], v13 offset:0
    ds_read_b128 v[92:95], v13 offset:4096
    ds_read_b128 v[96:99], v13 offset:8192
    ds_read_b128 v[100:103], v13 offset:12288
    ds_read_b64_tr_b16 v[104:105], v16 offset:8192
    ds_read_b64_tr_b16 v[106:107], v16 offset:10240
    ds_read_b64_tr_b16 v[108:109], v17 offset:8192
    ds_read_b64_tr_b16 v[110:111], v17 offset:10240
    s_waitcnt lgkmcnt(8)
    s_add_u32 s31, s29, 5
    s_and_b32 s31, s31, 7
    s_mul_i32 s31, s25, s31
    v_mfma_f32_32x32x16_bf16 v[128:143], v[64:67], v[80:83], v[128:143]
    v_mfma_f32_32x32x16_bf16 v[144:159], v[64:67], v[84:87], v[144:159]
    s_add_u32 m0, s28, 32768
    s_nop 0
    buffer_load_dwordx4 v8, s[12:15], s31 offen lds
    v_mfma_f32_32x32x16_bf16 v[160:175], v[68:71], v[80:83], v[160:175]
    v_mfma_f32_32x32x16_bf16 v[176:191], v[68:71], v[84:87], v[176:191]
    s_add_u32 m0, s28, 33792
    s_nop 0
    buffer_load_dwordx4 v9, s[12:15], s31 offen lds
    v_mfma_f32_32x32x16_bf16 v[192:207], v[72:75], v[80:83], v[192:207]
    v_mfma_f32_32x32x16_bf16 v[208:223], v[72:75], v[84:87], v[208:223]
    s_add_u32 m0, s28, 34816
    s_nop 0
    buffer_load_dwordx4 v10, s[12:15], s31 offen lds
    v_mfma_f32_32x32x16_bf16 v[224:239], v[76:79], v[80:83], v[224:239]
    v_mfma_f32_32x32x16_bf16 v[240:255], v[76:79], v[84:87], v[240:255]
    s_add_u32 m0, s28, 35840
    s_nop 0
    buffer_load_dwordx4 v11, s[12:15], s31 offen lds
    ds_read_b128 v[64:67], v14 offset:0
    ds_read_b128 v[68:71], v14 offset:4096
    ds_read_b128 v[72:75], v14 offset:8192
    ds_read_b128 v[76:79], v14 offset:12288
    ds_read_b64_tr_b16 v[80:81], v16 offset:16384
    ds_read_b64_tr_b16 v[82:83], v16 offset:18432
    ds_read_b64_tr_b16 v[84:85], v17 offset:16384
    ds_read_b64_tr_b16 v[86:87], v17 offset:18432
    s_waitcnt lgkmcnt(8)
    v_mfma_f32_32x32x16_bf16 v[128:143], v[88:91], v[104:107], v[128:143]
    v_mfma_f32_32x32x16_bf16 v[144:159], v[88:91], v[108:111], v[144:159]
    v_mfma_f32_32x32x16_bf16 v[160:175], v[92:95], v[104:107], v[160:175]
    v_mfma_f32_32x32x16_bf16 v[176:191], v[92:95], v[108:111], v[176:191]
    v_mfma_f32_32x32x16_bf16 v[192:207], v[96:99], v[104:107], v[192:207]
    v_mfma_f32_32x32x16_bf16 v[208:223], v[96:99], v[108:111], v[208:223]
    v_mfma_f32_32x32x16_bf16 v[224:239], v[100:103], v[104:107], v[224:239]
    v_mfma_f32_32x32x16_bf16 v[240:255], v[100:103], v[108:111], v[240:255]
    ds_read_b128 v[88:91], v15 offset:0
    ds_read_b128 v[92:95], v15 offset:4096
    ds_read_b128 v[96:99], v15 offset:8192
    ds_read_b128 v[100:103], v15 offset:12288
    ds_read_b64_tr_b16 v[104:105], v16 offset:24576
    ds_read_b64_tr_b16 v[106:107], v16 offset:26624
    ds_read_b64_tr_b16 v[108:109], v17 offset:24576
    ds_read_b64_tr_b16 v[110:111], v17 offset:26624
    s_waitcnt lgkmcnt(8)
    v_mfma_f32_32x32x16_bf16 v[128:143], v[64:67], v[80:83], v[128:143]
    v_mfma_f32_32x32x16_bf16 v[144:159], v[64:67], v[84:87], v[144:159]
    v_mfma_f32_32x32x16_bf16 v[160:175], v[68:71], v[80:83], v[160:175]
    v_mfma_f32_32x32x16_bf16 v[176:191], v[68:71], v[84:87], v[176:191]
    v_mfma_f32_32x32x16_bf16 v[192:207], v[72:75], v[80:83], v[192:207]
    v_mfma_f32_32x32x16_bf16 v[208:223], v[72:75], v[84:87], v[208:223]
    v_mfma_f32_32x32x16_bf16 v[224:239], v[76:79], v[80:83], v[224:239]
    v_mfma_f32_32x32x16_bf16 v[240:255], v[76:79], v[84:87], v[240:255]
    s_waitcnt vmcnt(0) lgkmcnt(0)
    s_barrier
    ds_read_b128 v[64:67], v12 offset:32768
    ds_read_b128 v[68:71], v12 offset:36864
    ds_read_b128 v[72:75], v12 offset:40960
    ds_read_b128 v[76:79], v12 offset:45056
    ds_read_b64_tr_b16 v[80:81], v16 offset:32768
    ds_read_b64_tr_b16 v[82:83], v16 offset:34816
    ds_read_b64_tr_b16 v[84:85], v17 offset:32768
    ds_read_b64_tr_b16 v[86:87], v17 offset:34816
    s_add_u32 s30, s29, 6
    s_and_b32 s30, s30, 7
    s_lshl_b32 s30, s30, 7
    s_add_u32 s30, s30, s56
    v_mfma_f32_32x32x16_bf16 v[128:143], v[88:91], v[104:107], v[128:143]
    v_mfma_f32_32x32x16_bf16 v[144:159], v[88:91], v[108:111], v[144:159]
    s_add_u32 m0, s27, 0
    s_nop 0
    buffer_load_dwordx4 v4, s[8:11], s30 offen lds
    v_mfma_f32_32x32x16_bf16 v[160:175], v[92:95], v[104:107], v[160:175]
    v_mfma_f32_32x32x16_bf16 v[176:191], v[92:95], v[108:111], v[176:191]
    s_add_u32 m0, s27, 1024
    s_nop 0
    buffer_load_dwordx4 v5, s[8:11], s30 offen lds
    v_mfma_f32_32x32x16_bf16 v[192:207], v[96:99], v[104:107], v[192:207]
    v_mfma_f32_32x32x16_bf16 v[208:223], v[96:99], v[108:111], v[208:223]
    s_add_u32 m0, s27, 2048
    s_nop 0
    buffer_load_dwordx4 v6, s[8:11], s30 offen lds
    v_mfma_f32_32x32x16_bf16 v[224:239], v[100:103], v[104:107], v[224:239]
    v_mfma_f32_32x32x16_bf16 v[240:255], v[100:103], v[108:111], v[240:255]
    s_add_u32 m0, s27, 3072
    s_nop 0
    buffer_load_dwordx4 v7, s[8:11], s30 offen lds
    ds_read_b128 v[88:91], v13 offset:32768
    ds_read_b128 v[92:95], v13 offset:36864
    ds_read_b128 v[96:99], v13 offset:40960
    ds_read_b128 v[100:103], v13 offset:45056
    ds_read_b64_tr_b16 v[104:105], v16 offset:40960
    ds_read_b64_tr_b16 v[106:107], v16 offset:43008
    ds_read_b64_tr_b16 v[108:109], v17 offset:40960
    ds_read_b64_tr_b16 v[110:111], v17 offset:43008
    s_waitcnt lgkmcnt(8)
    s_add_u32 s31, s29, 6
    s_and_b32 s31, s31, 7
    s_mul_i32 s31, s25, s31
    v_mfma_f32_32x32x16_bf16 v[128:143], v[64:67], v[80:83], v[128:143]
    v_mfma_f32_32x32x16_bf16 v[144:159], v[64:67], v[84:87], v[144:159]
    s_add_u32 m0, s28, 0
    s_nop 0
    buffer_load_dwordx4 v8, s[12:15], s31 offen lds
    v_mfma_f32_32x32x16_bf16 v[160:175], v[68:71], v[80:83], v[160:175]
    v_mfma_f32_32x32x16_bf16 v[176:191], v[68:71], v[84:87], v[176:191]
    s_add_u32 m0, s28, 1024
    s_nop 0
    buffer_load_dwordx4 v9, s[12:15], s31 offen lds
    v_mfma_f32_32x32x16_bf16 v[192:207], v[72:75], v[80:83], v[192:207]
    v_mfma_f32_32x32x16_bf16 v[208:223], v[72:75], v[84:87], v[208:223]
    s_add_u32 m0, s28, 2048
    s_nop 0
    buffer_load_dwordx4 v10, s[12:15], s31 offen lds
    v_mfma_f32_32x32x16_bf16 v[224:239], v[76:79], v[80:83], v[224:239]
    v_mfma_f32_32x32x16_bf16 v[240:255], v[76:79], v[84:87], v[240:255]
    s_add_u32 m0, s28, 3072
    s_nop 0
    buffer_load_dwordx4 v11, s[12:15], s31 offen lds
    ds_read_b128 v[64:67], v14 offset:32768
    ds_read_b128 v[68:71], v14 offset:36864
    ds_read_b128 v[72:75], v14 offset:40960
    ds_read_b128 v[76:79], v14 offset:45056
    ds_read_b64_tr_b16 v[80:81], v16 offset:49152
    ds_read_b64_tr_b16 v[82:83], v16 offset:51200
    ds_read_b64_tr_b16 v[84:85], v17 offset:49152
    ds_read_b64_tr_b16 v[86:87], v17 offset:51200
    s_waitcnt lgkmcnt(8)
    v_mfma_f32_32x32x16_bf16 v[128:143], v[88:91], v[104:107], v[128:143]
    v_mfma_f32_32x32x16_bf16 v[144:159], v[88:91], v[108:111], v[144:159]
    v_mfma_f32_32x32x16_bf16 v[160:175], v[92:95], v[104:107], v[160:175]
    v_mfma_f32_32x32x16_bf16 v[176:191], v[92:95], v[108:111], v[176:191]
    v_mfma_f32_32x32x16_bf16 v[192:207], v[96:99], v[104:107], v[192:207]
    v_mfma_f32_32x32x16_bf16 v[208:223], v[96:99], v[108:111], v[208:223]
    v_mfma_f32_32x32x16_bf16 v[224:239], v[100:103], v[104:107], v[224:239]
    v_mfma_f32_32x32x16_bf16 v[240:255], v[100:103], v[108:111], v[240:255]
    ds_read_b128 v[88:91], v15 offset:32768
    ds_read_b128 v[92:95], v15 offset:36864
    ds_read_b128 v[96:99], v15 offset:40960
    ds_read_b128 v[100:103], v15 offset:45056
    ds_read_b64_tr_b16 v[104:105], v16 offset:57344
    ds_read_b64_tr_b16 v[106:107], v16 offset:59392
    ds_read_b64_tr_b16 v[108:109], v17 offset:57344
    ds_read_b64_tr_b16 v[110:111], v17 offset:59392
    s_waitcnt lgkmcnt(8)
    v_mfma_f32_32x32x16_bf16 v[128:143], v[64:67], v[80:83], v[128:143]
    v_mfma_f32_32x32x16_bf16 v[144:159], v[64:67], v[84:87], v[144:159]
    v_mfma_f32_32x32x16_bf16 v[160:175], v[68:71], v[80:83], v[160:175]
    v_mfma_f32_32x32x16_bf16 v[176:191], v[68:71], v[84:87], v[176:191]
    v_mfma_f32_32x32x16_bf16 v[192:207], v[72:75], v[80:83], v[192:207]
    v_mfma_f32_32x32x16_bf16 v[208:223], v[72:75], v[84:87], v[208:223]
    v_mfma_f32_32x32x16_bf16 v[224:239], v[76:79], v[80:83], v[224:239]
    v_mfma_f32_32x32x16_bf16 v[240:255], v[76:79], v[84:87], v[240:255]
    s_waitcnt vmcnt(0) lgkmcnt(0)
    s_barrier
    ds_read_b128 v[64:67], v12 offset:0
    ds_read_b128 v[68:71], v12 offset:4096
    ds_read_b128 v[72:75], v12 offset:8192
    ds_read_b128 v[76:79], v12 offset:12288
    ds_read_b64_tr_b16 v[80:81], v16 offset:0
    ds_read_b64_tr_b16 v[82:83], v16 offset:2048
    ds_read_b64_tr_b16 v[84:85], v17 offset:0
    ds_read_b64_tr_b16 v[86:87], v17 offset:2048
    s_add_u32 s30, s29, 7
    s_and_b32 s30, s30, 7
    s_lshl_b32 s30, s30, 7
    s_add_u32 s30, s30, s56
    v_mfma_f32_32x32x16_bf16 v[128:143], v[88:91], v[104:107], v[128:143]
    v_mfma_f32_32x32x16_bf16 v[144:159], v[88:91], v[108:111], v[144:159]
    s_add_u32 m0, s27, 32768
    s_nop 0
    buffer_load_dwordx4 v4, s[8:11], s30 offen lds
    v_mfma_f32_32x32x16_bf16 v[160:175], v[92:95], v[104:107], v[160:175]
    v_mfma_f32_32x32x16_bf16 v[176:191], v[92:95], v[108:111], v[176:191]
    s_add_u32 m0, s27, 33792
    s_nop 0
    buffer_load_dwordx4 v5, s[8:11], s30 offen lds
    v_mfma_f32_32x32x16_bf16 v[192:207], v[96:99], v[104:107], v[192:207]
    v_mfma_f32_32x32x16_bf16 v[208:223], v[96:99], v[108:111], v[208:223]
    s_add_u32 m0, s27, 34816
    s_nop 0
    buffer_load_dwordx4 v6, s[8:11], s30 offen lds
    v_mfma_f32_32x32x16_bf16 v[224:239], v[100:103], v[104:107], v[224:239]
    v_mfma_f32_32x32x16_bf16 v[240:255], v[100:103], v[108:111], v[240:255]
    s_add_u32 m0, s27, 35840
    s_nop 0
    buffer_load_dwordx4 v7, s[8:11], s30 offen lds
    ds_read_b128 v[88:91], v13 offset:0
    ds_read_b128 v[92:95], v13 offset:4096
    ds_read_b128 v[96:99], v13 offset:8192
    ds_read_b128 v[100:103], v13 offset:12288
    ds_read_b64_tr_b16 v[104:105], v16 offset:8192
    ds_read_b64_tr_b16 v[106:107], v16 offset:10240
    ds_read_b64_tr_b16 v[108:109], v17 offset:8192
    ds_read_b64_tr_b16 v[110:111], v17 offset:10240
    s_waitcnt lgkmcnt(8)
    s_add_u32 s31, s29, 7
    s_and_b32 s31, s31, 7
    s_mul_i32 s31, s25, s31
    v_mfma_f32_32x32x16_bf16 v[128:143], v[64:67], v[80:83], v[128:143]
    v_mfma_f32_32x32x16_bf16 v[144:159], v[64:67], v[84:87], v[144:159]
    s_add_u32 m0, s28, 32768
    s_nop 0
    buffer_load_dwordx4 v8, s[12:15], s31 offen lds
    v_mfma_f32_32x32x16_bf16 v[160:175], v[68:71], v[80:83], v[160:175]
    v_mfma_f32_32x32x16_bf16 v[176:191], v[68:71], v[84:87], v[176:191]
    s_add_u32 m0, s28, 33792
    s_nop 0
    buffer_load_dwordx4 v9, s[12:15], s31 offen lds
    v_mfma_f32_32x32x16_bf16 v[192:207], v[72:75], v[80:83], v[192:207]
    v_mfma_f32_32x32x16_bf16 v[208:223], v[72:75], v[84:87], v[208:223]
    s_add_u32 m0, s28, 34816
    s_nop 0
    buffer_load_dwordx4 v10, s[12:15], s31 offen lds
    v_mfma_f32_32x32x16_bf16 v[224:239], v[76:79], v[80:83], v[224:239]
    v_mfma_f32_32x32x16_bf16 v[240:255], v[76:79], v[84:87], v[240:255]
    s_add_u32 m0, s28, 35840
    s_nop 0
    buffer_load_dwordx4 v11, s[12:15], s31 offen lds
    ds_read_b128 v[64:67], v14 offset:0
    ds_read_b128 v[68:71], v14 offset:4096
    ds_read_b128 v[72:75], v14 offset:8192
    ds_read_b128 v[76:79], v14 offset:12288
    ds_read_b64_tr_b16 v[80:81], v16 offset:16384
    ds_read_b64_tr_b16 v[82:83], v16 offset:18432
    ds_read_b64_tr_b16 v[84:85], v17 offset:16384
    ds_read_b64_tr_b16 v[86:87], v17 offset:18432
    s_waitcnt lgkmcnt(8)
    v_mfma_f32_32x32x16_bf16 v[128:143], v[88:91], v[104:107], v[128:143]
    v_mfma_f32_32x32x16_bf16 v[144:159], v[88:91], v[108:111], v[144:159]
    v_mfma_f32_32x32x16_bf16 v[160:175], v[92:95], v[104:107], v[160:175]
    v_mfma_f32_32x32x16_bf16 v[176:191], v[92:95], v[108:111], v[176:191]
    v_mfma_f32_32x32x16_bf16 v[192:207], v[96:99], v[104:107], v[192:207]
    v_mfma_f32_32x32x16_bf16 v[208:223], v[96:99], v[108:111], v[208:223]
    v_mfma_f32_32x32x16_bf16 v[224:239], v[100:103], v[104:107], v[224:239]
    v_mfma_f32_32x32x16_bf16 v[240:255], v[100:103], v[108:111], v[240:255]
    ds_read_b128 v[88:91], v15 offset:0
    ds_read_b128 v[92:95], v15 offset:4096
    ds_read_b128 v[96:99], v15 offset:8192
    ds_read_b128 v[100:103], v15 offset:12288
    ds_read_b64_tr_b16 v[104:105], v16 offset:24576
    ds_read_b64_tr_b16 v[106:107], v16 offset:26624
    ds_read_b64_tr_b16 v[108:109], v17 offset:24576
    ds_read_b64_tr_b16 v[110:111], v17 offset:26624
    s_waitcnt lgkmcnt(8)
    v_mfma_f32_32x32x16_bf16 v[128:143], v[64:67], v[80:83], v[128:143]
    v_mfma_f32_32x32x16_bf16 v[144:159], v[64:67], v[84:87], v[144:159]
    v_mfma_f32_32x32x16_bf16 v[160:175], v[68:71], v[80:83], v[160:175]
    v_mfma_f32_32x32x16_bf16 v[176:191], v[68:71], v[84:87], v[176:191]
    v_mfma_f32_32x32x16_bf16 v[192:207], v[72:75], v[80:83], v[192:207]
    v_mfma_f32_32x32x16_bf16 v[208:223], v[72:75], v[84:87], v[208:223]
    v_mfma_f32_32x32x16_bf16 v[224:239], v[76:79], v[80:83], v[224:239]
    v_mfma_f32_32x32x16_bf16 v[240:255], v[76:79], v[84:87], v[240:255]
    s_waitcnt vmcnt(0) lgkmcnt(0)
    s_barrier
    ds_read_b128 v[64:67], v12 offset:32768
    ds_read_b128 v[68:71], v12 offset:36864
    ds_read_b128 v[72:75], v12 offset:40960
    ds_read_b128 v[76:79], v12 offset:45056
    ds_read_b64_tr_b16 v[80:81], v16 offset:32768
    ds_read_b64_tr_b16 v[82:83], v16 offset:34816
    ds_read_b64_tr_b16 v[84:85], v17 offset:32768
    ds_read_b64_tr_b16 v[86:87], v17 offset:34816
    s_add_u32 s30, s29, 0
    s_and_b32 s30, s30, 7
    s_lshl_b32 s30, s30, 7
    s_add_u32 s30, s30, s57
    v_mfma_f32_32x32x16_bf16 v[128:143], v[88:91], v[104:107], v[128:143]
    v_mfma_f32_32x32x16_bf16 v[144:159], v[88:91], v[108:111], v[144:159]
    s_cbranch_vccz K1_SKN6_0
    s_add_u32 m0, s27, 0
    s_nop 0
    buffer_load_dwordx4 v4, s[8:11], s30 offen lds
K1_SKN6_0:
    v_mfma_f32_32x32x16_bf16 v[160:175], v[92:95], v[104:107], v[160:175]
    v_mfma_f32_32x32x16_bf16 v[176:191], v[92:95], v[108:111], v[176:191]
    s_cbranch_vccz K1_SKN6_1
    s_add_u32 m0, s27, 1024
    s_nop 0
    buffer_load_dwordx4 v5, s[8:11], s30 offen lds
K1_SKN6_1:
    v_mfma_f32_32x32x16_bf16 v[192:207], v[96:99], v[104:107], v[192:207]
    v_mfma_f32_32x32x16_bf16 v[208:223], v[96:99], v[108:111], v[208:223]
    s_cbranch_vccz K1_SKN6_2
    s_add_u32 m0, s27, 2048
    s_nop 0
    buffer_load_dwordx4 v6, s[8:11], s30 offen lds
K1_SKN6_2:
    v_mfma_f32_32x32x16_bf16 v[224:239], v[100:103], v[104:107], v[224:239]
    v_mfma_f32_32x32x16_bf16 v[240:255], v[100:103], v[108:111], v[240:255]
    s_cbranch_vccz K1_SKN6_3
    s_add_u32 m0, s27, 3072
    s_nop 0
    buffer_load_dwordx4 v7, s[8:11], s30 offen lds
K1_SKN6_3:
    ds_read_b128 v[88:91], v13 offset:32768
    ds_read_b128 v[92:95], v13 offset:36864
    ds_read_b128 v[96:99], v13 offset:40960
    ds_read_b128 v[100:103], v13 offset:45056
    ds_read_b64_tr_b16 v[104:105], v16 offset:40960
    ds_read_b64_tr_b16 v[106:107], v16 offset:43008
    ds_read_b64_tr_b16 v[108:109], v17 offset:40960
    ds_read_b64_tr_b16 v[110:111], v17 offset:43008
    s_waitcnt lgkmcnt(8)
    s_add_u32 s31, s29, 0
    s_and_b32 s31, s31, 7
    s_mul_i32 s31, s25, s31
    v_mfma_f32_32x32x16_bf16 v[128:143], v[64:67], v[80:83], v[128:143]
    v_mfma_f32_32x32x16_bf16 v[144:159], v[64:67], v[84:87], v[144:159]
    s_cbranch_vccz K1_SKN7_4
    s_add_u32 m0, s28, 0
    s_nop 0
    buffer_load_dwordx4 v8, s[12:15], s31 offen lds
K1_SKN7_4:
    v_mfma_f32_32x32x16_bf16 v[160:175], v[68:71], v[80:83], v[160:175]
    v_mfma_f32_32x32x16_bf16 v[176:191], v[68:71], v[84:87], v[176:191]
    s_cbranch_vccz K1_SKN7_5
    s_add_u32 m0, s28, 1024
    s_nop 0
    buffer_load_dwordx4 v9, s[12:15], s31 offen lds
K1_SKN7_5:
    v_mfma_f32_32x32x16_bf16 v[192:207], v[72:75], v[80:83], v[192:207]
    v_mfma_f32_32x32x16_bf16 v[208:223], v[72:75], v[84:87], v[208:223]
    s_cbranch_vccz K1_SKN7_6
    s_add_u32 m0, s28, 2048
    s_nop 0
    buffer_load_dwordx4 v10, s[12:15], s31 offen lds
K1_SKN7_6:
    v_mfma_f32_32x32x16_bf16 v[224:239], v[76:79], v[80:83], v[224:239]
    v_mfma_f32_32x32x16_bf16 v[240:255], v[76:79], v[84:87], v[240:255]
    s_cbranch_vccz K1_SKN7_7
    s_add_u32 m0, s28, 3072
    s_nop 0
    buffer_load_dwordx4 v11, s[12:15], s31 offen lds
K1_SKN7_7:
    ds_read_b128 v[64:67], v14 offset:32768
    ds_read_b128 v[68:71], v14 offset:36864
    ds_read_b128 v[72:75], v14 offset:40960
    ds_read_b128 v[76:79], v14 offset:45056
    ds_read_b64_tr_b16 v[80:81], v16 offset:49152
    ds_read_b64_tr_b16 v[82:83], v16 offset:51200
    ds_read_b64_tr_b16 v[84:85], v17 offset:49152
    ds_read_b64_tr_b16 v[86:87], v17 offset:51200
    s_waitcnt lgkmcnt(8)
    v_mfma_f32_32x32x16_bf16 v[128:143], v[88:91], v[104:107], v[128:143]
    v_mfma_f32_32x32x16_bf16 v[144:159], v[88:91], v[108:111], v[144:159]
    v_mfma_f32_32x32x16_bf16 v[160:175], v[92:95], v[104:107], v[160:175]
    v_mfma_f32_32x32x16_bf16 v[176:191], v[92:95], v[108:111], v[176:191]
    v_mfma_f32_32x32x16_bf16 v[192:207], v[96:99], v[104:107], v[192:207]
    v_mfma_f32_32x32x16_bf16 v[208:223], v[96:99], v[108:111], v[208:223]
    v_mfma_f32_32x32x16_bf16 v[224:239], v[100:103], v[104:107], v[224:239]
    v_mfma_f32_32x32x16_bf16 v[240:255], v[100:103], v[108:111], v[240:255]
    ds_read_b128 v[88:91], v15 offset:32768
    ds_read_b128 v[92:95], v15 offset:36864
    ds_read_b128 v[96:99], v15 offset:40960
    ds_read_b128 v[100:103], v15 offset:45056
    ds_read_b64_tr_b16 v[104:105], v16 offset:57344
    ds_read_b64_tr_b16 v[106:107], v16 offset:59392
    ds_read_b64_tr_b16 v[108:109], v17 offset:57344
    ds_read_b64_tr_b16 v[110:111], v17 offset:59392
    s_waitcnt lgkmcnt(8)
    v_mfma_f32_32x32x16_bf16 v[128:143], v[64:67], v[80:83], v[128:143]
    v_mfma_f32_32x32x16_bf16 v[144:159], v[64:67], v[84:87], v[144:159]
    v_mfma_f32_32x32x16_bf16 v[160:175], v[68:71], v[80:83], v[160:175]
    v_mfma_f32_32x32x16_bf16 v[176:191], v[68:71], v[84:87], v[176:191]
    v_mfma_f32_32x32x16_bf16 v[192:207], v[72:75], v[80:83], v[192:207]
    v_mfma_f32_32x32x16_bf16 v[208:223], v[72:75], v[84:87], v[208:223]
    v_mfma_f32_32x32x16_bf16 v[224:239], v[76:79], v[80:83], v[224:239]
    v_mfma_f32_32x32x16_bf16 v[240:255], v[76:79], v[84:87], v[240:255]
    s_waitcnt vmcnt(0) lgkmcnt(0)
    s_barrier
    ds_read_b128 v[64:67], v12 offset:0
    ds_read_b128 v[68:71], v12 offset:4096
    ds_read_b128 v[72:75], v12 offset:8192
    ds_read_b128 v[76:79], v12 offset:12288
    ds_read_b64_tr_b16 v[80:81], v16 offset:0
    ds_read_b64_tr_b16 v[82:83], v16 offset:2048
    ds_read_b64_tr_b16 v[84:85], v17 offset:0
    ds_read_b64_tr_b16 v[86:87], v17 offset:2048
    s_add_u32 s30, s29, 1
    s_and_b32 s30, s30, 7
    s_lshl_b32 s30, s30, 7
    s_add_u32 s30, s30, s57
    v_mfma_f32_32x32x16_bf16 v[128:143], v[88:91], v[104:107], v[128:143]
    v_mfma_f32_32x32x16_bf16 v[144:159], v[88:91], v[108:111], v[144:159]
    s_cbranch_vccz K1_SKN7_0
    s_add_u32 m0, s27, 32768
    s_nop 0
    buffer_load_dwordx4 v4, s[8:11], s30 offen lds
K1_SKN7_0:
    v_mfma_f32_32x32x16_bf16 v[160:175], v[92:95], v[104:107], v[160:175]
    v_mfma_f32_32x32x16_bf16 v[176:191], v[92:95], v[108:111], v[176:191]
    s_cbranch_vccz K1_SKN7_1
    s_add_u32 m0, s27, 33792
    s_nop 0
    buffer_load_dwordx4 v5, s[8:11], s30 offen lds
K1_SKN7_1:
    v_mfma_f32_32x32x16_bf16 v[192:207], v[96:99], v[104:107], v[192:207]
    v_mfma_f32_32x32x16_bf16 v[208:223], v[96:99], v[108:111], v[208:223]
    s_cbranch_vccz K1_SKN7_2
    s_add_u32 m0, s27, 34816
    s_nop 0
    buffer_load_dwordx4 v6, s[8:11], s30 offen lds
K1_SKN7_2:
    v_mfma_f32_32x32x16_bf16 v[224:239], v[100:103], v[104:107], v[224:239]
    v_mfma_f32_32x32x16_bf16 v[240:255], v[100:103], v[108:111], v[240:255]
    s_cbranch_vccz K1_SKN7_3
    s_add_u32 m0, s27, 35840
    s_nop 0
    buffer_load_dwordx4 v7, s[8:11], s30 offen lds
K1_SKN7_3:
K1_EPI:
    s_nop 15
    s_cmp_eq_u32 s21, 1
    s_cbranch_scc1 K1_EPIB
    s_lshr_b32 s30, s20, 1
    s_and_b32 s31, s20, 1
    s_lshr_b32 s32, s30, 1
    s_lshl_b32 s33, s23, 1
    s_add_u32 s32, s32, s33
    s_mul_i32 s35, s32, 16384
    s_cmp_eq_u32 s24, 1
    s_mov_b32 s33, 117440512
    s_cselect_b32 s33, 100663296, s33
    s_add_u32 s35, s35, s33
    s_cmp_eq_u32 s24, 0
    s_cselect_b32 s35, 0, s35
    s_lshl_b32 s32, s32, 6
    s_lshl_b32 s33, s22, 3
    s_add_u32 s32, s32, s33
    s_lshl_b32 s33, s31, 2
    s_add_u32 s32, s32, s33
    s_lshl_b32 s32, s32, 13
    s_lshl_b32 s33, s24, 24
    s_add_u32 s32, s32, s33
    s_add_u32 s32, s32, s35
    s_and_b32 s30, s30, 1
    s_cmp_eq_u32 s26, 1
    s_cbranch_scc1 K1_EPIV
    s_cmp_lg_u32 s24, 0
    s_cbranch_scc1 K1_NOSCALE
    s_mov_b32 s35, 0x3e0293ee
    v_mul_f32 v128, s35, v128
    v_mul_f32 v129, s35, v129
    v_mul_f32 v130, s35, v130
    v_mul_f32 v131, s35, v131
    v_mul_f32 v132, s35, v132
    v_mul_f32 v133, s35, v133
    v_mul_f32 v134, s35, v134
    v_mul_f32 v135, s35, v135
    v_mul_f32 v136, s35, v136
    v_mul_f32 v137, s35, v137
    v_mul_f32 v138, s35, v138
    v_mul_f32 v139, s35, v139
    v_mul_f32 v140, s35, v140
    v_mul_f32 v141, s35, v141
    v_mul_f32 v142, s35, v142
    v_mul_f32 v143, s35, v143
    v_mul_f32 v144, s35, v144
    v_mul_f32 v145, s35, v145
    v_mul_f32 v146, s35, v146
    v_mul_f32 v147, s35, v147
    v_mul_f32 v148, s35, v148
    v_mul_f32 v149, s35, v149
    v_mul_f32 v150, s35, v150
    v_mul_f32 v151, s35, v151
    v_mul_f32 v152, s35, v152
    v_mul_f32 v153, s35, v153
    v_mul_f32 v154, s35, v154
    v_mul_f32 v155, s35, v155
    v_mul_f32 v156, s35, v156
    v_mul_f32 v157, s35, v157
    v_mul_f32 v158, s35, v158
    v_mul_f32 v159, s35, v159
    v_mul_f32 v160, s35, v160
    v_mul_f32 v161, s35, v161
    v_mul_f32 v162, s35, v162
    v_mul_f32 v163, s35, v163
    v_mul_f32 v164, s35, v164
    v_mul_f32 v165, s35, v165
    v_mul_f32 v166, s35, v166
    v_mul_f32 v167, s35, v167
    v_mul_f32 v168, s35, v168
    v_mul_f32 v169, s35, v169
    v_mul_f32 v170, s35, v170
    v_mul_f32 v171, s35, v171
    v_mul_f32 v172, s35, v172
    v_mul_f32 v173, s35, v173
    v_mul_f32 v174, s35, v174
    v_mul_f32 v175, s35, v175
    v_mul_f32 v176, s35, v176
    v_mul_f32 v177, s35, v177
    v_mul_f32 v178, s35, v178
    v_mul_f32 v179, s35, v179
    v_mul_f32 v180, s35, v180
    v_mul_f32 v181, s35, v181
    v_mul_f32 v182, s35, v182
    v_mul_f32 v183, s35, v183
    v_mul_f32 v184, s35, v184
    v_mul_f32 v185, s35, v185
    v_mul_f32 v186, s35, v186
    v_mul_f32 v187, s35, v187
    v_mul_f32 v188, s35, v188
    v_mul_f32 v189, s35, v189
    v_mul_f32 v190, s35, v190
    v_mul_f32 v191, s35, v191
    v_mul_f32 v192, s35, v192
    v_mul_f32 v193, s35, v193
    v_mul_f32 v194, s35, v194
    v_mul_f32 v195, s35, v195
    v_mul_f32 v196, s35, v196
    v_mul_f32 v197, s35, v197
    v_mul_f32 v198, s35, v198
    v_mul_f32 v199, s35, v199
    v_mul_f32 v200, s35, v200
    v_mul_f32 v201, s35, v201
    v_mul_f32 v202, s35, v202
    v_mul_f32 v203, s35, v203
    v_mul_f32 v204, s35, v204
    v_mul_f32 v205, s35, v205
    v_mul_f32 v206, s35, v206
    v_mul_f32 v207, s35, v207
    v_mul_f32 v208, s35, v208
    v_mul_f32 v209, s35, v209
    v_mul_f32 v210, s35, v210
    v_mul_f32 v211, s35, v211
    v_mul_f32 v212, s35, v212
    v_mul_f32 v213, s35, v213
    v_mul_f32 v214, s35, v214
    v_mul_f32 v215, s35, v215
    v_mul_f32 v216, s35, v216
    v_mul_f32 v217, s35, v217
    v_mul_f32 v218, s35, v218
    v_mul_f32 v219, s35, v219
    v_mul_f32 v220, s35, v220
    v_mul_f32 v221, s35, v221
    v_mul_f32 v222, s35, v222
    v_mul_f32 v223, s35, v223
    v_mul_f32 v224, s35, v224
    v_mul_f32 v225, s35, v225
    v_mul_f32 v226, s35, v226
    v_mul_f32 v227, s35, v227
    v_mul_f32 v228, s35, v228
    v_mul_f32 v229, s35, v229
    v_mul_f32 v230, s35, v230
    v_mul_f32 v231, s35, v231
    v_mul_f32 v232, s35, v232
    v_mul_f32 v233, s35, v233
    v_mul_f32 v234, s35, v234
    v_mul_f32 v235, s35, v235
    v_mul_f32 v236, s35, v236
    v_mul_f32 v237, s35, v237
    v_mul_f32 v238, s35, v238
    v_mul_f32 v239, s35, v239
    v_mul_f32 v240, s35, v240
    v_mul_f32 v241, s35, v241
    v_mul_f32 v242, s35, v242
    v_mul_f32 v243, s35, v243
    v_mul_f32 v244, s35, v244
    v_mul_f32 v245, s35, v245
    v_mul_f32 v246, s35, v246
    v_mul_f32 v247, s35, v247
    v_mul_f32 v248, s35, v248
    v_mul_f32 v249, s35, v249
    v_mul_f32 v250, s35, v250
    v_mul_f32 v251, s35, v251
    v_mul_f32 v252, s35, v252
    v_mul_f32 v253, s35, v253
    v_mul_f32 v254, s35, v254
    v_mul_f32 v255, s35, v255
K1_NOSCALE:
    s_lshl_b32 s33, s30, 12
    s_add_u32 s32, s32, s33
    v_cvt_pk_bf16_f32 v24, v128, v129
    v_cvt_pk_bf16_f32 v25, v130, v131
    v_cvt_pk_bf16_f32 v26, v132, v133
    v_cvt_pk_bf16_f32 v27, v134, v135
    s_add_u32 s34, s32, 0
    buffer_store_dwordx4 v[24:27], v18, s[16:19], s34 offen offset:0
    v_cvt_pk_bf16_f32 v28, v136, v137
    v_cvt_pk_bf16_f32 v29, v138, v139
    v_cvt_pk_bf16_f32 v30, v140, v141
    v_cvt_pk_bf16_f32 v31, v142, v143
    s_add_u32 s34, s32, 0
    buffer_store_dwordx4 v[28:31], v18, s[16:19], s34 offen offset:1024
    v_cvt_pk_bf16_f32 v32, v144, v145
    v_cvt_pk_bf16_f32 v33, v146, v147
    v_cvt_pk_bf16_f32 v34, v148, v149
    v_cvt_pk_bf16_f32 v35, v150, v151
    s_add_u32 s34, s32, 0
    buffer_store_dwordx4 v[32:35], v18, s[16:19], s34 offen offset:2048
    v_cvt_pk_bf16_f32 v36, v152, v153
    v_cvt_pk_bf16_f32 v37, v154, v155
    v_cvt_pk_bf16_f32 v38, v156, v157
    v_cvt_pk_bf16_f32 v39, v158, v159
    s_add_u32 s34, s32, 0
    buffer_store_dwordx4 v[36:39], v18, s[16:19], s34 offen offset:3072
    v_cvt_pk_bf16_f32 v40, v160, v161
    v_cvt_pk_bf16_f32 v41, v162, v163
    v_cvt_pk_bf16_f32 v42, v164, v165
    v_cvt_pk_bf16_f32 v43, v166, v167
    s_add_u32 s34, s32, 8192
    buffer_store_dwordx4 v[40:43], v18, s[16:19], s34 offen offset:0
    v_cvt_pk_bf16_f32 v44, v168, v169
    v_cvt_pk_bf16_f32 v45, v170, v171
    v_cvt_pk_bf16_f32 v46, v172, v173
    v_cvt_pk_bf16_f32 v47, v174, v175
    s_add_u32 s34, s32, 8192
    buffer_store_dwordx4 v[44:47], v18, s[16:19], s34 offen offset:1024
    v_cvt_pk_bf16_f32 v48, v176, v177
    v_cvt_pk_bf16_f32 v49, v178, v179
    v_cvt_pk_bf16_f32 v50, v180, v181
    v_cvt_pk_bf16_f32 v51, v182, v183
    s_add_u32 s34, s32, 8192
    buffer_store_dwordx4 v[48:51], v18, s[16:19], s34 offen offset:2048
    v_cvt_pk_bf16_f32 v52, v184, v185
    v_cvt_pk_bf16_f32 v53, v186, v187
    v_cvt_pk_bf16_f32 v54, v188, v189
    v_cvt_pk_bf16_f32 v55, v190, v191
    s_add_u32 s34, s32, 8192
    buffer_store_dwordx4 v[52:55], v18, s[16:19], s34 offen offset:3072
    v_cvt_pk_bf16_f32 v24, v192, v193
    v_cvt_pk_bf16_f32 v25, v194, v195
    v_cvt_pk_bf16_f32 v26, v196, v197
    v_cvt_pk_bf16_f32 v27, v198, v199
    s_add_u32 s34, s32, 16384
    buffer_store_dwordx4 v[24:27], v18, s[16:19], s34 offen offset:0
    v_cvt_pk_bf16_f32 v28, v200, v201
    v_cvt_pk_bf16_f32 v29, v202, v203
    v_cvt_pk_bf16_f32 v30, v204, v205
    v_cvt_pk_bf16_f32 v31, v206, v207
    s_add_u32 s34, s32, 16384
    buffer_store_dwordx4 v[28:31], v18, s[16:19], s34 offen offset:1024
    v_cvt_pk_bf16_f32 v32, v208, v209
    v_cvt_pk_bf16_f32 v33, v210, v211
    v_cvt_pk_bf16_f32 v34, v212, v213
    v_cvt_pk_bf16_f32 v35, v214, v215
    s_add_u32 s34, s32, 16384
    buffer_store_dwordx4 v[32:35], v18, s[16:19], s34 offen offset:2048
    v_cvt_pk_bf16_f32 v36, v216, v217
    v_cvt_pk_bf16_f32 v37, v218, v219
    v_cvt_pk_bf16_f32 v38, v220, v221
    v_cvt_pk_bf16_f32 v39, v222, v223
    s_add_u32 s34, s32, 16384
    buffer_store_dwordx4 v[36:39], v18, s[16:19], s34 offen offset:3072
    v_cvt_pk_bf16_f32 v40, v224, v225
    v_cvt_pk_bf16_f32 v41, v226, v227
    v_cvt_pk_bf16_f32 v42, v228, v229
    v_cvt_pk_bf16_f32 v43, v230, v231
    s_add_u32 s34, s32, 24576
    buffer_store_dwordx4 v[40:43], v18, s[16:19], s34 offen offset:0
    v_cvt_pk_bf16_f32 v44, v232, v233
    v_cvt_pk_bf16_f32 v45, v234, v235
    v_cvt_pk_bf16_f32 v46, v236, v237
    v_cvt_pk_bf16_f32 v47, v238, v239
    s_add_u32 s34, s32, 24576
    buffer_store_dwordx4 v[44:47], v18, s[16:19], s34 offen offset:1024
    v_cvt_pk_bf16_f32 v48, v240, v241
    v_cvt_pk_bf16_f32 v49, v242, v243
    v_cvt_pk_bf16_f32 v50, v244, v245
    v_cvt_pk_bf16_f32 v51, v246, v247
    s_add_u32 s34, s32, 24576
    buffer_store_dwordx4 v[48:51], v18, s[16:19], s34 offen offset:2048
    v_cvt_pk_bf16_f32 v52, v248, v249
    v_cvt_pk_bf16_f32 v53, v250, v251
    v_cvt_pk_bf16_f32 v54, v252, v253
    v_cvt_pk_bf16_f32 v55, v254, v255
    s_add_u32 s34, s32, 24576
    buffer_store_dwordx4 v[52:55], v18, s[16:19], s34 offen offset:3072
    s_cbranch_vccz K1_FIN
    s_add_u32 s22, s22, 4
    s_mov_b32 s56, s57
    s_mov_b64 vcc, 0
    s_branch K1_AGAIN
K1_EPIV:
    s_lshl_b32 s33, s30, 11
    s_add_u32 s32, s32, s33
    v_cvt_pk_bf16_f32 v24, v128, v129
    v_cvt_pk_bf16_f32 v25, v130, v131
    v_cvt_pk_bf16_f32 v26, v132, v133
    v_cvt_pk_bf16_f32 v27, v134, v135
    s_add_u32 s34, s32, 0
    buffer_store_dwordx4 v[24:27], v18, s[16:19], s34 offen offset:0
    v_cvt_pk_bf16_f32 v28, v136, v137
    v_cvt_pk_bf16_f32 v29, v138, v139
    v_cvt_pk_bf16_f32 v30, v140, v141
    v_cvt_pk_bf16_f32 v31, v142, v143
    s_add_u32 s34, s32, 4096
    buffer_store_dwordx4 v[28:31], v18, s[16:19], s34 offen offset:0
    v_cvt_pk_bf16_f32 v32, v144, v145
    v_cvt_pk_bf16_f32 v33, v146, v147
    v_cvt_pk_bf16_f32 v34, v148, v149
    v_cvt_pk_bf16_f32 v35, v150, v151
    s_add_u32 s34, s32, 0
    buffer_store_dwordx4 v[32:35], v18, s[16:19], s34 offen offset:1024
    v_cvt_pk_bf16_f32 v36, v152, v153
    v_cvt_pk_bf16_f32 v37, v154, v155
    v_cvt_pk_bf16_f32 v38, v156, v157
    v_cvt_pk_bf16_f32 v39, v158, v159
    s_add_u32 s34, s32, 4096
    buffer_store_dwordx4 v[36:39], v18, s[16:19], s34 offen offset:1024
    v_cvt_pk_bf16_f32 v40, v160, v161
    v_cvt_pk_bf16_f32 v41, v162, v163
    v_cvt_pk_bf16_f32 v42, v164, v165
    v_cvt_pk_bf16_f32 v43, v166, v167
    s_add_u32 s34, s32, 8192
    buffer_store_dwordx4 v[40:43], v18, s[16:19], s34 offen offset:0
    v_cvt_pk_bf16_f32 v44, v168, v169
    v_cvt_pk_bf16_f32 v45, v170, v171
    v_cvt_pk_bf16_f32 v46, v172, v173
    v_cvt_pk_bf16_f32 v47, v174, v175
    s_add_u32 s34, s32, 12288
    buffer_store_dwordx4 v[44:47], v18, s[16:19], s34 offen offset:0
    v_cvt_pk_bf16_f32 v48, v176, v177
    v_cvt_pk_bf16_f32 v49, v178, v179
    v_cvt_pk_bf16_f32 v50, v180, v181
    v_cvt_pk_bf16_f32 v51, v182, v183
    s_add_u32 s34, s32, 8192
    buffer_store_dwordx4 v[48:51], v18, s[16:19], s34 offen offset:1024
    v_cvt_pk_bf16_f32 v52, v184, v185
    v_cvt_pk_bf16_f32 v53, v186, v187
    v_cvt_pk_bf16_f32 v54, v188, v189
    v_cvt_pk_bf16_f32 v55, v190, v191
    s_add_u32 s34, s32, 12288
    buffer_store_dwordx4 v[52:55], v18, s[16:19], s34 offen offset:1024
    v_cvt_pk_bf16_f32 v24, v192, v193
    v_cvt_pk_bf16_f32 v25, v194, v195
    v_cvt_pk_bf16_f32 v26, v196, v197
    v_cvt_pk_bf16_f32 v27, v198, v199
    s_add_u32 s34, s32, 16384
    buffer_store_dwordx4 v[24:27], v18, s[16:19], s34 offen offset:0
    v_cvt_pk_bf16_f32 v28, v200, v201
    v_cvt_pk_bf16_f32 v29, v202, v203
    v_cvt_pk_bf16_f32 v30, v204, v205
    v_cvt_pk_bf16_f32 v31, v206, v207
    s_add_u32 s34, s32, 20480
    buffer_store_dwordx4 v[28:31], v18, s[16:19], s34 offen offset:0
    v_cvt_pk_bf16_f32 v32, v208, v209
    v_cvt_pk_bf16_f32 v33, v210, v211
    v_cvt_pk_bf16_f32 v34, v212, v213
    v_cvt_pk_bf16_f32 v35, v214, v215
    s_add_u32 s34, s32, 16384
    buffer_store_dwordx4 v[32:35], v18, s[16:19], s34 offen offset:1024
    v_cvt_pk_bf16_f32 v36, v216, v217
    v_cvt_pk_bf16_f32 v37, v218, v219
    v_cvt_pk_bf16_f32 v38, v220, v221
    v_cvt_pk_bf16_f32 v39, v222, v223
    s_add_u32 s34, s32, 20480
    buffer_store_dwordx4 v[36:39], v18, s[16:19], s34 offen offset:1024
    v_cvt_pk_bf16_f32 v40, v224, v225
    v_cvt_pk_bf16_f32 v41, v226, v227
    v_cvt_pk_bf16_f32 v42, v228, v229
    v_cvt_pk_bf16_f32 v43, v230, v231
    s_add_u32 s34, s32, 24576
    buffer_store_dwordx4 v[40:43], v18, s[16:19], s34 offen offset:0
    v_cvt_pk_bf16_f32 v44, v232, v233
    v_cvt_pk_bf16_f32 v45, v234, v235
    v_cvt_pk_bf16_f32 v46, v236, v237
    v_cvt_pk_bf16_f32 v47, v238, v239
    s_add_u32 s34, s32, 28672
    buffer_store_dwordx4 v[44:47], v18, s[16:19], s34 offen offset:0
    v_cvt_pk_bf16_f32 v48, v240, v241
    v_cvt_pk_bf16_f32 v49, v242, v243
    v_cvt_pk_bf16_f32 v50, v244, v245
    v_cvt_pk_bf16_f32 v51, v246, v247
    s_add_u32 s34, s32, 24576
    buffer_store_dwordx4 v[48:51], v18, s[16:19], s34 offen offset:1024
    v_cvt_pk_bf16_f32 v52, v248, v249
    v_cvt_pk_bf16_f32 v53, v250, v251
    v_cvt_pk_bf16_f32 v54, v252, v253
    v_cvt_pk_bf16_f32 v55, v254, v255
    s_add_u32 s34, s32, 28672
    buffer_store_dwordx4 v[52:55], v18, s[16:19], s34 offen offset:1024
    s_cbranch_vccz K1_FIN
    s_add_u32 s22, s22, 4
    s_mov_b32 s56, s57
    s_mov_b64 vcc, 0
    s_branch K1_AGAIN
K1_FIN:
    s_endpgm
K1_EPIB:
    s_waitcnt lgkmcnt(0)
    s_barrier
    s_lshr_b32 s30, s20, 1
    s_and_b32 s31, s20, 1
    s_mov_b32 s33, 0x3fb8aa3b
    s_cmp_eq_u32 s30, 1
    s_cbranch_scc1 K1_BV
    s_cmp_eq_u32 s30, 2
    s_cbranch_scc1 K1_BGATE
    v_lshrrev_b32 v20, 5, v19
    v_lshlrev_b32 v20, 7, v20
    v_and_b32 v21, 15, v19
    v_lshl_add_u32 v20, v21, 1, v20
    v_bfe_u32 v21, v19, 4, 1
    v_mul_u32_u24 v21, 0x8000, v21
    v_lshl_or_b32 v21, v21, 16, v21
    v_and_b32 v22, 31, v19
    v_lshlrev_b32 v22, 6, v22
    v_lshrrev_b32 v23, 5, v19
    v_lshl_add_u32 v22, v23, 3, v22
    s_lshl_b32 s32, s31, 13
    v_add_u32 v22, s32, v22
    s_lshl_b32 s34, s23, 2
    s_add_u32 s34, s34, 0
    v_lshl_or_b32 v60, v29, 16, v28
    v_xor_b32 v60, v60, v21
    v_lshl_or_b32 v61, v31, 16, v30
    v_xor_b32 v61, v61, v21
    v_lshl_or_b32 v62, v33, 16, v32
    v_xor_b32 v62, v62, v21
    v_lshl_or_b32 v63, v35, 16, v34
    v_xor_b32 v63, v63, v21
    v_cvt_pk_bf16_f32 v88, v128, v129
    v_cvt_pk_bf16_f32 v89, v130, v131
    v_cvt_pk_bf16_f32 v90, v132, v133
    v_cvt_pk_bf16_f32 v91, v134, v135
    s_nop 1
    v_mfma_f32_32x32x16_bf16 v[64:79], v[60:63], v[88:91], 0
    s_nop 15
    v_cvt_pk_bf16_f32 v64, v64, v64
    v_lshlrev_b32 v64, 16, v64
    v_cvt_pk_bf16_f32 v65, v65, v65
    v_lshlrev_b32 v65, 16, v65
    v_cvt_pk_bf16_f32 v66, v66, v66
    v_lshlrev_b32 v66, 16, v66
    v_cvt_pk_bf16_f32 v67, v67, v67
    v_lshlrev_b32 v67, 16, v67
    v_cvt_pk_bf16_f32 v68, v68, v68
    v_lshlrev_b32 v68, 16, v68
    v_cvt_pk_bf16_f32 v69, v69, v69
    v_lshlrev_b32 v69, 16, v69
    v_cvt_pk_bf16_f32 v70, v70, v70
    v_lshlrev_b32 v70, 16, v70
    v_cvt_pk_bf16_f32 v71, v71, v71
    v_lshlrev_b32 v71, 16, v71
    v_cvt_pk_bf16_f32 v72, v72, v72
    v_lshlrev_b32 v72, 16, v72
    v_cvt_pk_bf16_f32 v73, v73, v73
    v_lshlrev_b32 v73, 16, v73
    v_cvt_pk_bf16_f32 v74, v74, v74
    v_lshlrev_b32 v74, 16, v74
    v_cvt_pk_bf16_f32 v75, v75, v75
    v_lshlrev_b32 v75, 16, v75
    v_cvt_pk_bf16_f32 v76, v76, v76
    v_lshlrev_b32 v76, 16, v76
    v_cvt_pk_bf16_f32 v77, v77, v77
    v_lshlrev_b32 v77, 16, v77
    v_cvt_pk_bf16_f32 v78, v78, v78
    v_lshlrev_b32 v78, 16, v78
    v_cvt_pk_bf16_f32 v79, v79, v79
    v_lshlrev_b32 v79, 16, v79
    v_max3_f32 v24, v64, v65, v66
    v_max3_f32 v24, v24, v67, v68
    v_max3_f32 v24, v24, v69, v70
    v_max_f32 v24, v24, v71
    v_mov_b32 v25, v24
    s_nop 1
    v_permlane32_swap_b32 v24, v25
    s_nop 1
    v_max_f32 v24, v24, v25
    v_sub_f32 v64, v64, v24
    v_sub_f32 v65, v65, v24
    v_sub_f32 v66, v66, v24
    v_sub_f32 v67, v67, v24
    v_sub_f32 v68, v68, v24
    v_sub_f32 v69, v69, v24
    v_sub_f32 v70, v70, v24
    v_sub_f32 v71, v71, v24
    v_mul_f32 v64, s33, v64
    v_mul_f32 v65, s33, v65
    v_mul_f32 v66, s33, v66
    v_mul_f32 v67, s33, v67
    v_mul_f32 v68, s33, v68
    v_mul_f32 v69, s33, v69
    v_mul_f32 v70, s33, v70
    v_mul_f32 v71, s33, v71
    v_exp_f32 v64, v64
    v_exp_f32 v65, v65
    v_exp_f32 v66, v66
    v_exp_f32 v67, v67
    v_exp_f32 v68, v68
    v_exp_f32 v69, v69
    v_exp_f32 v70, v70
    v_exp_f32 v71, v71
    s_nop 0
    v_add_f32 v24, v64, v65
    v_add_f32 v24, v24, v66
    v_add_f32 v24, v24, v67
    v_add_f32 v24, v24, v68
    v_add_f32 v24, v24, v69
    v_add_f32 v24, v24, v70
    v_add_f32 v24, v24, v71
    v_mov_b32 v25, v24
    s_nop 1
    v_permlane32_swap_b32 v24, v25
    s_nop 1
    v_add_f32 v24, v24, v25
    v_rcp_f32 v24, v24
    s_nop 0
    v_mul_f32 v64, v64, v24
    v_mul_f32 v65, v65, v24
    v_mul_f32 v66, v66, v24
    v_mul_f32 v67, v67, v24
    v_mul_f32 v68, v68, v24
    v_mul_f32 v69, v69, v24
    v_mul_f32 v70, v70, v24
    v_mul_f32 v71, v71, v24
    v_cvt_pk_bf16_f32 v80, v64, v65
    v_cvt_pk_bf16_f32 v81, v66, v67
    v_cvt_pk_bf16_f32 v82, v68, v69
    v_cvt_pk_bf16_f32 v83, v70, v71
    v_max3_f32 v24, v72, v73, v74
    v_max3_f32 v24, v24, v75, v76
    v_max3_f32 v24, v24, v77, v78
    v_max_f32 v24, v24, v79
    v_mov_b32 v25, v24
    s_nop 1
    v_permlane32_swap_b32 v24, v25
    s_nop 1
    v_max_f32 v24, v24, v25
    v_sub_f32 v72, v72, v24
    v_sub_f32 v73, v73, v24
    v_sub_f32 v74, v74, v24
    v_sub_f32 v75, v75, v24
    v_sub_f32 v76, v76, v24
    v_sub_f32 v77, v77, v24
    v_sub_f32 v78, v78, v24
    v_sub_f32 v79, v79, v24
    v_mul_f32 v72, s33, v72
    v_mul_f32 v73, s33, v73
    v_mul_f32 v74, s33, v74
    v_mul_f32 v75, s33, v75
    v_mul_f32 v76, s33, v76
    v_mul_f32 v77, s33, v77
    v_mul_f32 v78, s33, v78
    v_mul_f32 v79, s33, v79
    v_exp_f32 v72, v72
    v_exp_f32 v73, v73
    v_exp_f32 v74, v74
    v_exp_f32 v75, v75
    v_exp_f32 v76, v76
    v_exp_f32 v77, v77
    v_exp_f32 v78, v78
    v_exp_f32 v79, v79
    s_nop 0
    v_add_f32 v24, v72, v73
    v_add_f32 v24, v24, v74
    v_add_f32 v24, v24, v75
    v_add_f32 v24, v24, v76
    v_add_f32 v24, v24, v77
    v_add_f32 v24, v24, v78
    v_add_f32 v24, v24, v79
    v_mov_b32 v25, v24
    s_nop 1
    v_permlane32_swap_b32 v24, v25
    s_nop 1
    v_add_f32 v24, v24, v25
    v_rcp_f32 v24, v24
    s_nop 0
    v_mul_f32 v72, v72, v24
    v_mul_f32 v73, v73, v24
    v_mul_f32 v74, v74, v24
    v_mul_f32 v75, v75, v24
    v_mul_f32 v76, v76, v24
    v_mul_f32 v77, v77, v24
    v_mul_f32 v78, v78, v24
    v_mul_f32 v79, v79, v24
    v_cvt_pk_bf16_f32 v84, v72, v73
    v_cvt_pk_bf16_f32 v85, v74, v75
    v_cvt_pk_bf16_f32 v86, v76, v77
    v_cvt_pk_bf16_f32 v87, v78, v79
    s_cmp_eq_u32 s30, 3
    s_cbranch_scc1 K1_BQ0_0
    ds_write_b64 v22, v[80:81] offset:0
    ds_write_b64 v22, v[82:83] offset:16
    ds_write_b64 v22, v[84:85] offset:32
    ds_write_b64 v22, v[86:87] offset:48
    s_branch K1_BQD0_0
K1_BQ0_0:
    s_lshl_b32 s36, s34, 6
    s_lshl_b32 s37, s22, 3
    s_add_u32 s36, s36, s37
    s_lshl_b32 s37, s31, 2
    s_add_u32 s36, s36, s37
    s_add_u32 s36, s36, 0
    s_lshl_b32 s36, s36, 11
    s_add_u32 s36, s36, 67108864
    buffer_store_dwordx4 v[80:83], v18, s[16:19], s36 offen
    buffer_store_dwordx4 v[84:87], v18, s[16:19], s36 offen offset:1024
    s_nop 1
K1_BQD0_0:
    v_cvt_pk_bf16_f32 v88, v160, v161
    v_cvt_pk_bf16_f32 v89, v162, v163
    v_cvt_pk_bf16_f32 v90, v164, v165
    v_cvt_pk_bf16_f32 v91, v166, v167
    s_nop 1
    v_mfma_f32_32x32x16_bf16 v[64:79], v[60:63], v[88:91], 0
    s_nop 15
    v_cvt_pk_bf16_f32 v64, v64, v64
    v_lshlrev_b32 v64, 16, v64
    v_cvt_pk_bf16_f32 v65, v65, v65
    v_lshlrev_b32 v65, 16, v65
    v_cvt_pk_bf16_f32 v66, v66, v66
    v_lshlrev_b32 v66, 16, v66
    v_cvt_pk_bf16_f32 v67, v67, v67
    v_lshlrev_b32 v67, 16, v67
    v_cvt_pk_bf16_f32 v68, v68, v68
    v_lshlrev_b32 v68, 16, v68
    v_cvt_pk_bf16_f32 v69, v69, v69
    v_lshlrev_b32 v69, 16, v69
    v_cvt_pk_bf16_f32 v70, v70, v70
    v_lshlrev_b32 v70, 16, v70
    v_cvt_pk_bf16_f32 v71, v71, v71
    v_lshlrev_b32 v71, 16, v71
    v_cvt_pk_bf16_f32 v72, v72, v72
    v_lshlrev_b32 v72, 16, v72
    v_cvt_pk_bf16_f32 v73, v73, v73
    v_lshlrev_b32 v73, 16, v73
    v_cvt_pk_bf16_f32 v74, v74, v74
    v_lshlrev_b32 v74, 16, v74
    v_cvt_pk_bf16_f32 v75, v75, v75
    v_lshlrev_b32 v75, 16, v75
    v_cvt_pk_bf16_f32 v76, v76, v76
    v_lshlrev_b32 v76, 16, v76
    v_cvt_pk_bf16_f32 v77, v77, v77
    v_lshlrev_b32 v77, 16, v77
    v_cvt_pk_bf16_f32 v78, v78, v78
    v_lshlrev_b32 v78, 16, v78
    v_cvt_pk_bf16_f32 v79, v79, v79
    v_lshlrev_b32 v79, 16, v79
    v_max3_f32 v24, v64, v65, v66
    v_max3_f32 v24, v24, v67, v68
    v_max3_f32 v24, v24, v69, v70
    v_max_f32 v24, v24, v71
    v_mov_b32 v25, v24
    s_nop 1
    v_permlane32_swap_b32 v24, v25
    s_nop 1
    v_max_f32 v24, v24, v25
    v_sub_f32 v64, v64, v24
    v_sub_f32 v65, v65, v24
    v_sub_f32 v66, v66, v24
    v_sub_f32 v67, v67, v24
    v_sub_f32 v68, v68, v24
    v_sub_f32 v69, v69, v24
    v_sub_f32 v70, v70, v24
    v_sub_f32 v71, v71, v24
    v_mul_f32 v64, s33, v64
    v_mul_f32 v65, s33, v65
    v_mul_f32 v66, s33, v66
    v_mul_f32 v67, s33, v67
    v_mul_f32 v68, s33, v68
    v_mul_f32 v69, s33, v69
    v_mul_f32 v70, s33, v70
    v_mul_f32 v71, s33, v71
    v_exp_f32 v64, v64
    v_exp_f32 v65, v65
    v_exp_f32 v66, v66
    v_exp_f32 v67, v67
    v_exp_f32 v68, v68
    v_exp_f32 v69, v69
    v_exp_f32 v70, v70
    v_exp_f32 v71, v71
    s_nop 0
    v_add_f32 v24, v64, v65
    v_add_f32 v24, v24, v66
    v_add_f32 v24, v24, v67
    v_add_f32 v24, v24, v68
    v_add_f32 v24, v24, v69
    v_add_f32 v24, v24, v70
    v_add_f32 v24, v24, v71
    v_mov_b32 v25, v24
    s_nop 1
    v_permlane32_swap_b32 v24, v25
    s_nop 1
    v_add_f32 v24, v24, v25
    v_rcp_f32 v24, v24
    s_nop 0
    v_mul_f32 v64, v64, v24
    v_mul_f32 v65, v65, v24
    v_mul_f32 v66, v66, v24
    v_mul_f32 v67, v67, v24
    v_mul_f32 v68, v68, v24
    v_mul_f32 v69, v69, v24
    v_mul_f32 v70, v70, v24
    v_mul_f32 v71, v71, v24
    v_cvt_pk_bf16_f32 v80, v64, v65
    v_cvt_pk_bf16_f32 v81, v66, v67
    v_cvt_pk_bf16_f32 v82, v68, v69
    v_cvt_pk_bf16_f32 v83, v70, v71
    v_max3_f32 v24, v72, v73, v74
    v_max3_f32 v24, v24, v75, v76
    v_max3_f32 v24, v24, v77, v78
    v_max_f32 v24, v24, v79
    v_mov_b32 v25, v24
    s_nop 1
    v_permlane32_swap_b32 v24, v25
    s_nop 1
    v_max_f32 v24, v24, v25
    v_sub_f32 v72, v72, v24
    v_sub_f32 v73, v73, v24
    v_sub_f32 v74, v74, v24
    v_sub_f32 v75, v75, v24
    v_sub_f32 v76, v76, v24
    v_sub_f32 v77, v77, v24
    v_sub_f32 v78, v78, v24
    v_sub_f32 v79, v79, v24
    v_mul_f32 v72, s33, v72
    v_mul_f32 v73, s33, v73
    v_mul_f32 v74, s33, v74
    v_mul_f32 v75, s33, v75
    v_mul_f32 v76, s33, v76
    v_mul_f32 v77, s33, v77
    v_mul_f32 v78, s33, v78
    v_mul_f32 v79, s33, v79
    v_exp_f32 v72, v72
    v_exp_f32 v73, v73
    v_exp_f32 v74, v74
    v_exp_f32 v75, v75
    v_exp_f32 v76, v76
    v_exp_f32 v77, v77
    v_exp_f32 v78, v78
    v_exp_f32 v79, v79
    s_nop 0
    v_add_f32 v24, v72, v73
    v_add_f32 v24, v24, v74
    v_add_f32 v24, v24, v75
    v_add_f32 v24, v24, v76
    v_add_f32 v24, v24, v77
    v_add_f32 v24, v24, v78
    v_add_f32 v24, v24, v79
    v_mov_b32 v25, v24
    s_nop 1
    v_permlane32_swap_b32 v24, v25
    s_nop 1
    v_add_f32 v24, v24, v25
    v_rcp_f32 v24, v24
    s_nop 0
    v_mul_f32 v72, v72, v24
    v_mul_f32 v73, v73, v24
    v_mul_f32 v74, v74, v24
    v_mul_f32 v75, v75, v24
    v_mul_f32 v76, v76, v24
    v_mul_f32 v77, v77, v24
    v_mul_f32 v78, v78, v24
    v_mul_f32 v79, v79, v24
    v_cvt_pk_bf16_f32 v84, v72, v73
    v_cvt_pk_bf16_f32 v85, v74, v75
    v_cvt_pk_bf16_f32 v86, v76, v77
    v_cvt_pk_bf16_f32 v87, v78, v79
    s_cmp_eq_u32 s30, 3
    s_cbranch_scc1 K1_BQ0_1
    ds_write_b64 v22, v[80:81] offset:2048
    ds_write_b64 v22, v[82:83] offset:2064
    ds_write_b64 v22, v[84:85] offset:2080
    ds_write_b64 v22, v[86:87] offset:2096
    s_branch K1_BQD0_1
K1_BQ0_1:
    s_lshl_b32 s36, s34, 6
    s_lshl_b32 s37, s22, 3
    s_add_u32 s36, s36, s37
    s_lshl_b32 s37, s31, 2
    s_add_u32 s36, s36, s37
    s_add_u32 s36, s36, 1
    s_lshl_b32 s36, s36, 11
    s_add_u32 s36, s36, 67108864
    buffer_store_dwordx4 v[80:83], v18, s[16:19], s36 offen
    buffer_store_dwordx4 v[84:87], v18, s[16:19], s36 offen offset:1024
    s_nop 1
K1_BQD0_1:
    v_cvt_pk_bf16_f32 v88, v192, v193
    v_cvt_pk_bf16_f32 v89, v194, v195
    v_cvt_pk_bf16_f32 v90, v196, v197
    v_cvt_pk_bf16_f32 v91, v198, v199
    s_nop 1
    v_mfma_f32_32x32x16_bf16 v[64:79], v[60:63], v[88:91], 0
    s_nop 15
    v_cvt_pk_bf16_f32 v64, v64, v64
    v_lshlrev_b32 v64, 16, v64
    v_cvt_pk_bf16_f32 v65, v65, v65
    v_lshlrev_b32 v65, 16, v65
    v_cvt_pk_bf16_f32 v66, v66, v66
    v_lshlrev_b32 v66, 16, v66
    v_cvt_pk_bf16_f32 v67, v67, v67
    v_lshlrev_b32 v67, 16, v67
    v_cvt_pk_bf16_f32 v68, v68, v68
    v_lshlrev_b32 v68, 16, v68
    v_cvt_pk_bf16_f32 v69, v69, v69
    v_lshlrev_b32 v69, 16, v69
    v_cvt_pk_bf16_f32 v70, v70, v70
    v_lshlrev_b32 v70, 16, v70
    v_cvt_pk_bf16_f32 v71, v71, v71
    v_lshlrev_b32 v71, 16, v71
    v_cvt_pk_bf16_f32 v72, v72, v72
    v_lshlrev_b32 v72, 16, v72
    v_cvt_pk_bf16_f32 v73, v73, v73
    v_lshlrev_b32 v73, 16, v73
    v_cvt_pk_bf16_f32 v74, v74, v74
    v_lshlrev_b32 v74, 16, v74
    v_cvt_pk_bf16_f32 v75, v75, v75
    v_lshlrev_b32 v75, 16, v75
    v_cvt_pk_bf16_f32 v76, v76, v76
    v_lshlrev_b32 v76, 16, v76
    v_cvt_pk_bf16_f32 v77, v77, v77
    v_lshlrev_b32 v77, 16, v77
    v_cvt_pk_bf16_f32 v78, v78, v78
    v_lshlrev_b32 v78, 16, v78
    v_cvt_pk_bf16_f32 v79, v79, v79
    v_lshlrev_b32 v79, 16, v79
    v_max3_f32 v24, v64, v65, v66
    v_max3_f32 v24, v24, v67, v68
    v_max3_f32 v24, v24, v69, v70
    v_max_f32 v24, v24, v71
    v_mov_b32 v25, v24
    s_nop 1
    v_permlane32_swap_b32 v24, v25
    s_nop 1
    v_max_f32 v24, v24, v25
    v_sub_f32 v64, v64, v24
    v_sub_f32 v65, v65, v24
    v_sub_f32 v66, v66, v24
    v_sub_f32 v67, v67, v24
    v_sub_f32 v68, v68, v24
    v_sub_f32 v69, v69, v24
    v_sub_f32 v70, v70, v24
    v_sub_f32 v71, v71, v24
    v_mul_f32 v64, s33, v64
    v_mul_f32 v65, s33, v65
    v_mul_f32 v66, s33, v66
    v_mul_f32 v67, s33, v67
    v_mul_f32 v68, s33, v68
    v_mul_f32 v69, s33, v69
    v_mul_f32 v70, s33, v70
    v_mul_f32 v71, s33, v71
    v_exp_f32 v64, v64
    v_exp_f32 v65, v65
    v_exp_f32 v66, v66
    v_exp_f32 v67, v67
    v_exp_f32 v68, v68
    v_exp_f32 v69, v69
    v_exp_f32 v70, v70
    v_exp_f32 v71, v71
    s_nop 0
    v_add_f32 v24, v64, v65
    v_add_f32 v24, v24, v66
    v_add_f32 v24, v24, v67
    v_add_f32 v24, v24, v68
    v_add_f32 v24, v24, v69
    v_add_f32 v24, v24, v70
    v_add_f32 v24, v24, v71
    v_mov_b32 v25, v24
    s_nop 1
    v_permlane32_swap_b32 v24, v25
    s_nop 1
    v_add_f32 v24, v24, v25
    v_rcp_f32 v24, v24
    s_nop 0
    v_mul_f32 v64, v64, v24
    v_mul_f32 v65, v65, v24
    v_mul_f32 v66, v66, v24
    v_mul_f32 v67, v67, v24
    v_mul_f32 v68, v68, v24
    v_mul_f32 v69, v69, v24
    v_mul_f32 v70, v70, v24
    v_mul_f32 v71, v71, v24
    v_cvt_pk_bf16_f32 v80, v64, v65
    v_cvt_pk_bf16_f32 v81, v66, v67
    v_cvt_pk_bf16_f32 v82, v68, v69
    v_cvt_pk_bf16_f32 v83, v70, v71
    v_max3_f32 v24, v72, v73, v74
    v_max3_f32 v24, v24, v75, v76
    v_max3_f32 v24, v24, v77, v78
    v_max_f32 v24, v24, v79
    v_mov_b32 v25, v24
    s_nop 1
    v_permlane32_swap_b32 v24, v25
    s_nop 1
    v_max_f32 v24, v24, v25
    v_sub_f32 v72, v72, v24
    v_sub_f32 v73, v73, v24
    v_sub_f32 v74, v74, v24
    v_sub_f32 v75, v75, v24
    v_sub_f32 v76, v76, v24
    v_sub_f32 v77, v77, v24
    v_sub_f32 v78, v78, v24
    v_sub_f32 v79, v79, v24
    v_mul_f32 v72, s33, v72
    v_mul_f32 v73, s33, v73
    v_mul_f32 v74, s33, v74
    v_mul_f32 v75, s33, v75
    v_mul_f32 v76, s33, v76
    v_mul_f32 v77, s33, v77
    v_mul_f32 v78, s33, v78
    v_mul_f32 v79, s33, v79
    v_exp_f32 v72, v72
    v_exp_f32 v73, v73
    v_exp_f32 v74, v74
    v_exp_f32 v75, v75
    v_exp_f32 v76, v76
    v_exp_f32 v77, v77
    v_exp_f32 v78, v78
    v_exp_f32 v79, v79
    s_nop 0
    v_add_f32 v24, v72, v73
    v_add_f32 v24, v24, v74
    v_add_f32 v24, v24, v75
    v_add_f32 v24, v24, v76
    v_add_f32 v24, v24, v77
    v_add_f32 v24, v24, v78
    v_add_f32 v24, v24, v79
    v_mov_b32 v25, v24
    s_nop 1
    v_permlane32_swap_b32 v24, v25
    s_nop 1
    v_add_f32 v24, v24, v25
    v_rcp_f32 v24, v24
    s_nop 0
    v_mul_f32 v72, v72, v24
    v_mul_f32 v73, v73, v24
    v_mul_f32 v74, v74, v24
    v_mul_f32 v75, v75, v24
    v_mul_f32 v76, v76, v24
    v_mul_f32 v77, v77, v24
    v_mul_f32 v78, v78, v24
    v_mul_f32 v79, v79, v24
    v_cvt_pk_bf16_f32 v84, v72, v73
    v_cvt_pk_bf16_f32 v85, v74, v75
    v_cvt_pk_bf16_f32 v86, v76, v77
    v_cvt_pk_bf16_f32 v87, v78, v79
    s_cmp_eq_u32 s30, 3
    s_cbranch_scc1 K1_BQ0_2
    ds_write_b64 v22, v[80:81] offset:4096
    ds_write_b64 v22, v[82:83] offset:4112
    ds_write_b64 v22, v[84:85] offset:4128
    ds_write_b64 v22, v[86:87] offset:4144
    s_branch K1_BQD0_2
K1_BQ0_2:
    s_lshl_b32 s36, s34, 6
    s_lshl_b32 s37, s22, 3
    s_add_u32 s36, s36, s37
    s_lshl_b32 s37, s31, 2
    s_add_u32 s36, s36, s37
    s_add_u32 s36, s36, 2
    s_lshl_b32 s36, s36, 11
    s_add_u32 s36, s36, 67108864
    buffer_store_dwordx4 v[80:83], v18, s[16:19], s36 offen
    buffer_store_dwordx4 v[84:87], v18, s[16:19], s36 offen offset:1024
    s_nop 1
K1_BQD0_2:
    v_cvt_pk_bf16_f32 v88, v224, v225
    v_cvt_pk_bf16_f32 v89, v226, v227
    v_cvt_pk_bf16_f32 v90, v228, v229
    v_cvt_pk_bf16_f32 v91, v230, v231
    s_nop 1
    v_mfma_f32_32x32x16_bf16 v[64:79], v[60:63], v[88:91], 0
    s_nop 15
    v_cvt_pk_bf16_f32 v64, v64, v64
    v_lshlrev_b32 v64, 16, v64
    v_cvt_pk_bf16_f32 v65, v65, v65
    v_lshlrev_b32 v65, 16, v65
    v_cvt_pk_bf16_f32 v66, v66, v66
    v_lshlrev_b32 v66, 16, v66
    v_cvt_pk_bf16_f32 v67, v67, v67
    v_lshlrev_b32 v67, 16, v67
    v_cvt_pk_bf16_f32 v68, v68, v68
    v_lshlrev_b32 v68, 16, v68
    v_cvt_pk_bf16_f32 v69, v69, v69
    v_lshlrev_b32 v69, 16, v69
    v_cvt_pk_bf16_f32 v70, v70, v70
    v_lshlrev_b32 v70, 16, v70
    v_cvt_pk_bf16_f32 v71, v71, v71
    v_lshlrev_b32 v71, 16, v71
    v_cvt_pk_bf16_f32 v72, v72, v72
    v_lshlrev_b32 v72, 16, v72
    v_cvt_pk_bf16_f32 v73, v73, v73
    v_lshlrev_b32 v73, 16, v73
    v_cvt_pk_bf16_f32 v74, v74, v74
    v_lshlrev_b32 v74, 16, v74
    v_cvt_pk_bf16_f32 v75, v75, v75
    v_lshlrev_b32 v75, 16, v75
    v_cvt_pk_bf16_f32 v76, v76, v76
    v_lshlrev_b32 v76, 16, v76
    v_cvt_pk_bf16_f32 v77, v77, v77
    v_lshlrev_b32 v77, 16, v77
    v_cvt_pk_bf16_f32 v78, v78, v78
    v_lshlrev_b32 v78, 16, v78
    v_cvt_pk_bf16_f32 v79, v79, v79
    v_lshlrev_b32 v79, 16, v79
    v_max3_f32 v24, v64, v65, v66
    v_max3_f32 v24, v24, v67, v68
    v_max3_f32 v24, v24, v69, v70
    v_max_f32 v24, v24, v71
    v_mov_b32 v25, v24
    s_nop 1
    v_permlane32_swap_b32 v24, v25
    s_nop 1
    v_max_f32 v24, v24, v25
    v_sub_f32 v64, v64, v24
    v_sub_f32 v65, v65, v24
    v_sub_f32 v66, v66, v24
    v_sub_f32 v67, v67, v24
    v_sub_f32 v68, v68, v24
    v_sub_f32 v69, v69, v24
    v_sub_f32 v70, v70, v24
    v_sub_f32 v71, v71, v24
    v_mul_f32 v64, s33, v64
    v_mul_f32 v65, s33, v65
    v_mul_f32 v66, s33, v66
    v_mul_f32 v67, s33, v67
    v_mul_f32 v68, s33, v68
    v_mul_f32 v69, s33, v69
    v_mul_f32 v70, s33, v70
    v_mul_f32 v71, s33, v71
    v_exp_f32 v64, v64
    v_exp_f32 v65, v65
    v_exp_f32 v66, v66
    v_exp_f32 v67, v67
    v_exp_f32 v68, v68
    v_exp_f32 v69, v69
    v_exp_f32 v70, v70
    v_exp_f32 v71, v71
    s_nop 0
    v_add_f32 v24, v64, v65
    v_add_f32 v24, v24, v66
    v_add_f32 v24, v24, v67
    v_add_f32 v24, v24, v68
    v_add_f32 v24, v24, v69
    v_add_f32 v24, v24, v70
    v_add_f32 v24, v24, v71
    v_mov_b32 v25, v24
    s_nop 1
    v_permlane32_swap_b32 v24, v25
    s_nop 1
    v_add_f32 v24, v24, v25
    v_rcp_f32 v24, v24
    s_nop 0
    v_mul_f32 v64, v64, v24
    v_mul_f32 v65, v65, v24
    v_mul_f32 v66, v66, v24
    v_mul_f32 v67, v67, v24
    v_mul_f32 v68, v68, v24
    v_mul_f32 v69, v69, v24
    v_mul_f32 v70, v70, v24
    v_mul_f32 v71, v71, v24
    v_cvt_pk_bf16_f32 v80, v64, v65
    v_cvt_pk_bf16_f32 v81, v66, v67
    v_cvt_pk_bf16_f32 v82, v68, v69
    v_cvt_pk_bf16_f32 v83, v70, v71
    v_max3_f32 v24, v72, v73, v74
    v_max3_f32 v24, v24, v75, v76
    v_max3_f32 v24, v24, v77, v78
    v_max_f32 v24, v24, v79
    v_mov_b32 v25, v24
    s_nop 1
    v_permlane32_swap_b32 v24, v25
    s_nop 1
    v_max_f32 v24, v24, v25
    v_sub_f32 v72, v72, v24
    v_sub_f32 v73, v73, v24
    v_sub_f32 v74, v74, v24
    v_sub_f32 v75, v75, v24
    v_sub_f32 v76, v76, v24
    v_sub_f32 v77, v77, v24
    v_sub_f32 v78, v78, v24
    v_sub_f32 v79, v79, v24
    v_mul_f32 v72, s33, v72
    v_mul_f32 v73, s33, v73
    v_mul_f32 v74, s33, v74
    v_mul_f32 v75, s33, v75
    v_mul_f32 v76, s33, v76
    v_mul_f32 v77, s33, v77
    v_mul_f32 v78, s33, v78
    v_mul_f32 v79, s33, v79
    v_exp_f32 v72, v72
    v_exp_f32 v73, v73
    v_exp_f32 v74, v74
    v_exp_f32 v75, v75
    v_exp_f32 v76, v76
    v_exp_f32 v77, v77
    v_exp_f32 v78, v78
    v_exp_f32 v79, v79
    s_nop 0
    v_add_f32 v24, v72, v73
    v_add_f32 v24, v24, v74
    v_add_f32 v24, v24, v75
    v_add_f32 v24, v24, v76
    v_add_f32 v24, v24, v77
    v_add_f32 v24, v24, v78
    v_add_f32 v24, v24, v79
    v_mov_b32 v25, v24
    s_nop 1
    v_permlane32_swap_b32 v24, v25
    s_nop 1
    v_add_f32 v24, v24, v25
    v_rcp_f32 v24, v24
    s_nop 0
    v_mul_f32 v72, v72, v24
    v_mul_f32 v73, v73, v24
    v_mul_f32 v74, v74, v24
    v_mul_f32 v75, v75, v24
    v_mul_f32 v76, v76, v24
    v_mul_f32 v77, v77, v24
    v_mul_f32 v78, v78, v24
    v_mul_f32 v79, v79, v24
    v_cvt_pk_bf16_f32 v84, v72, v73
    v_cvt_pk_bf16_f32 v85, v74, v75
    v_cvt_pk_bf16_f32 v86, v76, v77
    v_cvt_pk_bf16_f32 v87, v78, v79
    s_cmp_eq_u32 s30, 3
    s_cbranch_scc1 K1_BQ0_3
    ds_write_b64 v22, v[80:81] offset:6144
    ds_write_b64 v22, v[82:83] offset:6160
    ds_write_b64 v22, v[84:85] offset:6176
    ds_write_b64 v22, v[86:87] offset:6192
    s_branch K1_BQD0_3
K1_BQ0_3:
    s_lshl_b32 s36, s34, 6
    s_lshl_b32 s37, s22, 3
    s_add_u32 s36, s36, s37
    s_lshl_b32 s37, s31, 2
    s_add_u32 s36, s36, s37
    s_add_u32 s36, s36, 3
    s_lshl_b32 s36, s36, 11
    s_add_u32 s36, s36, 67108864
    buffer_store_dwordx4 v[80:83], v18, s[16:19], s36 offen
    buffer_store_dwordx4 v[84:87], v18, s[16:19], s36 offen offset:1024
    s_nop 1
K1_BQD0_3:
    s_lshl_b32 s34, s23, 2
    s_add_u32 s34, s34, 1
    v_lshl_or_b32 v60, v37, 16, v36
    v_xor_b32 v60, v60, v21
    v_lshl_or_b32 v61, v39, 16, v38
    v_xor_b32 v61, v61, v21
    v_lshl_or_b32 v62, v41, 16, v40
    v_xor_b32 v62, v62, v21
    v_lshl_or_b32 v63, v43, 16, v42
    v_xor_b32 v63, v63, v21
    v_cvt_pk_bf16_f32 v88, v136, v137
    v_cvt_pk_bf16_f32 v89, v138, v139
    v_cvt_pk_bf16_f32 v90, v140, v141
    v_cvt_pk_bf16_f32 v91, v142, v143
    s_nop 1
    v_mfma_f32_32x32x16_bf16 v[64:79], v[60:63], v[88:91], 0
    s_nop 15
    v_cvt_pk_bf16_f32 v64, v64, v64
    v_lshlrev_b32 v64, 16, v64
    v_cvt_pk_bf16_f32 v65, v65, v65
    v_lshlrev_b32 v65, 16, v65
    v_cvt_pk_bf16_f32 v66, v66, v66
    v_lshlrev_b32 v66, 16, v66
    v_cvt_pk_bf16_f32 v67, v67, v67
    v_lshlrev_b32 v67, 16, v67
    v_cvt_pk_bf16_f32 v68, v68, v68
    v_lshlrev_b32 v68, 16, v68
    v_cvt_pk_bf16_f32 v69, v69, v69
    v_lshlrev_b32 v69, 16, v69
    v_cvt_pk_bf16_f32 v70, v70, v70
    v_lshlrev_b32 v70, 16, v70
    v_cvt_pk_bf16_f32 v71, v71, v71
    v_lshlrev_b32 v71, 16, v71
    v_cvt_pk_bf16_f32 v72, v72, v72
    v_lshlrev_b32 v72, 16, v72
    v_cvt_pk_bf16_f32 v73, v73, v73
    v_lshlrev_b32 v73, 16, v73
    v_cvt_pk_bf16_f32 v74, v74, v74
    v_lshlrev_b32 v74, 16, v74
    v_cvt_pk_bf16_f32 v75, v75, v75
    v_lshlrev_b32 v75, 16, v75
    v_cvt_pk_bf16_f32 v76, v76, v76
    v_lshlrev_b32 v76, 16, v76
    v_cvt_pk_bf16_f32 v77, v77, v77
    v_lshlrev_b32 v77, 16, v77
    v_cvt_pk_bf16_f32 v78, v78, v78
    v_lshlrev_b32 v78, 16, v78
    v_cvt_pk_bf16_f32 v79, v79, v79
    v_lshlrev_b32 v79, 16, v79
    v_max3_f32 v24, v64, v65, v66
    v_max3_f32 v24, v24, v67, v68
    v_max3_f32 v24, v24, v69, v70
    v_max_f32 v24, v24, v71
    v_mov_b32 v25, v24
    s_nop 1
    v_permlane32_swap_b32 v24, v25
    s_nop 1
    v_max_f32 v24, v24, v25
    v_sub_f32 v64, v64, v24
    v_sub_f32 v65, v65, v24
    v_sub_f32 v66, v66, v24
    v_sub_f32 v67, v67, v24
    v_sub_f32 v68, v68, v24
    v_sub_f32 v69, v69, v24
    v_sub_f32 v70, v70, v24
    v_sub_f32 v71, v71, v24
    v_mul_f32 v64, s33, v64
    v_mul_f32 v65, s33, v65
    v_mul_f32 v66, s33, v66
    v_mul_f32 v67, s33, v67
    v_mul_f32 v68, s33, v68
    v_mul_f32 v69, s33, v69
    v_mul_f32 v70, s33, v70
    v_mul_f32 v71, s33, v71
    v_exp_f32 v64, v64
    v_exp_f32 v65, v65
    v_exp_f32 v66, v66
    v_exp_f32 v67, v67
    v_exp_f32 v68, v68
    v_exp_f32 v69, v69
    v_exp_f32 v70, v70
    v_exp_f32 v71, v71
    s_nop 0
    v_add_f32 v24, v64, v65
    v_add_f32 v24, v24, v66
    v_add_f32 v24, v24, v67
    v_add_f32 v24, v24, v68
    v_add_f32 v24, v24, v69
    v_add_f32 v24, v24, v70
    v_add_f32 v24, v24, v71
    v_mov_b32 v25, v24
    s_nop 1
    v_permlane32_swap_b32 v24, v25
    s_nop 1
    v_add_f32 v24, v24, v25
    v_rcp_f32 v24, v24
    s_nop 0
    v_mul_f32 v64, v64, v24
    v_mul_f32 v65, v65, v24
    v_mul_f32 v66, v66, v24
    v_mul_f32 v67, v67, v24
    v_mul_f32 v68, v68, v24
    v_mul_f32 v69, v69, v24
    v_mul_f32 v70, v70, v24
    v_mul_f32 v71, v71, v24
    v_cvt_pk_bf16_f32 v80, v64, v65
    v_cvt_pk_bf16_f32 v81, v66, v67
    v_cvt_pk_bf16_f32 v82, v68, v69
    v_cvt_pk_bf16_f32 v83, v70, v71
    v_max3_f32 v24, v72, v73, v74
    v_max3_f32 v24, v24, v75, v76
    v_max3_f32 v24, v24, v77, v78
    v_max_f32 v24, v24, v79
    v_mov_b32 v25, v24
    s_nop 1
    v_permlane32_swap_b32 v24, v25
    s_nop 1
    v_max_f32 v24, v24, v25
    v_sub_f32 v72, v72, v24
    v_sub_f32 v73, v73, v24
    v_sub_f32 v74, v74, v24
    v_sub_f32 v75, v75, v24
    v_sub_f32 v76, v76, v24
    v_sub_f32 v77, v77, v24
    v_sub_f32 v78, v78, v24
    v_sub_f32 v79, v79, v24
    v_mul_f32 v72, s33, v72
    v_mul_f32 v73, s33, v73
    v_mul_f32 v74, s33, v74
    v_mul_f32 v75, s33, v75
    v_mul_f32 v76, s33, v76
    v_mul_f32 v77, s33, v77
    v_mul_f32 v78, s33, v78
    v_mul_f32 v79, s33, v79
    v_exp_f32 v72, v72
    v_exp_f32 v73, v73
    v_exp_f32 v74, v74
    v_exp_f32 v75, v75
    v_exp_f32 v76, v76
    v_exp_f32 v77, v77
    v_exp_f32 v78, v78
    v_exp_f32 v79, v79
    s_nop 0
    v_add_f32 v24, v72, v73
    v_add_f32 v24, v24, v74
    v_add_f32 v24, v24, v75
    v_add_f32 v24, v24, v76
    v_add_f32 v24, v24, v77
    v_add_f32 v24, v24, v78
    v_add_f32 v24, v24, v79
    v_mov_b32 v25, v24
    s_nop 1
    v_permlane32_swap_b32 v24, v25
    s_nop 1
    v_add_f32 v24, v24, v25
    v_rcp_f32 v24, v24
    s_nop 0
    v_mul_f32 v72, v72, v24
    v_mul_f32 v73, v73, v24
    v_mul_f32 v74, v74, v24
    v_mul_f32 v75, v75, v24
    v_mul_f32 v76, v76, v24
    v_mul_f32 v77, v77, v24
    v_mul_f32 v78, v78, v24
    v_mul_f32 v79, v79, v24
    v_cvt_pk_bf16_f32 v84, v72, v73
    v_cvt_pk_bf16_f32 v85, v74, v75
    v_cvt_pk_bf16_f32 v86, v76, v77
    v_cvt_pk_bf16_f32 v87, v78, v79
    s_cmp_eq_u32 s30, 3
    s_cbranch_scc1 K1_BQ1_0
    ds_write_b64 v22, v[80:81] offset:16384
    ds_write_b64 v22, v[82:83] offset:16400
    ds_write_b64 v22, v[84:85] offset:16416
    ds_write_b64 v22, v[86:87] offset:16432
    s_branch K1_BQD1_0
K1_BQ1_0:
    s_lshl_b32 s36, s34, 6
    s_lshl_b32 s37, s22, 3
    s_add_u32 s36, s36, s37
    s_lshl_b32 s37, s31, 2
    s_add_u32 s36, s36, s37
    s_add_u32 s36, s36, 0
    s_lshl_b32 s36, s36, 11
    s_add_u32 s36, s36, 67108864
    buffer_store_dwordx4 v[80:83], v18, s[16:19], s36 offen
    buffer_store_dwordx4 v[84:87], v18, s[16:19], s36 offen offset:1024
    s_nop 1
K1_BQD1_0:
    v_cvt_pk_bf16_f32 v88, v168, v169
    v_cvt_pk_bf16_f32 v89, v170, v171
    v_cvt_pk_bf16_f32 v90, v172, v173
    v_cvt_pk_bf16_f32 v91, v174, v175
    s_nop 1
    v_mfma_f32_32x32x16_bf16 v[64:79], v[60:63], v[88:91], 0
    s_nop 15
    v_cvt_pk_bf16_f32 v64, v64, v64
    v_lshlrev_b32 v64, 16, v64
    v_cvt_pk_bf16_f32 v65, v65, v65
    v_lshlrev_b32 v65, 16, v65
    v_cvt_pk_bf16_f32 v66, v66, v66
    v_lshlrev_b32 v66, 16, v66
    v_cvt_pk_bf16_f32 v67, v67, v67
    v_lshlrev_b32 v67, 16, v67
    v_cvt_pk_bf16_f32 v68, v68, v68
    v_lshlrev_b32 v68, 16, v68
    v_cvt_pk_bf16_f32 v69, v69, v69
    v_lshlrev_b32 v69, 16, v69
    v_cvt_pk_bf16_f32 v70, v70, v70
    v_lshlrev_b32 v70, 16, v70
    v_cvt_pk_bf16_f32 v71, v71, v71
    v_lshlrev_b32 v71, 16, v71
    v_cvt_pk_bf16_f32 v72, v72, v72
    v_lshlrev_b32 v72, 16, v72
    v_cvt_pk_bf16_f32 v73, v73, v73
    v_lshlrev_b32 v73, 16, v73
    v_cvt_pk_bf16_f32 v74, v74, v74
    v_lshlrev_b32 v74, 16, v74
    v_cvt_pk_bf16_f32 v75, v75, v75
    v_lshlrev_b32 v75, 16, v75
    v_cvt_pk_bf16_f32 v76, v76, v76
    v_lshlrev_b32 v76, 16, v76
    v_cvt_pk_bf16_f32 v77, v77, v77
    v_lshlrev_b32 v77, 16, v77
    v_cvt_pk_bf16_f32 v78, v78, v78
    v_lshlrev_b32 v78, 16, v78
    v_cvt_pk_bf16_f32 v79, v79, v79
    v_lshlrev_b32 v79, 16, v79
    v_max3_f32 v24, v64, v65, v66
    v_max3_f32 v24, v24, v67, v68
    v_max3_f32 v24, v24, v69, v70
    v_max_f32 v24, v24, v71
    v_mov_b32 v25, v24
    s_nop 1
    v_permlane32_swap_b32 v24, v25
    s_nop 1
    v_max_f32 v24, v24, v25
    v_sub_f32 v64, v64, v24
    v_sub_f32 v65, v65, v24
    v_sub_f32 v66, v66, v24
    v_sub_f32 v67, v67, v24
    v_sub_f32 v68, v68, v24
    v_sub_f32 v69, v69, v24
    v_sub_f32 v70, v70, v24
    v_sub_f32 v71, v71, v24
    v_mul_f32 v64, s33, v64
    v_mul_f32 v65, s33, v65
    v_mul_f32 v66, s33, v66
    v_mul_f32 v67, s33, v67
    v_mul_f32 v68, s33, v68
    v_mul_f32 v69, s33, v69
    v_mul_f32 v70, s33, v70
    v_mul_f32 v71, s33, v71
    v_exp_f32 v64, v64
    v_exp_f32 v65, v65
    v_exp_f32 v66, v66
    v_exp_f32 v67, v67
    v_exp_f32 v68, v68
    v_exp_f32 v69, v69
    v_exp_f32 v70, v70
    v_exp_f32 v71, v71
    s_nop 0
    v_add_f32 v24, v64, v65
    v_add_f32 v24, v24, v66
    v_add_f32 v24, v24, v67
    v_add_f32 v24, v24, v68
    v_add_f32 v24, v24, v69
    v_add_f32 v24, v24, v70
    v_add_f32 v24, v24, v71
    v_mov_b32 v25, v24
    s_nop 1
    v_permlane32_swap_b32 v24, v25
    s_nop 1
    v_add_f32 v24, v24, v25
    v_rcp_f32 v24, v24
    s_nop 0
    v_mul_f32 v64, v64, v24
    v_mul_f32 v65, v65, v24
    v_mul_f32 v66, v66, v24
    v_mul_f32 v67, v67, v24
    v_mul_f32 v68, v68, v24
    v_mul_f32 v69, v69, v24
    v_mul_f32 v70, v70, v24
    v_mul_f32 v71, v71, v24
    v_cvt_pk_bf16_f32 v80, v64, v65
    v_cvt_pk_bf16_f32 v81, v66, v67
    v_cvt_pk_bf16_f32 v82, v68, v69
    v_cvt_pk_bf16_f32 v83, v70, v71
    v_max3_f32 v24, v72, v73, v74
    v_max3_f32 v24, v24, v75, v76
    v_max3_f32 v24, v24, v77, v78
    v_max_f32 v24, v24, v79
    v_mov_b32 v25, v24
    s_nop 1
    v_permlane32_swap_b32 v24, v25
    s_nop 1
    v_max_f32 v24, v24, v25
    v_sub_f32 v72, v72, v24
    v_sub_f32 v73, v73, v24
    v_sub_f32 v74, v74, v24
    v_sub_f32 v75, v75, v24
    v_sub_f32 v76, v76, v24
    v_sub_f32 v77, v77, v24
    v_sub_f32 v78, v78, v24
    v_sub_f32 v79, v79, v24
    v_mul_f32 v72, s33, v72
    v_mul_f32 v73, s33, v73
    v_mul_f32 v74, s33, v74
    v_mul_f32 v75, s33, v75
    v_mul_f32 v76, s33, v76
    v_mul_f32 v77, s33, v77
    v_mul_f32 v78, s33, v78
    v_mul_f32 v79, s33, v79
    v_exp_f32 v72, v72
    v_exp_f32 v73, v73
    v_exp_f32 v74, v74
    v_exp_f32 v75, v75
    v_exp_f32 v76, v76
    v_exp_f32 v77, v77
    v_exp_f32 v78, v78
    v_exp_f32 v79, v79
    s_nop 0
    v_add_f32 v24, v72, v73
    v_add_f32 v24, v24, v74
    v_add_f32 v24, v24, v75
    v_add_f32 v24, v24, v76
    v_add_f32 v24, v24, v77
    v_add_f32 v24, v24, v78
    v_add_f32 v24, v24, v79
    v_mov_b32 v25, v24
    s_nop 1
    v_permlane32_swap_b32 v24, v25
    s_nop 1
    v_add_f32 v24, v24, v25
    v_rcp_f32 v24, v24
    s_nop 0
    v_mul_f32 v72, v72, v24
    v_mul_f32 v73, v73, v24
    v_mul_f32 v74, v74, v24
    v_mul_f32 v75, v75, v24
    v_mul_f32 v76, v76, v24
    v_mul_f32 v77, v77, v24
    v_mul_f32 v78, v78, v24
    v_mul_f32 v79, v79, v24
    v_cvt_pk_bf16_f32 v84, v72, v73
    v_cvt_pk_bf16_f32 v85, v74, v75
    v_cvt_pk_bf16_f32 v86, v76, v77
    v_cvt_pk_bf16_f32 v87, v78, v79
    s_cmp_eq_u32 s30, 3
    s_cbranch_scc1 K1_BQ1_1
    ds_write_b64 v22, v[80:81] offset:18432
    ds_write_b64 v22, v[82:83] offset:18448
    ds_write_b64 v22, v[84:85] offset:18464
    ds_write_b64 v22, v[86:87] offset:18480
    s_branch K1_BQD1_1
K1_BQ1_1:
    s_lshl_b32 s36, s34, 6
    s_lshl_b32 s37, s22, 3
    s_add_u32 s36, s36, s37
    s_lshl_b32 s37, s31, 2
    s_add_u32 s36, s36, s37
    s_add_u32 s36, s36, 1
    s_lshl_b32 s36, s36, 11
    s_add_u32 s36, s36, 67108864
    buffer_store_dwordx4 v[80:83], v18, s[16:19], s36 offen
    buffer_store_dwordx4 v[84:87], v18, s[16:19], s36 offen offset:1024
    s_nop 1
K1_BQD1_1:
    v_cvt_pk_bf16_f32 v88, v200, v201
    v_cvt_pk_bf16_f32 v89, v202, v203
    v_cvt_pk_bf16_f32 v90, v204, v205
    v_cvt_pk_bf16_f32 v91, v206, v207
    s_nop 1
    v_mfma_f32_32x32x16_bf16 v[64:79], v[60:63], v[88:91], 0
    s_nop 15
    v_cvt_pk_bf16_f32 v64, v64, v64
    v_lshlrev_b32 v64, 16, v64
    v_cvt_pk_bf16_f32 v65, v65, v65
    v_lshlrev_b32 v65, 16, v65
    v_cvt_pk_bf16_f32 v66, v66, v66
    v_lshlrev_b32 v66, 16, v66
    v_cvt_pk_bf16_f32 v67, v67, v67
    v_lshlrev_b32 v67, 16, v67
    v_cvt_pk_bf16_f32 v68, v68, v68
    v_lshlrev_b32 v68, 16, v68
    v_cvt_pk_bf16_f32 v69, v69, v69
    v_lshlrev_b32 v69, 16, v69
    v_cvt_pk_bf16_f32 v70, v70, v70
    v_lshlrev_b32 v70, 16, v70
    v_cvt_pk_bf16_f32 v71, v71, v71
    v_lshlrev_b32 v71, 16, v71
    v_cvt_pk_bf16_f32 v72, v72, v72
    v_lshlrev_b32 v72, 16, v72
    v_cvt_pk_bf16_f32 v73, v73, v73
    v_lshlrev_b32 v73, 16, v73
    v_cvt_pk_bf16_f32 v74, v74, v74
    v_lshlrev_b32 v74, 16, v74
    v_cvt_pk_bf16_f32 v75, v75, v75
    v_lshlrev_b32 v75, 16, v75
    v_cvt_pk_bf16_f32 v76, v76, v76
    v_lshlrev_b32 v76, 16, v76
    v_cvt_pk_bf16_f32 v77, v77, v77
    v_lshlrev_b32 v77, 16, v77
    v_cvt_pk_bf16_f32 v78, v78, v78
    v_lshlrev_b32 v78, 16, v78
    v_cvt_pk_bf16_f32 v79, v79, v79
    v_lshlrev_b32 v79, 16, v79
    v_max3_f32 v24, v64, v65, v66
    v_max3_f32 v24, v24, v67, v68
    v_max3_f32 v24, v24, v69, v70
    v_max_f32 v24, v24, v71
    v_mov_b32 v25, v24
    s_nop 1
    v_permlane32_swap_b32 v24, v25
    s_nop 1
    v_max_f32 v24, v24, v25
    v_sub_f32 v64, v64, v24
    v_sub_f32 v65, v65, v24
    v_sub_f32 v66, v66, v24
    v_sub_f32 v67, v67, v24
    v_sub_f32 v68, v68, v24
    v_sub_f32 v69, v69, v24
    v_sub_f32 v70, v70, v24
    v_sub_f32 v71, v71, v24
    v_mul_f32 v64, s33, v64
    v_mul_f32 v65, s33, v65
    v_mul_f32 v66, s33, v66
    v_mul_f32 v67, s33, v67
    v_mul_f32 v68, s33, v68
    v_mul_f32 v69, s33, v69
    v_mul_f32 v70, s33, v70
    v_mul_f32 v71, s33, v71
    v_exp_f32 v64, v64
    v_exp_f32 v65, v65
    v_exp_f32 v66, v66
    v_exp_f32 v67, v67
    v_exp_f32 v68, v68
    v_exp_f32 v69, v69
    v_exp_f32 v70, v70
    v_exp_f32 v71, v71
    s_nop 0
    v_add_f32 v24, v64, v65
    v_add_f32 v24, v24, v66
    v_add_f32 v24, v24, v67
    v_add_f32 v24, v24, v68
    v_add_f32 v24, v24, v69
    v_add_f32 v24, v24, v70
    v_add_f32 v24, v24, v71
    v_mov_b32 v25, v24
    s_nop 1
    v_permlane32_swap_b32 v24, v25
    s_nop 1
    v_add_f32 v24, v24, v25
    v_rcp_f32 v24, v24
    s_nop 0
    v_mul_f32 v64, v64, v24
    v_mul_f32 v65, v65, v24
    v_mul_f32 v66, v66, v24
    v_mul_f32 v67, v67, v24
    v_mul_f32 v68, v68, v24
    v_mul_f32 v69, v69, v24
    v_mul_f32 v70, v70, v24
    v_mul_f32 v71, v71, v24
    v_cvt_pk_bf16_f32 v80, v64, v65
    v_cvt_pk_bf16_f32 v81, v66, v67
    v_cvt_pk_bf16_f32 v82, v68, v69
    v_cvt_pk_bf16_f32 v83, v70, v71
    v_max3_f32 v24, v72, v73, v74
    v_max3_f32 v24, v24, v75, v76
    v_max3_f32 v24, v24, v77, v78
    v_max_f32 v24, v24, v79
    v_mov_b32 v25, v24
    s_nop 1
    v_permlane32_swap_b32 v24, v25
    s_nop 1
    v_max_f32 v24, v24, v25
    v_sub_f32 v72, v72, v24
    v_sub_f32 v73, v73, v24
    v_sub_f32 v74, v74, v24
    v_sub_f32 v75, v75, v24
    v_sub_f32 v76, v76, v24
    v_sub_f32 v77, v77, v24
    v_sub_f32 v78, v78, v24
    v_sub_f32 v79, v79, v24
    v_mul_f32 v72, s33, v72
    v_mul_f32 v73, s33, v73
    v_mul_f32 v74, s33, v74
    v_mul_f32 v75, s33, v75
    v_mul_f32 v76, s33, v76
    v_mul_f32 v77, s33, v77
    v_mul_f32 v78, s33, v78
    v_mul_f32 v79, s33, v79
    v_exp_f32 v72, v72
    v_exp_f32 v73, v73
    v_exp_f32 v74, v74
    v_exp_f32 v75, v75
    v_exp_f32 v76, v76
    v_exp_f32 v77, v77
    v_exp_f32 v78, v78
    v_exp_f32 v79, v79
    s_nop 0
    v_add_f32 v24, v72, v73
    v_add_f32 v24, v24, v74
    v_add_f32 v24, v24, v75
    v_add_f32 v24, v24, v76
    v_add_f32 v24, v24, v77
    v_add_f32 v24, v24, v78
    v_add_f32 v24, v24, v79
    v_mov_b32 v25, v24
    s_nop 1
    v_permlane32_swap_b32 v24, v25
    s_nop 1
    v_add_f32 v24, v24, v25
    v_rcp_f32 v24, v24
    s_nop 0
    v_mul_f32 v72, v72, v24
    v_mul_f32 v73, v73, v24
    v_mul_f32 v74, v74, v24
    v_mul_f32 v75, v75, v24
    v_mul_f32 v76, v76, v24
    v_mul_f32 v77, v77, v24
    v_mul_f32 v78, v78, v24
    v_mul_f32 v79, v79, v24
    v_cvt_pk_bf16_f32 v84, v72, v73
    v_cvt_pk_bf16_f32 v85, v74, v75
    v_cvt_pk_bf16_f32 v86, v76, v77
    v_cvt_pk_bf16_f32 v87, v78, v79
    s_cmp_eq_u32 s30, 3
    s_cbranch_scc1 K1_BQ1_2
    ds_write_b64 v22, v[80:81] offset:20480
    ds_write_b64 v22, v[82:83] offset:20496
    ds_write_b64 v22, v[84:85] offset:20512
    ds_write_b64 v22, v[86:87] offset:20528
    s_branch K1_BQD1_2
K1_BQ1_2:
    s_lshl_b32 s36, s34, 6
    s_lshl_b32 s37, s22, 3
    s_add_u32 s36, s36, s37
    s_lshl_b32 s37, s31, 2
    s_add_u32 s36, s36, s37
    s_add_u32 s36, s36, 2
    s_lshl_b32 s36, s36, 11
    s_add_u32 s36, s36, 67108864
    buffer_store_dwordx4 v[80:83], v18, s[16:19], s36 offen
    buffer_store_dwordx4 v[84:87], v18, s[16:19], s36 offen offset:1024
    s_nop 1
K1_BQD1_2:
    v_cvt_pk_bf16_f32 v88, v232, v233
    v_cvt_pk_bf16_f32 v89, v234, v235
    v_cvt_pk_bf16_f32 v90, v236, v237
    v_cvt_pk_bf16_f32 v91, v238, v239
    s_nop 1
    v_mfma_f32_32x32x16_bf16 v[64:79], v[60:63], v[88:91], 0
    s_nop 15
    v_cvt_pk_bf16_f32 v64, v64, v64
    v_lshlrev_b32 v64, 16, v64
    v_cvt_pk_bf16_f32 v65, v65, v65
    v_lshlrev_b32 v65, 16, v65
    v_cvt_pk_bf16_f32 v66, v66, v66
    v_lshlrev_b32 v66, 16, v66
    v_cvt_pk_bf16_f32 v67, v67, v67
    v_lshlrev_b32 v67, 16, v67
    v_cvt_pk_bf16_f32 v68, v68, v68
    v_lshlrev_b32 v68, 16, v68
    v_cvt_pk_bf16_f32 v69, v69, v69
    v_lshlrev_b32 v69, 16, v69
    v_cvt_pk_bf16_f32 v70, v70, v70
    v_lshlrev_b32 v70, 16, v70
    v_cvt_pk_bf16_f32 v71, v71, v71
    v_lshlrev_b32 v71, 16, v71
    v_cvt_pk_bf16_f32 v72, v72, v72
    v_lshlrev_b32 v72, 16, v72
    v_cvt_pk_bf16_f32 v73, v73, v73
    v_lshlrev_b32 v73, 16, v73
    v_cvt_pk_bf16_f32 v74, v74, v74
    v_lshlrev_b32 v74, 16, v74
    v_cvt_pk_bf16_f32 v75, v75, v75
    v_lshlrev_b32 v75, 16, v75
    v_cvt_pk_bf16_f32 v76, v76, v76
    v_lshlrev_b32 v76, 16, v76
    v_cvt_pk_bf16_f32 v77, v77, v77
    v_lshlrev_b32 v77, 16, v77
    v_cvt_pk_bf16_f32 v78, v78, v78
    v_lshlrev_b32 v78, 16, v78
    v_cvt_pk_bf16_f32 v79, v79, v79
    v_lshlrev_b32 v79, 16, v79
    v_max3_f32 v24, v64, v65, v66
    v_max3_f32 v24, v24, v67, v68
    v_max3_f32 v24, v24, v69, v70
    v_max_f32 v24, v24, v71
    v_mov_b32 v25, v24
    s_nop 1
    v_permlane32_swap_b32 v24, v25
    s_nop 1
    v_max_f32 v24, v24, v25
    v_sub_f32 v64, v64, v24
    v_sub_f32 v65, v65, v24
    v_sub_f32 v66, v66, v24
    v_sub_f32 v67, v67, v24
    v_sub_f32 v68, v68, v24
    v_sub_f32 v69, v69, v24
    v_sub_f32 v70, v70, v24
    v_sub_f32 v71, v71, v24
    v_mul_f32 v64, s33, v64
    v_mul_f32 v65, s33, v65
    v_mul_f32 v66, s33, v66
    v_mul_f32 v67, s33, v67
    v_mul_f32 v68, s33, v68
    v_mul_f32 v69, s33, v69
    v_mul_f32 v70, s33, v70
    v_mul_f32 v71, s33, v71
    v_exp_f32 v64, v64
    v_exp_f32 v65, v65
    v_exp_f32 v66, v66
    v_exp_f32 v67, v67
    v_exp_f32 v68, v68
    v_exp_f32 v69, v69
    v_exp_f32 v70, v70
    v_exp_f32 v71, v71
    s_nop 0
    v_add_f32 v24, v64, v65
    v_add_f32 v24, v24, v66
    v_add_f32 v24, v24, v67
    v_add_f32 v24, v24, v68
    v_add_f32 v24, v24, v69
    v_add_f32 v24, v24, v70
    v_add_f32 v24, v24, v71
    v_mov_b32 v25, v24
    s_nop 1
    v_permlane32_swap_b32 v24, v25
    s_nop 1
    v_add_f32 v24, v24, v25
    v_rcp_f32 v24, v24
    s_nop 0
    v_mul_f32 v64, v64, v24
    v_mul_f32 v65, v65, v24
    v_mul_f32 v66, v66, v24
    v_mul_f32 v67, v67, v24
    v_mul_f32 v68, v68, v24
    v_mul_f32 v69, v69, v24
    v_mul_f32 v70, v70, v24
    v_mul_f32 v71, v71, v24
    v_cvt_pk_bf16_f32 v80, v64, v65
    v_cvt_pk_bf16_f32 v81, v66, v67
    v_cvt_pk_bf16_f32 v82, v68, v69
    v_cvt_pk_bf16_f32 v83, v70, v71
    v_max3_f32 v24, v72, v73, v74
    v_max3_f32 v24, v24, v75, v76
    v_max3_f32 v24, v24, v77, v78
    v_max_f32 v24, v24, v79
    v_mov_b32 v25, v24
    s_nop 1
    v_permlane32_swap_b32 v24, v25
    s_nop 1
    v_max_f32 v24, v24, v25
    v_sub_f32 v72, v72, v24
    v_sub_f32 v73, v73, v24
    v_sub_f32 v74, v74, v24
    v_sub_f32 v75, v75, v24
    v_sub_f32 v76, v76, v24
    v_sub_f32 v77, v77, v24
    v_sub_f32 v78, v78, v24
    v_sub_f32 v79, v79, v24
    v_mul_f32 v72, s33, v72
    v_mul_f32 v73, s33, v73
    v_mul_f32 v74, s33, v74
    v_mul_f32 v75, s33, v75
    v_mul_f32 v76, s33, v76
    v_mul_f32 v77, s33, v77
    v_mul_f32 v78, s33, v78
    v_mul_f32 v79, s33, v79
    v_exp_f32 v72, v72
    v_exp_f32 v73, v73
    v_exp_f32 v74, v74
    v_exp_f32 v75, v75
    v_exp_f32 v76, v76
    v_exp_f32 v77, v77
    v_exp_f32 v78, v78
    v_exp_f32 v79, v79
    s_nop 0
    v_add_f32 v24, v72, v73
    v_add_f32 v24, v24, v74
    v_add_f32 v24, v24, v75
    v_add_f32 v24, v24, v76
    v_add_f32 v24, v24, v77
    v_add_f32 v24, v24, v78
    v_add_f32 v24, v24, v79
    v_mov_b32 v25, v24
    s_nop 1
    v_permlane32_swap_b32 v24, v25
    s_nop 1
    v_add_f32 v24, v24, v25
    v_rcp_f32 v24, v24
    s_nop 0
    v_mul_f32 v72, v72, v24
    v_mul_f32 v73, v73, v24
    v_mul_f32 v74, v74, v24
    v_mul_f32 v75, v75, v24
    v_mul_f32 v76, v76, v24
    v_mul_f32 v77, v77, v24
    v_mul_f32 v78, v78, v24
    v_mul_f32 v79, v79, v24
    v_cvt_pk_bf16_f32 v84, v72, v73
    v_cvt_pk_bf16_f32 v85, v74, v75
    v_cvt_pk_bf16_f32 v86, v76, v77
    v_cvt_pk_bf16_f32 v87, v78, v79
    s_cmp_eq_u32 s30, 3
    s_cbranch_scc1 K1_BQ1_3
    ds_write_b64 v22, v[80:81] offset:22528
    ds_write_b64 v22, v[82:83] offset:22544
    ds_write_b64 v22, v[84:85] offset:22560
    ds_write_b64 v22, v[86:87] offset:22576
    s_branch K1_BQD1_3
K1_BQ1_3:
    s_lshl_b32 s36, s34, 6
    s_lshl_b32 s37, s22, 3
    s_add_u32 s36, s36, s37
    s_lshl_b32 s37, s31, 2
    s_add_u32 s36, s36, s37
    s_add_u32 s36, s36, 3
    s_lshl_b32 s36, s36, 11
    s_add_u32 s36, s36, 67108864
    buffer_store_dwordx4 v[80:83], v18, s[16:19], s36 offen
    buffer_store_dwordx4 v[84:87], v18, s[16:19], s36 offen offset:1024
    s_nop 1
K1_BQD1_3:
    s_lshl_b32 s34, s23, 2
    s_add_u32 s34, s34, 2
    v_lshl_or_b32 v60, v45, 16, v44
    v_xor_b32 v60, v60, v21
    v_lshl_or_b32 v61, v47, 16, v46
    v_xor_b32 v61, v61, v21
    v_lshl_or_b32 v62, v49, 16, v48
    v_xor_b32 v62, v62, v21
    v_lshl_or_b32 v63, v51, 16, v50
    v_xor_b32 v63, v63, v21
    v_cvt_pk_bf16_f32 v88, v144, v145
    v_cvt_pk_bf16_f32 v89, v146, v147
    v_cvt_pk_bf16_f32 v90, v148, v149
    v_cvt_pk_bf16_f32 v91, v150, v151
    s_nop 1
    v_mfma_f32_32x32x16_bf16 v[64:79], v[60:63], v[88:91], 0
    s_nop 15
    v_cvt_pk_bf16_f32 v64, v64, v64
    v_lshlrev_b32 v64, 16, v64
    v_cvt_pk_bf16_f32 v65, v65, v65
    v_lshlrev_b32 v65, 16, v65
    v_cvt_pk_bf16_f32 v66, v66, v66
    v_lshlrev_b32 v66, 16, v66
    v_cvt_pk_bf16_f32 v67, v67, v67
    v_lshlrev_b32 v67, 16, v67
    v_cvt_pk_bf16_f32 v68, v68, v68
    v_lshlrev_b32 v68, 16, v68
    v_cvt_pk_bf16_f32 v69, v69, v69
    v_lshlrev_b32 v69, 16, v69
    v_cvt_pk_bf16_f32 v70, v70, v70
    v_lshlrev_b32 v70, 16, v70
    v_cvt_pk_bf16_f32 v71, v71, v71
    v_lshlrev_b32 v71, 16, v71
    v_cvt_pk_bf16_f32 v72, v72, v72
    v_lshlrev_b32 v72, 16, v72
    v_cvt_pk_bf16_f32 v73, v73, v73
    v_lshlrev_b32 v73, 16, v73
    v_cvt_pk_bf16_f32 v74, v74, v74
    v_lshlrev_b32 v74, 16, v74
    v_cvt_pk_bf16_f32 v75, v75, v75
    v_lshlrev_b32 v75, 16, v75
    v_cvt_pk_bf16_f32 v76, v76, v76
    v_lshlrev_b32 v76, 16, v76
    v_cvt_pk_bf16_f32 v77, v77, v77
    v_lshlrev_b32 v77, 16, v77
    v_cvt_pk_bf16_f32 v78, v78, v78
    v_lshlrev_b32 v78, 16, v78
    v_cvt_pk_bf16_f32 v79, v79, v79
    v_lshlrev_b32 v79, 16, v79
    v_max3_f32 v24, v64, v65, v66
    v_max3_f32 v24, v24, v67, v68
    v_max3_f32 v24, v24, v69, v70
    v_max_f32 v24, v24, v71
    v_mov_b32 v25, v24
    s_nop 1
    v_permlane32_swap_b32 v24, v25
    s_nop 1
    v_max_f32 v24, v24, v25
    v_sub_f32 v64, v64, v24
    v_sub_f32 v65, v65, v24
    v_sub_f32 v66, v66, v24
    v_sub_f32 v67, v67, v24
    v_sub_f32 v68, v68, v24
    v_sub_f32 v69, v69, v24
    v_sub_f32 v70, v70, v24
    v_sub_f32 v71, v71, v24
    v_mul_f32 v64, s33, v64
    v_mul_f32 v65, s33, v65
    v_mul_f32 v66, s33, v66
    v_mul_f32 v67, s33, v67
    v_mul_f32 v68, s33, v68
    v_mul_f32 v69, s33, v69
    v_mul_f32 v70, s33, v70
    v_mul_f32 v71, s33, v71
    v_exp_f32 v64, v64
    v_exp_f32 v65, v65
    v_exp_f32 v66, v66
    v_exp_f32 v67, v67
    v_exp_f32 v68, v68
    v_exp_f32 v69, v69
    v_exp_f32 v70, v70
    v_exp_f32 v71, v71
    s_nop 0
    v_add_f32 v24, v64, v65
    v_add_f32 v24, v24, v66
    v_add_f32 v24, v24, v67
    v_add_f32 v24, v24, v68
    v_add_f32 v24, v24, v69
    v_add_f32 v24, v24, v70
    v_add_f32 v24, v24, v71
    v_mov_b32 v25, v24
    s_nop 1
    v_permlane32_swap_b32 v24, v25
    s_nop 1
    v_add_f32 v24, v24, v25
    v_rcp_f32 v24, v24
    s_nop 0
    v_mul_f32 v64, v64, v24
    v_mul_f32 v65, v65, v24
    v_mul_f32 v66, v66, v24
    v_mul_f32 v67, v67, v24
    v_mul_f32 v68, v68, v24
    v_mul_f32 v69, v69, v24
    v_mul_f32 v70, v70, v24
    v_mul_f32 v71, v71, v24
    v_cvt_pk_bf16_f32 v80, v64, v65
    v_cvt_pk_bf16_f32 v81, v66, v67
    v_cvt_pk_bf16_f32 v82, v68, v69
    v_cvt_pk_bf16_f32 v83, v70, v71
    v_max3_f32 v24, v72, v73, v74
    v_max3_f32 v24, v24, v75, v76
    v_max3_f32 v24, v24, v77, v78
    v_max_f32 v24, v24, v79
    v_mov_b32 v25, v24
    s_nop 1
    v_permlane32_swap_b32 v24, v25
    s_nop 1
    v_max_f32 v24, v24, v25
    v_sub_f32 v72, v72, v24
    v_sub_f32 v73, v73, v24
    v_sub_f32 v74, v74, v24
    v_sub_f32 v75, v75, v24
    v_sub_f32 v76, v76, v24
    v_sub_f32 v77, v77, v24
    v_sub_f32 v78, v78, v24
    v_sub_f32 v79, v79, v24
    v_mul_f32 v72, s33, v72
    v_mul_f32 v73, s33, v73
    v_mul_f32 v74, s33, v74
    v_mul_f32 v75, s33, v75
    v_mul_f32 v76, s33, v76
    v_mul_f32 v77, s33, v77
    v_mul_f32 v78, s33, v78
    v_mul_f32 v79, s33, v79
    v_exp_f32 v72, v72
    v_exp_f32 v73, v73
    v_exp_f32 v74, v74
    v_exp_f32 v75, v75
    v_exp_f32 v76, v76
    v_exp_f32 v77, v77
    v_exp_f32 v78, v78
    v_exp_f32 v79, v79
    s_nop 0
    v_add_f32 v24, v72, v73
    v_add_f32 v24, v24, v74
    v_add_f32 v24, v24, v75
    v_add_f32 v24, v24, v76
    v_add_f32 v24, v24, v77
    v_add_f32 v24, v24, v78
    v_add_f32 v24, v24, v79
    v_mov_b32 v25, v24
    s_nop 1
    v_permlane32_swap_b32 v24, v25
    s_nop 1
    v_add_f32 v24, v24, v25
    v_rcp_f32 v24, v24
    s_nop 0
    v_mul_f32 v72, v72, v24
    v_mul_f32 v73, v73, v24
    v_mul_f32 v74, v74, v24
    v_mul_f32 v75, v75, v24
    v_mul_f32 v76, v76, v24
    v_mul_f32 v77, v77, v24
    v_mul_f32 v78, v78, v24
    v_mul_f32 v79, v79, v24
    v_cvt_pk_bf16_f32 v84, v72, v73
    v_cvt_pk_bf16_f32 v85, v74, v75
    v_cvt_pk_bf16_f32 v86, v76, v77
    v_cvt_pk_bf16_f32 v87, v78, v79
    s_cmp_eq_u32 s30, 3
    s_cbranch_scc1 K1_BQ2_0
    ds_write_b64 v22, v[80:81] offset:32768
    ds_write_b64 v22, v[82:83] offset:32784
    ds_write_b64 v22, v[84:85] offset:32800
    ds_write_b64 v22, v[86:87] offset:32816
    s_branch K1_BQD2_0
K1_BQ2_0:
    s_lshl_b32 s36, s34, 6
    s_lshl_b32 s37, s22, 3
    s_add_u32 s36, s36, s37
    s_lshl_b32 s37, s31, 2
    s_add_u32 s36, s36, s37
    s_add_u32 s36, s36, 0
    s_lshl_b32 s36, s36, 11
    s_add_u32 s36, s36, 67108864
    buffer_store_dwordx4 v[80:83], v18, s[16:19], s36 offen
    buffer_store_dwordx4 v[84:87], v18, s[16:19], s36 offen offset:1024
    s_nop 1
K1_BQD2_0:
    v_cvt_pk_bf16_f32 v88, v176, v177
    v_cvt_pk_bf16_f32 v89, v178, v179
    v_cvt_pk_bf16_f32 v90, v180, v181
    v_cvt_pk_bf16_f32 v91, v182, v183
    s_nop 1
    v_mfma_f32_32x32x16_bf16 v[64:79], v[60:63], v[88:91], 0
    s_nop 15
    v_cvt_pk_bf16_f32 v64, v64, v64
    v_lshlrev_b32 v64, 16, v64
    v_cvt_pk_bf16_f32 v65, v65, v65
    v_lshlrev_b32 v65, 16, v65
    v_cvt_pk_bf16_f32 v66, v66, v66
    v_lshlrev_b32 v66, 16, v66
    v_cvt_pk_bf16_f32 v67, v67, v67
    v_lshlrev_b32 v67, 16, v67
    v_cvt_pk_bf16_f32 v68, v68, v68
    v_lshlrev_b32 v68, 16, v68
    v_cvt_pk_bf16_f32 v69, v69, v69
    v_lshlrev_b32 v69, 16, v69
    v_cvt_pk_bf16_f32 v70, v70, v70
    v_lshlrev_b32 v70, 16, v70
    v_cvt_pk_bf16_f32 v71, v71, v71
    v_lshlrev_b32 v71, 16, v71
    v_cvt_pk_bf16_f32 v72, v72, v72
    v_lshlrev_b32 v72, 16, v72
    v_cvt_pk_bf16_f32 v73, v73, v73
    v_lshlrev_b32 v73, 16, v73
    v_cvt_pk_bf16_f32 v74, v74, v74
    v_lshlrev_b32 v74, 16, v74
    v_cvt_pk_bf16_f32 v75, v75, v75
    v_lshlrev_b32 v75, 16, v75
    v_cvt_pk_bf16_f32 v76, v76, v76
    v_lshlrev_b32 v76, 16, v76
    v_cvt_pk_bf16_f32 v77, v77, v77
    v_lshlrev_b32 v77, 16, v77
    v_cvt_pk_bf16_f32 v78, v78, v78
    v_lshlrev_b32 v78, 16, v78
    v_cvt_pk_bf16_f32 v79, v79, v79
    v_lshlrev_b32 v79, 16, v79
    v_max3_f32 v24, v64, v65, v66
    v_max3_f32 v24, v24, v67, v68
    v_max3_f32 v24, v24, v69, v70
    v_max_f32 v24, v24, v71
    v_mov_b32 v25, v24
    s_nop 1
    v_permlane32_swap_b32 v24, v25
    s_nop 1
    v_max_f32 v24, v24, v25
    v_sub_f32 v64, v64, v24
    v_sub_f32 v65, v65, v24
    v_sub_f32 v66, v66, v24
    v_sub_f32 v67, v67, v24
    v_sub_f32 v68, v68, v24
    v_sub_f32 v69, v69, v24
    v_sub_f32 v70, v70, v24
    v_sub_f32 v71, v71, v24
    v_mul_f32 v64, s33, v64
    v_mul_f32 v65, s33, v65
    v_mul_f32 v66, s33, v66
    v_mul_f32 v67, s33, v67
    v_mul_f32 v68, s33, v68
    v_mul_f32 v69, s33, v69
    v_mul_f32 v70, s33, v70
    v_mul_f32 v71, s33, v71
    v_exp_f32 v64, v64
    v_exp_f32 v65, v65
    v_exp_f32 v66, v66
    v_exp_f32 v67, v67
    v_exp_f32 v68, v68
    v_exp_f32 v69, v69
    v_exp_f32 v70, v70
    v_exp_f32 v71, v71
    s_nop 0
    v_add_f32 v24, v64, v65
    v_add_f32 v24, v24, v66
    v_add_f32 v24, v24, v67
    v_add_f32 v24, v24, v68
    v_add_f32 v24, v24, v69
    v_add_f32 v24, v24, v70
    v_add_f32 v24, v24, v71
    v_mov_b32 v25, v24
    s_nop 1
    v_permlane32_swap_b32 v24, v25
    s_nop 1
    v_add_f32 v24, v24, v25
    v_rcp_f32 v24, v24
    s_nop 0
    v_mul_f32 v64, v64, v24
    v_mul_f32 v65, v65, v24
    v_mul_f32 v66, v66, v24
    v_mul_f32 v67, v67, v24
    v_mul_f32 v68, v68, v24
    v_mul_f32 v69, v69, v24
    v_mul_f32 v70, v70, v24
    v_mul_f32 v71, v71, v24
    v_cvt_pk_bf16_f32 v80, v64, v65
    v_cvt_pk_bf16_f32 v81, v66, v67
    v_cvt_pk_bf16_f32 v82, v68, v69
    v_cvt_pk_bf16_f32 v83, v70, v71
    v_max3_f32 v24, v72, v73, v74
    v_max3_f32 v24, v24, v75, v76
    v_max3_f32 v24, v24, v77, v78
    v_max_f32 v24, v24, v79
    v_mov_b32 v25, v24
    s_nop 1
    v_permlane32_swap_b32 v24, v25
    s_nop 1
    v_max_f32 v24, v24, v25
    v_sub_f32 v72, v72, v24
    v_sub_f32 v73, v73, v24
    v_sub_f32 v74, v74, v24
    v_sub_f32 v75, v75, v24
    v_sub_f32 v76, v76, v24
    v_sub_f32 v77, v77, v24
    v_sub_f32 v78, v78, v24
    v_sub_f32 v79, v79, v24
    v_mul_f32 v72, s33, v72
    v_mul_f32 v73, s33, v73
    v_mul_f32 v74, s33, v74
    v_mul_f32 v75, s33, v75
    v_mul_f32 v76, s33, v76
    v_mul_f32 v77, s33, v77
    v_mul_f32 v78, s33, v78
    v_mul_f32 v79, s33, v79
    v_exp_f32 v72, v72
    v_exp_f32 v73, v73
    v_exp_f32 v74, v74
    v_exp_f32 v75, v75
    v_exp_f32 v76, v76
    v_exp_f32 v77, v77
    v_exp_f32 v78, v78
    v_exp_f32 v79, v79
    s_nop 0
    v_add_f32 v24, v72, v73
    v_add_f32 v24, v24, v74
    v_add_f32 v24, v24, v75
    v_add_f32 v24, v24, v76
    v_add_f32 v24, v24, v77
    v_add_f32 v24, v24, v78
    v_add_f32 v24, v24, v79
    v_mov_b32 v25, v24
    s_nop 1
    v_permlane32_swap_b32 v24, v25
    s_nop 1
    v_add_f32 v24, v24, v25
    v_rcp_f32 v24, v24
    s_nop 0
    v_mul_f32 v72, v72, v24
    v_mul_f32 v73, v73, v24
    v_mul_f32 v74, v74, v24
    v_mul_f32 v75, v75, v24
    v_mul_f32 v76, v76, v24
    v_mul_f32 v77, v77, v24
    v_mul_f32 v78, v78, v24
    v_mul_f32 v79, v79, v24
    v_cvt_pk_bf16_f32 v84, v72, v73
    v_cvt_pk_bf16_f32 v85, v74, v75
    v_cvt_pk_bf16_f32 v86, v76, v77
    v_cvt_pk_bf16_f32 v87, v78, v79
    s_cmp_eq_u32 s30, 3
    s_cbranch_scc1 K1_BQ2_1
    ds_write_b64 v22, v[80:81] offset:34816
    ds_write_b64 v22, v[82:83] offset:34832
    ds_write_b64 v22, v[84:85] offset:34848
    ds_write_b64 v22, v[86:87] offset:34864
    s_branch K1_BQD2_1
K1_BQ2_1:
    s_lshl_b32 s36, s34, 6
    s_lshl_b32 s37, s22, 3
    s_add_u32 s36, s36, s37
    s_lshl_b32 s37, s31, 2
    s_add_u32 s36, s36, s37
    s_add_u32 s36, s36, 1
    s_lshl_b32 s36, s36, 11
    s_add_u32 s36, s36, 67108864
    buffer_store_dwordx4 v[80:83], v18, s[16:19], s36 offen
    buffer_store_dwordx4 v[84:87], v18, s[16:19], s36 offen offset:1024
    s_nop 1
K1_BQD2_1:
    v_cvt_pk_bf16_f32 v88, v208, v209
    v_cvt_pk_bf16_f32 v89, v210, v211
    v_cvt_pk_bf16_f32 v90, v212, v213
    v_cvt_pk_bf16_f32 v91, v214, v215
    s_nop 1
    v_mfma_f32_32x32x16_bf16 v[64:79], v[60:63], v[88:91], 0
    s_nop 15
    v_cvt_pk_bf16_f32 v64, v64, v64
    v_lshlrev_b32 v64, 16, v64
    v_cvt_pk_bf16_f32 v65, v65, v65
    v_lshlrev_b32 v65, 16, v65
    v_cvt_pk_bf16_f32 v66, v66, v66
    v_lshlrev_b32 v66, 16, v66
    v_cvt_pk_bf16_f32 v67, v67, v67
    v_lshlrev_b32 v67, 16, v67
    v_cvt_pk_bf16_f32 v68, v68, v68
    v_lshlrev_b32 v68, 16, v68
    v_cvt_pk_bf16_f32 v69, v69, v69
    v_lshlrev_b32 v69, 16, v69
    v_cvt_pk_bf16_f32 v70, v70, v70
    v_lshlrev_b32 v70, 16, v70
    v_cvt_pk_bf16_f32 v71, v71, v71
    v_lshlrev_b32 v71, 16, v71
    v_cvt_pk_bf16_f32 v72, v72, v72
    v_lshlrev_b32 v72, 16, v72
    v_cvt_pk_bf16_f32 v73, v73, v73
    v_lshlrev_b32 v73, 16, v73
    v_cvt_pk_bf16_f32 v74, v74, v74
    v_lshlrev_b32 v74, 16, v74
    v_cvt_pk_bf16_f32 v75, v75, v75
    v_lshlrev_b32 v75, 16, v75
    v_cvt_pk_bf16_f32 v76, v76, v76
    v_lshlrev_b32 v76, 16, v76
    v_cvt_pk_bf16_f32 v77, v77, v77
    v_lshlrev_b32 v77, 16, v77
    v_cvt_pk_bf16_f32 v78, v78, v78
    v_lshlrev_b32 v78, 16, v78
    v_cvt_pk_bf16_f32 v79, v79, v79
    v_lshlrev_b32 v79, 16, v79
    v_max3_f32 v24, v64, v65, v66
    v_max3_f32 v24, v24, v67, v68
    v_max3_f32 v24, v24, v69, v70
    v_max_f32 v24, v24, v71
    v_mov_b32 v25, v24
    s_nop 1
    v_permlane32_swap_b32 v24, v25
    s_nop 1
    v_max_f32 v24, v24, v25
    v_sub_f32 v64, v64, v24
    v_sub_f32 v65, v65, v24
    v_sub_f32 v66, v66, v24
    v_sub_f32 v67, v67, v24
    v_sub_f32 v68, v68, v24
    v_sub_f32 v69, v69, v24
    v_sub_f32 v70, v70, v24
    v_sub_f32 v71, v71, v24
    v_mul_f32 v64, s33, v64
    v_mul_f32 v65, s33, v65
    v_mul_f32 v66, s33, v66
    v_mul_f32 v67, s33, v67
    v_mul_f32 v68, s33, v68
    v_mul_f32 v69, s33, v69
    v_mul_f32 v70, s33, v70
    v_mul_f32 v71, s33, v71
    v_exp_f32 v64, v64
    v_exp_f32 v65, v65
    v_exp_f32 v66, v66
    v_exp_f32 v67, v67
    v_exp_f32 v68, v68
    v_exp_f32 v69, v69
    v_exp_f32 v70, v70
    v_exp_f32 v71, v71
    s_nop 0
    v_add_f32 v24, v64, v65
    v_add_f32 v24, v24, v66
    v_add_f32 v24, v24, v67
    v_add_f32 v24, v24, v68
    v_add_f32 v24, v24, v69
    v_add_f32 v24, v24, v70
    v_add_f32 v24, v24, v71
    v_mov_b32 v25, v24
    s_nop 1
    v_permlane32_swap_b32 v24, v25
    s_nop 1
    v_add_f32 v24, v24, v25
    v_rcp_f32 v24, v24
    s_nop 0
    v_mul_f32 v64, v64, v24
    v_mul_f32 v65, v65, v24
    v_mul_f32 v66, v66, v24
    v_mul_f32 v67, v67, v24
    v_mul_f32 v68, v68, v24
    v_mul_f32 v69, v69, v24
    v_mul_f32 v70, v70, v24
    v_mul_f32 v71, v71, v24
    v_cvt_pk_bf16_f32 v80, v64, v65
    v_cvt_pk_bf16_f32 v81, v66, v67
    v_cvt_pk_bf16_f32 v82, v68, v69
    v_cvt_pk_bf16_f32 v83, v70, v71
    v_max3_f32 v24, v72, v73, v74
    v_max3_f32 v24, v24, v75, v76
    v_max3_f32 v24, v24, v77, v78
    v_max_f32 v24, v24, v79
    v_mov_b32 v25, v24
    s_nop 1
    v_permlane32_swap_b32 v24, v25
    s_nop 1
    v_max_f32 v24, v24, v25
    v_sub_f32 v72, v72, v24
    v_sub_f32 v73, v73, v24
    v_sub_f32 v74, v74, v24
    v_sub_f32 v75, v75, v24
    v_sub_f32 v76, v76, v24
    v_sub_f32 v77, v77, v24
    v_sub_f32 v78, v78, v24
    v_sub_f32 v79, v79, v24
    v_mul_f32 v72, s33, v72
    v_mul_f32 v73, s33, v73
    v_mul_f32 v74, s33, v74
    v_mul_f32 v75, s33, v75
    v_mul_f32 v76, s33, v76
    v_mul_f32 v77, s33, v77
    v_mul_f32 v78, s33, v78
    v_mul_f32 v79, s33, v79
    v_exp_f32 v72, v72
    v_exp_f32 v73, v73
    v_exp_f32 v74, v74
    v_exp_f32 v75, v75
    v_exp_f32 v76, v76
    v_exp_f32 v77, v77
    v_exp_f32 v78, v78
    v_exp_f32 v79, v79
    s_nop 0
    v_add_f32 v24, v72, v73
    v_add_f32 v24, v24, v74
    v_add_f32 v24, v24, v75
    v_add_f32 v24, v24, v76
    v_add_f32 v24, v24, v77
    v_add_f32 v24, v24, v78
    v_add_f32 v24, v24, v79
    v_mov_b32 v25, v24
    s_nop 1
    v_permlane32_swap_b32 v24, v25
    s_nop 1
    v_add_f32 v24, v24, v25
    v_rcp_f32 v24, v24
    s_nop 0
    v_mul_f32 v72, v72, v24
    v_mul_f32 v73, v73, v24
    v_mul_f32 v74, v74, v24
    v_mul_f32 v75, v75, v24
    v_mul_f32 v76, v76, v24
    v_mul_f32 v77, v77, v24
    v_mul_f32 v78, v78, v24
    v_mul_f32 v79, v79, v24
    v_cvt_pk_bf16_f32 v84, v72, v73
    v_cvt_pk_bf16_f32 v85, v74, v75
    v_cvt_pk_bf16_f32 v86, v76, v77
    v_cvt_pk_bf16_f32 v87, v78, v79
    s_cmp_eq_u32 s30, 3
    s_cbranch_scc1 K1_BQ2_2
    ds_write_b64 v22, v[80:81] offset:36864
    ds_write_b64 v22, v[82:83] offset:36880
    ds_write_b64 v22, v[84:85] offset:36896
    ds_write_b64 v22, v[86:87] offset:36912
    s_branch K1_BQD2_2
K1_BQ2_2:
    s_lshl_b32 s36, s34, 6
    s_lshl_b32 s37, s22, 3
    s_add_u32 s36, s36, s37
    s_lshl_b32 s37, s31, 2
    s_add_u32 s36, s36, s37
    s_add_u32 s36, s36, 2
    s_lshl_b32 s36, s36, 11
    s_add_u32 s36, s36, 67108864
    buffer_store_dwordx4 v[80:83], v18, s[16:19], s36 offen
    buffer_store_dwordx4 v[84:87], v18, s[16:19], s36 offen offset:1024
    s_nop 1
K1_BQD2_2:
    v_cvt_pk_bf16_f32 v88, v240, v241
    v_cvt_pk_bf16_f32 v89, v242, v243
    v_cvt_pk_bf16_f32 v90, v244, v245
    v_cvt_pk_bf16_f32 v91, v246, v247
    s_nop 1
    v_mfma_f32_32x32x16_bf16 v[64:79], v[60:63], v[88:91], 0
    s_nop 15
    v_cvt_pk_bf16_f32 v64, v64, v64
    v_lshlrev_b32 v64, 16, v64
    v_cvt_pk_bf16_f32 v65, v65, v65
    v_lshlrev_b32 v65, 16, v65
    v_cvt_pk_bf16_f32 v66, v66, v66
    v_lshlrev_b32 v66, 16, v66
    v_cvt_pk_bf16_f32 v67, v67, v67
    v_lshlrev_b32 v67, 16, v67
    v_cvt_pk_bf16_f32 v68, v68, v68
    v_lshlrev_b32 v68, 16, v68
    v_cvt_pk_bf16_f32 v69, v69, v69
    v_lshlrev_b32 v69, 16, v69
    v_cvt_pk_bf16_f32 v70, v70, v70
    v_lshlrev_b32 v70, 16, v70
    v_cvt_pk_bf16_f32 v71, v71, v71
    v_lshlrev_b32 v71, 16, v71
    v_cvt_pk_bf16_f32 v72, v72, v72
    v_lshlrev_b32 v72, 16, v72
    v_cvt_pk_bf16_f32 v73, v73, v73
    v_lshlrev_b32 v73, 16, v73
    v_cvt_pk_bf16_f32 v74, v74, v74
    v_lshlrev_b32 v74, 16, v74
    v_cvt_pk_bf16_f32 v75, v75, v75
    v_lshlrev_b32 v75, 16, v75
    v_cvt_pk_bf16_f32 v76, v76, v76
    v_lshlrev_b32 v76, 16, v76
    v_cvt_pk_bf16_f32 v77, v77, v77
    v_lshlrev_b32 v77, 16, v77
    v_cvt_pk_bf16_f32 v78, v78, v78
    v_lshlrev_b32 v78, 16, v78
    v_cvt_pk_bf16_f32 v79, v79, v79
    v_lshlrev_b32 v79, 16, v79
    v_max3_f32 v24, v64, v65, v66
    v_max3_f32 v24, v24, v67, v68
    v_max3_f32 v24, v24, v69, v70
    v_max_f32 v24, v24, v71
    v_mov_b32 v25, v24
    s_nop 1
    v_permlane32_swap_b32 v24, v25
    s_nop 1
    v_max_f32 v24, v24, v25
    v_sub_f32 v64, v64, v24
    v_sub_f32 v65, v65, v24
    v_sub_f32 v66, v66, v24
    v_sub_f32 v67, v67, v24
    v_sub_f32 v68, v68, v24
    v_sub_f32 v69, v69, v24
    v_sub_f32 v70, v70, v24
    v_sub_f32 v71, v71, v24
    v_mul_f32 v64, s33, v64
    v_mul_f32 v65, s33, v65
    v_mul_f32 v66, s33, v66
    v_mul_f32 v67, s33, v67
    v_mul_f32 v68, s33, v68
    v_mul_f32 v69, s33, v69
    v_mul_f32 v70, s33, v70
    v_mul_f32 v71, s33, v71
    v_exp_f32 v64, v64
    v_exp_f32 v65, v65
    v_exp_f32 v66, v66
    v_exp_f32 v67, v67
    v_exp_f32 v68, v68
    v_exp_f32 v69, v69
    v_exp_f32 v70, v70
    v_exp_f32 v71, v71
    s_nop 0
    v_add_f32 v24, v64, v65
    v_add_f32 v24, v24, v66
    v_add_f32 v24, v24, v67
    v_add_f32 v24, v24, v68
    v_add_f32 v24, v24, v69
    v_add_f32 v24, v24, v70
    v_add_f32 v24, v24, v71
    v_mov_b32 v25, v24
    s_nop 1
    v_permlane32_swap_b32 v24, v25
    s_nop 1
    v_add_f32 v24, v24, v25
    v_rcp_f32 v24, v24
    s_nop 0
    v_mul_f32 v64, v64, v24
    v_mul_f32 v65, v65, v24
    v_mul_f32 v66, v66, v24
    v_mul_f32 v67, v67, v24
    v_mul_f32 v68, v68, v24
    v_mul_f32 v69, v69, v24
    v_mul_f32 v70, v70, v24
    v_mul_f32 v71, v71, v24
    v_cvt_pk_bf16_f32 v80, v64, v65
    v_cvt_pk_bf16_f32 v81, v66, v67
    v_cvt_pk_bf16_f32 v82, v68, v69
    v_cvt_pk_bf16_f32 v83, v70, v71
    v_max3_f32 v24, v72, v73, v74
    v_max3_f32 v24, v24, v75, v76
    v_max3_f32 v24, v24, v77, v78
    v_max_f32 v24, v24, v79
    v_mov_b32 v25, v24
    s_nop 1
    v_permlane32_swap_b32 v24, v25
    s_nop 1
    v_max_f32 v24, v24, v25
    v_sub_f32 v72, v72, v24
    v_sub_f32 v73, v73, v24
    v_sub_f32 v74, v74, v24
    v_sub_f32 v75, v75, v24
    v_sub_f32 v76, v76, v24
    v_sub_f32 v77, v77, v24
    v_sub_f32 v78, v78, v24
    v_sub_f32 v79, v79, v24
    v_mul_f32 v72, s33, v72
    v_mul_f32 v73, s33, v73
    v_mul_f32 v74, s33, v74
    v_mul_f32 v75, s33, v75
    v_mul_f32 v76, s33, v76
    v_mul_f32 v77, s33, v77
    v_mul_f32 v78, s33, v78
    v_mul_f32 v79, s33, v79
    v_exp_f32 v72, v72
    v_exp_f32 v73, v73
    v_exp_f32 v74, v74
    v_exp_f32 v75, v75
    v_exp_f32 v76, v76
    v_exp_f32 v77, v77
    v_exp_f32 v78, v78
    v_exp_f32 v79, v79
    s_nop 0
    v_add_f32 v24, v72, v73
    v_add_f32 v24, v24, v74
    v_add_f32 v24, v24, v75
    v_add_f32 v24, v24, v76
    v_add_f32 v24, v24, v77
    v_add_f32 v24, v24, v78
    v_add_f32 v24, v24, v79
    v_mov_b32 v25, v24
    s_nop 1
    v_permlane32_swap_b32 v24, v25
    s_nop 1
    v_add_f32 v24, v24, v25
    v_rcp_f32 v24, v24
    s_nop 0
    v_mul_f32 v72, v72, v24
    v_mul_f32 v73, v73, v24
    v_mul_f32 v74, v74, v24
    v_mul_f32 v75, v75, v24
    v_mul_f32 v76, v76, v24
    v_mul_f32 v77, v77, v24
    v_mul_f32 v78, v78, v24
    v_mul_f32 v79, v79, v24
    v_cvt_pk_bf16_f32 v84, v72, v73
    v_cvt_pk_bf16_f32 v85, v74, v75
    v_cvt_pk_bf16_f32 v86, v76, v77
    v_cvt_pk_bf16_f32 v87, v78, v79
    s_cmp_eq_u32 s30, 3
    s_cbranch_scc1 K1_BQ2_3
    ds_write_b64 v22, v[80:81] offset:38912
    ds_write_b64 v22, v[82:83] offset:38928
    ds_write_b64 v22, v[84:85] offset:38944
    ds_write_b64 v22, v[86:87] offset:38960
    s_branch K1_BQD2_3
K1_BQ2_3:
    s_lshl_b32 s36, s34, 6
    s_lshl_b32 s37, s22, 3
    s_add_u32 s36, s36, s37
    s_lshl_b32 s37, s31, 2
    s_add_u32 s36, s36, s37
    s_add_u32 s36, s36, 3
    s_lshl_b32 s36, s36, 11
    s_add_u32 s36, s36, 67108864
    buffer_store_dwordx4 v[80:83], v18, s[16:19], s36 offen
    buffer_store_dwordx4 v[84:87], v18, s[16:19], s36 offen offset:1024
    s_nop 1
K1_BQD2_3:
    s_lshl_b32 s34, s23, 2
    s_add_u32 s34, s34, 3
    v_lshl_or_b32 v60, v53, 16, v52
    v_xor_b32 v60, v60, v21
    v_lshl_or_b32 v61, v55, 16, v54
    v_xor_b32 v61, v61, v21
    v_lshl_or_b32 v62, v57, 16, v56
    v_xor_b32 v62, v62, v21
    v_lshl_or_b32 v63, v59, 16, v58
    v_xor_b32 v63, v63, v21
    v_cvt_pk_bf16_f32 v88, v152, v153
    v_cvt_pk_bf16_f32 v89, v154, v155
    v_cvt_pk_bf16_f32 v90, v156, v157
    v_cvt_pk_bf16_f32 v91, v158, v159
    s_nop 1
    v_mfma_f32_32x32x16_bf16 v[64:79], v[60:63], v[88:91], 0
    s_nop 15
    v_cvt_pk_bf16_f32 v64, v64, v64
    v_lshlrev_b32 v64, 16, v64
    v_cvt_pk_bf16_f32 v65, v65, v65
    v_lshlrev_b32 v65, 16, v65
    v_cvt_pk_bf16_f32 v66, v66, v66
    v_lshlrev_b32 v66, 16, v66
    v_cvt_pk_bf16_f32 v67, v67, v67
    v_lshlrev_b32 v67, 16, v67
    v_cvt_pk_bf16_f32 v68, v68, v68
    v_lshlrev_b32 v68, 16, v68
    v_cvt_pk_bf16_f32 v69, v69, v69
    v_lshlrev_b32 v69, 16, v69
    v_cvt_pk_bf16_f32 v70, v70, v70
    v_lshlrev_b32 v70, 16, v70
    v_cvt_pk_bf16_f32 v71, v71, v71
    v_lshlrev_b32 v71, 16, v71
    v_cvt_pk_bf16_f32 v72, v72, v72
    v_lshlrev_b32 v72, 16, v72
    v_cvt_pk_bf16_f32 v73, v73, v73
    v_lshlrev_b32 v73, 16, v73
    v_cvt_pk_bf16_f32 v74, v74, v74
    v_lshlrev_b32 v74, 16, v74
    v_cvt_pk_bf16_f32 v75, v75, v75
    v_lshlrev_b32 v75, 16, v75
    v_cvt_pk_bf16_f32 v76, v76, v76
    v_lshlrev_b32 v76, 16, v76
    v_cvt_pk_bf16_f32 v77, v77, v77
    v_lshlrev_b32 v77, 16, v77
    v_cvt_pk_bf16_f32 v78, v78, v78
    v_lshlrev_b32 v78, 16, v78
    v_cvt_pk_bf16_f32 v79, v79, v79
    v_lshlrev_b32 v79, 16, v79
    v_max3_f32 v24, v64, v65, v66
    v_max3_f32 v24, v24, v67, v68
    v_max3_f32 v24, v24, v69, v70
    v_max_f32 v24, v24, v71
    v_mov_b32 v25, v24
    s_nop 1
    v_permlane32_swap_b32 v24, v25
    s_nop 1
    v_max_f32 v24, v24, v25
    v_sub_f32 v64, v64, v24
    v_sub_f32 v65, v65, v24
    v_sub_f32 v66, v66, v24
    v_sub_f32 v67, v67, v24
    v_sub_f32 v68, v68, v24
    v_sub_f32 v69, v69, v24
    v_sub_f32 v70, v70, v24
    v_sub_f32 v71, v71, v24
    v_mul_f32 v64, s33, v64
    v_mul_f32 v65, s33, v65
    v_mul_f32 v66, s33, v66
    v_mul_f32 v67, s33, v67
    v_mul_f32 v68, s33, v68
    v_mul_f32 v69, s33, v69
    v_mul_f32 v70, s33, v70
    v_mul_f32 v71, s33, v71
    v_exp_f32 v64, v64
    v_exp_f32 v65, v65
    v_exp_f32 v66, v66
    v_exp_f32 v67, v67
    v_exp_f32 v68, v68
    v_exp_f32 v69, v69
    v_exp_f32 v70, v70
    v_exp_f32 v71, v71
    s_nop 0
    v_add_f32 v24, v64, v65
    v_add_f32 v24, v24, v66
    v_add_f32 v24, v24, v67
    v_add_f32 v24, v24, v68
    v_add_f32 v24, v24, v69
    v_add_f32 v24, v24, v70
    v_add_f32 v24, v24, v71
    v_mov_b32 v25, v24
    s_nop 1
    v_permlane32_swap_b32 v24, v25
    s_nop 1
    v_add_f32 v24, v24, v25
    v_rcp_f32 v24, v24
    s_nop 0
    v_mul_f32 v64, v64, v24
    v_mul_f32 v65, v65, v24
    v_mul_f32 v66, v66, v24
    v_mul_f32 v67, v67, v24
    v_mul_f32 v68, v68, v24
    v_mul_f32 v69, v69, v24
    v_mul_f32 v70, v70, v24
    v_mul_f32 v71, v71, v24
    v_cvt_pk_bf16_f32 v80, v64, v65
    v_cvt_pk_bf16_f32 v81, v66, v67
    v_cvt_pk_bf16_f32 v82, v68, v69
    v_cvt_pk_bf16_f32 v83, v70, v71
    v_max3_f32 v24, v72, v73, v74
    v_max3_f32 v24, v24, v75, v76
    v_max3_f32 v24, v24, v77, v78
    v_max_f32 v24, v24, v79
    v_mov_b32 v25, v24
    s_nop 1
    v_permlane32_swap_b32 v24, v25
    s_nop 1
    v_max_f32 v24, v24, v25
    v_sub_f32 v72, v72, v24
    v_sub_f32 v73, v73, v24
    v_sub_f32 v74, v74, v24
    v_sub_f32 v75, v75, v24
    v_sub_f32 v76, v76, v24
    v_sub_f32 v77, v77, v24
    v_sub_f32 v78, v78, v24
    v_sub_f32 v79, v79, v24
    v_mul_f32 v72, s33, v72
    v_mul_f32 v73, s33, v73
    v_mul_f32 v74, s33, v74
    v_mul_f32 v75, s33, v75
    v_mul_f32 v76, s33, v76
    v_mul_f32 v77, s33, v77
    v_mul_f32 v78, s33, v78
    v_mul_f32 v79, s33, v79
    v_exp_f32 v72, v72
    v_exp_f32 v73, v73
    v_exp_f32 v74, v74
    v_exp_f32 v75, v75
    v_exp_f32 v76, v76
    v_exp_f32 v77, v77
    v_exp_f32 v78, v78
    v_exp_f32 v79, v79
    s_nop 0
    v_add_f32 v24, v72, v73
    v_add_f32 v24, v24, v74
    v_add_f32 v24, v24, v75
    v_add_f32 v24, v24, v76
    v_add_f32 v24, v24, v77
    v_add_f32 v24, v24, v78
    v_add_f32 v24, v24, v79
    v_mov_b32 v25, v24
    s_nop 1
    v_permlane32_swap_b32 v24, v25
    s_nop 1
    v_add_f32 v24, v24, v25
    v_rcp_f32 v24, v24
    s_nop 0
    v_mul_f32 v72, v72, v24
    v_mul_f32 v73, v73, v24
    v_mul_f32 v74, v74, v24
    v_mul_f32 v75, v75, v24
    v_mul_f32 v76, v76, v24
    v_mul_f32 v77, v77, v24
    v_mul_f32 v78, v78, v24
    v_mul_f32 v79, v79, v24
    v_cvt_pk_bf16_f32 v84, v72, v73
    v_cvt_pk_bf16_f32 v85, v74, v75
    v_cvt_pk_bf16_f32 v86, v76, v77
    v_cvt_pk_bf16_f32 v87, v78, v79
    s_cmp_eq_u32 s30, 3
    s_cbranch_scc1 K1_BQ3_0
    ds_write_b64 v22, v[80:81] offset:49152
    ds_write_b64 v22, v[82:83] offset:49168
    ds_write_b64 v22, v[84:85] offset:49184
    ds_write_b64 v22, v[86:87] offset:49200
    s_branch K1_BQD3_0
K1_BQ3_0:
    s_lshl_b32 s36, s34, 6
    s_lshl_b32 s37, s22, 3
    s_add_u32 s36, s36, s37
    s_lshl_b32 s37, s31, 2
    s_add_u32 s36, s36, s37
    s_add_u32 s36, s36, 0
    s_lshl_b32 s36, s36, 11
    s_add_u32 s36, s36, 67108864
    buffer_store_dwordx4 v[80:83], v18, s[16:19], s36 offen
    buffer_store_dwordx4 v[84:87], v18, s[16:19], s36 offen offset:1024
    s_nop 1
K1_BQD3_0:
    v_cvt_pk_bf16_f32 v88, v184, v185
    v_cvt_pk_bf16_f32 v89, v186, v187
    v_cvt_pk_bf16_f32 v90, v188, v189
    v_cvt_pk_bf16_f32 v91, v190, v191
    s_nop 1
    v_mfma_f32_32x32x16_bf16 v[64:79], v[60:63], v[88:91], 0
    s_nop 15
    v_cvt_pk_bf16_f32 v64, v64, v64
    v_lshlrev_b32 v64, 16, v64
    v_cvt_pk_bf16_f32 v65, v65, v65
    v_lshlrev_b32 v65, 16, v65
    v_cvt_pk_bf16_f32 v66, v66, v66
    v_lshlrev_b32 v66, 16, v66
    v_cvt_pk_bf16_f32 v67, v67, v67
    v_lshlrev_b32 v67, 16, v67
    v_cvt_pk_bf16_f32 v68, v68, v68
    v_lshlrev_b32 v68, 16, v68
    v_cvt_pk_bf16_f32 v69, v69, v69
    v_lshlrev_b32 v69, 16, v69
    v_cvt_pk_bf16_f32 v70, v70, v70
    v_lshlrev_b32 v70, 16, v70
    v_cvt_pk_bf16_f32 v71, v71, v71
    v_lshlrev_b32 v71, 16, v71
    v_cvt_pk_bf16_f32 v72, v72, v72
    v_lshlrev_b32 v72, 16, v72
    v_cvt_pk_bf16_f32 v73, v73, v73
    v_lshlrev_b32 v73, 16, v73
    v_cvt_pk_bf16_f32 v74, v74, v74
    v_lshlrev_b32 v74, 16, v74
    v_cvt_pk_bf16_f32 v75, v75, v75
    v_lshlrev_b32 v75, 16, v75
    v_cvt_pk_bf16_f32 v76, v76, v76
    v_lshlrev_b32 v76, 16, v76
    v_cvt_pk_bf16_f32 v77, v77, v77
    v_lshlrev_b32 v77, 16, v77
    v_cvt_pk_bf16_f32 v78, v78, v78
    v_lshlrev_b32 v78, 16, v78
    v_cvt_pk_bf16_f32 v79, v79, v79
    v_lshlrev_b32 v79, 16, v79
    v_max3_f32 v24, v64, v65, v66
    v_max3_f32 v24, v24, v67, v68
    v_max3_f32 v24, v24, v69, v70
    v_max_f32 v24, v24, v71
    v_mov_b32 v25, v24
    s_nop 1
    v_permlane32_swap_b32 v24, v25
    s_nop 1
    v_max_f32 v24, v24, v25
    v_sub_f32 v64, v64, v24
    v_sub_f32 v65, v65, v24
    v_sub_f32 v66, v66, v24
    v_sub_f32 v67, v67, v24
    v_sub_f32 v68, v68, v24
    v_sub_f32 v69, v69, v24
    v_sub_f32 v70, v70, v24
    v_sub_f32 v71, v71, v24
    v_mul_f32 v64, s33, v64
    v_mul_f32 v65, s33, v65
    v_mul_f32 v66, s33, v66
    v_mul_f32 v67, s33, v67
    v_mul_f32 v68, s33, v68
    v_mul_f32 v69, s33, v69
    v_mul_f32 v70, s33, v70
    v_mul_f32 v71, s33, v71
    v_exp_f32 v64, v64
    v_exp_f32 v65, v65
    v_exp_f32 v66, v66
    v_exp_f32 v67, v67
    v_exp_f32 v68, v68
    v_exp_f32 v69, v69
    v_exp_f32 v70, v70
    v_exp_f32 v71, v71
    s_nop 0
    v_add_f32 v24, v64, v65
    v_add_f32 v24, v24, v66
    v_add_f32 v24, v24, v67
    v_add_f32 v24, v24, v68
    v_add_f32 v24, v24, v69
    v_add_f32 v24, v24, v70
    v_add_f32 v24, v24, v71
    v_mov_b32 v25, v24
    s_nop 1
    v_permlane32_swap_b32 v24, v25
    s_nop 1
    v_add_f32 v24, v24, v25
    v_rcp_f32 v24, v24
    s_nop 0
    v_mul_f32 v64, v64, v24
    v_mul_f32 v65, v65, v24
    v_mul_f32 v66, v66, v24
    v_mul_f32 v67, v67, v24
    v_mul_f32 v68, v68, v24
    v_mul_f32 v69, v69, v24
    v_mul_f32 v70, v70, v24
    v_mul_f32 v71, v71, v24
    v_cvt_pk_bf16_f32 v80, v64, v65
    v_cvt_pk_bf16_f32 v81, v66, v67
    v_cvt_pk_bf16_f32 v82, v68, v69
    v_cvt_pk_bf16_f32 v83, v70, v71
    v_max3_f32 v24, v72, v73, v74
    v_max3_f32 v24, v24, v75, v76
    v_max3_f32 v24, v24, v77, v78
    v_max_f32 v24, v24, v79
    v_mov_b32 v25, v24
    s_nop 1
    v_permlane32_swap_b32 v24, v25
    s_nop 1
    v_max_f32 v24, v24, v25
    v_sub_f32 v72, v72, v24
    v_sub_f32 v73, v73, v24
    v_sub_f32 v74, v74, v24
    v_sub_f32 v75, v75, v24
    v_sub_f32 v76, v76, v24
    v_sub_f32 v77, v77, v24
    v_sub_f32 v78, v78, v24
    v_sub_f32 v79, v79, v24
    v_mul_f32 v72, s33, v72
    v_mul_f32 v73, s33, v73
    v_mul_f32 v74, s33, v74
    v_mul_f32 v75, s33, v75
    v_mul_f32 v76, s33, v76
    v_mul_f32 v77, s33, v77
    v_mul_f32 v78, s33, v78
    v_mul_f32 v79, s33, v79
    v_exp_f32 v72, v72
    v_exp_f32 v73, v73
    v_exp_f32 v74, v74
    v_exp_f32 v75, v75
    v_exp_f32 v76, v76
    v_exp_f32 v77, v77
    v_exp_f32 v78, v78
    v_exp_f32 v79, v79
    s_nop 0
    v_add_f32 v24, v72, v73
    v_add_f32 v24, v24, v74
    v_add_f32 v24, v24, v75
    v_add_f32 v24, v24, v76
    v_add_f32 v24, v24, v77
    v_add_f32 v24, v24, v78
    v_add_f32 v24, v24, v79
    v_mov_b32 v25, v24
    s_nop 1
    v_permlane32_swap_b32 v24, v25
    s_nop 1
    v_add_f32 v24, v24, v25
    v_rcp_f32 v24, v24
    s_nop 0
    v_mul_f32 v72, v72, v24
    v_mul_f32 v73, v73, v24
    v_mul_f32 v74, v74, v24
    v_mul_f32 v75, v75, v24
    v_mul_f32 v76, v76, v24
    v_mul_f32 v77, v77, v24
    v_mul_f32 v78, v78, v24
    v_mul_f32 v79, v79, v24
    v_cvt_pk_bf16_f32 v84, v72, v73
    v_cvt_pk_bf16_f32 v85, v74, v75
    v_cvt_pk_bf16_f32 v86, v76, v77
    v_cvt_pk_bf16_f32 v87, v78, v79
    s_cmp_eq_u32 s30, 3
    s_cbranch_scc1 K1_BQ3_1
    ds_write_b64 v22, v[80:81] offset:51200
    ds_write_b64 v22, v[82:83] offset:51216
    ds_write_b64 v22, v[84:85] offset:51232
    ds_write_b64 v22, v[86:87] offset:51248
    s_branch K1_BQD3_1
K1_BQ3_1:
    s_lshl_b32 s36, s34, 6
    s_lshl_b32 s37, s22, 3
    s_add_u32 s36, s36, s37
    s_lshl_b32 s37, s31, 2
    s_add_u32 s36, s36, s37
    s_add_u32 s36, s36, 1
    s_lshl_b32 s36, s36, 11
    s_add_u32 s36, s36, 67108864
    buffer_store_dwordx4 v[80:83], v18, s[16:19], s36 offen
    buffer_store_dwordx4 v[84:87], v18, s[16:19], s36 offen offset:1024
    s_nop 1
K1_BQD3_1:
    v_cvt_pk_bf16_f32 v88, v216, v217
    v_cvt_pk_bf16_f32 v89, v218, v219
    v_cvt_pk_bf16_f32 v90, v220, v221
    v_cvt_pk_bf16_f32 v91, v222, v223
    s_nop 1
    v_mfma_f32_32x32x16_bf16 v[64:79], v[60:63], v[88:91], 0
    s_nop 15
    v_cvt_pk_bf16_f32 v64, v64, v64
    v_lshlrev_b32 v64, 16, v64
    v_cvt_pk_bf16_f32 v65, v65, v65
    v_lshlrev_b32 v65, 16, v65
    v_cvt_pk_bf16_f32 v66, v66, v66
    v_lshlrev_b32 v66, 16, v66
    v_cvt_pk_bf16_f32 v67, v67, v67
    v_lshlrev_b32 v67, 16, v67
    v_cvt_pk_bf16_f32 v68, v68, v68
    v_lshlrev_b32 v68, 16, v68
    v_cvt_pk_bf16_f32 v69, v69, v69
    v_lshlrev_b32 v69, 16, v69
    v_cvt_pk_bf16_f32 v70, v70, v70
    v_lshlrev_b32 v70, 16, v70
    v_cvt_pk_bf16_f32 v71, v71, v71
    v_lshlrev_b32 v71, 16, v71
    v_cvt_pk_bf16_f32 v72, v72, v72
    v_lshlrev_b32 v72, 16, v72
    v_cvt_pk_bf16_f32 v73, v73, v73
    v_lshlrev_b32 v73, 16, v73
    v_cvt_pk_bf16_f32 v74, v74, v74
    v_lshlrev_b32 v74, 16, v74
    v_cvt_pk_bf16_f32 v75, v75, v75
    v_lshlrev_b32 v75, 16, v75
    v_cvt_pk_bf16_f32 v76, v76, v76
    v_lshlrev_b32 v76, 16, v76
    v_cvt_pk_bf16_f32 v77, v77, v77
    v_lshlrev_b32 v77, 16, v77
    v_cvt_pk_bf16_f32 v78, v78, v78
    v_lshlrev_b32 v78, 16, v78
    v_cvt_pk_bf16_f32 v79, v79, v79
    v_lshlrev_b32 v79, 16, v79
    v_max3_f32 v24, v64, v65, v66
    v_max3_f32 v24, v24, v67, v68
    v_max3_f32 v24, v24, v69, v70
    v_max_f32 v24, v24, v71
    v_mov_b32 v25, v24
    s_nop 1
    v_permlane32_swap_b32 v24, v25
    s_nop 1
    v_max_f32 v24, v24, v25
    v_sub_f32 v64, v64, v24
    v_sub_f32 v65, v65, v24
    v_sub_f32 v66, v66, v24
    v_sub_f32 v67, v67, v24
    v_sub_f32 v68, v68, v24
    v_sub_f32 v69, v69, v24
    v_sub_f32 v70, v70, v24
    v_sub_f32 v71, v71, v24
    v_mul_f32 v64, s33, v64
    v_mul_f32 v65, s33, v65
    v_mul_f32 v66, s33, v66
    v_mul_f32 v67, s33, v67
    v_mul_f32 v68, s33, v68
    v_mul_f32 v69, s33, v69
    v_mul_f32 v70, s33, v70
    v_mul_f32 v71, s33, v71
    v_exp_f32 v64, v64
    v_exp_f32 v65, v65
    v_exp_f32 v66, v66
    v_exp_f32 v67, v67
    v_exp_f32 v68, v68
    v_exp_f32 v69, v69
    v_exp_f32 v70, v70
    v_exp_f32 v71, v71
    s_nop 0
    v_add_f32 v24, v64, v65
    v_add_f32 v24, v24, v66
    v_add_f32 v24, v24, v67
    v_add_f32 v24, v24, v68
    v_add_f32 v24, v24, v69
    v_add_f32 v24, v24, v70
    v_add_f32 v24, v24, v71
    v_mov_b32 v25, v24
    s_nop 1
    v_permlane32_swap_b32 v24, v25
    s_nop 1
    v_add_f32 v24, v24, v25
    v_rcp_f32 v24, v24
    s_nop 0
    v_mul_f32 v64, v64, v24
    v_mul_f32 v65, v65, v24
    v_mul_f32 v66, v66, v24
    v_mul_f32 v67, v67, v24
    v_mul_f32 v68, v68, v24
    v_mul_f32 v69, v69, v24
    v_mul_f32 v70, v70, v24
    v_mul_f32 v71, v71, v24
    v_cvt_pk_bf16_f32 v80, v64, v65
    v_cvt_pk_bf16_f32 v81, v66, v67
    v_cvt_pk_bf16_f32 v82, v68, v69
    v_cvt_pk_bf16_f32 v83, v70, v71
    v_max3_f32 v24, v72, v73, v74
    v_max3_f32 v24, v24, v75, v76
    v_max3_f32 v24, v24, v77, v78
    v_max_f32 v24, v24, v79
    v_mov_b32 v25, v24
    s_nop 1
    v_permlane32_swap_b32 v24, v25
    s_nop 1
    v_max_f32 v24, v24, v25
    v_sub_f32 v72, v72, v24
    v_sub_f32 v73, v73, v24
    v_sub_f32 v74, v74, v24
    v_sub_f32 v75, v75, v24
    v_sub_f32 v76, v76, v24
    v_sub_f32 v77, v77, v24
    v_sub_f32 v78, v78, v24
    v_sub_f32 v79, v79, v24
    v_mul_f32 v72, s33, v72
    v_mul_f32 v73, s33, v73
    v_mul_f32 v74, s33, v74
    v_mul_f32 v75, s33, v75
    v_mul_f32 v76, s33, v76
    v_mul_f32 v77, s33, v77
    v_mul_f32 v78, s33, v78
    v_mul_f32 v79, s33, v79
    v_exp_f32 v72, v72
    v_exp_f32 v73, v73
    v_exp_f32 v74, v74
    v_exp_f32 v75, v75
    v_exp_f32 v76, v76
    v_exp_f32 v77, v77
    v_exp_f32 v78, v78
    v_exp_f32 v79, v79
    s_nop 0
    v_add_f32 v24, v72, v73
    v_add_f32 v24, v24, v74
    v_add_f32 v24, v24, v75
    v_add_f32 v24, v24, v76
    v_add_f32 v24, v24, v77
    v_add_f32 v24, v24, v78
    v_add_f32 v24, v24, v79
    v_mov_b32 v25, v24
    s_nop 1
    v_permlane32_swap_b32 v24, v25
    s_nop 1
    v_add_f32 v24, v24, v25
    v_rcp_f32 v24, v24
    s_nop 0
    v_mul_f32 v72, v72, v24
    v_mul_f32 v73, v73, v24
    v_mul_f32 v74, v74, v24
    v_mul_f32 v75, v75, v24
    v_mul_f32 v76, v76, v24
    v_mul_f32 v77, v77, v24
    v_mul_f32 v78, v78, v24
    v_mul_f32 v79, v79, v24
    v_cvt_pk_bf16_f32 v84, v72, v73
    v_cvt_pk_bf16_f32 v85, v74, v75
    v_cvt_pk_bf16_f32 v86, v76, v77
    v_cvt_pk_bf16_f32 v87, v78, v79
    s_cmp_eq_u32 s30, 3
    s_cbranch_scc1 K1_BQ3_2
    ds_write_b64 v22, v[80:81] offset:53248
    ds_write_b64 v22, v[82:83] offset:53264
    ds_write_b64 v22, v[84:85] offset:53280
    ds_write_b64 v22, v[86:87] offset:53296
    s_branch K1_BQD3_2
K1_BQ3_2:
    s_lshl_b32 s36, s34, 6
    s_lshl_b32 s37, s22, 3
    s_add_u32 s36, s36, s37
    s_lshl_b32 s37, s31, 2
    s_add_u32 s36, s36, s37
    s_add_u32 s36, s36, 2
    s_lshl_b32 s36, s36, 11
    s_add_u32 s36, s36, 67108864
    buffer_store_dwordx4 v[80:83], v18, s[16:19], s36 offen
    buffer_store_dwordx4 v[84:87], v18, s[16:19], s36 offen offset:1024
    s_nop 1
K1_BQD3_2:
    v_cvt_pk_bf16_f32 v88, v248, v249
    v_cvt_pk_bf16_f32 v89, v250, v251
    v_cvt_pk_bf16_f32 v90, v252, v253
    v_cvt_pk_bf16_f32 v91, v254, v255
    s_nop 1
    v_mfma_f32_32x32x16_bf16 v[64:79], v[60:63], v[88:91], 0
    s_nop 15
    v_cvt_pk_bf16_f32 v64, v64, v64
    v_lshlrev_b32 v64, 16, v64
    v_cvt_pk_bf16_f32 v65, v65, v65
    v_lshlrev_b32 v65, 16, v65
    v_cvt_pk_bf16_f32 v66, v66, v66
    v_lshlrev_b32 v66, 16, v66
    v_cvt_pk_bf16_f32 v67, v67, v67
    v_lshlrev_b32 v67, 16, v67
    v_cvt_pk_bf16_f32 v68, v68, v68
    v_lshlrev_b32 v68, 16, v68
    v_cvt_pk_bf16_f32 v69, v69, v69
    v_lshlrev_b32 v69, 16, v69
    v_cvt_pk_bf16_f32 v70, v70, v70
    v_lshlrev_b32 v70, 16, v70
    v_cvt_pk_bf16_f32 v71, v71, v71
    v_lshlrev_b32 v71, 16, v71
    v_cvt_pk_bf16_f32 v72, v72, v72
    v_lshlrev_b32 v72, 16, v72
    v_cvt_pk_bf16_f32 v73, v73, v73
    v_lshlrev_b32 v73, 16, v73
    v_cvt_pk_bf16_f32 v74, v74, v74
    v_lshlrev_b32 v74, 16, v74
    v_cvt_pk_bf16_f32 v75, v75, v75
    v_lshlrev_b32 v75, 16, v75
    v_cvt_pk_bf16_f32 v76, v76, v76
    v_lshlrev_b32 v76, 16, v76
    v_cvt_pk_bf16_f32 v77, v77, v77
    v_lshlrev_b32 v77, 16, v77
    v_cvt_pk_bf16_f32 v78, v78, v78
    v_lshlrev_b32 v78, 16, v78
    v_cvt_pk_bf16_f32 v79, v79, v79
    v_lshlrev_b32 v79, 16, v79
    v_max3_f32 v24, v64, v65, v66
    v_max3_f32 v24, v24, v67, v68
    v_max3_f32 v24, v24, v69, v70
    v_max_f32 v24, v24, v71
    v_mov_b32 v25, v24
    s_nop 1
    v_permlane32_swap_b32 v24, v25
    s_nop 1
    v_max_f32 v24, v24, v25
    v_sub_f32 v64, v64, v24
    v_sub_f32 v65, v65, v24
    v_sub_f32 v66, v66, v24
    v_sub_f32 v67, v67, v24
    v_sub_f32 v68, v68, v24
    v_sub_f32 v69, v69, v24
    v_sub_f32 v70, v70, v24
    v_sub_f32 v71, v71, v24
    v_mul_f32 v64, s33, v64
    v_mul_f32 v65, s33, v65
    v_mul_f32 v66, s33, v66
    v_mul_f32 v67, s33, v67
    v_mul_f32 v68, s33, v68
    v_mul_f32 v69, s33, v69
    v_mul_f32 v70, s33, v70
    v_mul_f32 v71, s33, v71
    v_exp_f32 v64, v64
    v_exp_f32 v65, v65
    v_exp_f32 v66, v66
    v_exp_f32 v67, v67
    v_exp_f32 v68, v68
    v_exp_f32 v69, v69
    v_exp_f32 v70, v70
    v_exp_f32 v71, v71
    s_nop 0
    v_add_f32 v24, v64, v65
    v_add_f32 v24, v24, v66
    v_add_f32 v24, v24, v67
    v_add_f32 v24, v24, v68
    v_add_f32 v24, v24, v69
    v_add_f32 v24, v24, v70
    v_add_f32 v24, v24, v71
    v_mov_b32 v25, v24
    s_nop 1
    v_permlane32_swap_b32 v24, v25
    s_nop 1
    v_add_f32 v24, v24, v25
    v_rcp_f32 v24, v24
    s_nop 0
    v_mul_f32 v64, v64, v24
    v_mul_f32 v65, v65, v24
    v_mul_f32 v66, v66, v24
    v_mul_f32 v67, v67, v24
    v_mul_f32 v68, v68, v24
    v_mul_f32 v69, v69, v24
    v_mul_f32 v70, v70, v24
    v_mul_f32 v71, v71, v24
    v_cvt_pk_bf16_f32 v80, v64, v65
    v_cvt_pk_bf16_f32 v81, v66, v67
    v_cvt_pk_bf16_f32 v82, v68, v69
    v_cvt_pk_bf16_f32 v83, v70, v71
    v_max3_f32 v24, v72, v73, v74
    v_max3_f32 v24, v24, v75, v76
    v_max3_f32 v24, v24, v77, v78
    v_max_f32 v24, v24, v79
    v_mov_b32 v25, v24
    s_nop 1
    v_permlane32_swap_b32 v24, v25
    s_nop 1
    v_max_f32 v24, v24, v25
    v_sub_f32 v72, v72, v24
    v_sub_f32 v73, v73, v24
    v_sub_f32 v74, v74, v24
    v_sub_f32 v75, v75, v24
    v_sub_f32 v76, v76, v24
    v_sub_f32 v77, v77, v24
    v_sub_f32 v78, v78, v24
    v_sub_f32 v79, v79, v24
    v_mul_f32 v72, s33, v72
    v_mul_f32 v73, s33, v73
    v_mul_f32 v74, s33, v74
    v_mul_f32 v75, s33, v75
    v_mul_f32 v76, s33, v76
    v_mul_f32 v77, s33, v77
    v_mul_f32 v78, s33, v78
    v_mul_f32 v79, s33, v79
    v_exp_f32 v72, v72
    v_exp_f32 v73, v73
    v_exp_f32 v74, v74
    v_exp_f32 v75, v75
    v_exp_f32 v76, v76
    v_exp_f32 v77, v77
    v_exp_f32 v78, v78
    v_exp_f32 v79, v79
    s_nop 0
    v_add_f32 v24, v72, v73
    v_add_f32 v24, v24, v74
    v_add_f32 v24, v24, v75
    v_add_f32 v24, v24, v76
    v_add_f32 v24, v24, v77
    v_add_f32 v24, v24, v78
    v_add_f32 v24, v24, v79
    v_mov_b32 v25, v24
    s_nop 1
    v_permlane32_swap_b32 v24, v25
    s_nop 1
    v_add_f32 v24, v24, v25
    v_rcp_f32 v24, v24
    s_nop 0
    v_mul_f32 v72, v72, v24
    v_mul_f32 v73, v73, v24
    v_mul_f32 v74, v74, v24
    v_mul_f32 v75, v75, v24
    v_mul_f32 v76, v76, v24
    v_mul_f32 v77, v77, v24
    v_mul_f32 v78, v78, v24
    v_mul_f32 v79, v79, v24
    v_cvt_pk_bf16_f32 v84, v72, v73
    v_cvt_pk_bf16_f32 v85, v74, v75
    v_cvt_pk_bf16_f32 v86, v76, v77
    v_cvt_pk_bf16_f32 v87, v78, v79
    s_cmp_eq_u32 s30, 3
    s_cbranch_scc1 K1_BQ3_3
    ds_write_b64 v22, v[80:81] offset:55296
    ds_write_b64 v22, v[82:83] offset:55312
    ds_write_b64 v22, v[84:85] offset:55328
    ds_write_b64 v22, v[86:87] offset:55344
    s_branch K1_BQD3_3
K1_BQ3_3:
    s_lshl_b32 s36, s34, 6
    s_lshl_b32 s37, s22, 3
    s_add_u32 s36, s36, s37
    s_lshl_b32 s37, s31, 2
    s_add_u32 s36, s36, s37
    s_add_u32 s36, s36, 3
    s_lshl_b32 s36, s36, 11
    s_add_u32 s36, s36, 67108864
    buffer_store_dwordx4 v[80:83], v18, s[16:19], s36 offen
    buffer_store_dwordx4 v[84:87], v18, s[16:19], s36 offen offset:1024
    s_nop 1
K1_BQD3_3:
    s_branch K1_BIDLE
K1_BGATE:
    buffer_load_dwordx4 v[20:23], v18, s[64:67], 0 offen
    s_lshl_b32 s34, s22, 8
    s_lshl_b32 s35, s23, 5
    s_add_u32 s34, s34, s35
    s_lshl_b32 s35, s31, 4
    s_add_u32 s34, s34, s35
    s_lshl_b32 s35, s34, 10
    s_add_u32 s36, s35, 0
    buffer_load_dwordx4 v[64:67], v18, s[8:11], s36 offen
    s_add_u32 s36, s35, 1024
    buffer_load_dwordx4 v[68:71], v18, s[8:11], s36 offen
    s_add_u32 s36, s35, 2048
    buffer_load_dwordx4 v[72:75], v18, s[8:11], s36 offen
    s_add_u32 s36, s35, 3072
    buffer_load_dwordx4 v[76:79], v18, s[8:11], s36 offen
    s_add_u32 s36, s35, 4096
    buffer_load_dwordx4 v[80:83], v18, s[8:11], s36 offen
    s_add_u32 s36, s35, 5120
    buffer_load_dwordx4 v[84:87], v18, s[8:11], s36 offen
    s_add_u32 s36, s35, 6144
    buffer_load_dwordx4 v[88:91], v18, s[8:11], s36 offen
    s_add_u32 s36, s35, 7168
    buffer_load_dwordx4 v[92:95], v18, s[8:11], s36 offen
    s_add_u32 s36, s35, 8192
    buffer_load_dwordx4 v[96:99], v18, s[8:11], s36 offen
    s_add_u32 s36, s35, 9216
    buffer_load_dwordx4 v[100:103], v18, s[8:11], s36 offen
    s_add_u32 s36, s35, 10240
    buffer_load_dwordx4 v[104:107], v18, s[8:11], s36 offen
    s_add_u32 s36, s35, 11264
    buffer_load_dwordx4 v[108:111], v18, s[8:11], s36 offen
    s_add_u32 s36, s35, 12288
    buffer_load_dwordx4 v[112:115], v18, s[8:11], s36 offen
    s_add_u32 s36, s35, 13312
    buffer_load_dwordx4 v[116:119], v18, s[8:11], s36 offen
    s_add_u32 s36, s35, 14336
    buffer_load_dwordx4 v[120:123], v18, s[8:11], s36 offen
    s_add_u32 s36, s35, 15360
    buffer_load_dwordx4 v[124:127], v18, s[8:11], s36 offen
    s_lshl_b32 s34, s34, 2
    s_add_u32 s34, s34, 76546048
    v_mov_b32 v138, 0
    v_lshlrev_b32 v141, 8, v19
    s_mov_b32 s36, 77594624
    buffer_store_dword v138, v141, s[16:19], s36 offen offset:0
    buffer_store_dword v138, v141, s[16:19], s36 offen offset:4
    buffer_store_dword v138, v141, s[16:19], s36 offen offset:8
    buffer_store_dword v138, v141, s[16:19], s36 offen offset:12
    buffer_store_dword v138, v141, s[16:19], s36 offen offset:16
    buffer_store_dword v138, v141, s[16:19], s36 offen offset:20
    buffer_store_dword v138, v141, s[16:19], s36 offen offset:24
    buffer_store_dword v138, v141, s[16:19], s36 offen offset:28
    buffer_store_dword v138, v141, s[16:19], s36 offen offset:128
    s_waitcnt vmcnt(25)
    v_lshlrev_b32 v128, 16, v20
    v_and_b32 v129, 0xffff0000, v20
    v_lshlrev_b32 v130, 16, v21
    v_and_b32 v131, 0xffff0000, v21
    v_lshlrev_b32 v132, 16, v22
    v_and_b32 v133, 0xffff0000, v22
    v_lshlrev_b32 v134, 16, v23
    v_and_b32 v135, 0xffff0000, v23
    s_waitcnt vmcnt(0)
    v_lshlrev_b32 v20, 16, v64
    v_and_b32 v21, 0xffff0000, v64
    v_lshlrev_b32 v22, 16, v65
    v_and_b32 v23, 0xffff0000, v65
    v_lshlrev_b32 v24, 16, v66
    v_and_b32 v25, 0xffff0000, v66
    v_lshlrev_b32 v26, 16, v67
    v_and_b32 v27, 0xffff0000, v67
    v_mul_f32 v20, v20, v128
    v_mul_f32 v21, v21, v129
    v_mul_f32 v22, v22, v130
    v_mul_f32 v23, v23, v131
    v_mul_f32 v24, v24, v132
    v_mul_f32 v25, v25, v133
    v_mul_f32 v26, v26, v134
    v_mul_f32 v27, v27, v135
    v_cvt_pk_bf16_f32 v20, v20, v20
    v_lshlrev_b32 v20, 16, v20
    v_cvt_pk_bf16_f32 v21, v21, v21
    v_lshlrev_b32 v21, 16, v21
    v_cvt_pk_bf16_f32 v22, v22, v22
    v_lshlrev_b32 v22, 16, v22
    v_cvt_pk_bf16_f32 v23, v23, v23
    v_lshlrev_b32 v23, 16, v23
    v_cvt_pk_bf16_f32 v24, v24, v24
    v_lshlrev_b32 v24, 16, v24
    v_cvt_pk_bf16_f32 v25, v25, v25
    v_lshlrev_b32 v25, 16, v25
    v_cvt_pk_bf16_f32 v26, v26, v26
    v_lshlrev_b32 v26, 16, v26
    v_cvt_pk_bf16_f32 v27, v27, v27
    v_lshlrev_b32 v27, 16, v27
    v_add_f32 v136, v20, v21
    v_add_f32 v136, v136, v22
    v_add_f32 v136, v136, v23
    v_add_f32 v136, v136, v24
    v_add_f32 v136, v136, v25
    v_add_f32 v136, v136, v26
    v_add_f32 v136, v136, v27
    s_nop 1
    v_add_f32_dpp v136, v136, v136 row_ror:8 row_mask:0xf bank_mask:0xf
    s_nop 1
    v_add_f32_dpp v136, v136, v136 row_ror:4 row_mask:0xf bank_mask:0xf
    s_nop 1
    v_add_f32_dpp v136, v136, v136 row_ror:2 row_mask:0xf bank_mask:0xf
    s_nop 1
    v_add_f32_dpp v136, v136, v136 row_ror:1 row_mask:0xf bank_mask:0xf
    s_nop 1
    v_readlane_b32 s36, v136, 0
    v_readlane_b32 s37, v136, 16
    v_readlane_b32 s38, v136, 32
    v_readlane_b32 s39, v136, 48
    s_nop 1
    v_mov_b32 v137, s36
    v_add_f32 v137, s37, v137
    v_add_f32 v137, s38, v137
    v_add_f32 v137, s39, v137
    v_cvt_pk_bf16_f32 v137, v137, v137
    v_lshlrev_b32 v137, 16, v137
    v_mul_f32 v137, 0xbfb8aa3b, v137
    v_exp_f32 v137, v137
    s_nop 0
    v_add_f32 v137, 1.0, v137
    v_rcp_f32 v137, v137
    s_nop 0
    v_cvt_pk_bf16_f32 v139, v137, v137
    v_lshlrev_b32 v139, 16, v139
    buffer_store_dword v139, v138, s[16:19], s34 offen offset:0
    v_lshlrev_b32 v20, 16, v68
    v_and_b32 v21, 0xffff0000, v68
    v_lshlrev_b32 v22, 16, v69
    v_and_b32 v23, 0xffff0000, v69
    v_lshlrev_b32 v24, 16, v70
    v_and_b32 v25, 0xffff0000, v70
    v_lshlrev_b32 v26, 16, v71
    v_and_b32 v27, 0xffff0000, v71
    v_mul_f32 v20, v20, v128
    v_mul_f32 v21, v21, v129
    v_mul_f32 v22, v22, v130
    v_mul_f32 v23, v23, v131
    v_mul_f32 v24, v24, v132
    v_mul_f32 v25, v25, v133
    v_mul_f32 v26, v26, v134
    v_mul_f32 v27, v27, v135
    v_cvt_pk_bf16_f32 v20, v20, v20
    v_lshlrev_b32 v20, 16, v20
    v_cvt_pk_bf16_f32 v21, v21, v21
    v_lshlrev_b32 v21, 16, v21
    v_cvt_pk_bf16_f32 v22, v22, v22
    v_lshlrev_b32 v22, 16, v22
    v_cvt_pk_bf16_f32 v23, v23, v23
    v_lshlrev_b32 v23, 16, v23
    v_cvt_pk_bf16_f32 v24, v24, v24
    v_lshlrev_b32 v24, 16, v24
    v_cvt_pk_bf16_f32 v25, v25, v25
    v_lshlrev_b32 v25, 16, v25
    v_cvt_pk_bf16_f32 v26, v26, v26
    v_lshlrev_b32 v26, 16, v26
    v_cvt_pk_bf16_f32 v27, v27, v27
    v_lshlrev_b32 v27, 16, v27
    v_add_f32 v136, v20, v21
    v_add_f32 v136, v136, v22
    v_add_f32 v136, v136, v23
    v_add_f32 v136, v136, v24
    v_add_f32 v136, v136, v25
    v_add_f32 v136, v136, v26
    v_add_f32 v136, v136, v27
    s_nop 1
    v_add_f32_dpp v136, v136, v136 row_ror:8 row_mask:0xf bank_mask:0xf
    s_nop 1
    v_add_f32_dpp v136, v136, v136 row_ror:4 row_mask:0xf bank_mask:0xf
    s_nop 1
    v_add_f32_dpp v136, v136, v136 row_ror:2 row_mask:0xf bank_mask:0xf
    s_nop 1
    v_add_f32_dpp v136, v136, v136 row_ror:1 row_mask:0xf bank_mask:0xf
    s_nop 1
    v_readlane_b32 s36, v136, 0
    v_readlane_b32 s37, v136, 16
    v_readlane_b32 s38, v136, 32
    v_readlane_b32 s39, v136, 48
    s_nop 1
    v_mov_b32 v137, s36
    v_add_f32 v137, s37, v137
    v_add_f32 v137, s38, v137
    v_add_f32 v137, s39, v137
    v_cvt_pk_bf16_f32 v137, v137, v137
    v_lshlrev_b32 v137, 16, v137
    v_mul_f32 v137, 0xbfb8aa3b, v137
    v_exp_f32 v137, v137
    s_nop 0
    v_add_f32 v137, 1.0, v137
    v_rcp_f32 v137, v137
    s_nop 0
    v_cvt_pk_bf16_f32 v140, v137, v137
    v_lshlrev_b32 v140, 16, v140
    buffer_store_dword v140, v138, s[16:19], s34 offen offset:4
    v_lshlrev_b32 v20, 16, v72
    v_and_b32 v21, 0xffff0000, v72
    v_lshlrev_b32 v22, 16, v73
    v_and_b32 v23, 0xffff0000, v73
    v_lshlrev_b32 v24, 16, v74
    v_and_b32 v25, 0xffff0000, v74
    v_lshlrev_b32 v26, 16, v75
    v_and_b32 v27, 0xffff0000, v75
    v_mul_f32 v20, v20, v128
    v_mul_f32 v21, v21, v129
    v_mul_f32 v22, v22, v130
    v_mul_f32 v23, v23, v131
    v_mul_f32 v24, v24, v132
    v_mul_f32 v25, v25, v133
    v_mul_f32 v26, v26, v134
    v_mul_f32 v27, v27, v135
    v_cvt_pk_bf16_f32 v20, v20, v20
    v_lshlrev_b32 v20, 16, v20
    v_cvt_pk_bf16_f32 v21, v21, v21
    v_lshlrev_b32 v21, 16, v21
    v_cvt_pk_bf16_f32 v22, v22, v22
    v_lshlrev_b32 v22, 16, v22
    v_cvt_pk_bf16_f32 v23, v23, v23
    v_lshlrev_b32 v23, 16, v23
    v_cvt_pk_bf16_f32 v24, v24, v24
    v_lshlrev_b32 v24, 16, v24
    v_cvt_pk_bf16_f32 v25, v25, v25
    v_lshlrev_b32 v25, 16, v25
    v_cvt_pk_bf16_f32 v26, v26, v26
    v_lshlrev_b32 v26, 16, v26
    v_cvt_pk_bf16_f32 v27, v27, v27
    v_lshlrev_b32 v27, 16, v27
    v_add_f32 v136, v20, v21
    v_add_f32 v136, v136, v22
    v_add_f32 v136, v136, v23
    v_add_f32 v136, v136, v24
    v_add_f32 v136, v136, v25
    v_add_f32 v136, v136, v26
    v_add_f32 v136, v136, v27
    s_nop 1
    v_add_f32_dpp v136, v136, v136 row_ror:8 row_mask:0xf bank_mask:0xf
    s_nop 1
    v_add_f32_dpp v136, v136, v136 row_ror:4 row_mask:0xf bank_mask:0xf
    s_nop 1
    v_add_f32_dpp v136, v136, v136 row_ror:2 row_mask:0xf bank_mask:0xf
    s_nop 1
    v_add_f32_dpp v136, v136, v136 row_ror:1 row_mask:0xf bank_mask:0xf
    s_nop 1
    v_readlane_b32 s36, v136, 0
    v_readlane_b32 s37, v136, 16
    v_readlane_b32 s38, v136, 32
    v_readlane_b32 s39, v136, 48
    s_nop 1
    v_mov_b32 v137, s36
    v_add_f32 v137, s37, v137
    v_add_f32 v137, s38, v137
    v_add_f32 v137, s39, v137
    v_cvt_pk_bf16_f32 v137, v137, v137
    v_lshlrev_b32 v137, 16, v137
    v_mul_f32 v137, 0xbfb8aa3b, v137
    v_exp_f32 v137, v137
    s_nop 0
    v_add_f32 v137, 1.0, v137
    v_rcp_f32 v137, v137
    s_nop 0
    v_cvt_pk_bf16_f32 v139, v137, v137
    v_lshlrev_b32 v139, 16, v139
    buffer_store_dword v139, v138, s[16:19], s34 offen offset:8
    v_lshlrev_b32 v20, 16, v76
    v_and_b32 v21, 0xffff0000, v76
    v_lshlrev_b32 v22, 16, v77
    v_and_b32 v23, 0xffff0000, v77
    v_lshlrev_b32 v24, 16, v78
    v_and_b32 v25, 0xffff0000, v78
    v_lshlrev_b32 v26, 16, v79
    v_and_b32 v27, 0xffff0000, v79
    v_mul_f32 v20, v20, v128
    v_mul_f32 v21, v21, v129
    v_mul_f32 v22, v22, v130
    v_mul_f32 v23, v23, v131
    v_mul_f32 v24, v24, v132
    v_mul_f32 v25, v25, v133
    v_mul_f32 v26, v26, v134
    v_mul_f32 v27, v27, v135
    v_cvt_pk_bf16_f32 v20, v20, v20
    v_lshlrev_b32 v20, 16, v20
    v_cvt_pk_bf16_f32 v21, v21, v21
    v_lshlrev_b32 v21, 16, v21
    v_cvt_pk_bf16_f32 v22, v22, v22
    v_lshlrev_b32 v22, 16, v22
    v_cvt_pk_bf16_f32 v23, v23, v23
    v_lshlrev_b32 v23, 16, v23
    v_cvt_pk_bf16_f32 v24, v24, v24
    v_lshlrev_b32 v24, 16, v24
    v_cvt_pk_bf16_f32 v25, v25, v25
    v_lshlrev_b32 v25, 16, v25
    v_cvt_pk_bf16_f32 v26, v26, v26
    v_lshlrev_b32 v26, 16, v26
    v_cvt_pk_bf16_f32 v27, v27, v27
    v_lshlrev_b32 v27, 16, v27
    v_add_f32 v136, v20, v21
    v_add_f32 v136, v136, v22
    v_add_f32 v136, v136, v23
    v_add_f32 v136, v136, v24
    v_add_f32 v136, v136, v25
    v_add_f32 v136, v136, v26
    v_add_f32 v136, v136, v27
    s_nop 1
    v_add_f32_dpp v136, v136, v136 row_ror:8 row_mask:0xf bank_mask:0xf
    s_nop 1
    v_add_f32_dpp v136, v136, v136 row_ror:4 row_mask:0xf bank_mask:0xf
    s_nop 1
    v_add_f32_dpp v136, v136, v136 row_ror:2 row_mask:0xf bank_mask:0xf
    s_nop 1
    v_add_f32_dpp v136, v136, v136 row_ror:1 row_mask:0xf bank_mask:0xf
    s_nop 1
    v_readlane_b32 s36, v136, 0
    v_readlane_b32 s37, v136, 16
    v_readlane_b32 s38, v136, 32
    v_readlane_b32 s39, v136, 48
    s_nop 1
    v_mov_b32 v137, s36
    v_add_f32 v137, s37, v137
    v_add_f32 v137, s38, v137
    v_add_f32 v137, s39, v137
    v_cvt_pk_bf16_f32 v137, v137, v137
    v_lshlrev_b32 v137, 16, v137
    v_mul_f32 v137, 0xbfb8aa3b, v137
    v_exp_f32 v137, v137
    s_nop 0
    v_add_f32 v137, 1.0, v137
    v_rcp_f32 v137, v137
    s_nop 0
    v_cvt_pk_bf16_f32 v140, v137, v137
    v_lshlrev_b32 v140, 16, v140
    buffer_store_dword v140, v138, s[16:19], s34 offen offset:12
    v_lshlrev_b32 v20, 16, v80
    v_and_b32 v21, 0xffff0000, v80
    v_lshlrev_b32 v22, 16, v81
    v_and_b32 v23, 0xffff0000, v81
    v_lshlrev_b32 v24, 16, v82
    v_and_b32 v25, 0xffff0000, v82
    v_lshlrev_b32 v26, 16, v83
    v_and_b32 v27, 0xffff0000, v83
    v_mul_f32 v20, v20, v128
    v_mul_f32 v21, v21, v129
    v_mul_f32 v22, v22, v130
    v_mul_f32 v23, v23, v131
    v_mul_f32 v24, v24, v132
    v_mul_f32 v25, v25, v133
    v_mul_f32 v26, v26, v134
    v_mul_f32 v27, v27, v135
    v_cvt_pk_bf16_f32 v20, v20, v20
    v_lshlrev_b32 v20, 16, v20
    v_cvt_pk_bf16_f32 v21, v21, v21
    v_lshlrev_b32 v21, 16, v21
    v_cvt_pk_bf16_f32 v22, v22, v22
    v_lshlrev_b32 v22, 16, v22
    v_cvt_pk_bf16_f32 v23, v23, v23
    v_lshlrev_b32 v23, 16, v23
    v_cvt_pk_bf16_f32 v24, v24, v24
    v_lshlrev_b32 v24, 16, v24
    v_cvt_pk_bf16_f32 v25, v25, v25
    v_lshlrev_b32 v25, 16, v25
    v_cvt_pk_bf16_f32 v26, v26, v26
    v_lshlrev_b32 v26, 16, v26
    v_cvt_pk_bf16_f32 v27, v27, v27
    v_lshlrev_b32 v27, 16, v27
    v_add_f32 v136, v20, v21
    v_add_f32 v136, v136, v22
    v_add_f32 v136, v136, v23
    v_add_f32 v136, v136, v24
    v_add_f32 v136, v136, v25
    v_add_f32 v136, v136, v26
    v_add_f32 v136, v136, v27
    s_nop 1
    v_add_f32_dpp v136, v136, v136 row_ror:8 row_mask:0xf bank_mask:0xf
    s_nop 1
    v_add_f32_dpp v136, v136, v136 row_ror:4 row_mask:0xf bank_mask:0xf
    s_nop 1
    v_add_f32_dpp v136, v136, v136 row_ror:2 row_mask:0xf bank_mask:0xf
    s_nop 1
    v_add_f32_dpp v136, v136, v136 row_ror:1 row_mask:0xf bank_mask:0xf
    s_nop 1
    v_readlane_b32 s36, v136, 0
    v_readlane_b32 s37, v136, 16
    v_readlane_b32 s38, v136, 32
    v_readlane_b32 s39, v136, 48
    s_nop 1
    v_mov_b32 v137, s36
    v_add_f32 v137, s37, v137
    v_add_f32 v137, s38, v137
    v_add_f32 v137, s39, v137
    v_cvt_pk_bf16_f32 v137, v137, v137
    v_lshlrev_b32 v137, 16, v137
    v_mul_f32 v137, 0xbfb8aa3b, v137
    v_exp_f32 v137, v137
    s_nop 0
    v_add_f32 v137, 1.0, v137
    v_rcp_f32 v137, v137
    s_nop 0
    v_cvt_pk_bf16_f32 v139, v137, v137
    v_lshlrev_b32 v139, 16, v139
    buffer_store_dword v139, v138, s[16:19], s34 offen offset:16
    v_lshlrev_b32 v20, 16, v84
    v_and_b32 v21, 0xffff0000, v84
    v_lshlrev_b32 v22, 16, v85
    v_and_b32 v23, 0xffff0000, v85
    v_lshlrev_b32 v24, 16, v86
    v_and_b32 v25, 0xffff0000, v86
    v_lshlrev_b32 v26, 16, v87
    v_and_b32 v27, 0xffff0000, v87
    v_mul_f32 v20, v20, v128
    v_mul_f32 v21, v21, v129
    v_mul_f32 v22, v22, v130
    v_mul_f32 v23, v23, v131
    v_mul_f32 v24, v24, v132
    v_mul_f32 v25, v25, v133
    v_mul_f32 v26, v26, v134
    v_mul_f32 v27, v27, v135
    v_cvt_pk_bf16_f32 v20, v20, v20
    v_lshlrev_b32 v20, 16, v20
    v_cvt_pk_bf16_f32 v21, v21, v21
    v_lshlrev_b32 v21, 16, v21
    v_cvt_pk_bf16_f32 v22, v22, v22
    v_lshlrev_b32 v22, 16, v22
    v_cvt_pk_bf16_f32 v23, v23, v23
    v_lshlrev_b32 v23, 16, v23
    v_cvt_pk_bf16_f32 v24, v24, v24
    v_lshlrev_b32 v24, 16, v24
    v_cvt_pk_bf16_f32 v25, v25, v25
    v_lshlrev_b32 v25, 16, v25
    v_cvt_pk_bf16_f32 v26, v26, v26
    v_lshlrev_b32 v26, 16, v26
    v_cvt_pk_bf16_f32 v27, v27, v27
    v_lshlrev_b32 v27, 16, v27
    v_add_f32 v136, v20, v21
    v_add_f32 v136, v136, v22
    v_add_f32 v136, v136, v23
    v_add_f32 v136, v136, v24
    v_add_f32 v136, v136, v25
    v_add_f32 v136, v136, v26
    v_add_f32 v136, v136, v27
    s_nop 1
    v_add_f32_dpp v136, v136, v136 row_ror:8 row_mask:0xf bank_mask:0xf
    s_nop 1
    v_add_f32_dpp v136, v136, v136 row_ror:4 row_mask:0xf bank_mask:0xf
    s_nop 1
    v_add_f32_dpp v136, v136, v136 row_ror:2 row_mask:0xf bank_mask:0xf
    s_nop 1
    v_add_f32_dpp v136, v136, v136 row_ror:1 row_mask:0xf bank_mask:0xf
    s_nop 1
    v_readlane_b32 s36, v136, 0
    v_readlane_b32 s37, v136, 16
    v_readlane_b32 s38, v136, 32
    v_readlane_b32 s39, v136, 48
    s_nop 1
    v_mov_b32 v137, s36
    v_add_f32 v137, s37, v137
    v_add_f32 v137, s38, v137
    v_add_f32 v137, s39, v137
    v_cvt_pk_bf16_f32 v137, v137, v137
    v_lshlrev_b32 v137, 16, v137
    v_mul_f32 v137, 0xbfb8aa3b, v137
    v_exp_f32 v137, v137
    s_nop 0
    v_add_f32 v137, 1.0, v137
    v_rcp_f32 v137, v137
    s_nop 0
    v_cvt_pk_bf16_f32 v140, v137, v137
    v_lshlrev_b32 v140, 16, v140
    buffer_store_dword v140, v138, s[16:19], s34 offen offset:20
    v_lshlrev_b32 v20, 16, v88
    v_and_b32 v21, 0xffff0000, v88
    v_lshlrev_b32 v22, 16, v89
    v_and_b32 v23, 0xffff0000, v89
    v_lshlrev_b32 v24, 16, v90
    v_and_b32 v25, 0xffff0000, v90
    v_lshlrev_b32 v26, 16, v91
    v_and_b32 v27, 0xffff0000, v91
    v_mul_f32 v20, v20, v128
    v_mul_f32 v21, v21, v129
    v_mul_f32 v22, v22, v130
    v_mul_f32 v23, v23, v131
    v_mul_f32 v24, v24, v132
    v_mul_f32 v25, v25, v133
    v_mul_f32 v26, v26, v134
    v_mul_f32 v27, v27, v135
    v_cvt_pk_bf16_f32 v20, v20, v20
    v_lshlrev_b32 v20, 16, v20
    v_cvt_pk_bf16_f32 v21, v21, v21
    v_lshlrev_b32 v21, 16, v21
    v_cvt_pk_bf16_f32 v22, v22, v22
    v_lshlrev_b32 v22, 16, v22
    v_cvt_pk_bf16_f32 v23, v23, v23
    v_lshlrev_b32 v23, 16, v23
    v_cvt_pk_bf16_f32 v24, v24, v24
    v_lshlrev_b32 v24, 16, v24
    v_cvt_pk_bf16_f32 v25, v25, v25
    v_lshlrev_b32 v25, 16, v25
    v_cvt_pk_bf16_f32 v26, v26, v26
    v_lshlrev_b32 v26, 16, v26
    v_cvt_pk_bf16_f32 v27, v27, v27
    v_lshlrev_b32 v27, 16, v27
    v_add_f32 v136, v20, v21
    v_add_f32 v136, v136, v22
    v_add_f32 v136, v136, v23
    v_add_f32 v136, v136, v24
    v_add_f32 v136, v136, v25
    v_add_f32 v136, v136, v26
    v_add_f32 v136, v136, v27
    s_nop 1
    v_add_f32_dpp v136, v136, v136 row_ror:8 row_mask:0xf bank_mask:0xf
    s_nop 1
    v_add_f32_dpp v136, v136, v136 row_ror:4 row_mask:0xf bank_mask:0xf
    s_nop 1
    v_add_f32_dpp v136, v136, v136 row_ror:2 row_mask:0xf bank_mask:0xf
    s_nop 1
    v_add_f32_dpp v136, v136, v136 row_ror:1 row_mask:0xf bank_mask:0xf
    s_nop 1
    v_readlane_b32 s36, v136, 0
    v_readlane_b32 s37, v136, 16
    v_readlane_b32 s38, v136, 32
    v_readlane_b32 s39, v136, 48
    s_nop 1
    v_mov_b32 v137, s36
    v_add_f32 v137, s37, v137
    v_add_f32 v137, s38, v137
    v_add_f32 v137, s39, v137
    v_cvt_pk_bf16_f32 v137, v137, v137
    v_lshlrev_b32 v137, 16, v137
    v_mul_f32 v137, 0xbfb8aa3b, v137
    v_exp_f32 v137, v137
    s_nop 0
    v_add_f32 v137, 1.0, v137
    v_rcp_f32 v137, v137
    s_nop 0
    v_cvt_pk_bf16_f32 v139, v137, v137
    v_lshlrev_b32 v139, 16, v139
    buffer_store_dword v139, v138, s[16:19], s34 offen offset:24
    v_lshlrev_b32 v20, 16, v92
    v_and_b32 v21, 0xffff0000, v92
    v_lshlrev_b32 v22, 16, v93
    v_and_b32 v23, 0xffff0000, v93
    v_lshlrev_b32 v24, 16, v94
    v_and_b32 v25, 0xffff0000, v94
    v_lshlrev_b32 v26, 16, v95
    v_and_b32 v27, 0xffff0000, v95
    v_mul_f32 v20, v20, v128
    v_mul_f32 v21, v21, v129
    v_mul_f32 v22, v22, v130
    v_mul_f32 v23, v23, v131
    v_mul_f32 v24, v24, v132
    v_mul_f32 v25, v25, v133
    v_mul_f32 v26, v26, v134
    v_mul_f32 v27, v27, v135
    v_cvt_pk_bf16_f32 v20, v20, v20
    v_lshlrev_b32 v20, 16, v20
    v_cvt_pk_bf16_f32 v21, v21, v21
    v_lshlrev_b32 v21, 16, v21
    v_cvt_pk_bf16_f32 v22, v22, v22
    v_lshlrev_b32 v22, 16, v22
    v_cvt_pk_bf16_f32 v23, v23, v23
    v_lshlrev_b32 v23, 16, v23
    v_cvt_pk_bf16_f32 v24, v24, v24
    v_lshlrev_b32 v24, 16, v24
    v_cvt_pk_bf16_f32 v25, v25, v25
    v_lshlrev_b32 v25, 16, v25
    v_cvt_pk_bf16_f32 v26, v26, v26
    v_lshlrev_b32 v26, 16, v26
    v_cvt_pk_bf16_f32 v27, v27, v27
    v_lshlrev_b32 v27, 16, v27
    v_add_f32 v136, v20, v21
    v_add_f32 v136, v136, v22
    v_add_f32 v136, v136, v23
    v_add_f32 v136, v136, v24
    v_add_f32 v136, v136, v25
    v_add_f32 v136, v136, v26
    v_add_f32 v136, v136, v27
    s_nop 1
    v_add_f32_dpp v136, v136, v136 row_ror:8 row_mask:0xf bank_mask:0xf
    s_nop 1
    v_add_f32_dpp v136, v136, v136 row_ror:4 row_mask:0xf bank_mask:0xf
    s_nop 1
    v_add_f32_dpp v136, v136, v136 row_ror:2 row_mask:0xf bank_mask:0xf
    s_nop 1
    v_add_f32_dpp v136, v136, v136 row_ror:1 row_mask:0xf bank_mask:0xf
    s_nop 1
    v_readlane_b32 s36, v136, 0
    v_readlane_b32 s37, v136, 16
    v_readlane_b32 s38, v136, 32
    v_readlane_b32 s39, v136, 48
    s_nop 1
    v_mov_b32 v137, s36
    v_add_f32 v137, s37, v137
    v_add_f32 v137, s38, v137
    v_add_f32 v137, s39, v137
    v_cvt_pk_bf16_f32 v137, v137, v137
    v_lshlrev_b32 v137, 16, v137
    v_mul_f32 v137, 0xbfb8aa3b, v137
    v_exp_f32 v137, v137
    s_nop 0
    v_add_f32 v137, 1.0, v137
    v_rcp_f32 v137, v137
    s_nop 0
    v_cvt_pk_bf16_f32 v140, v137, v137
    v_lshlrev_b32 v140, 16, v140
    buffer_store_dword v140, v138, s[16:19], s34 offen offset:28
    v_lshlrev_b32 v20, 16, v96
    v_and_b32 v21, 0xffff0000, v96
    v_lshlrev_b32 v22, 16, v97
    v_and_b32 v23, 0xffff0000, v97
    v_lshlrev_b32 v24, 16, v98
    v_and_b32 v25, 0xffff0000, v98
    v_lshlrev_b32 v26, 16, v99
    v_and_b32 v27, 0xffff0000, v99
    v_mul_f32 v20, v20, v128
    v_mul_f32 v21, v21, v129
    v_mul_f32 v22, v22, v130
    v_mul_f32 v23, v23, v131
    v_mul_f32 v24, v24, v132
    v_mul_f32 v25, v25, v133
    v_mul_f32 v26, v26, v134
    v_mul_f32 v27, v27, v135
    v_cvt_pk_bf16_f32 v20, v20, v20
    v_lshlrev_b32 v20, 16, v20
    v_cvt_pk_bf16_f32 v21, v21, v21
    v_lshlrev_b32 v21, 16, v21
    v_cvt_pk_bf16_f32 v22, v22, v22
    v_lshlrev_b32 v22, 16, v22
    v_cvt_pk_bf16_f32 v23, v23, v23
    v_lshlrev_b32 v23, 16, v23
    v_cvt_pk_bf16_f32 v24, v24, v24
    v_lshlrev_b32 v24, 16, v24
    v_cvt_pk_bf16_f32 v25, v25, v25
    v_lshlrev_b32 v25, 16, v25
    v_cvt_pk_bf16_f32 v26, v26, v26
    v_lshlrev_b32 v26, 16, v26
    v_cvt_pk_bf16_f32 v27, v27, v27
    v_lshlrev_b32 v27, 16, v27
    v_add_f32 v136, v20, v21
    v_add_f32 v136, v136, v22
    v_add_f32 v136, v136, v23
    v_add_f32 v136, v136, v24
    v_add_f32 v136, v136, v25
    v_add_f32 v136, v136, v26
    v_add_f32 v136, v136, v27
    s_nop 1
    v_add_f32_dpp v136, v136, v136 row_ror:8 row_mask:0xf bank_mask:0xf
    s_nop 1
    v_add_f32_dpp v136, v136, v136 row_ror:4 row_mask:0xf bank_mask:0xf
    s_nop 1
    v_add_f32_dpp v136, v136, v136 row_ror:2 row_mask:0xf bank_mask:0xf
    s_nop 1
    v_add_f32_dpp v136, v136, v136 row_ror:1 row_mask:0xf bank_mask:0xf
    s_nop 1
    v_readlane_b32 s36, v136, 0
    v_readlane_b32 s37, v136, 16
    v_readlane_b32 s38, v136, 32
    v_readlane_b32 s39, v136, 48
    s_nop 1
    v_mov_b32 v137, s36
    v_add_f32 v137, s37, v137
    v_add_f32 v137, s38, v137
    v_add_f32 v137, s39, v137
    v_cvt_pk_bf16_f32 v137, v137, v137
    v_lshlrev_b32 v137, 16, v137
    v_mul_f32 v137, 0xbfb8aa3b, v137
    v_exp_f32 v137, v137
    s_nop 0
    v_add_f32 v137, 1.0, v137
    v_rcp_f32 v137, v137
    s_nop 0
    v_cvt_pk_bf16_f32 v139, v137, v137
    v_lshlrev_b32 v139, 16, v139
    buffer_store_dword v139, v138, s[16:19], s34 offen offset:32
    v_lshlrev_b32 v20, 16, v100
    v_and_b32 v21, 0xffff0000, v100
    v_lshlrev_b32 v22, 16, v101
    v_and_b32 v23, 0xffff0000, v101
    v_lshlrev_b32 v24, 16, v102
    v_and_b32 v25, 0xffff0000, v102
    v_lshlrev_b32 v26, 16, v103
    v_and_b32 v27, 0xffff0000, v103
    v_mul_f32 v20, v20, v128
    v_mul_f32 v21, v21, v129
    v_mul_f32 v22, v22, v130
    v_mul_f32 v23, v23, v131
    v_mul_f32 v24, v24, v132
    v_mul_f32 v25, v25, v133
    v_mul_f32 v26, v26, v134
    v_mul_f32 v27, v27, v135
    v_cvt_pk_bf16_f32 v20, v20, v20
    v_lshlrev_b32 v20, 16, v20
    v_cvt_pk_bf16_f32 v21, v21, v21
    v_lshlrev_b32 v21, 16, v21
    v_cvt_pk_bf16_f32 v22, v22, v22
    v_lshlrev_b32 v22, 16, v22
    v_cvt_pk_bf16_f32 v23, v23, v23
    v_lshlrev_b32 v23, 16, v23
    v_cvt_pk_bf16_f32 v24, v24, v24
    v_lshlrev_b32 v24, 16, v24
    v_cvt_pk_bf16_f32 v25, v25, v25
    v_lshlrev_b32 v25, 16, v25
    v_cvt_pk_bf16_f32 v26, v26, v26
    v_lshlrev_b32 v26, 16, v26
    v_cvt_pk_bf16_f32 v27, v27, v27
    v_lshlrev_b32 v27, 16, v27
    v_add_f32 v136, v20, v21
    v_add_f32 v136, v136, v22
    v_add_f32 v136, v136, v23
    v_add_f32 v136, v136, v24
    v_add_f32 v136, v136, v25
    v_add_f32 v136, v136, v26
    v_add_f32 v136, v136, v27
    s_nop 1
    v_add_f32_dpp v136, v136, v136 row_ror:8 row_mask:0xf bank_mask:0xf
    s_nop 1
    v_add_f32_dpp v136, v136, v136 row_ror:4 row_mask:0xf bank_mask:0xf
    s_nop 1
    v_add_f32_dpp v136, v136, v136 row_ror:2 row_mask:0xf bank_mask:0xf
    s_nop 1
    v_add_f32_dpp v136, v136, v136 row_ror:1 row_mask:0xf bank_mask:0xf
    s_nop 1
    v_readlane_b32 s36, v136, 0
    v_readlane_b32 s37, v136, 16
    v_readlane_b32 s38, v136, 32
    v_readlane_b32 s39, v136, 48
    s_nop 1
    v_mov_b32 v137, s36
    v_add_f32 v137, s37, v137
    v_add_f32 v137, s38, v137
    v_add_f32 v137, s39, v137
    v_cvt_pk_bf16_f32 v137, v137, v137
    v_lshlrev_b32 v137, 16, v137
    v_mul_f32 v137, 0xbfb8aa3b, v137
    v_exp_f32 v137, v137
    s_nop 0
    v_add_f32 v137, 1.0, v137
    v_rcp_f32 v137, v137
    s_nop 0
    v_cvt_pk_bf16_f32 v140, v137, v137
    v_lshlrev_b32 v140, 16, v140
    buffer_store_dword v140, v138, s[16:19], s34 offen offset:36
    v_lshlrev_b32 v20, 16, v104
    v_and_b32 v21, 0xffff0000, v104
    v_lshlrev_b32 v22, 16, v105
    v_and_b32 v23, 0xffff0000, v105
    v_lshlrev_b32 v24, 16, v106
    v_and_b32 v25, 0xffff0000, v106
    v_lshlrev_b32 v26, 16, v107
    v_and_b32 v27, 0xffff0000, v107
    v_mul_f32 v20, v20, v128
    v_mul_f32 v21, v21, v129
    v_mul_f32 v22, v22, v130
    v_mul_f32 v23, v23, v131
    v_mul_f32 v24, v24, v132
    v_mul_f32 v25, v25, v133
    v_mul_f32 v26, v26, v134
    v_mul_f32 v27, v27, v135
    v_cvt_pk_bf16_f32 v20, v20, v20
    v_lshlrev_b32 v20, 16, v20
    v_cvt_pk_bf16_f32 v21, v21, v21
    v_lshlrev_b32 v21, 16, v21
    v_cvt_pk_bf16_f32 v22, v22, v22
    v_lshlrev_b32 v22, 16, v22
    v_cvt_pk_bf16_f32 v23, v23, v23
    v_lshlrev_b32 v23, 16, v23
    v_cvt_pk_bf16_f32 v24, v24, v24
    v_lshlrev_b32 v24, 16, v24
    v_cvt_pk_bf16_f32 v25, v25, v25
    v_lshlrev_b32 v25, 16, v25
    v_cvt_pk_bf16_f32 v26, v26, v26
    v_lshlrev_b32 v26, 16, v26
    v_cvt_pk_bf16_f32 v27, v27, v27
    v_lshlrev_b32 v27, 16, v27
    v_add_f32 v136, v20, v21
    v_add_f32 v136, v136, v22
    v_add_f32 v136, v136, v23
    v_add_f32 v136, v136, v24
    v_add_f32 v136, v136, v25
    v_add_f32 v136, v136, v26
    v_add_f32 v136, v136, v27
    s_nop 1
    v_add_f32_dpp v136, v136, v136 row_ror:8 row_mask:0xf bank_mask:0xf
    s_nop 1
    v_add_f32_dpp v136, v136, v136 row_ror:4 row_mask:0xf bank_mask:0xf
    s_nop 1
    v_add_f32_dpp v136, v136, v136 row_ror:2 row_mask:0xf bank_mask:0xf
    s_nop 1
    v_add_f32_dpp v136, v136, v136 row_ror:1 row_mask:0xf bank_mask:0xf
    s_nop 1
    v_readlane_b32 s36, v136, 0
    v_readlane_b32 s37, v136, 16
    v_readlane_b32 s38, v136, 32
    v_readlane_b32 s39, v136, 48
    s_nop 1
    v_mov_b32 v137, s36
    v_add_f32 v137, s37, v137
    v_add_f32 v137, s38, v137
    v_add_f32 v137, s39, v137
    v_cvt_pk_bf16_f32 v137, v137, v137
    v_lshlrev_b32 v137, 16, v137
    v_mul_f32 v137, 0xbfb8aa3b, v137
    v_exp_f32 v137, v137
    s_nop 0
    v_add_f32 v137, 1.0, v137
    v_rcp_f32 v137, v137
    s_nop 0
    v_cvt_pk_bf16_f32 v139, v137, v137
    v_lshlrev_b32 v139, 16, v139
    buffer_store_dword v139, v138, s[16:19], s34 offen offset:40
    v_lshlrev_b32 v20, 16, v108
    v_and_b32 v21, 0xffff0000, v108
    v_lshlrev_b32 v22, 16, v109
    v_and_b32 v23, 0xffff0000, v109
    v_lshlrev_b32 v24, 16, v110
    v_and_b32 v25, 0xffff0000, v110
    v_lshlrev_b32 v26, 16, v111
    v_and_b32 v27, 0xffff0000, v111
    v_mul_f32 v20, v20, v128
    v_mul_f32 v21, v21, v129
    v_mul_f32 v22, v22, v130
    v_mul_f32 v23, v23, v131
    v_mul_f32 v24, v24, v132
    v_mul_f32 v25, v25, v133
    v_mul_f32 v26, v26, v134
    v_mul_f32 v27, v27, v135
    v_cvt_pk_bf16_f32 v20, v20, v20
    v_lshlrev_b32 v20, 16, v20
    v_cvt_pk_bf16_f32 v21, v21, v21
    v_lshlrev_b32 v21, 16, v21
    v_cvt_pk_bf16_f32 v22, v22, v22
    v_lshlrev_b32 v22, 16, v22
    v_cvt_pk_bf16_f32 v23, v23, v23
    v_lshlrev_b32 v23, 16, v23
    v_cvt_pk_bf16_f32 v24, v24, v24
    v_lshlrev_b32 v24, 16, v24
    v_cvt_pk_bf16_f32 v25, v25, v25
    v_lshlrev_b32 v25, 16, v25
    v_cvt_pk_bf16_f32 v26, v26, v26
    v_lshlrev_b32 v26, 16, v26
    v_cvt_pk_bf16_f32 v27, v27, v27
    v_lshlrev_b32 v27, 16, v27
    v_add_f32 v136, v20, v21
    v_add_f32 v136, v136, v22
    v_add_f32 v136, v136, v23
    v_add_f32 v136, v136, v24
    v_add_f32 v136, v136, v25
    v_add_f32 v136, v136, v26
    v_add_f32 v136, v136, v27
    s_nop 1
    v_add_f32_dpp v136, v136, v136 row_ror:8 row_mask:0xf bank_mask:0xf
    s_nop 1
    v_add_f32_dpp v136, v136, v136 row_ror:4 row_mask:0xf bank_mask:0xf
    s_nop 1
    v_add_f32_dpp v136, v136, v136 row_ror:2 row_mask:0xf bank_mask:0xf
    s_nop 1
    v_add_f32_dpp v136, v136, v136 row_ror:1 row_mask:0xf bank_mask:0xf
    s_nop 1
    v_readlane_b32 s36, v136, 0
    v_readlane_b32 s37, v136, 16
    v_readlane_b32 s38, v136, 32
    v_readlane_b32 s39, v136, 48
    s_nop 1
    v_mov_b32 v137, s36
    v_add_f32 v137, s37, v137
    v_add_f32 v137, s38, v137
    v_add_f32 v137, s39, v137
    v_cvt_pk_bf16_f32 v137, v137, v137
    v_lshlrev_b32 v137, 16, v137
    v_mul_f32 v137, 0xbfb8aa3b, v137
    v_exp_f32 v137, v137
    s_nop 0
    v_add_f32 v137, 1.0, v137
    v_rcp_f32 v137, v137
    s_nop 0
    v_cvt_pk_bf16_f32 v140, v137, v137
    v_lshlrev_b32 v140, 16, v140
    buffer_store_dword v140, v138, s[16:19], s34 offen offset:44
    v_lshlrev_b32 v20, 16, v112
    v_and_b32 v21, 0xffff0000, v112
    v_lshlrev_b32 v22, 16, v113
    v_and_b32 v23, 0xffff0000, v113
    v_lshlrev_b32 v24, 16, v114
    v_and_b32 v25, 0xffff0000, v114
    v_lshlrev_b32 v26, 16, v115
    v_and_b32 v27, 0xffff0000, v115
    v_mul_f32 v20, v20, v128
    v_mul_f32 v21, v21, v129
    v_mul_f32 v22, v22, v130
    v_mul_f32 v23, v23, v131
    v_mul_f32 v24, v24, v132
    v_mul_f32 v25, v25, v133
    v_mul_f32 v26, v26, v134
    v_mul_f32 v27, v27, v135
    v_cvt_pk_bf16_f32 v20, v20, v20
    v_lshlrev_b32 v20, 16, v20
    v_cvt_pk_bf16_f32 v21, v21, v21
    v_lshlrev_b32 v21, 16, v21
    v_cvt_pk_bf16_f32 v22, v22, v22
    v_lshlrev_b32 v22, 16, v22
    v_cvt_pk_bf16_f32 v23, v23, v23
    v_lshlrev_b32 v23, 16, v23
    v_cvt_pk_bf16_f32 v24, v24, v24
    v_lshlrev_b32 v24, 16, v24
    v_cvt_pk_bf16_f32 v25, v25, v25
    v_lshlrev_b32 v25, 16, v25
    v_cvt_pk_bf16_f32 v26, v26, v26
    v_lshlrev_b32 v26, 16, v26
    v_cvt_pk_bf16_f32 v27, v27, v27
    v_lshlrev_b32 v27, 16, v27
    v_add_f32 v136, v20, v21
    v_add_f32 v136, v136, v22
    v_add_f32 v136, v136, v23
    v_add_f32 v136, v136, v24
    v_add_f32 v136, v136, v25
    v_add_f32 v136, v136, v26
    v_add_f32 v136, v136, v27
    s_nop 1
    v_add_f32_dpp v136, v136, v136 row_ror:8 row_mask:0xf bank_mask:0xf
    s_nop 1
    v_add_f32_dpp v136, v136, v136 row_ror:4 row_mask:0xf bank_mask:0xf
    s_nop 1
    v_add_f32_dpp v136, v136, v136 row_ror:2 row_mask:0xf bank_mask:0xf
    s_nop 1
    v_add_f32_dpp v136, v136, v136 row_ror:1 row_mask:0xf bank_mask:0xf
    s_nop 1
    v_readlane_b32 s36, v136, 0
    v_readlane_b32 s37, v136, 16
    v_readlane_b32 s38, v136, 32
    v_readlane_b32 s39, v136, 48
    s_nop 1
    v_mov_b32 v137, s36
    v_add_f32 v137, s37, v137
    v_add_f32 v137, s38, v137
    v_add_f32 v137, s39, v137
    v_cvt_pk_bf16_f32 v137, v137, v137
    v_lshlrev_b32 v137, 16, v137
    v_mul_f32 v137, 0xbfb8aa3b, v137
    v_exp_f32 v137, v137
    s_nop 0
    v_add_f32 v137, 1.0, v137
    v_rcp_f32 v137, v137
    s_nop 0
    v_cvt_pk_bf16_f32 v139, v137, v137
    v_lshlrev_b32 v139, 16, v139
    buffer_store_dword v139, v138, s[16:19], s34 offen offset:48
    v_lshlrev_b32 v20, 16, v116
    v_and_b32 v21, 0xffff0000, v116
    v_lshlrev_b32 v22, 16, v117
    v_and_b32 v23, 0xffff0000, v117
    v_lshlrev_b32 v24, 16, v118
    v_and_b32 v25, 0xffff0000, v118
    v_lshlrev_b32 v26, 16, v119
    v_and_b32 v27, 0xffff0000, v119
    v_mul_f32 v20, v20, v128
    v_mul_f32 v21, v21, v129
    v_mul_f32 v22, v22, v130
    v_mul_f32 v23, v23, v131
    v_mul_f32 v24, v24, v132
    v_mul_f32 v25, v25, v133
    v_mul_f32 v26, v26, v134
    v_mul_f32 v27, v27, v135
    v_cvt_pk_bf16_f32 v20, v20, v20
    v_lshlrev_b32 v20, 16, v20
    v_cvt_pk_bf16_f32 v21, v21, v21
    v_lshlrev_b32 v21, 16, v21
    v_cvt_pk_bf16_f32 v22, v22, v22
    v_lshlrev_b32 v22, 16, v22
    v_cvt_pk_bf16_f32 v23, v23, v23
    v_lshlrev_b32 v23, 16, v23
    v_cvt_pk_bf16_f32 v24, v24, v24
    v_lshlrev_b32 v24, 16, v24
    v_cvt_pk_bf16_f32 v25, v25, v25
    v_lshlrev_b32 v25, 16, v25
    v_cvt_pk_bf16_f32 v26, v26, v26
    v_lshlrev_b32 v26, 16, v26
    v_cvt_pk_bf16_f32 v27, v27, v27
    v_lshlrev_b32 v27, 16, v27
    v_add_f32 v136, v20, v21
    v_add_f32 v136, v136, v22
    v_add_f32 v136, v136, v23
    v_add_f32 v136, v136, v24
    v_add_f32 v136, v136, v25
    v_add_f32 v136, v136, v26
    v_add_f32 v136, v136, v27
    s_nop 1
    v_add_f32_dpp v136, v136, v136 row_ror:8 row_mask:0xf bank_mask:0xf
    s_nop 1
    v_add_f32_dpp v136, v136, v136 row_ror:4 row_mask:0xf bank_mask:0xf
    s_nop 1
    v_add_f32_dpp v136, v136, v136 row_ror:2 row_mask:0xf bank_mask:0xf
    s_nop 1
    v_add_f32_dpp v136, v136, v136 row_ror:1 row_mask:0xf bank_mask:0xf
    s_nop 1
    v_readlane_b32 s36, v136, 0
    v_readlane_b32 s37, v136, 16
    v_readlane_b32 s38, v136, 32
    v_readlane_b32 s39, v136, 48
    s_nop 1
    v_mov_b32 v137, s36
    v_add_f32 v137, s37, v137
    v_add_f32 v137, s38, v137
    v_add_f32 v137, s39, v137
    v_cvt_pk_bf16_f32 v137, v137, v137
    v_lshlrev_b32 v137, 16, v137
    v_mul_f32 v137, 0xbfb8aa3b, v137
    v_exp_f32 v137, v137
    s_nop 0
    v_add_f32 v137, 1.0, v137
    v_rcp_f32 v137, v137
    s_nop 0
    v_cvt_pk_bf16_f32 v140, v137, v137
    v_lshlrev_b32 v140, 16, v140
    buffer_store_dword v140, v138, s[16:19], s34 offen offset:52
    v_lshlrev_b32 v20, 16, v120
    v_and_b32 v21, 0xffff0000, v120
    v_lshlrev_b32 v22, 16, v121
    v_and_b32 v23, 0xffff0000, v121
    v_lshlrev_b32 v24, 16, v122
    v_and_b32 v25, 0xffff0000, v122
    v_lshlrev_b32 v26, 16, v123
    v_and_b32 v27, 0xffff0000, v123
    v_mul_f32 v20, v20, v128
    v_mul_f32 v21, v21, v129
    v_mul_f32 v22, v22, v130
    v_mul_f32 v23, v23, v131
    v_mul_f32 v24, v24, v132
    v_mul_f32 v25, v25, v133
    v_mul_f32 v26, v26, v134
    v_mul_f32 v27, v27, v135
    v_cvt_pk_bf16_f32 v20, v20, v20
    v_lshlrev_b32 v20, 16, v20
    v_cvt_pk_bf16_f32 v21, v21, v21
    v_lshlrev_b32 v21, 16, v21
    v_cvt_pk_bf16_f32 v22, v22, v22
    v_lshlrev_b32 v22, 16, v22
    v_cvt_pk_bf16_f32 v23, v23, v23
    v_lshlrev_b32 v23, 16, v23
    v_cvt_pk_bf16_f32 v24, v24, v24
    v_lshlrev_b32 v24, 16, v24
    v_cvt_pk_bf16_f32 v25, v25, v25
    v_lshlrev_b32 v25, 16, v25
    v_cvt_pk_bf16_f32 v26, v26, v26
    v_lshlrev_b32 v26, 16, v26
    v_cvt_pk_bf16_f32 v27, v27, v27
    v_lshlrev_b32 v27, 16, v27
    v_add_f32 v136, v20, v21
    v_add_f32 v136, v136, v22
    v_add_f32 v136, v136, v23
    v_add_f32 v136, v136, v24
    v_add_f32 v136, v136, v25
    v_add_f32 v136, v136, v26
    v_add_f32 v136, v136, v27
    s_nop 1
    v_add_f32_dpp v136, v136, v136 row_ror:8 row_mask:0xf bank_mask:0xf
    s_nop 1
    v_add_f32_dpp v136, v136, v136 row_ror:4 row_mask:0xf bank_mask:0xf
    s_nop 1
    v_add_f32_dpp v136, v136, v136 row_ror:2 row_mask:0xf bank_mask:0xf
    s_nop 1
    v_add_f32_dpp v136, v136, v136 row_ror:1 row_mask:0xf bank_mask:0xf
    s_nop 1
    v_readlane_b32 s36, v136, 0
    v_readlane_b32 s37, v136, 16
    v_readlane_b32 s38, v136, 32
    v_readlane_b32 s39, v136, 48
    s_nop 1
    v_mov_b32 v137, s36
    v_add_f32 v137, s37, v137
    v_add_f32 v137, s38, v137
    v_add_f32 v137, s39, v137
    v_cvt_pk_bf16_f32 v137, v137, v137
    v_lshlrev_b32 v137, 16, v137
    v_mul_f32 v137, 0xbfb8aa3b, v137
    v_exp_f32 v137, v137
    s_nop 0
    v_add_f32 v137, 1.0, v137
    v_rcp_f32 v137, v137
    s_nop 0
    v_cvt_pk_bf16_f32 v139, v137, v137
    v_lshlrev_b32 v139, 16, v139
    buffer_store_dword v139, v138, s[16:19], s34 offen offset:56
    v_lshlrev_b32 v20, 16, v124
    v_and_b32 v21, 0xffff0000, v124
    v_lshlrev_b32 v22, 16, v125
    v_and_b32 v23, 0xffff0000, v125
    v_lshlrev_b32 v24, 16, v126
    v_and_b32 v25, 0xffff0000, v126
    v_lshlrev_b32 v26, 16, v127
    v_and_b32 v27, 0xffff0000, v127
    v_mul_f32 v20, v20, v128
    v_mul_f32 v21, v21, v129
    v_mul_f32 v22, v22, v130
    v_mul_f32 v23, v23, v131
    v_mul_f32 v24, v24, v132
    v_mul_f32 v25, v25, v133
    v_mul_f32 v26, v26, v134
    v_mul_f32 v27, v27, v135
    v_cvt_pk_bf16_f32 v20, v20, v20
    v_lshlrev_b32 v20, 16, v20
    v_cvt_pk_bf16_f32 v21, v21, v21
    v_lshlrev_b32 v21, 16, v21
    v_cvt_pk_bf16_f32 v22, v22, v22
    v_lshlrev_b32 v22, 16, v22
    v_cvt_pk_bf16_f32 v23, v23, v23
    v_lshlrev_b32 v23, 16, v23
    v_cvt_pk_bf16_f32 v24, v24, v24
    v_lshlrev_b32 v24, 16, v24
    v_cvt_pk_bf16_f32 v25, v25, v25
    v_lshlrev_b32 v25, 16, v25
    v_cvt_pk_bf16_f32 v26, v26, v26
    v_lshlrev_b32 v26, 16, v26
    v_cvt_pk_bf16_f32 v27, v27, v27
    v_lshlrev_b32 v27, 16, v27
    v_add_f32 v136, v20, v21
    v_add_f32 v136, v136, v22
    v_add_f32 v136, v136, v23
    v_add_f32 v136, v136, v24
    v_add_f32 v136, v136, v25
    v_add_f32 v136, v136, v26
    v_add_f32 v136, v136, v27
    s_nop 1
    v_add_f32_dpp v136, v136, v136 row_ror:8 row_mask:0xf bank_mask:0xf
    s_nop 1
    v_add_f32_dpp v136, v136, v136 row_ror:4 row_mask:0xf bank_mask:0xf
    s_nop 1
    v_add_f32_dpp v136, v136, v136 row_ror:2 row_mask:0xf bank_mask:0xf
    s_nop 1
    v_add_f32_dpp v136, v136, v136 row_ror:1 row_mask:0xf bank_mask:0xf
    s_nop 1
    v_readlane_b32 s36, v136, 0
    v_readlane_b32 s37, v136, 16
    v_readlane_b32 s38, v136, 32
    v_readlane_b32 s39, v136, 48
    s_nop 1
    v_mov_b32 v137, s36
    v_add_f32 v137, s37, v137
    v_add_f32 v137, s38, v137
    v_add_f32 v137, s39, v137
    v_cvt_pk_bf16_f32 v137, v137, v137
    v_lshlrev_b32 v137, 16, v137
    v_mul_f32 v137, 0xbfb8aa3b, v137
    v_exp_f32 v137, v137
    s_nop 0
    v_add_f32 v137, 1.0, v137
    v_rcp_f32 v137, v137
    s_nop 0
    v_cvt_pk_bf16_f32 v140, v137, v137
    v_lshlrev_b32 v140, 16, v140
    buffer_store_dword v140, v138, s[16:19], s34 offen offset:60
K1_BIDLE:
    s_waitcnt lgkmcnt(0)
    s_barrier
    s_endpgm
K1_BV:
    v_cvt_pk_bf16_f32 v40, v128, v129
    v_cvt_pk_bf16_f32 v41, v130, v131
    v_cvt_pk_bf16_f32 v42, v132, v133
    v_cvt_pk_bf16_f32 v43, v134, v135
    v_cvt_pk_bf16_f32 v44, v136, v137
    v_cvt_pk_bf16_f32 v45, v138, v139
    v_cvt_pk_bf16_f32 v46, v140, v141
    v_cvt_pk_bf16_f32 v47, v142, v143
    v_cvt_pk_bf16_f32 v48, v144, v145
    v_cvt_pk_bf16_f32 v49, v146, v147
    v_cvt_pk_bf16_f32 v50, v148, v149
    v_cvt_pk_bf16_f32 v51, v150, v151
    v_cvt_pk_bf16_f32 v52, v152, v153
    v_cvt_pk_bf16_f32 v53, v154, v155
    v_cvt_pk_bf16_f32 v54, v156, v157
    v_cvt_pk_bf16_f32 v55, v158, v159
    v_cvt_pk_bf16_f32 v56, v160, v161
    v_cvt_pk_bf16_f32 v57, v162, v163
    v_cvt_pk_bf16_f32 v58, v164, v165
    v_cvt_pk_bf16_f32 v59, v166, v167
    v_cvt_pk_bf16_f32 v60, v168, v169
    v_cvt_pk_bf16_f32 v61, v170, v171
    v_cvt_pk_bf16_f32 v62, v172, v173
    v_cvt_pk_bf16_f32 v63, v174, v175
    v_cvt_pk_bf16_f32 v64, v176, v177
    v_cvt_pk_bf16_f32 v65, v178, v179
    v_cvt_pk_bf16_f32 v66, v180, v181
    v_cvt_pk_bf16_f32 v67, v182, v183
    v_cvt_pk_bf16_f32 v68, v184, v185
    v_cvt_pk_bf16_f32 v69, v186, v187
    v_cvt_pk_bf16_f32 v70, v188, v189
    v_cvt_pk_bf16_f32 v71, v190, v191
    v_cvt_pk_bf16_f32 v72, v192, v193
    v_cvt_pk_bf16_f32 v73, v194, v195
    v_cvt_pk_bf16_f32 v74, v196, v197
    v_cvt_pk_bf16_f32 v75, v198, v199
    v_cvt_pk_bf16_f32 v76, v200, v201
    v_cvt_pk_bf16_f32 v77, v202, v203
    v_cvt_pk_bf16_f32 v78, v204, v205
    v_cvt_pk_bf16_f32 v79, v206, v207
    v_cvt_pk_bf16_f32 v80, v208, v209
    v_cvt_pk_bf16_f32 v81, v210, v211
    v_cvt_pk_bf16_f32 v82, v212, v213
    v_cvt_pk_bf16_f32 v83, v214, v215
    v_cvt_pk_bf16_f32 v84, v216, v217
    v_cvt_pk_bf16_f32 v85, v218, v219
    v_cvt_pk_bf16_f32 v86, v220, v221
    v_cvt_pk_bf16_f32 v87, v222, v223
    v_cvt_pk_bf16_f32 v88, v224, v225
    v_cvt_pk_bf16_f32 v89, v226, v227
    v_cvt_pk_bf16_f32 v90, v228, v229
    v_cvt_pk_bf16_f32 v91, v230, v231
    v_cvt_pk_bf16_f32 v92, v232, v233
    v_cvt_pk_bf16_f32 v93, v234, v235
    v_cvt_pk_bf16_f32 v94, v236, v237
    v_cvt_pk_bf16_f32 v95, v238, v239
    v_cvt_pk_bf16_f32 v96, v240, v241
    v_cvt_pk_bf16_f32 v97, v242, v243
    v_cvt_pk_bf16_f32 v98, v244, v245
    v_cvt_pk_bf16_f32 v99, v246, v247
    v_cvt_pk_bf16_f32 v100, v248, v249
    v_cvt_pk_bf16_f32 v101, v250, v251
    v_cvt_pk_bf16_f32 v102, v252, v253
    v_cvt_pk_bf16_f32 v103, v254, v255
    v_lshrrev_b32 v20, 5, v19
    v_bfe_u32 v21, v19, 2, 2
    v_lshl_add_u32 v20, v20, 2, v21
    v_lshlrev_b32 v20, 6, v20
    v_bfe_u32 v21, v19, 4, 1
    v_lshl_add_u32 v20, v21, 5, v20
    v_and_b32 v22, 3, v19
    v_lshl_add_u32 v20, v22, 3, v20
    s_lshl_b32 s32, s31, 13
    v_add_u32 v20, s32, v20
    v_cmp_eq_u32 s[60:61], 1, v21
    v_cmp_eq_u32 s[62:63], 0, v21
    v_mov_b32 v23, 0x3f803f80
    s_barrier
    s_lshl_b32 s34, s22, 1
    s_add_u32 s34, s34, s31
    s_lshl_b32 s34, s34, 5
    s_lshl_b32 s35, s23, 2
    s_add_u32 s34, s34, s35
    s_lshl_b32 s34, s34, 12
    s_add_u32 s34, s34, 71303168
    ds_read_b64_tr_b16 v[104:105], v20 offset:0
    ds_read_b64_tr_b16 v[106:107], v20 offset:512
    ds_read_b64_tr_b16 v[112:113], v20 offset:1024
    ds_read_b64_tr_b16 v[114:115], v20 offset:1536
    v_cndmask_b32 v108, v40, v23, s[60:61]
    v_cndmask_b32 v109, v41, v23, s[60:61]
    v_cndmask_b32 v110, v42, v23, s[60:61]
    v_cndmask_b32 v111, v43, v23, s[60:61]
    s_waitcnt lgkmcnt(2)
    s_nop 1
    v_mfma_f32_32x32x16_bf16 v[128:143], v[104:107], v[108:111], 0
    s_nop 3
    ds_read_b64_tr_b16 v[104:105], v20 offset:2048
    ds_read_b64_tr_b16 v[106:107], v20 offset:2560
    v_cndmask_b32 v116, v44, v23, s[60:61]
    v_cndmask_b32 v117, v45, v23, s[60:61]
    v_cndmask_b32 v118, v46, v23, s[60:61]
    v_cndmask_b32 v119, v47, v23, s[60:61]
    s_waitcnt lgkmcnt(2)
    s_nop 1
    v_mfma_f32_32x32x16_bf16 v[128:143], v[112:115], v[116:119], v[128:143]
    s_nop 3
    ds_read_b64_tr_b16 v[112:113], v20 offset:3072
    ds_read_b64_tr_b16 v[114:115], v20 offset:3584
    v_cndmask_b32 v108, v56, v23, s[60:61]
    v_cndmask_b32 v109, v57, v23, s[60:61]
    v_cndmask_b32 v110, v58, v23, s[60:61]
    v_cndmask_b32 v111, v59, v23, s[60:61]
    s_waitcnt lgkmcnt(2)
    s_nop 1
    v_mfma_f32_32x32x16_bf16 v[128:143], v[104:107], v[108:111], v[128:143]
    s_nop 3
    ds_read_b64_tr_b16 v[104:105], v20 offset:4096
    ds_read_b64_tr_b16 v[106:107], v20 offset:4608
    v_cndmask_b32 v116, v60, v23, s[60:61]
    v_cndmask_b32 v117, v61, v23, s[60:61]
    v_cndmask_b32 v118, v62, v23, s[60:61]
    v_cndmask_b32 v119, v63, v23, s[60:61]
    s_waitcnt lgkmcnt(2)
    s_nop 1
    v_mfma_f32_32x32x16_bf16 v[128:143], v[112:115], v[116:119], v[128:143]
    s_nop 3
    ds_read_b64_tr_b16 v[112:113], v20 offset:5120
    ds_read_b64_tr_b16 v[114:115], v20 offset:5632
    v_cndmask_b32 v108, v72, v23, s[60:61]
    v_cndmask_b32 v109, v73, v23, s[60:61]
    v_cndmask_b32 v110, v74, v23, s[60:61]
    v_cndmask_b32 v111, v75, v23, s[60:61]
    s_waitcnt lgkmcnt(2)
    s_nop 1
    v_mfma_f32_32x32x16_bf16 v[128:143], v[104:107], v[108:111], v[128:143]
    s_nop 3
    ds_read_b64_tr_b16 v[104:105], v20 offset:6144
    ds_read_b64_tr_b16 v[106:107], v20 offset:6656
    v_cndmask_b32 v116, v76, v23, s[60:61]
    v_cndmask_b32 v117, v77, v23, s[60:61]
    v_cndmask_b32 v118, v78, v23, s[60:61]
    v_cndmask_b32 v119, v79, v23, s[60:61]
    s_waitcnt lgkmcnt(2)
    s_nop 1
    v_mfma_f32_32x32x16_bf16 v[128:143], v[112:115], v[116:119], v[128:143]
    s_nop 3
    ds_read_b64_tr_b16 v[112:113], v20 offset:7168
    ds_read_b64_tr_b16 v[114:115], v20 offset:7680
    v_cndmask_b32 v108, v88, v23, s[60:61]
    v_cndmask_b32 v109, v89, v23, s[60:61]
    v_cndmask_b32 v110, v90, v23, s[60:61]
    v_cndmask_b32 v111, v91, v23, s[60:61]
    s_waitcnt lgkmcnt(2)
    s_nop 1
    v_mfma_f32_32x32x16_bf16 v[128:143], v[104:107], v[108:111], v[128:143]
    s_nop 3
    ds_read_b64_tr_b16 v[104:105], v20 offset:16384
    ds_read_b64_tr_b16 v[106:107], v20 offset:16896
    v_cndmask_b32 v116, v92, v23, s[60:61]
    v_cndmask_b32 v117, v93, v23, s[60:61]
    v_cndmask_b32 v118, v94, v23, s[60:61]
    v_cndmask_b32 v119, v95, v23, s[60:61]
    s_waitcnt lgkmcnt(2)
    s_nop 1
    v_mfma_f32_32x32x16_bf16 v[128:143], v[112:115], v[116:119], v[128:143]
    s_nop 3
    ds_read_b64_tr_b16 v[112:113], v20 offset:17408
    ds_read_b64_tr_b16 v[114:115], v20 offset:17920
    v_cndmask_b32 v108, v40, v23, s[62:63]
    v_cndmask_b32 v109, v41, v23, s[62:63]
    v_cndmask_b32 v110, v42, v23, s[62:63]
    v_cndmask_b32 v111, v43, v23, s[62:63]
    s_waitcnt lgkmcnt(2)
    s_nop 1
    v_mfma_f32_32x32x16_bf16 v[144:159], v[104:107], v[108:111], 0
    s_nop 3
    ds_read_b64_tr_b16 v[104:105], v20 offset:18432
    ds_read_b64_tr_b16 v[106:107], v20 offset:18944
    v_cndmask_b32 v116, v44, v23, s[62:63]
    v_cndmask_b32 v117, v45, v23, s[62:63]
    v_cndmask_b32 v118, v46, v23, s[62:63]
    v_cndmask_b32 v119, v47, v23, s[62:63]
    s_waitcnt lgkmcnt(2)
    s_nop 1
    v_mfma_f32_32x32x16_bf16 v[144:159], v[112:115], v[116:119], v[144:159]
    s_nop 3
    ds_read_b64_tr_b16 v[112:113], v20 offset:19456
    ds_read_b64_tr_b16 v[114:115], v20 offset:19968
    v_cndmask_b32 v108, v56, v23, s[62:63]
    v_cndmask_b32 v109, v57, v23, s[62:63]
    v_cndmask_b32 v110, v58, v23, s[62:63]
    v_cndmask_b32 v111, v59, v23, s[62:63]
    s_waitcnt lgkmcnt(2)
    s_nop 1
    v_mfma_f32_32x32x16_bf16 v[144:159], v[104:107], v[108:111], v[144:159]
    s_nop 3
    s_add_u32 s35, s34, 0
    buffer_store_dwordx4 v[128:131], v18, s[16:19], s35 offen offset:0
    buffer_store_dwordx4 v[132:135], v18, s[16:19], s35 offen offset:1024
    buffer_store_dwordx4 v[136:139], v18, s[16:19], s35 offen offset:2048
    buffer_store_dwordx4 v[140:143], v18, s[16:19], s35 offen offset:3072
    ds_read_b64_tr_b16 v[104:105], v20 offset:20480
    ds_read_b64_tr_b16 v[106:107], v20 offset:20992
    v_cndmask_b32 v116, v60, v23, s[62:63]
    v_cndmask_b32 v117, v61, v23, s[62:63]
    v_cndmask_b32 v118, v62, v23, s[62:63]
    v_cndmask_b32 v119, v63, v23, s[62:63]
    s_waitcnt lgkmcnt(2)
    s_nop 1
    v_mfma_f32_32x32x16_bf16 v[144:159], v[112:115], v[116:119], v[144:159]
    s_nop 3
    ds_read_b64_tr_b16 v[112:113], v20 offset:21504
    ds_read_b64_tr_b16 v[114:115], v20 offset:22016
    v_cndmask_b32 v108, v72, v23, s[62:63]
    v_cndmask_b32 v109, v73, v23, s[62:63]
    v_cndmask_b32 v110, v74, v23, s[62:63]
    v_cndmask_b32 v111, v75, v23, s[62:63]
    s_waitcnt lgkmcnt(2)
    s_nop 1
    v_mfma_f32_32x32x16_bf16 v[144:159], v[104:107], v[108:111], v[144:159]
    s_nop 3
    ds_read_b64_tr_b16 v[104:105], v20 offset:22528
    ds_read_b64_tr_b16 v[106:107], v20 offset:23040
    v_cndmask_b32 v116, v76, v23, s[62:63]
    v_cndmask_b32 v117, v77, v23, s[62:63]
    v_cndmask_b32 v118, v78, v23, s[62:63]
    v_cndmask_b32 v119, v79, v23, s[62:63]
    s_waitcnt lgkmcnt(2)
    s_nop 1
    v_mfma_f32_32x32x16_bf16 v[144:159], v[112:115], v[116:119], v[144:159]
    s_nop 3
    ds_read_b64_tr_b16 v[112:113], v20 offset:23552
    ds_read_b64_tr_b16 v[114:115], v20 offset:24064
    v_cndmask_b32 v108, v88, v23, s[62:63]
    v_cndmask_b32 v109, v89, v23, s[62:63]
    v_cndmask_b32 v110, v90, v23, s[62:63]
    v_cndmask_b32 v111, v91, v23, s[62:63]
    s_waitcnt lgkmcnt(2)
    s_nop 1
    v_mfma_f32_32x32x16_bf16 v[144:159], v[104:107], v[108:111], v[144:159]
    s_nop 3
    ds_read_b64_tr_b16 v[104:105], v20 offset:32768
    ds_read_b64_tr_b16 v[106:107], v20 offset:33280
    v_cndmask_b32 v116, v92, v23, s[62:63]
    v_cndmask_b32 v117, v93, v23, s[62:63]
    v_cndmask_b32 v118, v94, v23, s[62:63]
    v_cndmask_b32 v119, v95, v23, s[62:63]
    s_waitcnt lgkmcnt(2)
    s_nop 1
    v_mfma_f32_32x32x16_bf16 v[144:159], v[112:115], v[116:119], v[144:159]
    s_nop 3
    ds_read_b64_tr_b16 v[112:113], v20 offset:33792
    ds_read_b64_tr_b16 v[114:115], v20 offset:34304
    v_cndmask_b32 v108, v48, v23, s[60:61]
    v_cndmask_b32 v109, v49, v23, s[60:61]
    v_cndmask_b32 v110, v50, v23, s[60:61]
    v_cndmask_b32 v111, v51, v23, s[60:61]
    s_waitcnt lgkmcnt(2)
    s_nop 1
    v_mfma_f32_32x32x16_bf16 v[160:175], v[104:107], v[108:111], 0
    s_nop 3
    ds_read_b64_tr_b16 v[104:105], v20 offset:34816
    ds_read_b64_tr_b16 v[106:107], v20 offset:35328
    v_cndmask_b32 v116, v52, v23, s[60:61]
    v_cndmask_b32 v117, v53, v23, s[60:61]
    v_cndmask_b32 v118, v54, v23, s[60:61]
    v_cndmask_b32 v119, v55, v23, s[60:61]
    s_waitcnt lgkmcnt(2)
    s_nop 1
    v_mfma_f32_32x32x16_bf16 v[160:175], v[112:115], v[116:119], v[160:175]
    s_nop 3
    ds_read_b64_tr_b16 v[112:113], v20 offset:35840
    ds_read_b64_tr_b16 v[114:115], v20 offset:36352
    v_cndmask_b32 v108, v64, v23, s[60:61]
    v_cndmask_b32 v109, v65, v23, s[60:61]
    v_cndmask_b32 v110, v66, v23, s[60:61]
    v_cndmask_b32 v111, v67, v23, s[60:61]
    s_waitcnt lgkmcnt(2)
    s_nop 1
    v_mfma_f32_32x32x16_bf16 v[160:175], v[104:107], v[108:111], v[160:175]
    s_nop 3
    s_add_u32 s35, s34, 4096
    buffer_store_dwordx4 v[144:147], v18, s[16:19], s35 offen offset:0
    buffer_store_dwordx4 v[148:151], v18, s[16:19], s35 offen offset:1024
    buffer_store_dwordx4 v[152:155], v18, s[16:19], s35 offen offset:2048
    buffer_store_dwordx4 v[156:159], v18, s[16:19], s35 offen offset:3072
    ds_read_b64_tr_b16 v[104:105], v20 offset:36864
    ds_read_b64_tr_b16 v[106:107], v20 offset:37376
    v_cndmask_b32 v116, v68, v23, s[60:61]
    v_cndmask_b32 v117, v69, v23, s[60:61]
    v_cndmask_b32 v118, v70, v23, s[60:61]
    v_cndmask_b32 v119, v71, v23, s[60:61]
    s_waitcnt lgkmcnt(2)
    s_nop 1
    v_mfma_f32_32x32x16_bf16 v[160:175], v[112:115], v[116:119], v[160:175]
    s_nop 3
    ds_read_b64_tr_b16 v[112:113], v20 offset:37888
    ds_read_b64_tr_b16 v[114:115], v20 offset:38400
    v_cndmask_b32 v108, v80, v23, s[60:61]
    v_cndmask_b32 v109, v81, v23, s[60:61]
    v_cndmask_b32 v110, v82, v23, s[60:61]
    v_cndmask_b32 v111, v83, v23, s[60:61]
    s_waitcnt lgkmcnt(2)
    s_nop 1
    v_mfma_f32_32x32x16_bf16 v[160:175], v[104:107], v[108:111], v[160:175]
    s_nop 3
    ds_read_b64_tr_b16 v[104:105], v20 offset:38912
    ds_read_b64_tr_b16 v[106:107], v20 offset:39424
    v_cndmask_b32 v116, v84, v23, s[60:61]
    v_cndmask_b32 v117, v85, v23, s[60:61]
    v_cndmask_b32 v118, v86, v23, s[60:61]
    v_cndmask_b32 v119, v87, v23, s[60:61]
    s_waitcnt lgkmcnt(2)
    s_nop 1
    v_mfma_f32_32x32x16_bf16 v[160:175], v[112:115], v[116:119], v[160:175]
    s_nop 3
    ds_read_b64_tr_b16 v[112:113], v20 offset:39936
    ds_read_b64_tr_b16 v[114:115], v20 offset:40448
    v_cndmask_b32 v108, v96, v23, s[60:61]
    v_cndmask_b32 v109, v97, v23, s[60:61]
    v_cndmask_b32 v110, v98, v23, s[60:61]
    v_cndmask_b32 v111, v99, v23, s[60:61]
    s_waitcnt lgkmcnt(2)
    s_nop 1
    v_mfma_f32_32x32x16_bf16 v[160:175], v[104:107], v[108:111], v[160:175]
    s_nop 3
    ds_read_b64_tr_b16 v[104:105], v20 offset:49152
    ds_read_b64_tr_b16 v[106:107], v20 offset:49664
    v_cndmask_b32 v116, v100, v23, s[60:61]
    v_cndmask_b32 v117, v101, v23, s[60:61]
    v_cndmask_b32 v118, v102, v23, s[60:61]
    v_cndmask_b32 v119, v103, v23, s[60:61]
    s_waitcnt lgkmcnt(2)
    s_nop 1
    v_mfma_f32_32x32x16_bf16 v[160:175], v[112:115], v[116:119], v[160:175]
    s_nop 3
    ds_read_b64_tr_b16 v[112:113], v20 offset:50176
    ds_read_b64_tr_b16 v[114:115], v20 offset:50688
    v_cndmask_b32 v108, v48, v23, s[62:63]
    v_cndmask_b32 v109, v49, v23, s[62:63]
    v_cndmask_b32 v110, v50, v23, s[62:63]
    v_cndmask_b32 v111, v51, v23, s[62:63]
    s_waitcnt lgkmcnt(2)
    s_nop 1
    v_mfma_f32_32x32x16_bf16 v[176:191], v[104:107], v[108:111], 0
    s_nop 3
    ds_read_b64_tr_b16 v[104:105], v20 offset:51200
    ds_read_b64_tr_b16 v[106:107], v20 offset:51712
    v_cndmask_b32 v116, v52, v23, s[62:63]
    v_cndmask_b32 v117, v53, v23, s[62:63]
    v_cndmask_b32 v118, v54, v23, s[62:63]
    v_cndmask_b32 v119, v55, v23, s[62:63]
    s_waitcnt lgkmcnt(2)
    s_nop 1
    v_mfma_f32_32x32x16_bf16 v[176:191], v[112:115], v[116:119], v[176:191]
    s_nop 3
    ds_read_b64_tr_b16 v[112:113], v20 offset:52224
    ds_read_b64_tr_b16 v[114:115], v20 offset:52736
    v_cndmask_b32 v108, v64, v23, s[62:63]
    v_cndmask_b32 v109, v65, v23, s[62:63]
    v_cndmask_b32 v110, v66, v23, s[62:63]
    v_cndmask_b32 v111, v67, v23, s[62:63]
    s_waitcnt lgkmcnt(2)
    s_nop 1
    v_mfma_f32_32x32x16_bf16 v[176:191], v[104:107], v[108:111], v[176:191]
    s_nop 3
    s_add_u32 s35, s34, 8192
    buffer_store_dwordx4 v[160:163], v18, s[16:19], s35 offen offset:0
    buffer_store_dwordx4 v[164:167], v18, s[16:19], s35 offen offset:1024
    buffer_store_dwordx4 v[168:171], v18, s[16:19], s35 offen offset:2048
    buffer_store_dwordx4 v[172:175], v18, s[16:19], s35 offen offset:3072
    ds_read_b64_tr_b16 v[104:105], v20 offset:53248
    ds_read_b64_tr_b16 v[106:107], v20 offset:53760
    v_cndmask_b32 v116, v68, v23, s[62:63]
    v_cndmask_b32 v117, v69, v23, s[62:63]
    v_cndmask_b32 v118, v70, v23, s[62:63]
    v_cndmask_b32 v119, v71, v23, s[62:63]
    s_waitcnt lgkmcnt(2)
    s_nop 1
    v_mfma_f32_32x32x16_bf16 v[176:191], v[112:115], v[116:119], v[176:191]
    s_nop 3
    ds_read_b64_tr_b16 v[112:113], v20 offset:54272
    ds_read_b64_tr_b16 v[114:115], v20 offset:54784
    v_cndmask_b32 v108, v80, v23, s[62:63]
    v_cndmask_b32 v109, v81, v23, s[62:63]
    v_cndmask_b32 v110, v82, v23, s[62:63]
    v_cndmask_b32 v111, v83, v23, s[62:63]
    s_waitcnt lgkmcnt(2)
    s_nop 1
    v_mfma_f32_32x32x16_bf16 v[176:191], v[104:107], v[108:111], v[176:191]
    s_nop 3
    ds_read_b64_tr_b16 v[104:105], v20 offset:55296
    ds_read_b64_tr_b16 v[106:107], v20 offset:55808
    v_cndmask_b32 v116, v84, v23, s[62:63]
    v_cndmask_b32 v117, v85, v23, s[62:63]
    v_cndmask_b32 v118, v86, v23, s[62:63]
    v_cndmask_b32 v119, v87, v23, s[62:63]
    s_waitcnt lgkmcnt(2)
    s_nop 1
    v_mfma_f32_32x32x16_bf16 v[176:191], v[112:115], v[116:119], v[176:191]
    s_nop 3
    ds_read_b64_tr_b16 v[112:113], v20 offset:56320
    ds_read_b64_tr_b16 v[114:115], v20 offset:56832
    v_cndmask_b32 v108, v96, v23, s[62:63]
    v_cndmask_b32 v109, v97, v23, s[62:63]
    v_cndmask_b32 v110, v98, v23, s[62:63]
    v_cndmask_b32 v111, v99, v23, s[62:63]
    s_waitcnt lgkmcnt(2)
    s_nop 1
    v_mfma_f32_32x32x16_bf16 v[176:191], v[104:107], v[108:111], v[176:191]
    s_nop 3
    v_cndmask_b32 v116, v100, v23, s[62:63]
    v_cndmask_b32 v117, v101, v23, s[62:63]
    v_cndmask_b32 v118, v102, v23, s[62:63]
    v_cndmask_b32 v119, v103, v23, s[62:63]
    s_waitcnt lgkmcnt(0)
    s_nop 1
    v_mfma_f32_32x32x16_bf16 v[176:191], v[112:115], v[116:119], v[176:191]
    s_nop 3
    s_nop 15
    s_add_u32 s35, s34, 12288
    buffer_store_dwordx4 v[176:179], v18, s[16:19], s35 offen offset:0
    buffer_store_dwordx4 v[180:183], v18, s[16:19], s35 offen offset:1024
    buffer_store_dwordx4 v[184:187], v18, s[16:19], s35 offen offset:2048
    buffer_store_dwordx4 v[188:191], v18, s[16:19], s35 offen offset:3072
K1_EXIT:
    s_endpgm
.section .rodata,"a"
.p2align 6
.amdhsa_kernel proj_kernel
  .amdhsa_next_free_vgpr 256
  .amdhsa_next_free_sgpr 102
  .amdhsa_accum_offset 256
  .amdhsa_group_segment_fixed_size 0
  .amdhsa_kernarg_size 112
  .amdhsa_user_sgpr_count 2
  .amdhsa_user_sgpr_kernarg_segment_ptr 1
  .amdhsa_system_sgpr_workgroup_id_x 1
.end_amdhsa_kernel
.text
.globl attn_kernel
.p2align 8
.type attn_kernel,@function
attn_kernel:
    s_cmp_ge_u32 s2, 256
    s_cbranch_scc1 K2_EXIT
    s_load_dwordx2 s[46:47], s[0:1], 104
    s_load_dwordx2 s[84:85], s[0:1], 40
    s_load_dwordx2 s[86:87], s[0:1], 72
    s_load_dwordx2 s[88:89], s[0:1], 88
    v_lshrrev_b32 v1, 6, v0
    v_and_b32 v3, 63, v0
    v_readfirstlane_b32 s20, v1
    v_lshlrev_b32 v2, 4, v3
    s_waitcnt lgkmcnt(0)
    s_mov_b32 s16, s46
    s_and_b32 s17, s47, 0xffff
    s_mov_b32 s18, 268435456
    s_mov_b32 s19, 0x00020000
    s_mov_b32 s8, s84
    s_and_b32 s9, s85, 0xffff
    s_mov_b32 s10, 4194304
    s_mov_b32 s11, 0x00020000
    s_mov_b32 s12, s86
    s_and_b32 s13, s87, 0xffff
    s_mov_b32 s14, 524288
    s_mov_b32 s15, 0x00020000
    s_and_b32 s33, s2, 7
    s_lshl_b32 s33, s33, 2
    s_bfe_u32 s34, s2, 0x20003
    s_add_u32 s21, s33, s34
    s_lshr_b32 s22, s2, 5
    s_sub_u32 s33, 15, s22
    s_cmp_ge_u32 s20, 4
    s_cselect_b32 s33, s33, s22
    s_and_b32 s34, s20, 3
    s_lshl_b32 s31, s33, 2
    s_add_u32 s31, s31, s34
    s_lshr_b32 s23, s31, 1
    s_lshl_b32 s33, s22, 1
    s_sub_u32 s24, 32, s33
    s_lshl_b32 s32, s20, 11
    v_add_u32 v11, s32, v2
    s_mul_i32 s33, s21, 540672
    s_add_u32 s34, s33, 117440512
    s_add_u32 s35, s33, 150994944
    s_mov_b32 s28, 0
    s_mov_b32 s29, 65536
    s_add_u32 m0, s28, s32
    s_add_u32 s28, s28, 16384
    buffer_load_dwordx4 v11, s[16:19], s34 offen lds
    buffer_load_dwordx4 v11, s[16:19], s34 offen offset:1024 lds
    s_and_b32 s28, s28, 0xffff
    s_add_u32 s34, s34, 16384
    s_lshl_b32 s36, s21, 6
    s_add_u32 s36, s36, s31
    s_lshl_b32 s36, s36, 13
    buffer_load_dwordx4 v[28:31], v2, s[16:19], s36 offen offset:0
    buffer_load_dwordx4 v[32:35], v2, s[16:19], s36 offen offset:1024
    buffer_load_dwordx4 v[36:39], v2, s[16:19], s36 offen offset:2048
    buffer_load_dwordx4 v[40:43], v2, s[16:19], s36 offen offset:3072
    s_add_u32 s36, s36, 4096
    buffer_load_dwordx4 v[44:47], v2, s[16:19], s36 offen offset:0
    buffer_load_dwordx4 v[48:51], v2, s[16:19], s36 offen offset:1024
    buffer_load_dwordx4 v[52:55], v2, s[16:19], s36 offen offset:2048
    buffer_load_dwordx4 v[56:59], v2, s[16:19], s36 offen offset:3072
    s_add_u32 m0, s28, s32
    s_add_u32 s28, s28, 16384
    buffer_load_dwordx4 v11, s[16:19], s34 offen lds
    buffer_load_dwordx4 v11, s[16:19], s34 offen offset:1024 lds
    s_and_b32 s28, s28, 0xffff
    s_add_u32 s34, s34, 16384
    s_add_u32 m0, s28, s32
    s_add_u32 s28, s28, 16384
    buffer_load_dwordx4 v11, s[16:19], s34 offen lds
    buffer_load_dwordx4 v11, s[16:19], s34 offen offset:1024 lds
    s_and_b32 s28, s28, 0xffff
    s_add_u32 s34, s34, 16384
    s_add_u32 m0, s29, s32
    s_add_u32 s29, s29, 16384
    buffer_load_dwordx4 v11, s[16:19], s35 offen lds
    buffer_load_dwordx4 v11, s[16:19], s35 offen offset:1024 lds
    s_cmp_eq_u32 s29, 114688
    s_cselect_b32 s29, 65536, s29
    s_add_u32 s35, s35, 16384
    s_add_u32 m0, s28, s32
    s_add_u32 s28, s28, 16384
    buffer_load_dwordx4 v11, s[16:19], s34 offen lds
    buffer_load_dwordx4 v11, s[16:19], s34 offen offset:1024 lds
    s_and_b32 s28, s28, 0xffff
    s_add_u32 s34, s34, 16384
    s_add_u32 m0, s29, s32
    s_add_u32 s29, s29, 16384
    buffer_load_dwordx4 v11, s[16:19], s35 offen lds
    buffer_load_dwordx4 v11, s[16:19], s35 offen offset:1024 lds
    s_cmp_eq_u32 s29, 114688
    s_cselect_b32 s29, 65536, s29
    s_add_u32 s35, s35, 16384
    v_and_b32 v12, 31, v3
    v_lshrrev_b32 v13, 5, v3
    v_lshlrev_b32 v13, 2, v13
    v_sub_u32 v12, v12, v13
    s_lshl_b32 s33, s31, 5
    v_add_u32 v7, s33, v12
    v_mov_b32 v10, 0xf149f2ca
    v_mov_b32 v21, 0x41000000
    v_mov_b32 v24, 0x3f803f80
    v_mov_b32 v25, 0x3f803f80
    v_mov_b32 v26, 0x3f803f80
    v_mov_b32 v27, 0x3f803f80
    v_mov_b32 v188, 0
    v_mov_b32 v189, 0
    v_mov_b32 v190, 0
    v_mov_b32 v191, 0
    v_mov_b32 v192, 0
    v_mov_b32 v193, 0
    v_mov_b32 v194, 0
    v_mov_b32 v195, 0
    v_mov_b32 v196, 0
    v_mov_b32 v197, 0
    v_mov_b32 v198, 0
    v_mov_b32 v199, 0
    v_mov_b32 v200, 0
    v_mov_b32 v201, 0
    v_mov_b32 v202, 0
    v_mov_b32 v203, 0
    v_mov_b32 v204, 0
    v_mov_b32 v205, 0
    v_mov_b32 v206, 0
    v_mov_b32 v207, 0
    v_mov_b32 v208, 0
    v_mov_b32 v209, 0
    v_mov_b32 v210, 0
    v_mov_b32 v211, 0
    v_mov_b32 v212, 0
    v_mov_b32 v213, 0
    v_mov_b32 v214, 0
    v_mov_b32 v215, 0
    v_mov_b32 v216, 0
    v_mov_b32 v217, 0
    v_mov_b32 v218, 0
    v_mov_b32 v219, 0
    v_mov_b32 v220, 0
    v_mov_b32 v221, 0
    v_mov_b32 v222, 0
    v_mov_b32 v223, 0
    v_mov_b32 v224, 0
    v_mov_b32 v225, 0
    v_mov_b32 v226, 0
    v_mov_b32 v227, 0
    v_mov_b32 v228, 0
    v_mov_b32 v229, 0
    v_mov_b32 v230, 0
    v_mov_b32 v231, 0
    v_mov_b32 v232, 0
    v_mov_b32 v233, 0
    v_mov_b32 v234, 0
    v_mov_b32 v235, 0
    v_mov_b32 v236, 0
    v_mov_b32 v237, 0
    v_mov_b32 v238, 0
    v_mov_b32 v239, 0
    v_mov_b32 v240, 0
    v_mov_b32 v241, 0
    v_mov_b32 v242, 0
    v_mov_b32 v243, 0
    v_mov_b32 v244, 0
    v_mov_b32 v245, 0
    v_mov_b32 v246, 0
    v_mov_b32 v247, 0
    v_mov_b32 v248, 0
    v_mov_b32 v249, 0
    v_mov_b32 v250, 0
    v_mov_b32 v251, 0
    v_mov_b32 v156, 0
    v_mov_b32 v172, 0
    v_mov_b32 v157, 0
    v_mov_b32 v173, 0
    v_mov_b32 v158, 0
    v_mov_b32 v174, 0
    v_mov_b32 v159, 0
    v_mov_b32 v175, 0
    v_mov_b32 v160, 0
    v_mov_b32 v176, 0
    v_mov_b32 v161, 0
    v_mov_b32 v177, 0
    v_mov_b32 v162, 0
    v_mov_b32 v178, 0
    v_mov_b32 v163, 0
    v_mov_b32 v179, 0
    v_mov_b32 v164, 0
    v_mov_b32 v180, 0
    v_mov_b32 v165, 0
    v_mov_b32 v181, 0
    v_mov_b32 v166, 0
    v_mov_b32 v182, 0
    v_mov_b32 v167, 0
    v_mov_b32 v183, 0
    v_mov_b32 v168, 0
    v_mov_b32 v184, 0
    v_mov_b32 v169, 0
    v_mov_b32 v185, 0
    v_mov_b32 v170, 0
    v_mov_b32 v186, 0
    v_mov_b32 v171, 0
    v_mov_b32 v187, 0
    s_mov_b32 s25, 0
    s_mov_b32 s42, 0
    s_mov_b32 s43, 0
    s_mov_b32 s26, 16384
    s_mov_b32 s27, 65536
    s_waitcnt vmcnt(10)
    s_barrier
    ds_read_b128 v[124:127], v2 offset:0
    ds_read_b128 v[128:131], v2 offset:1024
    ds_read_b128 v[132:135], v2 offset:2048
    ds_read_b128 v[136:139], v2 offset:3072
    ds_read_b128 v[140:143], v2 offset:4096
    ds_read_b128 v[144:147], v2 offset:5120
    ds_read_b128 v[148:151], v2 offset:6144
    ds_read_b128 v[152:155], v2 offset:7168
    s_waitcnt lgkmcnt(7)
    v_mfma_f32_32x32x16_bf16 v[60:75], v[124:127], v[28:31], 0
    s_waitcnt lgkmcnt(6)
    v_mfma_f32_32x32x16_bf16 v[60:75], v[128:131], v[32:35], v[60:75]
    s_waitcnt lgkmcnt(5)
    v_mfma_f32_32x32x16_bf16 v[60:75], v[132:135], v[36:39], v[60:75]
    s_waitcnt lgkmcnt(4)
    v_mfma_f32_32x32x16_bf16 v[60:75], v[136:139], v[40:43], v[60:75]
    s_waitcnt lgkmcnt(3)
    v_mfma_f32_32x32x16_bf16 v[60:75], v[140:143], v[44:47], v[60:75]
    s_waitcnt lgkmcnt(2)
    v_mfma_f32_32x32x16_bf16 v[60:75], v[144:147], v[48:51], v[60:75]
    s_waitcnt lgkmcnt(1)
    v_mfma_f32_32x32x16_bf16 v[60:75], v[148:151], v[52:55], v[60:75]
    s_waitcnt lgkmcnt(0)
    v_mfma_f32_32x32x16_bf16 v[60:75], v[152:155], v[56:59], v[60:75]
    ds_read_b128 v[124:127], v2 offset:8192
    ds_read_b128 v[128:131], v2 offset:9216
    ds_read_b128 v[132:135], v2 offset:10240
    ds_read_b128 v[136:139], v2 offset:11264
    ds_read_b128 v[140:143], v2 offset:12288
    ds_read_b128 v[144:147], v2 offset:13312
    ds_read_b128 v[148:151], v2 offset:14336
    ds_read_b128 v[152:155], v2 offset:15360
    s_waitcnt lgkmcnt(7)
    v_mfma_f32_32x32x16_bf16 v[76:91], v[124:127], v[28:31], 0
    s_waitcnt lgkmcnt(6)
    v_mfma_f32_32x32x16_bf16 v[76:91], v[128:131], v[32:35], v[76:91]
    s_waitcnt lgkmcnt(5)
    v_mfma_f32_32x32x16_bf16 v[76:91], v[132:135], v[36:39], v[76:91]
    s_waitcnt lgkmcnt(4)
    v_mfma_f32_32x32x16_bf16 v[76:91], v[136:139], v[40:43], v[76:91]
    s_waitcnt lgkmcnt(3)
    v_mfma_f32_32x32x16_bf16 v[76:91], v[140:143], v[44:47], v[76:91]
    s_waitcnt lgkmcnt(2)
    v_mfma_f32_32x32x16_bf16 v[76:91], v[144:147], v[48:51], v[76:91]
    s_waitcnt lgkmcnt(1)
    v_mfma_f32_32x32x16_bf16 v[76:91], v[148:151], v[52:55], v[76:91]
    s_waitcnt lgkmcnt(0)
    v_mfma_f32_32x32x16_bf16 v[76:91], v[152:155], v[56:59], v[76:91]
    s_nop 15
    s_cmp_lg_u32 s23, 0
    s_cbranch_scc1 K2_PNM
    s_add_u32 s33, s25, 0
    s_lshl_b32 s33, s33, 6
    v_subrev_u32 v12, s33, v7
    v_cmp_gt_i32 s[60:61], 0, v12
    v_cmp_gt_i32 s[62:63], 1, v12
    v_cmp_gt_i32 s[64:65], 2, v12
    v_cmp_gt_i32 s[66:67], 3, v12
    s_nop 1
    v_cndmask_b32 v60, v60, v10, s[60:61]
    v_cndmask_b32 v61, v61, v10, s[62:63]
    v_cndmask_b32 v62, v62, v10, s[64:65]
    v_cndmask_b32 v63, v63, v10, s[66:67]
    v_cmp_gt_i32 s[60:61], 8, v12
    v_cmp_gt_i32 s[62:63], 9, v12
    v_cmp_gt_i32 s[64:65], 10, v12
    v_cmp_gt_i32 s[66:67], 11, v12
    s_nop 1
    v_cndmask_b32 v64, v64, v10, s[60:61]
    v_cndmask_b32 v65, v65, v10, s[62:63]
    v_cndmask_b32 v66, v66, v10, s[64:65]
    v_cndmask_b32 v67, v67, v10, s[66:67]
    v_cmp_gt_i32 s[60:61], 16, v12
    v_cmp_gt_i32 s[62:63], 17, v12
    v_cmp_gt_i32 s[64:65], 18, v12
    v_cmp_gt_i32 s[66:67], 19, v12
    s_nop 1
    v_cndmask_b32 v68, v68, v10, s[60:61]
    v_cndmask_b32 v69, v69, v10, s[62:63]
    v_cndmask_b32 v70, v70, v10, s[64:65]
    v_cndmask_b32 v71, v71, v10, s[66:67]
    v_cmp_gt_i32 s[60:61], 24, v12
    v_cmp_gt_i32 s[62:63], 25, v12
    v_cmp_gt_i32 s[64:65], 26, v12
    v_cmp_gt_i32 s[66:67], 27, v12
    s_nop 1
    v_cndmask_b32 v72, v72, v10, s[60:61]
    v_cndmask_b32 v73, v73, v10, s[62:63]
    v_cndmask_b32 v74, v74, v10, s[64:65]
    v_cndmask_b32 v75, v75, v10, s[66:67]
    v_cmp_gt_i32 s[60:61], 32, v12
    v_cmp_gt_i32 s[62:63], 33, v12
    v_cmp_gt_i32 s[64:65], 34, v12
    v_cmp_gt_i32 s[66:67], 35, v12
    s_nop 1
    v_cndmask_b32 v76, v76, v10, s[60:61]
    v_cndmask_b32 v77, v77, v10, s[62:63]
    v_cndmask_b32 v78, v78, v10, s[64:65]
    v_cndmask_b32 v79, v79, v10, s[66:67]
    v_cmp_gt_i32 s[60:61], 40, v12
    v_cmp_gt_i32 s[62:63], 41, v12
    v_cmp_gt_i32 s[64:65], 42, v12
    v_cmp_gt_i32 s[66:67], 43, v12
    s_nop 1
    v_cndmask_b32 v80, v80, v10, s[60:61]
    v_cndmask_b32 v81, v81, v10, s[62:63]
    v_cndmask_b32 v82, v82, v10, s[64:65]
    v_cndmask_b32 v83, v83, v10, s[66:67]
    v_cmp_gt_i32 s[60:61], 48, v12
    v_cmp_gt_i32 s[62:63], 49, v12
    v_cmp_gt_i32 s[64:65], 50, v12
    v_cmp_gt_i32 s[66:67], 51, v12
    s_nop 1
    v_cndmask_b32 v84, v84, v10, s[60:61]
    v_cndmask_b32 v85, v85, v10, s[62:63]
    v_cndmask_b32 v86, v86, v10, s[64:65]
    v_cndmask_b32 v87, v87, v10, s[66:67]
    v_cmp_gt_i32 s[60:61], 56, v12
    v_cmp_gt_i32 s[62:63], 57, v12
    v_cmp_gt_i32 s[64:65], 58, v12
    v_cmp_gt_i32 s[66:67], 59, v12
    s_nop 1
    v_cndmask_b32 v88, v88, v10, s[60:61]
    v_cndmask_b32 v89, v89, v10, s[62:63]
    v_cndmask_b32 v90, v90, v10, s[64:65]
    v_cndmask_b32 v91, v91, v10, s[66:67]
K2_PNM:
    v_max3_f32 v20, v60, v61, v62
    v_max3_f32 v20, v20, v63, v64
    v_max3_f32 v20, v20, v65, v66
    v_max3_f32 v20, v20, v67, v68
    v_max3_f32 v20, v20, v69, v70
    v_max3_f32 v20, v20, v71, v72
    v_max3_f32 v20, v20, v73, v74
    v_max_f32 v20, v20, v75
    v_max3_f32 v12, v20, v76, v77
    v_max3_f32 v12, v12, v78, v79
    v_max3_f32 v12, v12, v80, v81
    v_max3_f32 v12, v12, v82, v83
    v_max3_f32 v12, v12, v84, v85
    v_max3_f32 v12, v12, v86, v87
    v_max3_f32 v12, v12, v88, v89
    v_max3_f32 v12, v12, v90, v91
    s_nop 15
    v_mov_b32 v13, v12
    s_nop 1
    v_permlane32_swap_b32 v12, v13
    s_nop 1
    v_max_f32 v12, v12, v13
    v_sub_f32 v13, 0, v12
    v_exp_f32 v13, v13
    v_sub_f32 v60, v60, v12
    v_sub_f32 v76, v76, v12
    v_sub_f32 v156, v156, v12
    v_sub_f32 v61, v61, v12
    v_sub_f32 v77, v77, v12
    v_sub_f32 v157, v157, v12
    v_sub_f32 v62, v62, v12
    v_sub_f32 v78, v78, v12
    v_sub_f32 v158, v158, v12
    v_sub_f32 v63, v63, v12
    v_sub_f32 v79, v79, v12
    v_sub_f32 v159, v159, v12
    v_sub_f32 v64, v64, v12
    v_sub_f32 v80, v80, v12
    v_sub_f32 v160, v160, v12
    v_sub_f32 v65, v65, v12
    v_sub_f32 v81, v81, v12
    v_sub_f32 v161, v161, v12
    v_sub_f32 v66, v66, v12
    v_sub_f32 v82, v82, v12
    v_sub_f32 v162, v162, v12
    v_sub_f32 v67, v67, v12
    v_sub_f32 v83, v83, v12
    v_sub_f32 v163, v163, v12
    v_sub_f32 v68, v68, v12
    v_sub_f32 v84, v84, v12
    v_sub_f32 v164, v164, v12
    v_sub_f32 v69, v69, v12
    v_sub_f32 v85, v85, v12
    v_sub_f32 v165, v165, v12
    v_sub_f32 v70, v70, v12
    v_sub_f32 v86, v86, v12
    v_sub_f32 v166, v166, v12
    v_sub_f32 v71, v71, v12
    v_sub_f32 v87, v87, v12
    v_sub_f32 v167, v167, v12
    v_sub_f32 v72, v72, v12
    v_sub_f32 v88, v88, v12
    v_sub_f32 v168, v168, v12
    v_sub_f32 v73, v73, v12
    v_sub_f32 v89, v89, v12
    v_sub_f32 v169, v169, v12
    v_sub_f32 v74, v74, v12
    v_sub_f32 v90, v90, v12
    v_sub_f32 v170, v170, v12
    v_sub_f32 v75, v75, v12
    v_sub_f32 v91, v91, v12
    v_sub_f32 v171, v171, v12
    s_nop 1
K2_IT0:
    s_waitcnt vmcnt(4)
    s_barrier
    v_add_u32 v4, s26, v2
    s_add_u32 s33, s26, 16384
    s_and_b32 s33, s33, 0xffff
    v_add_u32 v5, s33, v2
    v_add_u32 v6, s27, v2
    s_cmp_eq_u32 s25, s23
    s_cbranch_scc1 K2_FIN0
    s_cmp_lg_u32 s25, 0
    s_cbranch_scc1 K2_RA0
    ds_read_b128 v[124:127], v4 offset:0
    ds_read_b128 v[128:131], v4 offset:1024
    ds_read_b128 v[132:135], v4 offset:2048
    ds_read_b128 v[136:139], v4 offset:3072
    ds_read_b128 v[140:143], v4 offset:4096
    ds_read_b128 v[144:147], v4 offset:5120
K2_RA0:
    s_add_u32 s33, s25, 1
    s_cmp_eq_u32 s33, s23
    s_cbranch_scc1 K2_MSK0
    s_waitcnt lgkmcnt(4)
    v_mfma_f32_32x32x16_bf16 v[92:107], v[124:127], v[28:31], v[156:171]
    ds_read_b128 v[148:151], v4 offset:6144
    v_exp_f32 v60, v60
    v_exp_f32 v61, v61
    v_exp_f32 v62, v62
    v_mfma_f32_32x32x16_bf16 v[92:107], v[128:131], v[32:35], v[92:107]
    ds_read_b128 v[152:155], v4 offset:7168
    v_exp_f32 v63, v63
    v_exp_f32 v64, v64
    v_exp_f32 v65, v65
    s_waitcnt lgkmcnt(4)
    v_mfma_f32_32x32x16_bf16 v[92:107], v[132:135], v[36:39], v[92:107]
    ds_read_b128 v[124:127], v6 offset:0
    v_exp_f32 v66, v66
    v_exp_f32 v67, v67
    v_cvt_pk_bf16_f32 v108, v60, v61
    v_mfma_f32_32x32x16_bf16 v[92:107], v[136:139], v[40:43], v[92:107]
    ds_read_b128 v[128:131], v6 offset:1024
    v_cvt_pk_bf16_f32 v109, v62, v63
    v_cvt_pk_bf16_f32 v110, v64, v65
    v_cvt_pk_bf16_f32 v111, v66, v67
    s_waitcnt lgkmcnt(4)
    v_mfma_f32_32x32x16_bf16 v[92:107], v[140:143], v[44:47], v[92:107]
    ds_read_b128 v[132:135], v6 offset:2048
    v_exp_f32 v68, v68
    v_exp_f32 v69, v69
    v_exp_f32 v70, v70
    v_mfma_f32_32x32x16_bf16 v[92:107], v[144:147], v[48:51], v[92:107]
    ds_read_b128 v[136:139], v6 offset:3072
    v_exp_f32 v71, v71
    v_exp_f32 v72, v72
    v_exp_f32 v73, v73
    s_waitcnt lgkmcnt(4)
    v_mfma_f32_32x32x16_bf16 v[92:107], v[148:151], v[52:55], v[92:107]
    ds_read_b128 v[140:143], v6 offset:4096
    s_add_u32 m0, s28, s32
    s_add_u32 s28, s28, 16384
    buffer_load_dwordx4 v11, s[16:19], s34 offen lds
    v_exp_f32 v74, v74
    v_exp_f32 v75, v75
    v_cvt_pk_bf16_f32 v112, v68, v69
    v_mfma_f32_32x32x16_bf16 v[92:107], v[152:155], v[56:59], v[92:107]
    ds_read_b128 v[144:147], v6 offset:5120
    v_cvt_pk_bf16_f32 v113, v70, v71
    v_cvt_pk_bf16_f32 v114, v72, v73
    v_cvt_pk_bf16_f32 v115, v74, v75
    s_waitcnt lgkmcnt(4)
    v_mfma_f32_32x32x16_bf16 v[188:203], v[124:127], v[108:111], v[188:203]
    ds_read_b128 v[148:151], v6 offset:6144
    v_exp_f32 v76, v76
    v_exp_f32 v77, v77
    v_mfma_f32_32x32x16_bf16 v[204:219], v[128:131], v[108:111], v[204:219]
    ds_read_b128 v[152:155], v6 offset:7168
    v_exp_f32 v78, v78
    v_exp_f32 v79, v79
    v_exp_f32 v80, v80
    s_waitcnt lgkmcnt(4)
    v_mfma_f32_32x32x16_bf16 v[220:235], v[132:135], v[108:111], v[220:235]
    ds_read_b128 v[124:127], v4 offset:8192
    v_exp_f32 v81, v81
    v_exp_f32 v82, v82
    v_mfma_f32_32x32x16_bf16 v[236:251], v[136:139], v[108:111], v[236:251]
    ds_read_b128 v[128:131], v4 offset:9216
    v_exp_f32 v83, v83
    v_cvt_pk_bf16_f32 v116, v76, v77
    v_cvt_pk_bf16_f32 v117, v78, v79
    s_waitcnt lgkmcnt(4)
    v_mfma_f32_32x32x16_bf16 v[188:203], v[140:143], v[112:115], v[188:203]
    ds_read_b128 v[132:135], v4 offset:10240
    v_cvt_pk_bf16_f32 v118, v80, v81
    v_cvt_pk_bf16_f32 v119, v82, v83
    v_mfma_f32_32x32x16_bf16 v[204:219], v[144:147], v[112:115], v[204:219]
    ds_read_b128 v[136:139], v4 offset:11264
    buffer_load_dwordx4 v11, s[16:19], s34 offen offset:1024 lds
    s_and_b32 s28, s28, 0xffff
    s_add_u32 s34, s34, 16384
    v_pk_add_f32 v[172:173], v[172:173], v[60:61]
    v_pk_add_f32 v[174:175], v[174:175], v[62:63]
    v_pk_add_f32 v[172:173], v[172:173], v[64:65]
    s_waitcnt lgkmcnt(4)
    v_mfma_f32_32x32x16_bf16 v[220:235], v[148:151], v[112:115], v[220:235]
    ds_read_b128 v[140:143], v4 offset:12288
    v_pk_add_f32 v[174:175], v[174:175], v[66:67]
    v_pk_add_f32 v[172:173], v[172:173], v[68:69]
    v_mfma_f32_32x32x16_bf16 v[236:251], v[152:155], v[112:115], v[236:251]
    ds_read_b128 v[144:147], v4 offset:13312
    v_pk_add_f32 v[174:175], v[174:175], v[70:71]
    v_pk_add_f32 v[172:173], v[172:173], v[72:73]
    v_pk_add_f32 v[174:175], v[174:175], v[74:75]
    s_waitcnt lgkmcnt(4)
    v_mfma_f32_32x32x16_bf16 v[60:75], v[124:127], v[28:31], v[156:171]
    ds_read_b128 v[148:151], v4 offset:14336
    v_exp_f32 v84, v84
    v_exp_f32 v85, v85
    v_mfma_f32_32x32x16_bf16 v[60:75], v[128:131], v[32:35], v[60:75]
    ds_read_b128 v[152:155], v4 offset:15360
    v_exp_f32 v86, v86
    v_exp_f32 v87, v87
    v_exp_f32 v88, v88
    s_waitcnt lgkmcnt(4)
    v_mfma_f32_32x32x16_bf16 v[60:75], v[132:135], v[36:39], v[60:75]
    ds_read_b128 v[124:127], v6 offset:8192
    v_exp_f32 v89, v89
    v_exp_f32 v90, v90
    v_mfma_f32_32x32x16_bf16 v[60:75], v[136:139], v[40:43], v[60:75]
    ds_read_b128 v[128:131], v6 offset:9216
    v_exp_f32 v91, v91
    v_cvt_pk_bf16_f32 v120, v84, v85
    v_cvt_pk_bf16_f32 v121, v86, v87
    s_waitcnt lgkmcnt(4)
    v_mfma_f32_32x32x16_bf16 v[60:75], v[140:143], v[44:47], v[60:75]
    ds_read_b128 v[132:135], v6 offset:10240
    s_add_u32 m0, s29, s32
    s_add_u32 s29, s29, 16384
    buffer_load_dwordx4 v11, s[16:19], s35 offen lds
    v_cvt_pk_bf16_f32 v122, v88, v89
    v_cvt_pk_bf16_f32 v123, v90, v91
    v_mfma_f32_32x32x16_bf16 v[60:75], v[144:147], v[48:51], v[60:75]
    ds_read_b128 v[136:139], v6 offset:11264
    v_max3_f32 v20, v92, v93, v94
    v_max3_f32 v20, v20, v95, v96
    v_max3_f32 v20, v20, v97, v98
    s_waitcnt lgkmcnt(4)
    v_mfma_f32_32x32x16_bf16 v[60:75], v[148:151], v[52:55], v[60:75]
    ds_read_b128 v[140:143], v6 offset:12288
    v_max3_f32 v20, v20, v99, v100
    v_max3_f32 v20, v20, v101, v102
    v_mfma_f32_32x32x16_bf16 v[60:75], v[152:155], v[56:59], v[60:75]
    ds_read_b128 v[144:147], v6 offset:13312
    v_max3_f32 v20, v20, v103, v104
    v_max3_f32 v20, v20, v105, v106
    v_max_f32 v20, v20, v107
    s_waitcnt lgkmcnt(4)
    v_mfma_f32_32x32x16_bf16 v[188:203], v[124:127], v[116:119], v[188:203]
    ds_read_b128 v[148:151], v6 offset:14336
    v_pk_add_f32 v[172:173], v[172:173], v[76:77]
    v_pk_add_f32 v[174:175], v[174:175], v[78:79]
    v_pk_add_f32 v[172:173], v[172:173], v[80:81]
    v_mfma_f32_32x32x16_bf16 v[204:219], v[128:131], v[116:119], v[204:219]
    ds_read_b128 v[152:155], v6 offset:15360
    v_pk_add_f32 v[174:175], v[174:175], v[82:83]
    v_pk_add_f32 v[172:173], v[172:173], v[84:85]
    v_pk_add_f32 v[174:175], v[174:175], v[86:87]
    s_waitcnt lgkmcnt(4)
    v_mfma_f32_32x32x16_bf16 v[220:235], v[132:135], v[116:119], v[220:235]
    ds_read_b128 v[124:127], v5 offset:0
    v_pk_add_f32 v[172:173], v[172:173], v[88:89]
    v_pk_add_f32 v[174:175], v[174:175], v[90:91]
    v_mfma_f32_32x32x16_bf16 v[236:251], v[136:139], v[116:119], v[236:251]
    ds_read_b128 v[128:131], v5 offset:1024
    buffer_load_dwordx4 v11, s[16:19], s35 offen offset:1024 lds
    s_cmp_eq_u32 s29, 114688
    s_cselect_b32 s29, 65536, s29
    s_add_u32 s35, s35, 16384
    v_max3_f32 v12, v20, v60, v61
    s_waitcnt lgkmcnt(4)
    v_mfma_f32_32x32x16_bf16 v[188:203], v[140:143], v[120:123], v[188:203]
    ds_read_b128 v[132:135], v5 offset:2048
    v_max3_f32 v12, v12, v62, v63
    v_max3_f32 v12, v12, v64, v65
    v_mfma_f32_32x32x16_bf16 v[204:219], v[144:147], v[120:123], v[204:219]
    ds_read_b128 v[136:139], v5 offset:3072
    v_max3_f32 v12, v12, v66, v67
    v_max3_f32 v12, v12, v68, v69
    s_waitcnt lgkmcnt(4)
    v_mfma_f32_32x32x16_bf16 v[220:235], v[148:151], v[120:123], v[220:235]
    ds_read_b128 v[140:143], v5 offset:4096
    v_max3_f32 v12, v12, v70, v71
    v_max3_f32 v12, v12, v72, v73
    v_mfma_f32_32x32x16_bf16 v[236:251], v[152:155], v[120:123], v[236:251]
    ds_read_b128 v[144:147], v5 offset:5120
    v_max3_f32 v12, v12, v74, v75
    v_cmp_gt_f32 vcc, v12, v21
    s_nop 4
    s_cbranch_vccz K2_NRB00
    s_nop 15
    v_mov_b32 v13, v12
    s_nop 1
    v_permlane32_swap_b32 v12, v13
    s_nop 1
    v_max_f32 v12, v12, v13
    v_max_f32 v12, 0, v12
    v_sub_f32 v13, 0, v12
    v_exp_f32 v13, v13
    v_sub_f32 v92, v92, v12
    v_sub_f32 v60, v60, v12
    v_sub_f32 v156, v156, v12
    v_sub_f32 v93, v93, v12
    v_sub_f32 v61, v61, v12
    v_sub_f32 v157, v157, v12
    v_sub_f32 v94, v94, v12
    v_sub_f32 v62, v62, v12
    v_sub_f32 v158, v158, v12
    v_sub_f32 v95, v95, v12
    v_sub_f32 v63, v63, v12
    v_sub_f32 v159, v159, v12
    v_sub_f32 v96, v96, v12
    v_sub_f32 v64, v64, v12
    v_sub_f32 v160, v160, v12
    v_sub_f32 v97, v97, v12
    v_sub_f32 v65, v65, v12
    v_sub_f32 v161, v161, v12
    v_sub_f32 v98, v98, v12
    v_sub_f32 v66, v66, v12
    v_sub_f32 v162, v162, v12
    v_sub_f32 v99, v99, v12
    v_sub_f32 v67, v67, v12
    v_sub_f32 v163, v163, v12
    v_sub_f32 v100, v100, v12
    v_sub_f32 v68, v68, v12
    v_sub_f32 v164, v164, v12
    v_sub_f32 v101, v101, v12
    v_sub_f32 v69, v69, v12
    v_sub_f32 v165, v165, v12
    v_sub_f32 v102, v102, v12
    v_sub_f32 v70, v70, v12
    v_sub_f32 v166, v166, v12
    v_sub_f32 v103, v103, v12
    v_sub_f32 v71, v71, v12
    v_sub_f32 v167, v167, v12
    v_sub_f32 v104, v104, v12
    v_sub_f32 v72, v72, v12
    v_sub_f32 v168, v168, v12
    v_sub_f32 v105, v105, v12
    v_sub_f32 v73, v73, v12
    v_sub_f32 v169, v169, v12
    v_sub_f32 v106, v106, v12
    v_sub_f32 v74, v74, v12
    v_sub_f32 v170, v170, v12
    v_sub_f32 v107, v107, v12
    v_sub_f32 v75, v75, v12
    v_sub_f32 v171, v171, v12
    v_mul_f32 v172, v172, v13
    v_mul_f32 v173, v173, v13
    v_mul_f32 v174, v174, v13
    v_mul_f32 v175, v175, v13
    v_mul_f32 v188, v188, v13
    v_mul_f32 v189, v189, v13
    v_mul_f32 v190, v190, v13
    v_mul_f32 v191, v191, v13
    v_mul_f32 v192, v192, v13
    v_mul_f32 v193, v193, v13
    v_mul_f32 v194, v194, v13
    v_mul_f32 v195, v195, v13
    v_mul_f32 v196, v196, v13
    v_mul_f32 v197, v197, v13
    v_mul_f32 v198, v198, v13
    v_mul_f32 v199, v199, v13
    v_mul_f32 v200, v200, v13
    v_mul_f32 v201, v201, v13
    v_mul_f32 v202, v202, v13
    v_mul_f32 v203, v203, v13
    v_mul_f32 v204, v204, v13
    v_mul_f32 v205, v205, v13
    v_mul_f32 v206, v206, v13
    v_mul_f32 v207, v207, v13
    v_mul_f32 v208, v208, v13
    v_mul_f32 v209, v209, v13
    v_mul_f32 v210, v210, v13
    v_mul_f32 v211, v211, v13
    v_mul_f32 v212, v212, v13
    v_mul_f32 v213, v213, v13
    v_mul_f32 v214, v214, v13
    v_mul_f32 v215, v215, v13
    v_mul_f32 v216, v216, v13
    v_mul_f32 v217, v217, v13
    v_mul_f32 v218, v218, v13
    v_mul_f32 v219, v219, v13
    v_mul_f32 v220, v220, v13
    v_mul_f32 v221, v221, v13
    v_mul_f32 v222, v222, v13
    v_mul_f32 v223, v223, v13
    v_mul_f32 v224, v224, v13
    v_mul_f32 v225, v225, v13
    v_mul_f32 v226, v226, v13
    v_mul_f32 v227, v227, v13
    v_mul_f32 v228, v228, v13
    v_mul_f32 v229, v229, v13
    v_mul_f32 v230, v230, v13
    v_mul_f32 v231, v231, v13
    v_mul_f32 v232, v232, v13
    v_mul_f32 v233, v233, v13
    v_mul_f32 v234, v234, v13
    v_mul_f32 v235, v235, v13
    v_mul_f32 v236, v236, v13
    v_mul_f32 v237, v237, v13
    v_mul_f32 v238, v238, v13
    v_mul_f32 v239, v239, v13
    v_mul_f32 v240, v240, v13
    v_mul_f32 v241, v241, v13
    v_mul_f32 v242, v242, v13
    v_mul_f32 v243, v243, v13
    v_mul_f32 v244, v244, v13
    v_mul_f32 v245, v245, v13
    v_mul_f32 v246, v246, v13
    v_mul_f32 v247, v247, v13
    v_mul_f32 v248, v248, v13
    v_mul_f32 v249, v249, v13
    v_mul_f32 v250, v250, v13
    v_mul_f32 v251, v251, v13
    s_nop 1
K2_NRB00:
    s_add_u32 s26, s26, 16384
    s_and_b32 s26, s26, 0xffff
    s_add_u32 s27, s27, 16384
    s_cmp_eq_u32 s27, 114688
    s_cselect_b32 s27, 65536, s27
    s_add_u32 s25, s25, 1
    s_branch K2_IT1
K2_MSK0:
    s_waitcnt lgkmcnt(4)
    v_mfma_f32_32x32x16_bf16 v[92:107], v[124:127], v[28:31], v[156:171]
    ds_read_b128 v[148:151], v4 offset:6144
    v_exp_f32 v60, v60
    v_exp_f32 v61, v61
    v_exp_f32 v62, v62
    v_mfma_f32_32x32x16_bf16 v[92:107], v[128:131], v[32:35], v[92:107]
    ds_read_b128 v[152:155], v4 offset:7168
    v_exp_f32 v63, v63
    v_exp_f32 v64, v64
    v_exp_f32 v65, v65
    s_waitcnt lgkmcnt(4)
    v_mfma_f32_32x32x16_bf16 v[92:107], v[132:135], v[36:39], v[92:107]
    ds_read_b128 v[124:127], v6 offset:0
    v_exp_f32 v66, v66
    v_exp_f32 v67, v67
    v_cvt_pk_bf16_f32 v108, v60, v61
    v_mfma_f32_32x32x16_bf16 v[92:107], v[136:139], v[40:43], v[92:107]
    ds_read_b128 v[128:131], v6 offset:1024
    v_cvt_pk_bf16_f32 v109, v62, v63
    v_cvt_pk_bf16_f32 v110, v64, v65
    v_cvt_pk_bf16_f32 v111, v66, v67
    s_waitcnt lgkmcnt(4)
    v_mfma_f32_32x32x16_bf16 v[92:107], v[140:143], v[44:47], v[92:107]
    ds_read_b128 v[132:135], v6 offset:2048
    v_exp_f32 v68, v68
    v_exp_f32 v69, v69
    v_exp_f32 v70, v70
    v_mfma_f32_32x32x16_bf16 v[92:107], v[144:147], v[48:51], v[92:107]
    ds_read_b128 v[136:139], v6 offset:3072
    v_exp_f32 v71, v71
    v_exp_f32 v72, v72
    v_exp_f32 v73, v73
    s_waitcnt lgkmcnt(4)
    v_mfma_f32_32x32x16_bf16 v[92:107], v[148:151], v[52:55], v[92:107]
    ds_read_b128 v[140:143], v6 offset:4096
    s_add_u32 m0, s28, s32
    s_add_u32 s28, s28, 16384
    buffer_load_dwordx4 v11, s[16:19], s34 offen lds
    v_exp_f32 v74, v74
    v_exp_f32 v75, v75
    v_cvt_pk_bf16_f32 v112, v68, v69
    v_mfma_f32_32x32x16_bf16 v[92:107], v[152:155], v[56:59], v[92:107]
    ds_read_b128 v[144:147], v6 offset:5120
    v_cvt_pk_bf16_f32 v113, v70, v71
    v_cvt_pk_bf16_f32 v114, v72, v73
    v_cvt_pk_bf16_f32 v115, v74, v75
    s_waitcnt lgkmcnt(4)
    v_mfma_f32_32x32x16_bf16 v[188:203], v[124:127], v[108:111], v[188:203]
    ds_read_b128 v[148:151], v6 offset:6144
    v_exp_f32 v76, v76
    v_exp_f32 v77, v77
    v_mfma_f32_32x32x16_bf16 v[204:219], v[128:131], v[108:111], v[204:219]
    ds_read_b128 v[152:155], v6 offset:7168
    v_exp_f32 v78, v78
    v_exp_f32 v79, v79
    v_exp_f32 v80, v80
    s_waitcnt lgkmcnt(4)
    v_mfma_f32_32x32x16_bf16 v[220:235], v[132:135], v[108:111], v[220:235]
    ds_read_b128 v[124:127], v4 offset:8192
    v_exp_f32 v81, v81
    v_exp_f32 v82, v82
    v_mfma_f32_32x32x16_bf16 v[236:251], v[136:139], v[108:111], v[236:251]
    ds_read_b128 v[128:131], v4 offset:9216
    v_exp_f32 v83, v83
    v_cvt_pk_bf16_f32 v116, v76, v77
    v_cvt_pk_bf16_f32 v117, v78, v79
    s_waitcnt lgkmcnt(4)
    v_mfma_f32_32x32x16_bf16 v[188:203], v[140:143], v[112:115], v[188:203]
    ds_read_b128 v[132:135], v4 offset:10240
    v_cvt_pk_bf16_f32 v118, v80, v81
    v_cvt_pk_bf16_f32 v119, v82, v83
    v_mfma_f32_32x32x16_bf16 v[204:219], v[144:147], v[112:115], v[204:219]
    ds_read_b128 v[136:139], v4 offset:11264
    buffer_load_dwordx4 v11, s[16:19], s34 offen offset:1024 lds
    s_and_b32 s28, s28, 0xffff
    s_add_u32 s34, s34, 16384
    v_pk_add_f32 v[172:173], v[172:173], v[60:61]
    v_pk_add_f32 v[174:175], v[174:175], v[62:63]
    v_pk_add_f32 v[172:173], v[172:173], v[64:65]
    s_waitcnt lgkmcnt(4)
    v_mfma_f32_32x32x16_bf16 v[220:235], v[148:151], v[112:115], v[220:235]
    ds_read_b128 v[140:143], v4 offset:12288
    v_pk_add_f32 v[174:175], v[174:175], v[66:67]
    v_pk_add_f32 v[172:173], v[172:173], v[68:69]
    v_mfma_f32_32x32x16_bf16 v[236:251], v[152:155], v[112:115], v[236:251]
    ds_read_b128 v[144:147], v4 offset:13312
    v_pk_add_f32 v[174:175], v[174:175], v[70:71]
    v_pk_add_f32 v[172:173], v[172:173], v[72:73]
    v_pk_add_f32 v[174:175], v[174:175], v[74:75]
    s_waitcnt lgkmcnt(4)
    v_mfma_f32_32x32x16_bf16 v[60:75], v[124:127], v[28:31], v[156:171]
    ds_read_b128 v[148:151], v4 offset:14336
    v_exp_f32 v84, v84
    v_mfma_f32_32x32x16_bf16 v[60:75], v[128:131], v[32:35], v[60:75]
    ds_read_b128 v[152:155], v4 offset:15360
    v_exp_f32 v85, v85
    v_exp_f32 v86, v86
    s_waitcnt lgkmcnt(4)
    v_mfma_f32_32x32x16_bf16 v[60:75], v[132:135], v[36:39], v[60:75]
    ds_read_b128 v[124:127], v6 offset:8192
    v_exp_f32 v87, v87
    v_mfma_f32_32x32x16_bf16 v[60:75], v[136:139], v[40:43], v[60:75]
    ds_read_b128 v[128:131], v6 offset:9216
    v_exp_f32 v88, v88
    v_exp_f32 v89, v89
    s_waitcnt lgkmcnt(4)
    v_mfma_f32_32x32x16_bf16 v[60:75], v[140:143], v[44:47], v[60:75]
    ds_read_b128 v[132:135], v6 offset:10240
    s_add_u32 m0, s29, s32
    s_add_u32 s29, s29, 16384
    buffer_load_dwordx4 v11, s[16:19], s35 offen lds
    v_exp_f32 v90, v90
    v_mfma_f32_32x32x16_bf16 v[60:75], v[144:147], v[48:51], v[60:75]
    ds_read_b128 v[136:139], v6 offset:11264
    v_exp_f32 v91, v91
    v_cvt_pk_bf16_f32 v120, v84, v85
    s_waitcnt lgkmcnt(4)
    v_mfma_f32_32x32x16_bf16 v[60:75], v[148:151], v[52:55], v[60:75]
    ds_read_b128 v[140:143], v6 offset:12288
    v_cvt_pk_bf16_f32 v121, v86, v87
    v_mfma_f32_32x32x16_bf16 v[60:75], v[152:155], v[56:59], v[60:75]
    ds_read_b128 v[144:147], v6 offset:13312
    v_cvt_pk_bf16_f32 v122, v88, v89
    v_cvt_pk_bf16_f32 v123, v90, v91
    s_waitcnt lgkmcnt(4)
    v_mfma_f32_32x32x16_bf16 v[188:203], v[124:127], v[116:119], v[188:203]
    ds_read_b128 v[148:151], v6 offset:14336
    v_pk_add_f32 v[172:173], v[172:173], v[76:77]
    v_pk_add_f32 v[174:175], v[174:175], v[78:79]
    v_pk_add_f32 v[172:173], v[172:173], v[80:81]
    v_mfma_f32_32x32x16_bf16 v[204:219], v[128:131], v[116:119], v[204:219]
    ds_read_b128 v[152:155], v6 offset:15360
    v_pk_add_f32 v[174:175], v[174:175], v[82:83]
    v_pk_add_f32 v[172:173], v[172:173], v[84:85]
    v_pk_add_f32 v[174:175], v[174:175], v[86:87]
    s_waitcnt lgkmcnt(4)
    v_mfma_f32_32x32x16_bf16 v[220:235], v[132:135], v[116:119], v[220:235]
    ds_read_b128 v[124:127], v5 offset:0
    v_pk_add_f32 v[172:173], v[172:173], v[88:89]
    v_pk_add_f32 v[174:175], v[174:175], v[90:91]
    v_mfma_f32_32x32x16_bf16 v[236:251], v[136:139], v[116:119], v[236:251]
    ds_read_b128 v[128:131], v5 offset:1024
    buffer_load_dwordx4 v11, s[16:19], s35 offen offset:1024 lds
    s_cmp_eq_u32 s29, 114688
    s_cselect_b32 s29, 65536, s29
    s_add_u32 s35, s35, 16384
    s_waitcnt lgkmcnt(4)
    v_mfma_f32_32x32x16_bf16 v[188:203], v[140:143], v[120:123], v[188:203]
    ds_read_b128 v[132:135], v5 offset:2048
    v_mfma_f32_32x32x16_bf16 v[204:219], v[144:147], v[120:123], v[204:219]
    ds_read_b128 v[136:139], v5 offset:3072
    s_waitcnt lgkmcnt(4)
    v_mfma_f32_32x32x16_bf16 v[220:235], v[148:151], v[120:123], v[220:235]
    ds_read_b128 v[140:143], v5 offset:4096
    v_mfma_f32_32x32x16_bf16 v[236:251], v[152:155], v[120:123], v[236:251]
    ds_read_b128 v[144:147], v5 offset:5120
    s_nop 7
    s_add_u32 s33, s25, 1
    s_lshl_b32 s33, s33, 6
    v_subrev_u32 v12, s33, v7
    v_cmp_gt_i32 s[60:61], 0, v12
    v_cmp_gt_i32 s[62:63], 1, v12
    v_cmp_gt_i32 s[64:65], 2, v12
    v_cmp_gt_i32 s[66:67], 3, v12
    s_nop 1
    v_cndmask_b32 v92, v92, v10, s[60:61]
    v_cndmask_b32 v93, v93, v10, s[62:63]
    v_cndmask_b32 v94, v94, v10, s[64:65]
    v_cndmask_b32 v95, v95, v10, s[66:67]
    v_cmp_gt_i32 s[60:61], 8, v12
    v_cmp_gt_i32 s[62:63], 9, v12
    v_cmp_gt_i32 s[64:65], 10, v12
    v_cmp_gt_i32 s[66:67], 11, v12
    s_nop 1
    v_cndmask_b32 v96, v96, v10, s[60:61]
    v_cndmask_b32 v97, v97, v10, s[62:63]
    v_cndmask_b32 v98, v98, v10, s[64:65]
    v_cndmask_b32 v99, v99, v10, s[66:67]
    v_cmp_gt_i32 s[60:61], 16, v12
    v_cmp_gt_i32 s[62:63], 17, v12
    v_cmp_gt_i32 s[64:65], 18, v12
    v_cmp_gt_i32 s[66:67], 19, v12
    s_nop 1
    v_cndmask_b32 v100, v100, v10, s[60:61]
    v_cndmask_b32 v101, v101, v10, s[62:63]
    v_cndmask_b32 v102, v102, v10, s[64:65]
    v_cndmask_b32 v103, v103, v10, s[66:67]
    v_cmp_gt_i32 s[60:61], 24, v12
    v_cmp_gt_i32 s[62:63], 25, v12
    v_cmp_gt_i32 s[64:65], 26, v12
    v_cmp_gt_i32 s[66:67], 27, v12
    s_nop 1
    v_cndmask_b32 v104, v104, v10, s[60:61]
    v_cndmask_b32 v105, v105, v10, s[62:63]
    v_cndmask_b32 v106, v106, v10, s[64:65]
    v_cndmask_b32 v107, v107, v10, s[66:67]
    v_cmp_gt_i32 s[60:61], 32, v12
    v_cmp_gt_i32 s[62:63], 33, v12
    v_cmp_gt_i32 s[64:65], 34, v12
    v_cmp_gt_i32 s[66:67], 35, v12
    s_nop 1
    v_cndmask_b32 v60, v60, v10, s[60:61]
    v_cndmask_b32 v61, v61, v10, s[62:63]
    v_cndmask_b32 v62, v62, v10, s[64:65]
    v_cndmask_b32 v63, v63, v10, s[66:67]
    v_cmp_gt_i32 s[60:61], 40, v12
    v_cmp_gt_i32 s[62:63], 41, v12
    v_cmp_gt_i32 s[64:65], 42, v12
    v_cmp_gt_i32 s[66:67], 43, v12
    s_nop 1
    v_cndmask_b32 v64, v64, v10, s[60:61]
    v_cndmask_b32 v65, v65, v10, s[62:63]
    v_cndmask_b32 v66, v66, v10, s[64:65]
    v_cndmask_b32 v67, v67, v10, s[66:67]
    v_cmp_gt_i32 s[60:61], 48, v12
    v_cmp_gt_i32 s[62:63], 49, v12
    v_cmp_gt_i32 s[64:65], 50, v12
    v_cmp_gt_i32 s[66:67], 51, v12
    s_nop 1
    v_cndmask_b32 v68, v68, v10, s[60:61]
    v_cndmask_b32 v69, v69, v10, s[62:63]
    v_cndmask_b32 v70, v70, v10, s[64:65]
    v_cndmask_b32 v71, v71, v10, s[66:67]
    v_cmp_gt_i32 s[60:61], 56, v12
    v_cmp_gt_i32 s[62:63], 57, v12
    v_cmp_gt_i32 s[64:65], 58, v12
    v_cmp_gt_i32 s[66:67], 59, v12
    s_nop 1
    v_cndmask_b32 v72, v72, v10, s[60:61]
    v_cndmask_b32 v73, v73, v10, s[62:63]
    v_cndmask_b32 v74, v74, v10, s[64:65]
    v_cndmask_b32 v75, v75, v10, s[66:67]
    v_max3_f32 v20, v92, v93, v94
    v_max3_f32 v20, v20, v95, v96
    v_max3_f32 v20, v20, v97, v98
    v_max3_f32 v20, v20, v99, v100
    v_max3_f32 v20, v20, v101, v102
    v_max3_f32 v20, v20, v103, v104
    v_max3_f32 v20, v20, v105, v106
    v_max_f32 v20, v20, v107
    v_max3_f32 v12, v20, v60, v61
    v_max3_f32 v12, v12, v62, v63
    v_max3_f32 v12, v12, v64, v65
    v_max3_f32 v12, v12, v66, v67
    v_max3_f32 v12, v12, v68, v69
    v_max3_f32 v12, v12, v70, v71
    v_max3_f32 v12, v12, v72, v73
    v_max3_f32 v12, v12, v74, v75
    v_cmp_gt_f32 vcc, v12, v21
    s_nop 4
    s_cbranch_vccz K2_NRB01
    s_nop 15
    v_mov_b32 v13, v12
    s_nop 1
    v_permlane32_swap_b32 v12, v13
    s_nop 1
    v_max_f32 v12, v12, v13
    v_max_f32 v12, 0, v12
    v_sub_f32 v13, 0, v12
    v_exp_f32 v13, v13
    v_sub_f32 v92, v92, v12
    v_sub_f32 v60, v60, v12
    v_sub_f32 v156, v156, v12
    v_sub_f32 v93, v93, v12
    v_sub_f32 v61, v61, v12
    v_sub_f32 v157, v157, v12
    v_sub_f32 v94, v94, v12
    v_sub_f32 v62, v62, v12
    v_sub_f32 v158, v158, v12
    v_sub_f32 v95, v95, v12
    v_sub_f32 v63, v63, v12
    v_sub_f32 v159, v159, v12
    v_sub_f32 v96, v96, v12
    v_sub_f32 v64, v64, v12
    v_sub_f32 v160, v160, v12
    v_sub_f32 v97, v97, v12
    v_sub_f32 v65, v65, v12
    v_sub_f32 v161, v161, v12
    v_sub_f32 v98, v98, v12
    v_sub_f32 v66, v66, v12
    v_sub_f32 v162, v162, v12
    v_sub_f32 v99, v99, v12
    v_sub_f32 v67, v67, v12
    v_sub_f32 v163, v163, v12
    v_sub_f32 v100, v100, v12
    v_sub_f32 v68, v68, v12
    v_sub_f32 v164, v164, v12
    v_sub_f32 v101, v101, v12
    v_sub_f32 v69, v69, v12
    v_sub_f32 v165, v165, v12
    v_sub_f32 v102, v102, v12
    v_sub_f32 v70, v70, v12
    v_sub_f32 v166, v166, v12
    v_sub_f32 v103, v103, v12
    v_sub_f32 v71, v71, v12
    v_sub_f32 v167, v167, v12
    v_sub_f32 v104, v104, v12
    v_sub_f32 v72, v72, v12
    v_sub_f32 v168, v168, v12
    v_sub_f32 v105, v105, v12
    v_sub_f32 v73, v73, v12
    v_sub_f32 v169, v169, v12
    v_sub_f32 v106, v106, v12
    v_sub_f32 v74, v74, v12
    v_sub_f32 v170, v170, v12
    v_sub_f32 v107, v107, v12
    v_sub_f32 v75, v75, v12
    v_sub_f32 v171, v171, v12
    v_mul_f32 v172, v172, v13
    v_mul_f32 v173, v173, v13
    v_mul_f32 v174, v174, v13
    v_mul_f32 v175, v175, v13
    v_mul_f32 v188, v188, v13
    v_mul_f32 v189, v189, v13
    v_mul_f32 v190, v190, v13
    v_mul_f32 v191, v191, v13
    v_mul_f32 v192, v192, v13
    v_mul_f32 v193, v193, v13
    v_mul_f32 v194, v194, v13
    v_mul_f32 v195, v195, v13
    v_mul_f32 v196, v196, v13
    v_mul_f32 v197, v197, v13
    v_mul_f32 v198, v198, v13
    v_mul_f32 v199, v199, v13
    v_mul_f32 v200, v200, v13
    v_mul_f32 v201, v201, v13
    v_mul_f32 v202, v202, v13
    v_mul_f32 v203, v203, v13
    v_mul_f32 v204, v204, v13
    v_mul_f32 v205, v205, v13
    v_mul_f32 v206, v206, v13
    v_mul_f32 v207, v207, v13
    v_mul_f32 v208, v208, v13
    v_mul_f32 v209, v209, v13
    v_mul_f32 v210, v210, v13
    v_mul_f32 v211, v211, v13
    v_mul_f32 v212, v212, v13
    v_mul_f32 v213, v213, v13
    v_mul_f32 v214, v214, v13
    v_mul_f32 v215, v215, v13
    v_mul_f32 v216, v216, v13
    v_mul_f32 v217, v217, v13
    v_mul_f32 v218, v218, v13
    v_mul_f32 v219, v219, v13
    v_mul_f32 v220, v220, v13
    v_mul_f32 v221, v221, v13
    v_mul_f32 v222, v222, v13
    v_mul_f32 v223, v223, v13
    v_mul_f32 v224, v224, v13
    v_mul_f32 v225, v225, v13
    v_mul_f32 v226, v226, v13
    v_mul_f32 v227, v227, v13
    v_mul_f32 v228, v228, v13
    v_mul_f32 v229, v229, v13
    v_mul_f32 v230, v230, v13
    v_mul_f32 v231, v231, v13
    v_mul_f32 v232, v232, v13
    v_mul_f32 v233, v233, v13
    v_mul_f32 v234, v234, v13
    v_mul_f32 v235, v235, v13
    v_mul_f32 v236, v236, v13
    v_mul_f32 v237, v237, v13
    v_mul_f32 v238, v238, v13
    v_mul_f32 v239, v239, v13
    v_mul_f32 v240, v240, v13
    v_mul_f32 v241, v241, v13
    v_mul_f32 v242, v242, v13
    v_mul_f32 v243, v243, v13
    v_mul_f32 v244, v244, v13
    v_mul_f32 v245, v245, v13
    v_mul_f32 v246, v246, v13
    v_mul_f32 v247, v247, v13
    v_mul_f32 v248, v248, v13
    v_mul_f32 v249, v249, v13
    v_mul_f32 v250, v250, v13
    v_mul_f32 v251, v251, v13
    s_nop 1
K2_NRB01:
    s_add_u32 s26, s26, 16384
    s_and_b32 s26, s26, 0xffff
    s_add_u32 s27, s27, 16384
    s_cmp_eq_u32 s27, 114688
    s_cselect_b32 s27, 65536, s27
    s_add_u32 s25, s25, 1
    s_branch K2_IT1
K2_FIN0:
    s_add_u32 m0, s28, s32
    s_add_u32 s28, s28, 16384
    buffer_load_dwordx4 v11, s[16:19], s34 offen lds
    buffer_load_dwordx4 v11, s[16:19], s34 offen offset:1024 lds
    s_and_b32 s28, s28, 0xffff
    s_add_u32 s34, s34, 16384
    s_add_u32 m0, s29, s32
    s_add_u32 s29, s29, 16384
    buffer_load_dwordx4 v11, s[16:19], s35 offen lds
    buffer_load_dwordx4 v11, s[16:19], s35 offen offset:1024 lds
    s_cmp_eq_u32 s29, 114688
    s_cselect_b32 s29, 65536, s29
    s_add_u32 s35, s35, 16384
    s_waitcnt lgkmcnt(0)
    v_exp_f32 v60, v60
    v_exp_f32 v61, v61
    v_exp_f32 v62, v62
    v_exp_f32 v63, v63
    v_exp_f32 v64, v64
    v_exp_f32 v65, v65
    v_exp_f32 v66, v66
    v_exp_f32 v67, v67
    v_cvt_pk_bf16_f32 v108, v60, v61
    v_pk_add_f32 v[172:173], v[172:173], v[60:61]
    v_cvt_pk_bf16_f32 v109, v62, v63
    v_pk_add_f32 v[174:175], v[174:175], v[62:63]
    v_cvt_pk_bf16_f32 v110, v64, v65
    v_pk_add_f32 v[172:173], v[172:173], v[64:65]
    v_cvt_pk_bf16_f32 v111, v66, v67
    v_pk_add_f32 v[174:175], v[174:175], v[66:67]
    v_exp_f32 v68, v68
    v_exp_f32 v69, v69
    v_exp_f32 v70, v70
    v_exp_f32 v71, v71
    v_exp_f32 v72, v72
    v_exp_f32 v73, v73
    v_exp_f32 v74, v74
    v_exp_f32 v75, v75
    v_cvt_pk_bf16_f32 v112, v68, v69
    v_pk_add_f32 v[172:173], v[172:173], v[68:69]
    v_cvt_pk_bf16_f32 v113, v70, v71
    v_pk_add_f32 v[174:175], v[174:175], v[70:71]
    v_cvt_pk_bf16_f32 v114, v72, v73
    v_pk_add_f32 v[172:173], v[172:173], v[72:73]
    v_cvt_pk_bf16_f32 v115, v74, v75
    v_pk_add_f32 v[174:175], v[174:175], v[74:75]
    v_exp_f32 v76, v76
    v_exp_f32 v77, v77
    v_exp_f32 v78, v78
    v_exp_f32 v79, v79
    v_exp_f32 v80, v80
    v_exp_f32 v81, v81
    v_exp_f32 v82, v82
    v_exp_f32 v83, v83
    v_cvt_pk_bf16_f32 v116, v76, v77
    v_pk_add_f32 v[172:173], v[172:173], v[76:77]
    v_cvt_pk_bf16_f32 v117, v78, v79
    v_pk_add_f32 v[174:175], v[174:175], v[78:79]
    v_cvt_pk_bf16_f32 v118, v80, v81
    v_pk_add_f32 v[172:173], v[172:173], v[80:81]
    v_cvt_pk_bf16_f32 v119, v82, v83
    v_pk_add_f32 v[174:175], v[174:175], v[82:83]
    v_exp_f32 v84, v84
    v_exp_f32 v85, v85
    v_exp_f32 v86, v86
    v_exp_f32 v87, v87
    v_exp_f32 v88, v88
    v_exp_f32 v89, v89
    v_exp_f32 v90, v90
    v_exp_f32 v91, v91
    v_cvt_pk_bf16_f32 v120, v84, v85
    v_pk_add_f32 v[172:173], v[172:173], v[84:85]
    v_cvt_pk_bf16_f32 v121, v86, v87
    v_pk_add_f32 v[174:175], v[174:175], v[86:87]
    v_cvt_pk_bf16_f32 v122, v88, v89
    v_pk_add_f32 v[172:173], v[172:173], v[88:89]
    v_cvt_pk_bf16_f32 v123, v90, v91
    v_pk_add_f32 v[174:175], v[174:175], v[90:91]
    ds_read_b128 v[124:127], v6 offset:0
    ds_read_b128 v[128:131], v6 offset:1024
    ds_read_b128 v[132:135], v6 offset:2048
    ds_read_b128 v[136:139], v6 offset:3072
    ds_read_b128 v[140:143], v6 offset:4096
    ds_read_b128 v[144:147], v6 offset:5120
    ds_read_b128 v[148:151], v6 offset:6144
    ds_read_b128 v[152:155], v6 offset:7168
    s_waitcnt lgkmcnt(7)
    v_mfma_f32_32x32x16_bf16 v[188:203], v[124:127], v[108:111], v[188:203]
    s_waitcnt lgkmcnt(6)
    v_mfma_f32_32x32x16_bf16 v[204:219], v[128:131], v[108:111], v[204:219]
    s_waitcnt lgkmcnt(5)
    v_mfma_f32_32x32x16_bf16 v[220:235], v[132:135], v[108:111], v[220:235]
    s_waitcnt lgkmcnt(4)
    v_mfma_f32_32x32x16_bf16 v[236:251], v[136:139], v[108:111], v[236:251]
    s_waitcnt lgkmcnt(3)
    v_mfma_f32_32x32x16_bf16 v[188:203], v[140:143], v[112:115], v[188:203]
    s_waitcnt lgkmcnt(2)
    v_mfma_f32_32x32x16_bf16 v[204:219], v[144:147], v[112:115], v[204:219]
    s_waitcnt lgkmcnt(1)
    v_mfma_f32_32x32x16_bf16 v[220:235], v[148:151], v[112:115], v[220:235]
    s_waitcnt lgkmcnt(0)
    v_mfma_f32_32x32x16_bf16 v[236:251], v[152:155], v[112:115], v[236:251]
    ds_read_b128 v[124:127], v6 offset:8192
    ds_read_b128 v[128:131], v6 offset:9216
    ds_read_b128 v[132:135], v6 offset:10240
    ds_read_b128 v[136:139], v6 offset:11264
    ds_read_b128 v[140:143], v6 offset:12288
    ds_read_b128 v[144:147], v6 offset:13312
    ds_read_b128 v[148:151], v6 offset:14336
    ds_read_b128 v[152:155], v6 offset:15360
    s_waitcnt lgkmcnt(7)
    v_mfma_f32_32x32x16_bf16 v[188:203], v[124:127], v[116:119], v[188:203]
    s_waitcnt lgkmcnt(6)
    v_mfma_f32_32x32x16_bf16 v[204:219], v[128:131], v[116:119], v[204:219]
    s_waitcnt lgkmcnt(5)
    v_mfma_f32_32x32x16_bf16 v[220:235], v[132:135], v[116:119], v[220:235]
    s_waitcnt lgkmcnt(4)
    v_mfma_f32_32x32x16_bf16 v[236:251], v[136:139], v[116:119], v[236:251]
    s_waitcnt lgkmcnt(3)
    v_mfma_f32_32x32x16_bf16 v[188:203], v[140:143], v[120:123], v[188:203]
    s_waitcnt lgkmcnt(2)
    v_mfma_f32_32x32x16_bf16 v[204:219], v[144:147], v[120:123], v[204:219]
    s_waitcnt lgkmcnt(1)
    v_mfma_f32_32x32x16_bf16 v[220:235], v[148:151], v[120:123], v[220:235]
    s_waitcnt lgkmcnt(0)
    v_mfma_f32_32x32x16_bf16 v[236:251], v[152:155], v[120:123], v[236:251]
    v_add_f32 v172, v172, v173
    v_add_f32 v174, v174, v175
    v_add_f32 v172, v172, v174
    v_mov_b32 v173, v172
    s_nop 1
    v_permlane32_swap_b32 v172, v173
    s_nop 1
    v_add_f32 v172, v172, v173
    s_nop 15
    v_rcp_f32 v12, v172
    s_nop 0
    v_mul_f32 v188, v188, v12
    v_mul_f32 v189, v189, v12
    v_mul_f32 v190, v190, v12
    v_mul_f32 v191, v191, v12
    v_mul_f32 v192, v192, v12
    v_mul_f32 v193, v193, v12
    v_mul_f32 v194, v194, v12
    v_mul_f32 v195, v195, v12
    v_mul_f32 v196, v196, v12
    v_mul_f32 v197, v197, v12
    v_mul_f32 v198, v198, v12
    v_mul_f32 v199, v199, v12
    v_mul_f32 v200, v200, v12
    v_mul_f32 v201, v201, v12
    v_mul_f32 v202, v202, v12
    v_mul_f32 v203, v203, v12
    v_mul_f32 v204, v204, v12
    v_mul_f32 v205, v205, v12
    v_mul_f32 v206, v206, v12
    v_mul_f32 v207, v207, v12
    v_mul_f32 v208, v208, v12
    v_mul_f32 v209, v209, v12
    v_mul_f32 v210, v210, v12
    v_mul_f32 v211, v211, v12
    v_mul_f32 v212, v212, v12
    v_mul_f32 v213, v213, v12
    v_mul_f32 v214, v214, v12
    v_mul_f32 v215, v215, v12
    v_mul_f32 v216, v216, v12
    v_mul_f32 v217, v217, v12
    v_mul_f32 v218, v218, v12
    v_mul_f32 v219, v219, v12
    v_mul_f32 v220, v220, v12
    v_mul_f32 v221, v221, v12
    v_mul_f32 v222, v222, v12
    v_mul_f32 v223, v223, v12
    v_mul_f32 v224, v224, v12
    v_mul_f32 v225, v225, v12
    v_mul_f32 v226, v226, v12
    v_mul_f32 v227, v227, v12
    v_mul_f32 v228, v228, v12
    v_mul_f32 v229, v229, v12
    v_mul_f32 v230, v230, v12
    v_mul_f32 v231, v231, v12
    v_mul_f32 v232, v232, v12
    v_mul_f32 v233, v233, v12
    v_mul_f32 v234, v234, v12
    v_mul_f32 v235, v235, v12
    v_mul_f32 v236, v236, v12
    v_mul_f32 v237, v237, v12
    v_mul_f32 v238, v238, v12
    v_mul_f32 v239, v239, v12
    v_mul_f32 v240, v240, v12
    v_mul_f32 v241, v241, v12
    v_mul_f32 v242, v242, v12
    v_mul_f32 v243, v243, v12
    v_mul_f32 v244, v244, v12
    v_mul_f32 v245, v245, v12
    v_mul_f32 v246, v246, v12
    v_mul_f32 v247, v247, v12
    v_mul_f32 v248, v248, v12
    v_mul_f32 v249, v249, v12
    v_mul_f32 v250, v250, v12
    v_mul_f32 v251, v251, v12
    s_lshl_b32 s33, s31, 5
    s_add_u32 s33, s33, s21
    s_lshl_b32 s33, s33, 13
    s_add_u32 s36, s33, 50331648
    s_add_u32 s37, s36, 4096
    v_cvt_pk_bf16_f32 v60, v188, v189
    v_cvt_pk_bf16_f32 v61, v190, v191
    v_cvt_pk_bf16_f32 v62, v192, v193
    v_cvt_pk_bf16_f32 v63, v194, v195
    buffer_store_dwordx4 v[60:63], v2, s[16:19], s36 offen offset:0 sc1
    v_cvt_pk_bf16_f32 v64, v196, v197
    v_cvt_pk_bf16_f32 v65, v198, v199
    v_cvt_pk_bf16_f32 v66, v200, v201
    v_cvt_pk_bf16_f32 v67, v202, v203
    buffer_store_dwordx4 v[64:67], v2, s[16:19], s36 offen offset:1024 sc1
    v_cvt_pk_bf16_f32 v68, v204, v205
    v_cvt_pk_bf16_f32 v69, v206, v207
    v_cvt_pk_bf16_f32 v70, v208, v209
    v_cvt_pk_bf16_f32 v71, v210, v211
    buffer_store_dwordx4 v[68:71], v2, s[16:19], s36 offen offset:2048 sc1
    v_cvt_pk_bf16_f32 v72, v212, v213
    v_cvt_pk_bf16_f32 v73, v214, v215
    v_cvt_pk_bf16_f32 v74, v216, v217
    v_cvt_pk_bf16_f32 v75, v218, v219
    buffer_store_dwordx4 v[72:75], v2, s[16:19], s36 offen offset:3072 sc1
    v_cvt_pk_bf16_f32 v76, v220, v221
    v_cvt_pk_bf16_f32 v77, v222, v223
    v_cvt_pk_bf16_f32 v78, v224, v225
    v_cvt_pk_bf16_f32 v79, v226, v227
    buffer_store_dwordx4 v[76:79], v2, s[16:19], s37 offen offset:0 sc1
    v_cvt_pk_bf16_f32 v80, v228, v229
    v_cvt_pk_bf16_f32 v81, v230, v231
    v_cvt_pk_bf16_f32 v82, v232, v233
    v_cvt_pk_bf16_f32 v83, v234, v235
    buffer_store_dwordx4 v[80:83], v2, s[16:19], s37 offen offset:1024 sc1
    v_cvt_pk_bf16_f32 v84, v236, v237
    v_cvt_pk_bf16_f32 v85, v238, v239
    v_cvt_pk_bf16_f32 v86, v240, v241
    v_cvt_pk_bf16_f32 v87, v242, v243
    buffer_store_dwordx4 v[84:87], v2, s[16:19], s37 offen offset:2048 sc1
    v_cvt_pk_bf16_f32 v88, v244, v245
    v_cvt_pk_bf16_f32 v89, v246, v247
    v_cvt_pk_bf16_f32 v90, v248, v249
    v_cvt_pk_bf16_f32 v91, v250, v251
    buffer_store_dwordx4 v[88:91], v2, s[16:19], s37 offen offset:3072 sc1
    s_branch K2_POST
K2_IT1:
    s_waitcnt vmcnt(4)
    s_barrier
    v_add_u32 v4, s26, v2
    s_add_u32 s33, s26, 16384
    s_and_b32 s33, s33, 0xffff
    v_add_u32 v5, s33, v2
    v_add_u32 v6, s27, v2
    s_cmp_eq_u32 s25, s23
    s_cbranch_scc1 K2_FIN1
    s_add_u32 s33, s25, 1
    s_cmp_eq_u32 s33, s23
    s_cbranch_scc1 K2_MSK1
    s_waitcnt lgkmcnt(4)
    v_mfma_f32_32x32x16_bf16 v[76:91], v[124:127], v[28:31], v[156:171]
    ds_read_b128 v[148:151], v4 offset:6144
    v_exp_f32 v92, v92
    v_exp_f32 v93, v93
    v_exp_f32 v94, v94
    v_mfma_f32_32x32x16_bf16 v[76:91], v[128:131], v[32:35], v[76:91]
    ds_read_b128 v[152:155], v4 offset:7168
    v_exp_f32 v95, v95
    v_exp_f32 v96, v96
    v_exp_f32 v97, v97
    s_waitcnt lgkmcnt(4)
    v_mfma_f32_32x32x16_bf16 v[76:91], v[132:135], v[36:39], v[76:91]
    ds_read_b128 v[124:127], v6 offset:0
    v_exp_f32 v98, v98
    v_exp_f32 v99, v99
    v_cvt_pk_bf16_f32 v108, v92, v93
    v_mfma_f32_32x32x16_bf16 v[76:91], v[136:139], v[40:43], v[76:91]
    ds_read_b128 v[128:131], v6 offset:1024
    v_cvt_pk_bf16_f32 v109, v94, v95
    v_cvt_pk_bf16_f32 v110, v96, v97
    v_cvt_pk_bf16_f32 v111, v98, v99
    s_waitcnt lgkmcnt(4)
    v_mfma_f32_32x32x16_bf16 v[76:91], v[140:143], v[44:47], v[76:91]
    ds_read_b128 v[132:135], v6 offset:2048
    v_exp_f32 v100, v100
    v_exp_f32 v101, v101
    v_exp_f32 v102, v102
    v_mfma_f32_32x32x16_bf16 v[76:91], v[144:147], v[48:51], v[76:91]
    ds_read_b128 v[136:139], v6 offset:3072
    v_exp_f32 v103, v103
    v_exp_f32 v104, v104
    v_exp_f32 v105, v105
    s_waitcnt lgkmcnt(4)
    v_mfma_f32_32x32x16_bf16 v[76:91], v[148:151], v[52:55], v[76:91]
    ds_read_b128 v[140:143], v6 offset:4096
    s_add_u32 m0, s28, s32
    s_add_u32 s28, s28, 16384
    buffer_load_dwordx4 v11, s[16:19], s34 offen lds
    v_exp_f32 v106, v106
    v_exp_f32 v107, v107
    v_cvt_pk_bf16_f32 v112, v100, v101
    v_mfma_f32_32x32x16_bf16 v[76:91], v[152:155], v[56:59], v[76:91]
    ds_read_b128 v[144:147], v6 offset:5120
    v_cvt_pk_bf16_f32 v113, v102, v103
    v_cvt_pk_bf16_f32 v114, v104, v105
    v_cvt_pk_bf16_f32 v115, v106, v107
    s_waitcnt lgkmcnt(4)
    v_mfma_f32_32x32x16_bf16 v[188:203], v[124:127], v[108:111], v[188:203]
    ds_read_b128 v[148:151], v6 offset:6144
    v_exp_f32 v60, v60
    v_exp_f32 v61, v61
    v_mfma_f32_32x32x16_bf16 v[204:219], v[128:131], v[108:111], v[204:219]
    ds_read_b128 v[152:155], v6 offset:7168
    v_exp_f32 v62, v62
    v_exp_f32 v63, v63
    v_exp_f32 v64, v64
    s_waitcnt lgkmcnt(4)
    v_mfma_f32_32x32x16_bf16 v[220:235], v[132:135], v[108:111], v[220:235]
    ds_read_b128 v[124:127], v4 offset:8192
    v_exp_f32 v65, v65
    v_exp_f32 v66, v66
    v_mfma_f32_32x32x16_bf16 v[236:251], v[136:139], v[108:111], v[236:251]
    ds_read_b128 v[128:131], v4 offset:9216
    v_exp_f32 v67, v67
    v_cvt_pk_bf16_f32 v116, v60, v61
    v_cvt_pk_bf16_f32 v117, v62, v63
    s_waitcnt lgkmcnt(4)
    v_mfma_f32_32x32x16_bf16 v[188:203], v[140:143], v[112:115], v[188:203]
    ds_read_b128 v[132:135], v4 offset:10240
    v_cvt_pk_bf16_f32 v118, v64, v65
    v_cvt_pk_bf16_f32 v119, v66, v67
    v_mfma_f32_32x32x16_bf16 v[204:219], v[144:147], v[112:115], v[204:219]
    ds_read_b128 v[136:139], v4 offset:11264
    buffer_load_dwordx4 v11, s[16:19], s34 offen offset:1024 lds
    s_and_b32 s28, s28, 0xffff
    s_add_u32 s34, s34, 16384
    v_pk_add_f32 v[172:173], v[172:173], v[92:93]
    v_pk_add_f32 v[174:175], v[174:175], v[94:95]
    v_pk_add_f32 v[172:173], v[172:173], v[96:97]
    s_waitcnt lgkmcnt(4)
    v_mfma_f32_32x32x16_bf16 v[220:235], v[148:151], v[112:115], v[220:235]
    ds_read_b128 v[140:143], v4 offset:12288
    v_pk_add_f32 v[174:175], v[174:175], v[98:99]
    v_pk_add_f32 v[172:173], v[172:173], v[100:101]
    v_mfma_f32_32x32x16_bf16 v[236:251], v[152:155], v[112:115], v[236:251]
    ds_read_b128 v[144:147], v4 offset:13312
    v_pk_add_f32 v[174:175], v[174:175], v[102:103]
    v_pk_add_f32 v[172:173], v[172:173], v[104:105]
    v_pk_add_f32 v[174:175], v[174:175], v[106:107]
    s_waitcnt lgkmcnt(4)
    v_mfma_f32_32x32x16_bf16 v[92:107], v[124:127], v[28:31], v[156:171]
    ds_read_b128 v[148:151], v4 offset:14336
    v_exp_f32 v68, v68
    v_exp_f32 v69, v69
    v_mfma_f32_32x32x16_bf16 v[92:107], v[128:131], v[32:35], v[92:107]
    ds_read_b128 v[152:155], v4 offset:15360
    v_exp_f32 v70, v70
    v_exp_f32 v71, v71
    v_exp_f32 v72, v72
    s_waitcnt lgkmcnt(4)
    v_mfma_f32_32x32x16_bf16 v[92:107], v[132:135], v[36:39], v[92:107]
    ds_read_b128 v[124:127], v6 offset:8192
    v_exp_f32 v73, v73
    v_exp_f32 v74, v74
    v_mfma_f32_32x32x16_bf16 v[92:107], v[136:139], v[40:43], v[92:107]
    ds_read_b128 v[128:131], v6 offset:9216
    v_exp_f32 v75, v75
    v_cvt_pk_bf16_f32 v120, v68, v69
    v_cvt_pk_bf16_f32 v121, v70, v71
    s_waitcnt lgkmcnt(4)
    v_mfma_f32_32x32x16_bf16 v[92:107], v[140:143], v[44:47], v[92:107]
    ds_read_b128 v[132:135], v6 offset:10240
    s_add_u32 m0, s29, s32
    s_add_u32 s29, s29, 16384
    buffer_load_dwordx4 v11, s[16:19], s35 offen lds
    v_cvt_pk_bf16_f32 v122, v72, v73
    v_cvt_pk_bf16_f32 v123, v74, v75
    v_mfma_f32_32x32x16_bf16 v[92:107], v[144:147], v[48:51], v[92:107]
    ds_read_b128 v[136:139], v6 offset:11264
    v_max3_f32 v20, v76, v77, v78
    v_max3_f32 v20, v20, v79, v80
    v_max3_f32 v20, v20, v81, v82
    s_waitcnt lgkmcnt(4)
    v_mfma_f32_32x32x16_bf16 v[92:107], v[148:151], v[52:55], v[92:107]
    ds_read_b128 v[140:143], v6 offset:12288
    v_max3_f32 v20, v20, v83, v84
    v_max3_f32 v20, v20, v85, v86
    v_mfma_f32_32x32x16_bf16 v[92:107], v[152:155], v[56:59], v[92:107]
    ds_read_b128 v[144:147], v6 offset:13312
    v_max3_f32 v20, v20, v87, v88
    v_max3_f32 v20, v20, v89, v90
    v_max_f32 v20, v20, v91
    s_waitcnt lgkmcnt(4)
    v_mfma_f32_32x32x16_bf16 v[188:203], v[124:127], v[116:119], v[188:203]
    ds_read_b128 v[148:151], v6 offset:14336
    v_pk_add_f32 v[172:173], v[172:173], v[60:61]
    v_pk_add_f32 v[174:175], v[174:175], v[62:63]
    v_pk_add_f32 v[172:173], v[172:173], v[64:65]
    v_mfma_f32_32x32x16_bf16 v[204:219], v[128:131], v[116:119], v[204:219]
    ds_read_b128 v[152:155], v6 offset:15360
    v_pk_add_f32 v[174:175], v[174:175], v[66:67]
    v_pk_add_f32 v[172:173], v[172:173], v[68:69]
    v_pk_add_f32 v[174:175], v[174:175], v[70:71]
    s_waitcnt lgkmcnt(4)
    v_mfma_f32_32x32x16_bf16 v[220:235], v[132:135], v[116:119], v[220:235]
    ds_read_b128 v[124:127], v5 offset:0
    v_pk_add_f32 v[172:173], v[172:173], v[72:73]
    v_pk_add_f32 v[174:175], v[174:175], v[74:75]
    v_mfma_f32_32x32x16_bf16 v[236:251], v[136:139], v[116:119], v[236:251]
    ds_read_b128 v[128:131], v5 offset:1024
    buffer_load_dwordx4 v11, s[16:19], s35 offen offset:1024 lds
    s_cmp_eq_u32 s29, 114688
    s_cselect_b32 s29, 65536, s29
    s_add_u32 s35, s35, 16384
    v_max3_f32 v12, v20, v92, v93
    s_waitcnt lgkmcnt(4)
    v_mfma_f32_32x32x16_bf16 v[188:203], v[140:143], v[120:123], v[188:203]
    ds_read_b128 v[132:135], v5 offset:2048
    v_max3_f32 v12, v12, v94, v95
    v_max3_f32 v12, v12, v96, v97
    v_mfma_f32_32x32x16_bf16 v[204:219], v[144:147], v[120:123], v[204:219]
    ds_read_b128 v[136:139], v5 offset:3072
    v_max3_f32 v12, v12, v98, v99
    v_max3_f32 v12, v12, v100, v101
    s_waitcnt lgkmcnt(4)
    v_mfma_f32_32x32x16_bf16 v[220:235], v[148:151], v[120:123], v[220:235]
    ds_read_b128 v[140:143], v5 offset:4096
    v_max3_f32 v12, v12, v102, v103
    v_max3_f32 v12, v12, v104, v105
    v_mfma_f32_32x32x16_bf16 v[236:251], v[152:155], v[120:123], v[236:251]
    ds_read_b128 v[144:147], v5 offset:5120
    v_max3_f32 v12, v12, v106, v107
    v_cmp_gt_f32 vcc, v12, v21
    s_nop 4
    s_cbranch_vccz K2_NRB10
    s_nop 15
    v_mov_b32 v13, v12
    s_nop 1
    v_permlane32_swap_b32 v12, v13
    s_nop 1
    v_max_f32 v12, v12, v13
    v_max_f32 v12, 0, v12
    v_sub_f32 v13, 0, v12
    v_exp_f32 v13, v13
    v_sub_f32 v76, v76, v12
    v_sub_f32 v92, v92, v12
    v_sub_f32 v156, v156, v12
    v_sub_f32 v77, v77, v12
    v_sub_f32 v93, v93, v12
    v_sub_f32 v157, v157, v12
    v_sub_f32 v78, v78, v12
    v_sub_f32 v94, v94, v12
    v_sub_f32 v158, v158, v12
    v_sub_f32 v79, v79, v12
    v_sub_f32 v95, v95, v12
    v_sub_f32 v159, v159, v12
    v_sub_f32 v80, v80, v12
    v_sub_f32 v96, v96, v12
    v_sub_f32 v160, v160, v12
    v_sub_f32 v81, v81, v12
    v_sub_f32 v97, v97, v12
    v_sub_f32 v161, v161, v12
    v_sub_f32 v82, v82, v12
    v_sub_f32 v98, v98, v12
    v_sub_f32 v162, v162, v12
    v_sub_f32 v83, v83, v12
    v_sub_f32 v99, v99, v12
    v_sub_f32 v163, v163, v12
    v_sub_f32 v84, v84, v12
    v_sub_f32 v100, v100, v12
    v_sub_f32 v164, v164, v12
    v_sub_f32 v85, v85, v12
    v_sub_f32 v101, v101, v12
    v_sub_f32 v165, v165, v12
    v_sub_f32 v86, v86, v12
    v_sub_f32 v102, v102, v12
    v_sub_f32 v166, v166, v12
    v_sub_f32 v87, v87, v12
    v_sub_f32 v103, v103, v12
    v_sub_f32 v167, v167, v12
    v_sub_f32 v88, v88, v12
    v_sub_f32 v104, v104, v12
    v_sub_f32 v168, v168, v12
    v_sub_f32 v89, v89, v12
    v_sub_f32 v105, v105, v12
    v_sub_f32 v169, v169, v12
    v_sub_f32 v90, v90, v12
    v_sub_f32 v106, v106, v12
    v_sub_f32 v170, v170, v12
    v_sub_f32 v91, v91, v12
    v_sub_f32 v107, v107, v12
    v_sub_f32 v171, v171, v12
    v_mul_f32 v172, v172, v13
    v_mul_f32 v173, v173, v13
    v_mul_f32 v174, v174, v13
    v_mul_f32 v175, v175, v13
    v_mul_f32 v188, v188, v13
    v_mul_f32 v189, v189, v13
    v_mul_f32 v190, v190, v13
    v_mul_f32 v191, v191, v13
    v_mul_f32 v192, v192, v13
    v_mul_f32 v193, v193, v13
    v_mul_f32 v194, v194, v13
    v_mul_f32 v195, v195, v13
    v_mul_f32 v196, v196, v13
    v_mul_f32 v197, v197, v13
    v_mul_f32 v198, v198, v13
    v_mul_f32 v199, v199, v13
    v_mul_f32 v200, v200, v13
    v_mul_f32 v201, v201, v13
    v_mul_f32 v202, v202, v13
    v_mul_f32 v203, v203, v13
    v_mul_f32 v204, v204, v13
    v_mul_f32 v205, v205, v13
    v_mul_f32 v206, v206, v13
    v_mul_f32 v207, v207, v13
    v_mul_f32 v208, v208, v13
    v_mul_f32 v209, v209, v13
    v_mul_f32 v210, v210, v13
    v_mul_f32 v211, v211, v13
    v_mul_f32 v212, v212, v13
    v_mul_f32 v213, v213, v13
    v_mul_f32 v214, v214, v13
    v_mul_f32 v215, v215, v13
    v_mul_f32 v216, v216, v13
    v_mul_f32 v217, v217, v13
    v_mul_f32 v218, v218, v13
    v_mul_f32 v219, v219, v13
    v_mul_f32 v220, v220, v13
    v_mul_f32 v221, v221, v13
    v_mul_f32 v222, v222, v13
    v_mul_f32 v223, v223, v13
    v_mul_f32 v224, v224, v13
    v_mul_f32 v225, v225, v13
    v_mul_f32 v226, v226, v13
    v_mul_f32 v227, v227, v13
    v_mul_f32 v228, v228, v13
    v_mul_f32 v229, v229, v13
    v_mul_f32 v230, v230, v13
    v_mul_f32 v231, v231, v13
    v_mul_f32 v232, v232, v13
    v_mul_f32 v233, v233, v13
    v_mul_f32 v234, v234, v13
    v_mul_f32 v235, v235, v13
    v_mul_f32 v236, v236, v13
    v_mul_f32 v237, v237, v13
    v_mul_f32 v238, v238, v13
    v_mul_f32 v239, v239, v13
    v_mul_f32 v240, v240, v13
    v_mul_f32 v241, v241, v13
    v_mul_f32 v242, v242, v13
    v_mul_f32 v243, v243, v13
    v_mul_f32 v244, v244, v13
    v_mul_f32 v245, v245, v13
    v_mul_f32 v246, v246, v13
    v_mul_f32 v247, v247, v13
    v_mul_f32 v248, v248, v13
    v_mul_f32 v249, v249, v13
    v_mul_f32 v250, v250, v13
    v_mul_f32 v251, v251, v13
    s_nop 1
K2_NRB10:
    s_add_u32 s26, s26, 16384
    s_and_b32 s26, s26, 0xffff
    s_add_u32 s27, s27, 16384
    s_cmp_eq_u32 s27, 114688
    s_cselect_b32 s27, 65536, s27
    s_add_u32 s25, s25, 1
    s_branch K2_IT2
K2_MSK1:
    s_waitcnt lgkmcnt(4)
    v_mfma_f32_32x32x16_bf16 v[76:91], v[124:127], v[28:31], v[156:171]
    ds_read_b128 v[148:151], v4 offset:6144
    v_exp_f32 v92, v92
    v_exp_f32 v93, v93
    v_exp_f32 v94, v94
    v_mfma_f32_32x32x16_bf16 v[76:91], v[128:131], v[32:35], v[76:91]
    ds_read_b128 v[152:155], v4 offset:7168
    v_exp_f32 v95, v95
    v_exp_f32 v96, v96
    v_exp_f32 v97, v97
    s_waitcnt lgkmcnt(4)
    v_mfma_f32_32x32x16_bf16 v[76:91], v[132:135], v[36:39], v[76:91]
    ds_read_b128 v[124:127], v6 offset:0
    v_exp_f32 v98, v98
    v_exp_f32 v99, v99
    v_cvt_pk_bf16_f32 v108, v92, v93
    v_mfma_f32_32x32x16_bf16 v[76:91], v[136:139], v[40:43], v[76:91]
    ds_read_b128 v[128:131], v6 offset:1024
    v_cvt_pk_bf16_f32 v109, v94, v95
    v_cvt_pk_bf16_f32 v110, v96, v97
    v_cvt_pk_bf16_f32 v111, v98, v99
    s_waitcnt lgkmcnt(4)
    v_mfma_f32_32x32x16_bf16 v[76:91], v[140:143], v[44:47], v[76:91]
    ds_read_b128 v[132:135], v6 offset:2048
    v_exp_f32 v100, v100
    v_exp_f32 v101, v101
    v_exp_f32 v102, v102
    v_mfma_f32_32x32x16_bf16 v[76:91], v[144:147], v[48:51], v[76:91]
    ds_read_b128 v[136:139], v6 offset:3072
    v_exp_f32 v103, v103
    v_exp_f32 v104, v104
    v_exp_f32 v105, v105
    s_waitcnt lgkmcnt(4)
    v_mfma_f32_32x32x16_bf16 v[76:91], v[148:151], v[52:55], v[76:91]
    ds_read_b128 v[140:143], v6 offset:4096
    s_add_u32 m0, s28, s32
    s_add_u32 s28, s28, 16384
    buffer_load_dwordx4 v11, s[16:19], s34 offen lds
    v_exp_f32 v106, v106
    v_exp_f32 v107, v107
    v_cvt_pk_bf16_f32 v112, v100, v101
    v_mfma_f32_32x32x16_bf16 v[76:91], v[152:155], v[56:59], v[76:91]
    ds_read_b128 v[144:147], v6 offset:5120
    v_cvt_pk_bf16_f32 v113, v102, v103
    v_cvt_pk_bf16_f32 v114, v104, v105
    v_cvt_pk_bf16_f32 v115, v106, v107
    s_waitcnt lgkmcnt(4)
    v_mfma_f32_32x32x16_bf16 v[188:203], v[124:127], v[108:111], v[188:203]
    ds_read_b128 v[148:151], v6 offset:6144
    v_exp_f32 v60, v60
    v_exp_f32 v61, v61
    v_mfma_f32_32x32x16_bf16 v[204:219], v[128:131], v[108:111], v[204:219]
    ds_read_b128 v[152:155], v6 offset:7168
    v_exp_f32 v62, v62
    v_exp_f32 v63, v63
    v_exp_f32 v64, v64
    s_waitcnt lgkmcnt(4)
    v_mfma_f32_32x32x16_bf16 v[220:235], v[132:135], v[108:111], v[220:235]
    ds_read_b128 v[124:127], v4 offset:8192
    v_exp_f32 v65, v65
    v_exp_f32 v66, v66
    v_mfma_f32_32x32x16_bf16 v[236:251], v[136:139], v[108:111], v[236:251]
    ds_read_b128 v[128:131], v4 offset:9216
    v_exp_f32 v67, v67
    v_cvt_pk_bf16_f32 v116, v60, v61
    v_cvt_pk_bf16_f32 v117, v62, v63
    s_waitcnt lgkmcnt(4)
    v_mfma_f32_32x32x16_bf16 v[188:203], v[140:143], v[112:115], v[188:203]
    ds_read_b128 v[132:135], v4 offset:10240
    v_cvt_pk_bf16_f32 v118, v64, v65
    v_cvt_pk_bf16_f32 v119, v66, v67
    v_mfma_f32_32x32x16_bf16 v[204:219], v[144:147], v[112:115], v[204:219]
    ds_read_b128 v[136:139], v4 offset:11264
    buffer_load_dwordx4 v11, s[16:19], s34 offen offset:1024 lds
    s_and_b32 s28, s28, 0xffff
    s_add_u32 s34, s34, 16384
    v_pk_add_f32 v[172:173], v[172:173], v[92:93]
    v_pk_add_f32 v[174:175], v[174:175], v[94:95]
    v_pk_add_f32 v[172:173], v[172:173], v[96:97]
    s_waitcnt lgkmcnt(4)
    v_mfma_f32_32x32x16_bf16 v[220:235], v[148:151], v[112:115], v[220:235]
    ds_read_b128 v[140:143], v4 offset:12288
    v_pk_add_f32 v[174:175], v[174:175], v[98:99]
    v_pk_add_f32 v[172:173], v[172:173], v[100:101]
    v_mfma_f32_32x32x16_bf16 v[236:251], v[152:155], v[112:115], v[236:251]
    ds_read_b128 v[144:147], v4 offset:13312
    v_pk_add_f32 v[174:175], v[174:175], v[102:103]
    v_pk_add_f32 v[172:173], v[172:173], v[104:105]
    v_pk_add_f32 v[174:175], v[174:175], v[106:107]
    s_waitcnt lgkmcnt(4)
    v_mfma_f32_32x32x16_bf16 v[92:107], v[124:127], v[28:31], v[156:171]
    ds_read_b128 v[148:151], v4 offset:14336
    v_exp_f32 v68, v68
    v_mfma_f32_32x32x16_bf16 v[92:107], v[128:131], v[32:35], v[92:107]
    ds_read_b128 v[152:155], v4 offset:15360
    v_exp_f32 v69, v69
    v_exp_f32 v70, v70
    s_waitcnt lgkmcnt(4)
    v_mfma_f32_32x32x16_bf16 v[92:107], v[132:135], v[36:39], v[92:107]
    ds_read_b128 v[124:127], v6 offset:8192
    v_exp_f32 v71, v71
    v_mfma_f32_32x32x16_bf16 v[92:107], v[136:139], v[40:43], v[92:107]
    ds_read_b128 v[128:131], v6 offset:9216
    v_exp_f32 v72, v72
    v_exp_f32 v73, v73
    s_waitcnt lgkmcnt(4)
    v_mfma_f32_32x32x16_bf16 v[92:107], v[140:143], v[44:47], v[92:107]
    ds_read_b128 v[132:135], v6 offset:10240
    s_add_u32 m0, s29, s32
    s_add_u32 s29, s29, 16384
    buffer_load_dwordx4 v11, s[16:19], s35 offen lds
    v_exp_f32 v74, v74
    v_mfma_f32_32x32x16_bf16 v[92:107], v[144:147], v[48:51], v[92:107]
    ds_read_b128 v[136:139], v6 offset:11264
    v_exp_f32 v75, v75
    v_cvt_pk_bf16_f32 v120, v68, v69
    s_waitcnt lgkmcnt(4)
    v_mfma_f32_32x32x16_bf16 v[92:107], v[148:151], v[52:55], v[92:107]
    ds_read_b128 v[140:143], v6 offset:12288
    v_cvt_pk_bf16_f32 v121, v70, v71
    v_mfma_f32_32x32x16_bf16 v[92:107], v[152:155], v[56:59], v[92:107]
    ds_read_b128 v[144:147], v6 offset:13312
    v_cvt_pk_bf16_f32 v122, v72, v73
    v_cvt_pk_bf16_f32 v123, v74, v75
    s_waitcnt lgkmcnt(4)
    v_mfma_f32_32x32x16_bf16 v[188:203], v[124:127], v[116:119], v[188:203]
    ds_read_b128 v[148:151], v6 offset:14336
    v_pk_add_f32 v[172:173], v[172:173], v[60:61]
    v_pk_add_f32 v[174:175], v[174:175], v[62:63]
    v_pk_add_f32 v[172:173], v[172:173], v[64:65]
    v_mfma_f32_32x32x16_bf16 v[204:219], v[128:131], v[116:119], v[204:219]
    ds_read_b128 v[152:155], v6 offset:15360
    v_pk_add_f32 v[174:175], v[174:175], v[66:67]
    v_pk_add_f32 v[172:173], v[172:173], v[68:69]
    v_pk_add_f32 v[174:175], v[174:175], v[70:71]
    s_waitcnt lgkmcnt(4)
    v_mfma_f32_32x32x16_bf16 v[220:235], v[132:135], v[116:119], v[220:235]
    ds_read_b128 v[124:127], v5 offset:0
    v_pk_add_f32 v[172:173], v[172:173], v[72:73]
    v_pk_add_f32 v[174:175], v[174:175], v[74:75]
    v_mfma_f32_32x32x16_bf16 v[236:251], v[136:139], v[116:119], v[236:251]
    ds_read_b128 v[128:131], v5 offset:1024
    buffer_load_dwordx4 v11, s[16:19], s35 offen offset:1024 lds
    s_cmp_eq_u32 s29, 114688
    s_cselect_b32 s29, 65536, s29
    s_add_u32 s35, s35, 16384
    s_waitcnt lgkmcnt(4)
    v_mfma_f32_32x32x16_bf16 v[188:203], v[140:143], v[120:123], v[188:203]
    ds_read_b128 v[132:135], v5 offset:2048
    v_mfma_f32_32x32x16_bf16 v[204:219], v[144:147], v[120:123], v[204:219]
    ds_read_b128 v[136:139], v5 offset:3072
    s_waitcnt lgkmcnt(4)
    v_mfma_f32_32x32x16_bf16 v[220:235], v[148:151], v[120:123], v[220:235]
    ds_read_b128 v[140:143], v5 offset:4096
    v_mfma_f32_32x32x16_bf16 v[236:251], v[152:155], v[120:123], v[236:251]
    ds_read_b128 v[144:147], v5 offset:5120
    s_nop 7
    s_add_u32 s33, s25, 1
    s_lshl_b32 s33, s33, 6
    v_subrev_u32 v12, s33, v7
    v_cmp_gt_i32 s[60:61], 0, v12
    v_cmp_gt_i32 s[62:63], 1, v12
    v_cmp_gt_i32 s[64:65], 2, v12
    v_cmp_gt_i32 s[66:67], 3, v12
    s_nop 1
    v_cndmask_b32 v76, v76, v10, s[60:61]
    v_cndmask_b32 v77, v77, v10, s[62:63]
    v_cndmask_b32 v78, v78, v10, s[64:65]
    v_cndmask_b32 v79, v79, v10, s[66:67]
    v_cmp_gt_i32 s[60:61], 8, v12
    v_cmp_gt_i32 s[62:63], 9, v12
    v_cmp_gt_i32 s[64:65], 10, v12
    v_cmp_gt_i32 s[66:67], 11, v12
    s_nop 1
    v_cndmask_b32 v80, v80, v10, s[60:61]
    v_cndmask_b32 v81, v81, v10, s[62:63]
    v_cndmask_b32 v82, v82, v10, s[64:65]
    v_cndmask_b32 v83, v83, v10, s[66:67]
    v_cmp_gt_i32 s[60:61], 16, v12
    v_cmp_gt_i32 s[62:63], 17, v12
    v_cmp_gt_i32 s[64:65], 18, v12
    v_cmp_gt_i32 s[66:67], 19, v12
    s_nop 1
    v_cndmask_b32 v84, v84, v10, s[60:61]
    v_cndmask_b32 v85, v85, v10, s[62:63]
    v_cndmask_b32 v86, v86, v10, s[64:65]
    v_cndmask_b32 v87, v87, v10, s[66:67]
    v_cmp_gt_i32 s[60:61], 24, v12
    v_cmp_gt_i32 s[62:63], 25, v12
    v_cmp_gt_i32 s[64:65], 26, v12
    v_cmp_gt_i32 s[66:67], 27, v12
    s_nop 1
    v_cndmask_b32 v88, v88, v10, s[60:61]
    v_cndmask_b32 v89, v89, v10, s[62:63]
    v_cndmask_b32 v90, v90, v10, s[64:65]
    v_cndmask_b32 v91, v91, v10, s[66:67]
    v_cmp_gt_i32 s[60:61], 32, v12
    v_cmp_gt_i32 s[62:63], 33, v12
    v_cmp_gt_i32 s[64:65], 34, v12
    v_cmp_gt_i32 s[66:67], 35, v12
    s_nop 1
    v_cndmask_b32 v92, v92, v10, s[60:61]
    v_cndmask_b32 v93, v93, v10, s[62:63]
    v_cndmask_b32 v94, v94, v10, s[64:65]
    v_cndmask_b32 v95, v95, v10, s[66:67]
    v_cmp_gt_i32 s[60:61], 40, v12
    v_cmp_gt_i32 s[62:63], 41, v12
    v_cmp_gt_i32 s[64:65], 42, v12
    v_cmp_gt_i32 s[66:67], 43, v12
    s_nop 1
    v_cndmask_b32 v96, v96, v10, s[60:61]
    v_cndmask_b32 v97, v97, v10, s[62:63]
    v_cndmask_b32 v98, v98, v10, s[64:65]
    v_cndmask_b32 v99, v99, v10, s[66:67]
    v_cmp_gt_i32 s[60:61], 48, v12
    v_cmp_gt_i32 s[62:63], 49, v12
    v_cmp_gt_i32 s[64:65], 50, v12
    v_cmp_gt_i32 s[66:67], 51, v12
    s_nop 1
    v_cndmask_b32 v100, v100, v10, s[60:61]
    v_cndmask_b32 v101, v101, v10, s[62:63]
    v_cndmask_b32 v102, v102, v10, s[64:65]
    v_cndmask_b32 v103, v103, v10, s[66:67]
    v_cmp_gt_i32 s[60:61], 56, v12
    v_cmp_gt_i32 s[62:63], 57, v12
    v_cmp_gt_i32 s[64:65], 58, v12
    v_cmp_gt_i32 s[66:67], 59, v12
    s_nop 1
    v_cndmask_b32 v104, v104, v10, s[60:61]
    v_cndmask_b32 v105, v105, v10, s[62:63]
    v_cndmask_b32 v106, v106, v10, s[64:65]
    v_cndmask_b32 v107, v107, v10, s[66:67]
    v_max3_f32 v20, v76, v77, v78
    v_max3_f32 v20, v20, v79, v80
    v_max3_f32 v20, v20, v81, v82
    v_max3_f32 v20, v20, v83, v84
    v_max3_f32 v20, v20, v85, v86
    v_max3_f32 v20, v20, v87, v88
    v_max3_f32 v20, v20, v89, v90
    v_max_f32 v20, v20, v91
    v_max3_f32 v12, v20, v92, v93
    v_max3_f32 v12, v12, v94, v95
    v_max3_f32 v12, v12, v96, v97
    v_max3_f32 v12, v12, v98, v99
    v_max3_f32 v12, v12, v100, v101
    v_max3_f32 v12, v12, v102, v103
    v_max3_f32 v12, v12, v104, v105
    v_max3_f32 v12, v12, v106, v107
    v_cmp_gt_f32 vcc, v12, v21
    s_nop 4
    s_cbranch_vccz K2_NRB11
    s_nop 15
    v_mov_b32 v13, v12
    s_nop 1
    v_permlane32_swap_b32 v12, v13
    s_nop 1
    v_max_f32 v12, v12, v13
    v_max_f32 v12, 0, v12
    v_sub_f32 v13, 0, v12
    v_exp_f32 v13, v13
    v_sub_f32 v76, v76, v12
    v_sub_f32 v92, v92, v12
    v_sub_f32 v156, v156, v12
    v_sub_f32 v77, v77, v12
    v_sub_f32 v93, v93, v12
    v_sub_f32 v157, v157, v12
    v_sub_f32 v78, v78, v12
    v_sub_f32 v94, v94, v12
    v_sub_f32 v158, v158, v12
    v_sub_f32 v79, v79, v12
    v_sub_f32 v95, v95, v12
    v_sub_f32 v159, v159, v12
    v_sub_f32 v80, v80, v12
    v_sub_f32 v96, v96, v12
    v_sub_f32 v160, v160, v12
    v_sub_f32 v81, v81, v12
    v_sub_f32 v97, v97, v12
    v_sub_f32 v161, v161, v12
    v_sub_f32 v82, v82, v12
    v_sub_f32 v98, v98, v12
    v_sub_f32 v162, v162, v12
    v_sub_f32 v83, v83, v12
    v_sub_f32 v99, v99, v12
    v_sub_f32 v163, v163, v12
    v_sub_f32 v84, v84, v12
    v_sub_f32 v100, v100, v12
    v_sub_f32 v164, v164, v12
    v_sub_f32 v85, v85, v12
    v_sub_f32 v101, v101, v12
    v_sub_f32 v165, v165, v12
    v_sub_f32 v86, v86, v12
    v_sub_f32 v102, v102, v12
    v_sub_f32 v166, v166, v12
    v_sub_f32 v87, v87, v12
    v_sub_f32 v103, v103, v12
    v_sub_f32 v167, v167, v12
    v_sub_f32 v88, v88, v12
    v_sub_f32 v104, v104, v12
    v_sub_f32 v168, v168, v12
    v_sub_f32 v89, v89, v12
    v_sub_f32 v105, v105, v12
    v_sub_f32 v169, v169, v12
    v_sub_f32 v90, v90, v12
    v_sub_f32 v106, v106, v12
    v_sub_f32 v170, v170, v12
    v_sub_f32 v91, v91, v12
    v_sub_f32 v107, v107, v12
    v_sub_f32 v171, v171, v12
    v_mul_f32 v172, v172, v13
    v_mul_f32 v173, v173, v13
    v_mul_f32 v174, v174, v13
    v_mul_f32 v175, v175, v13
    v_mul_f32 v188, v188, v13
    v_mul_f32 v189, v189, v13
    v_mul_f32 v190, v190, v13
    v_mul_f32 v191, v191, v13
    v_mul_f32 v192, v192, v13
    v_mul_f32 v193, v193, v13
    v_mul_f32 v194, v194, v13
    v_mul_f32 v195, v195, v13
    v_mul_f32 v196, v196, v13
    v_mul_f32 v197, v197, v13
    v_mul_f32 v198, v198, v13
    v_mul_f32 v199, v199, v13
    v_mul_f32 v200, v200, v13
    v_mul_f32 v201, v201, v13
    v_mul_f32 v202, v202, v13
    v_mul_f32 v203, v203, v13
    v_mul_f32 v204, v204, v13
    v_mul_f32 v205, v205, v13
    v_mul_f32 v206, v206, v13
    v_mul_f32 v207, v207, v13
    v_mul_f32 v208, v208, v13
    v_mul_f32 v209, v209, v13
    v_mul_f32 v210, v210, v13
    v_mul_f32 v211, v211, v13
    v_mul_f32 v212, v212, v13
    v_mul_f32 v213, v213, v13
    v_mul_f32 v214, v214, v13
    v_mul_f32 v215, v215, v13
    v_mul_f32 v216, v216, v13
    v_mul_f32 v217, v217, v13
    v_mul_f32 v218, v218, v13
    v_mul_f32 v219, v219, v13
    v_mul_f32 v220, v220, v13
    v_mul_f32 v221, v221, v13
    v_mul_f32 v222, v222, v13
    v_mul_f32 v223, v223, v13
    v_mul_f32 v224, v224, v13
    v_mul_f32 v225, v225, v13
    v_mul_f32 v226, v226, v13
    v_mul_f32 v227, v227, v13
    v_mul_f32 v228, v228, v13
    v_mul_f32 v229, v229, v13
    v_mul_f32 v230, v230, v13
    v_mul_f32 v231, v231, v13
    v_mul_f32 v232, v232, v13
    v_mul_f32 v233, v233, v13
    v_mul_f32 v234, v234, v13
    v_mul_f32 v235, v235, v13
    v_mul_f32 v236, v236, v13
    v_mul_f32 v237, v237, v13
    v_mul_f32 v238, v238, v13
    v_mul_f32 v239, v239, v13
    v_mul_f32 v240, v240, v13
    v_mul_f32 v241, v241, v13
    v_mul_f32 v242, v242, v13
    v_mul_f32 v243, v243, v13
    v_mul_f32 v244, v244, v13
    v_mul_f32 v245, v245, v13
    v_mul_f32 v246, v246, v13
    v_mul_f32 v247, v247, v13
    v_mul_f32 v248, v248, v13
    v_mul_f32 v249, v249, v13
    v_mul_f32 v250, v250, v13
    v_mul_f32 v251, v251, v13
    s_nop 1
K2_NRB11:
    s_add_u32 s26, s26, 16384
    s_and_b32 s26, s26, 0xffff
    s_add_u32 s27, s27, 16384
    s_cmp_eq_u32 s27, 114688
    s_cselect_b32 s27, 65536, s27
    s_add_u32 s25, s25, 1
    s_branch K2_IT2
K2_FIN1:
    s_add_u32 m0, s28, s32
    s_add_u32 s28, s28, 16384
    buffer_load_dwordx4 v11, s[16:19], s34 offen lds
    buffer_load_dwordx4 v11, s[16:19], s34 offen offset:1024 lds
    s_and_b32 s28, s28, 0xffff
    s_add_u32 s34, s34, 16384
    s_add_u32 m0, s29, s32
    s_add_u32 s29, s29, 16384
    buffer_load_dwordx4 v11, s[16:19], s35 offen lds
    buffer_load_dwordx4 v11, s[16:19], s35 offen offset:1024 lds
    s_cmp_eq_u32 s29, 114688
    s_cselect_b32 s29, 65536, s29
    s_add_u32 s35, s35, 16384
    s_waitcnt lgkmcnt(0)
    v_exp_f32 v92, v92
    v_exp_f32 v93, v93
    v_exp_f32 v94, v94
    v_exp_f32 v95, v95
    v_exp_f32 v96, v96
    v_exp_f32 v97, v97
    v_exp_f32 v98, v98
    v_exp_f32 v99, v99
    v_cvt_pk_bf16_f32 v108, v92, v93
    v_pk_add_f32 v[172:173], v[172:173], v[92:93]
    v_cvt_pk_bf16_f32 v109, v94, v95
    v_pk_add_f32 v[174:175], v[174:175], v[94:95]
    v_cvt_pk_bf16_f32 v110, v96, v97
    v_pk_add_f32 v[172:173], v[172:173], v[96:97]
    v_cvt_pk_bf16_f32 v111, v98, v99
    v_pk_add_f32 v[174:175], v[174:175], v[98:99]
    v_exp_f32 v100, v100
    v_exp_f32 v101, v101
    v_exp_f32 v102, v102
    v_exp_f32 v103, v103
    v_exp_f32 v104, v104
    v_exp_f32 v105, v105
    v_exp_f32 v106, v106
    v_exp_f32 v107, v107
    v_cvt_pk_bf16_f32 v112, v100, v101
    v_pk_add_f32 v[172:173], v[172:173], v[100:101]
    v_cvt_pk_bf16_f32 v113, v102, v103
    v_pk_add_f32 v[174:175], v[174:175], v[102:103]
    v_cvt_pk_bf16_f32 v114, v104, v105
    v_pk_add_f32 v[172:173], v[172:173], v[104:105]
    v_cvt_pk_bf16_f32 v115, v106, v107
    v_pk_add_f32 v[174:175], v[174:175], v[106:107]
    v_exp_f32 v60, v60
    v_exp_f32 v61, v61
    v_exp_f32 v62, v62
    v_exp_f32 v63, v63
    v_exp_f32 v64, v64
    v_exp_f32 v65, v65
    v_exp_f32 v66, v66
    v_exp_f32 v67, v67
    v_cvt_pk_bf16_f32 v116, v60, v61
    v_pk_add_f32 v[172:173], v[172:173], v[60:61]
    v_cvt_pk_bf16_f32 v117, v62, v63
    v_pk_add_f32 v[174:175], v[174:175], v[62:63]
    v_cvt_pk_bf16_f32 v118, v64, v65
    v_pk_add_f32 v[172:173], v[172:173], v[64:65]
    v_cvt_pk_bf16_f32 v119, v66, v67
    v_pk_add_f32 v[174:175], v[174:175], v[66:67]
    v_exp_f32 v68, v68
    v_exp_f32 v69, v69
    v_exp_f32 v70, v70
    v_exp_f32 v71, v71
    v_exp_f32 v72, v72
    v_exp_f32 v73, v73
    v_exp_f32 v74, v74
    v_exp_f32 v75, v75
    v_cvt_pk_bf16_f32 v120, v68, v69
    v_pk_add_f32 v[172:173], v[172:173], v[68:69]
    v_cvt_pk_bf16_f32 v121, v70, v71
    v_pk_add_f32 v[174:175], v[174:175], v[70:71]
    v_cvt_pk_bf16_f32 v122, v72, v73
    v_pk_add_f32 v[172:173], v[172:173], v[72:73]
    v_cvt_pk_bf16_f32 v123, v74, v75
    v_pk_add_f32 v[174:175], v[174:175], v[74:75]
    ds_read_b128 v[124:127], v6 offset:0
    ds_read_b128 v[128:131], v6 offset:1024
    ds_read_b128 v[132:135], v6 offset:2048
    ds_read_b128 v[136:139], v6 offset:3072
    ds_read_b128 v[140:143], v6 offset:4096
    ds_read_b128 v[144:147], v6 offset:5120
    ds_read_b128 v[148:151], v6 offset:6144
    ds_read_b128 v[152:155], v6 offset:7168
    s_waitcnt lgkmcnt(7)
    v_mfma_f32_32x32x16_bf16 v[188:203], v[124:127], v[108:111], v[188:203]
    s_waitcnt lgkmcnt(6)
    v_mfma_f32_32x32x16_bf16 v[204:219], v[128:131], v[108:111], v[204:219]
    s_waitcnt lgkmcnt(5)
    v_mfma_f32_32x32x16_bf16 v[220:235], v[132:135], v[108:111], v[220:235]
    s_waitcnt lgkmcnt(4)
    v_mfma_f32_32x32x16_bf16 v[236:251], v[136:139], v[108:111], v[236:251]
    s_waitcnt lgkmcnt(3)
    v_mfma_f32_32x32x16_bf16 v[188:203], v[140:143], v[112:115], v[188:203]
    s_waitcnt lgkmcnt(2)
    v_mfma_f32_32x32x16_bf16 v[204:219], v[144:147], v[112:115], v[204:219]
    s_waitcnt lgkmcnt(1)
    v_mfma_f32_32x32x16_bf16 v[220:235], v[148:151], v[112:115], v[220:235]
    s_waitcnt lgkmcnt(0)
    v_mfma_f32_32x32x16_bf16 v[236:251], v[152:155], v[112:115], v[236:251]
    ds_read_b128 v[124:127], v6 offset:8192
    ds_read_b128 v[128:131], v6 offset:9216
    ds_read_b128 v[132:135], v6 offset:10240
    ds_read_b128 v[136:139], v6 offset:11264
    ds_read_b128 v[140:143], v6 offset:12288
    ds_read_b128 v[144:147], v6 offset:13312
    ds_read_b128 v[148:151], v6 offset:14336
    ds_read_b128 v[152:155], v6 offset:15360
    s_waitcnt lgkmcnt(7)
    v_mfma_f32_32x32x16_bf16 v[188:203], v[124:127], v[116:119], v[188:203]
    s_waitcnt lgkmcnt(6)
    v_mfma_f32_32x32x16_bf16 v[204:219], v[128:131], v[116:119], v[204:219]
    s_waitcnt lgkmcnt(5)
    v_mfma_f32_32x32x16_bf16 v[220:235], v[132:135], v[116:119], v[220:235]
    s_waitcnt lgkmcnt(4)
    v_mfma_f32_32x32x16_bf16 v[236:251], v[136:139], v[116:119], v[236:251]
    s_waitcnt lgkmcnt(3)
    v_mfma_f32_32x32x16_bf16 v[188:203], v[140:143], v[120:123], v[188:203]
    s_waitcnt lgkmcnt(2)
    v_mfma_f32_32x32x16_bf16 v[204:219], v[144:147], v[120:123], v[204:219]
    s_waitcnt lgkmcnt(1)
    v_mfma_f32_32x32x16_bf16 v[220:235], v[148:151], v[120:123], v[220:235]
    s_waitcnt lgkmcnt(0)
    v_mfma_f32_32x32x16_bf16 v[236:251], v[152:155], v[120:123], v[236:251]
    v_add_f32 v172, v172, v173
    v_add_f32 v174, v174, v175
    v_add_f32 v172, v172, v174
    v_mov_b32 v173, v172
    s_nop 1
    v_permlane32_swap_b32 v172, v173
    s_nop 1
    v_add_f32 v172, v172, v173
    s_nop 15
    v_rcp_f32 v12, v172
    s_nop 0
    v_mul_f32 v188, v188, v12
    v_mul_f32 v189, v189, v12
    v_mul_f32 v190, v190, v12
    v_mul_f32 v191, v191, v12
    v_mul_f32 v192, v192, v12
    v_mul_f32 v193, v193, v12
    v_mul_f32 v194, v194, v12
    v_mul_f32 v195, v195, v12
    v_mul_f32 v196, v196, v12
    v_mul_f32 v197, v197, v12
    v_mul_f32 v198, v198, v12
    v_mul_f32 v199, v199, v12
    v_mul_f32 v200, v200, v12
    v_mul_f32 v201, v201, v12
    v_mul_f32 v202, v202, v12
    v_mul_f32 v203, v203, v12
    v_mul_f32 v204, v204, v12
    v_mul_f32 v205, v205, v12
    v_mul_f32 v206, v206, v12
    v_mul_f32 v207, v207, v12
    v_mul_f32 v208, v208, v12
    v_mul_f32 v209, v209, v12
    v_mul_f32 v210, v210, v12
    v_mul_f32 v211, v211, v12
    v_mul_f32 v212, v212, v12
    v_mul_f32 v213, v213, v12
    v_mul_f32 v214, v214, v12
    v_mul_f32 v215, v215, v12
    v_mul_f32 v216, v216, v12
    v_mul_f32 v217, v217, v12
    v_mul_f32 v218, v218, v12
    v_mul_f32 v219, v219, v12
    v_mul_f32 v220, v220, v12
    v_mul_f32 v221, v221, v12
    v_mul_f32 v222, v222, v12
    v_mul_f32 v223, v223, v12
    v_mul_f32 v224, v224, v12
    v_mul_f32 v225, v225, v12
    v_mul_f32 v226, v226, v12
    v_mul_f32 v227, v227, v12
    v_mul_f32 v228, v228, v12
    v_mul_f32 v229, v229, v12
    v_mul_f32 v230, v230, v12
    v_mul_f32 v231, v231, v12
    v_mul_f32 v232, v232, v12
    v_mul_f32 v233, v233, v12
    v_mul_f32 v234, v234, v12
    v_mul_f32 v235, v235, v12
    v_mul_f32 v236, v236, v12
    v_mul_f32 v237, v237, v12
    v_mul_f32 v238, v238, v12
    v_mul_f32 v239, v239, v12
    v_mul_f32 v240, v240, v12
    v_mul_f32 v241, v241, v12
    v_mul_f32 v242, v242, v12
    v_mul_f32 v243, v243, v12
    v_mul_f32 v244, v244, v12
    v_mul_f32 v245, v245, v12
    v_mul_f32 v246, v246, v12
    v_mul_f32 v247, v247, v12
    v_mul_f32 v248, v248, v12
    v_mul_f32 v249, v249, v12
    v_mul_f32 v250, v250, v12
    v_mul_f32 v251, v251, v12
    s_lshl_b32 s33, s31, 5
    s_add_u32 s33, s33, s21
    s_lshl_b32 s33, s33, 13
    s_add_u32 s36, s33, 50331648
    s_add_u32 s37, s36, 4096
    v_cvt_pk_bf16_f32 v60, v188, v189
    v_cvt_pk_bf16_f32 v61, v190, v191
    v_cvt_pk_bf16_f32 v62, v192, v193
    v_cvt_pk_bf16_f32 v63, v194, v195
    buffer_store_dwordx4 v[60:63], v2, s[16:19], s36 offen offset:0 sc1
    v_cvt_pk_bf16_f32 v64, v196, v197
    v_cvt_pk_bf16_f32 v65, v198, v199
    v_cvt_pk_bf16_f32 v66, v200, v201
    v_cvt_pk_bf16_f32 v67, v202, v203
    buffer_store_dwordx4 v[64:67], v2, s[16:19], s36 offen offset:1024 sc1
    v_cvt_pk_bf16_f32 v68, v204, v205
    v_cvt_pk_bf16_f32 v69, v206, v207
    v_cvt_pk_bf16_f32 v70, v208, v209
    v_cvt_pk_bf16_f32 v71, v210, v211
    buffer_store_dwordx4 v[68:71], v2, s[16:19], s36 offen offset:2048 sc1
    v_cvt_pk_bf16_f32 v72, v212, v213
    v_cvt_pk_bf16_f32 v73, v214, v215
    v_cvt_pk_bf16_f32 v74, v216, v217
    v_cvt_pk_bf16_f32 v75, v218, v219
    buffer_store_dwordx4 v[72:75], v2, s[16:19], s36 offen offset:3072 sc1
    v_cvt_pk_bf16_f32 v76, v220, v221
    v_cvt_pk_bf16_f32 v77, v222, v223
    v_cvt_pk_bf16_f32 v78, v224, v225
    v_cvt_pk_bf16_f32 v79, v226, v227
    buffer_store_dwordx4 v[76:79], v2, s[16:19], s37 offen offset:0 sc1
    v_cvt_pk_bf16_f32 v80, v228, v229
    v_cvt_pk_bf16_f32 v81, v230, v231
    v_cvt_pk_bf16_f32 v82, v232, v233
    v_cvt_pk_bf16_f32 v83, v234, v235
    buffer_store_dwordx4 v[80:83], v2, s[16:19], s37 offen offset:1024 sc1
    v_cvt_pk_bf16_f32 v84, v236, v237
    v_cvt_pk_bf16_f32 v85, v238, v239
    v_cvt_pk_bf16_f32 v86, v240, v241
    v_cvt_pk_bf16_f32 v87, v242, v243
    buffer_store_dwordx4 v[84:87], v2, s[16:19], s37 offen offset:2048 sc1
    v_cvt_pk_bf16_f32 v88, v244, v245
    v_cvt_pk_bf16_f32 v89, v246, v247
    v_cvt_pk_bf16_f32 v90, v248, v249
    v_cvt_pk_bf16_f32 v91, v250, v251
    buffer_store_dwordx4 v[88:91], v2, s[16:19], s37 offen offset:3072 sc1
    s_branch K2_POST
K2_IT2:
    s_waitcnt vmcnt(4)
    s_barrier
    v_add_u32 v4, s26, v2
    s_add_u32 s33, s26, 16384
    s_and_b32 s33, s33, 0xffff
    v_add_u32 v5, s33, v2
    v_add_u32 v6, s27, v2
    s_cmp_eq_u32 s25, s23
    s_cbranch_scc1 K2_FIN2
    s_add_u32 s33, s25, 1
    s_cmp_eq_u32 s33, s23
    s_cbranch_scc1 K2_MSK2
    s_waitcnt lgkmcnt(4)
    v_mfma_f32_32x32x16_bf16 v[60:75], v[124:127], v[28:31], v[156:171]
    ds_read_b128 v[148:151], v4 offset:6144
    v_exp_f32 v76, v76
    v_exp_f32 v77, v77
    v_exp_f32 v78, v78
    v_mfma_f32_32x32x16_bf16 v[60:75], v[128:131], v[32:35], v[60:75]
    ds_read_b128 v[152:155], v4 offset:7168
    v_exp_f32 v79, v79
    v_exp_f32 v80, v80
    v_exp_f32 v81, v81
    s_waitcnt lgkmcnt(4)
    v_mfma_f32_32x32x16_bf16 v[60:75], v[132:135], v[36:39], v[60:75]
    ds_read_b128 v[124:127], v6 offset:0
    v_exp_f32 v82, v82
    v_exp_f32 v83, v83
    v_cvt_pk_bf16_f32 v108, v76, v77
    v_mfma_f32_32x32x16_bf16 v[60:75], v[136:139], v[40:43], v[60:75]
    ds_read_b128 v[128:131], v6 offset:1024
    v_cvt_pk_bf16_f32 v109, v78, v79
    v_cvt_pk_bf16_f32 v110, v80, v81
    v_cvt_pk_bf16_f32 v111, v82, v83
    s_waitcnt lgkmcnt(4)
    v_mfma_f32_32x32x16_bf16 v[60:75], v[140:143], v[44:47], v[60:75]
    ds_read_b128 v[132:135], v6 offset:2048
    v_exp_f32 v84, v84
    v_exp_f32 v85, v85
    v_exp_f32 v86, v86
    v_mfma_f32_32x32x16_bf16 v[60:75], v[144:147], v[48:51], v[60:75]
    ds_read_b128 v[136:139], v6 offset:3072
    v_exp_f32 v87, v87
    v_exp_f32 v88, v88
    v_exp_f32 v89, v89
    s_waitcnt lgkmcnt(4)
    v_mfma_f32_32x32x16_bf16 v[60:75], v[148:151], v[52:55], v[60:75]
    ds_read_b128 v[140:143], v6 offset:4096
    s_add_u32 m0, s28, s32
    s_add_u32 s28, s28, 16384
    buffer_load_dwordx4 v11, s[16:19], s34 offen lds
    v_exp_f32 v90, v90
    v_exp_f32 v91, v91
    v_cvt_pk_bf16_f32 v112, v84, v85
    v_mfma_f32_32x32x16_bf16 v[60:75], v[152:155], v[56:59], v[60:75]
    ds_read_b128 v[144:147], v6 offset:5120
    v_cvt_pk_bf16_f32 v113, v86, v87
    v_cvt_pk_bf16_f32 v114, v88, v89
    v_cvt_pk_bf16_f32 v115, v90, v91
    s_waitcnt lgkmcnt(4)
    v_mfma_f32_32x32x16_bf16 v[188:203], v[124:127], v[108:111], v[188:203]
    ds_read_b128 v[148:151], v6 offset:6144
    v_exp_f32 v92, v92
    v_exp_f32 v93, v93
    v_mfma_f32_32x32x16_bf16 v[204:219], v[128:131], v[108:111], v[204:219]
    ds_read_b128 v[152:155], v6 offset:7168
    v_exp_f32 v94, v94
    v_exp_f32 v95, v95
    v_exp_f32 v96, v96
    s_waitcnt lgkmcnt(4)
    v_mfma_f32_32x32x16_bf16 v[220:235], v[132:135], v[108:111], v[220:235]
    ds_read_b128 v[124:127], v4 offset:8192
    v_exp_f32 v97, v97
    v_exp_f32 v98, v98
    v_mfma_f32_32x32x16_bf16 v[236:251], v[136:139], v[108:111], v[236:251]
    ds_read_b128 v[128:131], v4 offset:9216
    v_exp_f32 v99, v99
    v_cvt_pk_bf16_f32 v116, v92, v93
    v_cvt_pk_bf16_f32 v117, v94, v95
    s_waitcnt lgkmcnt(4)
    v_mfma_f32_32x32x16_bf16 v[188:203], v[140:143], v[112:115], v[188:203]
    ds_read_b128 v[132:135], v4 offset:10240
    v_cvt_pk_bf16_f32 v118, v96, v97
    v_cvt_pk_bf16_f32 v119, v98, v99
    v_mfma_f32_32x32x16_bf16 v[204:219], v[144:147], v[112:115], v[204:219]
    ds_read_b128 v[136:139], v4 offset:11264
    buffer_load_dwordx4 v11, s[16:19], s34 offen offset:1024 lds
    s_and_b32 s28, s28, 0xffff
    s_add_u32 s34, s34, 16384
    v_pk_add_f32 v[172:173], v[172:173], v[76:77]
    v_pk_add_f32 v[174:175], v[174:175], v[78:79]
    v_pk_add_f32 v[172:173], v[172:173], v[80:81]
    s_waitcnt lgkmcnt(4)
    v_mfma_f32_32x32x16_bf16 v[220:235], v[148:151], v[112:115], v[220:235]
    ds_read_b128 v[140:143], v4 offset:12288
    v_pk_add_f32 v[174:175], v[174:175], v[82:83]
    v_pk_add_f32 v[172:173], v[172:173], v[84:85]
    v_mfma_f32_32x32x16_bf16 v[236:251], v[152:155], v[112:115], v[236:251]
    ds_read_b128 v[144:147], v4 offset:13312
    v_pk_add_f32 v[174:175], v[174:175], v[86:87]
    v_pk_add_f32 v[172:173], v[172:173], v[88:89]
    v_pk_add_f32 v[174:175], v[174:175], v[90:91]
    s_waitcnt lgkmcnt(4)
    v_mfma_f32_32x32x16_bf16 v[76:91], v[124:127], v[28:31], v[156:171]
    ds_read_b128 v[148:151], v4 offset:14336
    v_exp_f32 v100, v100
    v_exp_f32 v101, v101
    v_mfma_f32_32x32x16_bf16 v[76:91], v[128:131], v[32:35], v[76:91]
    ds_read_b128 v[152:155], v4 offset:15360
    v_exp_f32 v102, v102
    v_exp_f32 v103, v103
    v_exp_f32 v104, v104
    s_waitcnt lgkmcnt(4)
    v_mfma_f32_32x32x16_bf16 v[76:91], v[132:135], v[36:39], v[76:91]
    ds_read_b128 v[124:127], v6 offset:8192
    v_exp_f32 v105, v105
    v_exp_f32 v106, v106
    v_mfma_f32_32x32x16_bf16 v[76:91], v[136:139], v[40:43], v[76:91]
    ds_read_b128 v[128:131], v6 offset:9216
    v_exp_f32 v107, v107
    v_cvt_pk_bf16_f32 v120, v100, v101
    v_cvt_pk_bf16_f32 v121, v102, v103
    s_waitcnt lgkmcnt(4)
    v_mfma_f32_32x32x16_bf16 v[76:91], v[140:143], v[44:47], v[76:91]
    ds_read_b128 v[132:135], v6 offset:10240
    s_add_u32 m0, s29, s32
    s_add_u32 s29, s29, 16384
    buffer_load_dwordx4 v11, s[16:19], s35 offen lds
    v_cvt_pk_bf16_f32 v122, v104, v105
    v_cvt_pk_bf16_f32 v123, v106, v107
    v_mfma_f32_32x32x16_bf16 v[76:91], v[144:147], v[48:51], v[76:91]
    ds_read_b128 v[136:139], v6 offset:11264
    v_max3_f32 v20, v60, v61, v62
    v_max3_f32 v20, v20, v63, v64
    v_max3_f32 v20, v20, v65, v66
    s_waitcnt lgkmcnt(4)
    v_mfma_f32_32x32x16_bf16 v[76:91], v[148:151], v[52:55], v[76:91]
    ds_read_b128 v[140:143], v6 offset:12288
    v_max3_f32 v20, v20, v67, v68
    v_max3_f32 v20, v20, v69, v70
    v_mfma_f32_32x32x16_bf16 v[76:91], v[152:155], v[56:59], v[76:91]
    ds_read_b128 v[144:147], v6 offset:13312
    v_max3_f32 v20, v20, v71, v72
    v_max3_f32 v20, v20, v73, v74
    v_max_f32 v20, v20, v75
    s_waitcnt lgkmcnt(4)
    v_mfma_f32_32x32x16_bf16 v[188:203], v[124:127], v[116:119], v[188:203]
    ds_read_b128 v[148:151], v6 offset:14336
    v_pk_add_f32 v[172:173], v[172:173], v[92:93]
    v_pk_add_f32 v[174:175], v[174:175], v[94:95]
    v_pk_add_f32 v[172:173], v[172:173], v[96:97]
    v_mfma_f32_32x32x16_bf16 v[204:219], v[128:131], v[116:119], v[204:219]
    ds_read_b128 v[152:155], v6 offset:15360
    v_pk_add_f32 v[174:175], v[174:175], v[98:99]
    v_pk_add_f32 v[172:173], v[172:173], v[100:101]
    v_pk_add_f32 v[174:175], v[174:175], v[102:103]
    s_waitcnt lgkmcnt(4)
    v_mfma_f32_32x32x16_bf16 v[220:235], v[132:135], v[116:119], v[220:235]
    ds_read_b128 v[124:127], v5 offset:0
    v_pk_add_f32 v[172:173], v[172:173], v[104:105]
    v_pk_add_f32 v[174:175], v[174:175], v[106:107]
    v_mfma_f32_32x32x16_bf16 v[236:251], v[136:139], v[116:119], v[236:251]
    ds_read_b128 v[128:131], v5 offset:1024
    buffer_load_dwordx4 v11, s[16:19], s35 offen offset:1024 lds
    s_cmp_eq_u32 s29, 114688
    s_cselect_b32 s29, 65536, s29
    s_add_u32 s35, s35, 16384
    v_max3_f32 v12, v20, v76, v77
    s_waitcnt lgkmcnt(4)
    v_mfma_f32_32x32x16_bf16 v[188:203], v[140:143], v[120:123], v[188:203]
    ds_read_b128 v[132:135], v5 offset:2048
    v_max3_f32 v12, v12, v78, v79
    v_max3_f32 v12, v12, v80, v81
    v_mfma_f32_32x32x16_bf16 v[204:219], v[144:147], v[120:123], v[204:219]
    ds_read_b128 v[136:139], v5 offset:3072
    v_max3_f32 v12, v12, v82, v83
    v_max3_f32 v12, v12, v84, v85
    s_waitcnt lgkmcnt(4)
    v_mfma_f32_32x32x16_bf16 v[220:235], v[148:151], v[120:123], v[220:235]
    ds_read_b128 v[140:143], v5 offset:4096
    v_max3_f32 v12, v12, v86, v87
    v_max3_f32 v12, v12, v88, v89
    v_mfma_f32_32x32x16_bf16 v[236:251], v[152:155], v[120:123], v[236:251]
    ds_read_b128 v[144:147], v5 offset:5120
    v_max3_f32 v12, v12, v90, v91
    v_cmp_gt_f32 vcc, v12, v21
    s_nop 4
    s_cbranch_vccz K2_NRB20
    s_nop 15
    v_mov_b32 v13, v12
    s_nop 1
    v_permlane32_swap_b32 v12, v13
    s_nop 1
    v_max_f32 v12, v12, v13
    v_max_f32 v12, 0, v12
    v_sub_f32 v13, 0, v12
    v_exp_f32 v13, v13
    v_sub_f32 v60, v60, v12
    v_sub_f32 v76, v76, v12
    v_sub_f32 v156, v156, v12
    v_sub_f32 v61, v61, v12
    v_sub_f32 v77, v77, v12
    v_sub_f32 v157, v157, v12
    v_sub_f32 v62, v62, v12
    v_sub_f32 v78, v78, v12
    v_sub_f32 v158, v158, v12
    v_sub_f32 v63, v63, v12
    v_sub_f32 v79, v79, v12
    v_sub_f32 v159, v159, v12
    v_sub_f32 v64, v64, v12
    v_sub_f32 v80, v80, v12
    v_sub_f32 v160, v160, v12
    v_sub_f32 v65, v65, v12
    v_sub_f32 v81, v81, v12
    v_sub_f32 v161, v161, v12
    v_sub_f32 v66, v66, v12
    v_sub_f32 v82, v82, v12
    v_sub_f32 v162, v162, v12
    v_sub_f32 v67, v67, v12
    v_sub_f32 v83, v83, v12
    v_sub_f32 v163, v163, v12
    v_sub_f32 v68, v68, v12
    v_sub_f32 v84, v84, v12
    v_sub_f32 v164, v164, v12
    v_sub_f32 v69, v69, v12
    v_sub_f32 v85, v85, v12
    v_sub_f32 v165, v165, v12
    v_sub_f32 v70, v70, v12
    v_sub_f32 v86, v86, v12
    v_sub_f32 v166, v166, v12
    v_sub_f32 v71, v71, v12
    v_sub_f32 v87, v87, v12
    v_sub_f32 v167, v167, v12
    v_sub_f32 v72, v72, v12
    v_sub_f32 v88, v88, v12
    v_sub_f32 v168, v168, v12
    v_sub_f32 v73, v73, v12
    v_sub_f32 v89, v89, v12
    v_sub_f32 v169, v169, v12
    v_sub_f32 v74, v74, v12
    v_sub_f32 v90, v90, v12
    v_sub_f32 v170, v170, v12
    v_sub_f32 v75, v75, v12
    v_sub_f32 v91, v91, v12
    v_sub_f32 v171, v171, v12
    v_mul_f32 v172, v172, v13
    v_mul_f32 v173, v173, v13
    v_mul_f32 v174, v174, v13
    v_mul_f32 v175, v175, v13
    v_mul_f32 v188, v188, v13
    v_mul_f32 v189, v189, v13
    v_mul_f32 v190, v190, v13
    v_mul_f32 v191, v191, v13
    v_mul_f32 v192, v192, v13
    v_mul_f32 v193, v193, v13
    v_mul_f32 v194, v194, v13
    v_mul_f32 v195, v195, v13
    v_mul_f32 v196, v196, v13
    v_mul_f32 v197, v197, v13
    v_mul_f32 v198, v198, v13
    v_mul_f32 v199, v199, v13
    v_mul_f32 v200, v200, v13
    v_mul_f32 v201, v201, v13
    v_mul_f32 v202, v202, v13
    v_mul_f32 v203, v203, v13
    v_mul_f32 v204, v204, v13
    v_mul_f32 v205, v205, v13
    v_mul_f32 v206, v206, v13
    v_mul_f32 v207, v207, v13
    v_mul_f32 v208, v208, v13
    v_mul_f32 v209, v209, v13
    v_mul_f32 v210, v210, v13
    v_mul_f32 v211, v211, v13
    v_mul_f32 v212, v212, v13
    v_mul_f32 v213, v213, v13
    v_mul_f32 v214, v214, v13
    v_mul_f32 v215, v215, v13
    v_mul_f32 v216, v216, v13
    v_mul_f32 v217, v217, v13
    v_mul_f32 v218, v218, v13
    v_mul_f32 v219, v219, v13
    v_mul_f32 v220, v220, v13
    v_mul_f32 v221, v221, v13
    v_mul_f32 v222, v222, v13
    v_mul_f32 v223, v223, v13
    v_mul_f32 v224, v224, v13
    v_mul_f32 v225, v225, v13
    v_mul_f32 v226, v226, v13
    v_mul_f32 v227, v227, v13
    v_mul_f32 v228, v228, v13
    v_mul_f32 v229, v229, v13
    v_mul_f32 v230, v230, v13
    v_mul_f32 v231, v231, v13
    v_mul_f32 v232, v232, v13
    v_mul_f32 v233, v233, v13
    v_mul_f32 v234, v234, v13
    v_mul_f32 v235, v235, v13
    v_mul_f32 v236, v236, v13
    v_mul_f32 v237, v237, v13
    v_mul_f32 v238, v238, v13
    v_mul_f32 v239, v239, v13
    v_mul_f32 v240, v240, v13
    v_mul_f32 v241, v241, v13
    v_mul_f32 v242, v242, v13
    v_mul_f32 v243, v243, v13
    v_mul_f32 v244, v244, v13
    v_mul_f32 v245, v245, v13
    v_mul_f32 v246, v246, v13
    v_mul_f32 v247, v247, v13
    v_mul_f32 v248, v248, v13
    v_mul_f32 v249, v249, v13
    v_mul_f32 v250, v250, v13
    v_mul_f32 v251, v251, v13
    s_nop 1
K2_NRB20:
    s_add_u32 s26, s26, 16384
    s_and_b32 s26, s26, 0xffff
    s_add_u32 s27, s27, 16384
    s_cmp_eq_u32 s27, 114688
    s_cselect_b32 s27, 65536, s27
    s_add_u32 s25, s25, 1
    s_branch K2_IT0
K2_MSK2:
    s_waitcnt lgkmcnt(4)
    v_mfma_f32_32x32x16_bf16 v[60:75], v[124:127], v[28:31], v[156:171]
    ds_read_b128 v[148:151], v4 offset:6144
    v_exp_f32 v76, v76
    v_exp_f32 v77, v77
    v_exp_f32 v78, v78
    v_mfma_f32_32x32x16_bf16 v[60:75], v[128:131], v[32:35], v[60:75]
    ds_read_b128 v[152:155], v4 offset:7168
    v_exp_f32 v79, v79
    v_exp_f32 v80, v80
    v_exp_f32 v81, v81
    s_waitcnt lgkmcnt(4)
    v_mfma_f32_32x32x16_bf16 v[60:75], v[132:135], v[36:39], v[60:75]
    ds_read_b128 v[124:127], v6 offset:0
    v_exp_f32 v82, v82
    v_exp_f32 v83, v83
    v_cvt_pk_bf16_f32 v108, v76, v77
    v_mfma_f32_32x32x16_bf16 v[60:75], v[136:139], v[40:43], v[60:75]
    ds_read_b128 v[128:131], v6 offset:1024
    v_cvt_pk_bf16_f32 v109, v78, v79
    v_cvt_pk_bf16_f32 v110, v80, v81
    v_cvt_pk_bf16_f32 v111, v82, v83
    s_waitcnt lgkmcnt(4)
    v_mfma_f32_32x32x16_bf16 v[60:75], v[140:143], v[44:47], v[60:75]
    ds_read_b128 v[132:135], v6 offset:2048
    v_exp_f32 v84, v84
    v_exp_f32 v85, v85
    v_exp_f32 v86, v86
    v_mfma_f32_32x32x16_bf16 v[60:75], v[144:147], v[48:51], v[60:75]
    ds_read_b128 v[136:139], v6 offset:3072
    v_exp_f32 v87, v87
    v_exp_f32 v88, v88
    v_exp_f32 v89, v89
    s_waitcnt lgkmcnt(4)
    v_mfma_f32_32x32x16_bf16 v[60:75], v[148:151], v[52:55], v[60:75]
    ds_read_b128 v[140:143], v6 offset:4096
    s_add_u32 m0, s28, s32
    s_add_u32 s28, s28, 16384
    buffer_load_dwordx4 v11, s[16:19], s34 offen lds
    v_exp_f32 v90, v90
    v_exp_f32 v91, v91
    v_cvt_pk_bf16_f32 v112, v84, v85
    v_mfma_f32_32x32x16_bf16 v[60:75], v[152:155], v[56:59], v[60:75]
    ds_read_b128 v[144:147], v6 offset:5120
    v_cvt_pk_bf16_f32 v113, v86, v87
    v_cvt_pk_bf16_f32 v114, v88, v89
    v_cvt_pk_bf16_f32 v115, v90, v91
    s_waitcnt lgkmcnt(4)
    v_mfma_f32_32x32x16_bf16 v[188:203], v[124:127], v[108:111], v[188:203]
    ds_read_b128 v[148:151], v6 offset:6144
    v_exp_f32 v92, v92
    v_exp_f32 v93, v93
    v_mfma_f32_32x32x16_bf16 v[204:219], v[128:131], v[108:111], v[204:219]
    ds_read_b128 v[152:155], v6 offset:7168
    v_exp_f32 v94, v94
    v_exp_f32 v95, v95
    v_exp_f32 v96, v96
    s_waitcnt lgkmcnt(4)
    v_mfma_f32_32x32x16_bf16 v[220:235], v[132:135], v[108:111], v[220:235]
    ds_read_b128 v[124:127], v4 offset:8192
    v_exp_f32 v97, v97
    v_exp_f32 v98, v98
    v_mfma_f32_32x32x16_bf16 v[236:251], v[136:139], v[108:111], v[236:251]
    ds_read_b128 v[128:131], v4 offset:9216
    v_exp_f32 v99, v99
    v_cvt_pk_bf16_f32 v116, v92, v93
    v_cvt_pk_bf16_f32 v117, v94, v95
    s_waitcnt lgkmcnt(4)
    v_mfma_f32_32x32x16_bf16 v[188:203], v[140:143], v[112:115], v[188:203]
    ds_read_b128 v[132:135], v4 offset:10240
    v_cvt_pk_bf16_f32 v118, v96, v97
    v_cvt_pk_bf16_f32 v119, v98, v99
    v_mfma_f32_32x32x16_bf16 v[204:219], v[144:147], v[112:115], v[204:219]
    ds_read_b128 v[136:139], v4 offset:11264
    buffer_load_dwordx4 v11, s[16:19], s34 offen offset:1024 lds
    s_and_b32 s28, s28, 0xffff
    s_add_u32 s34, s34, 16384
    v_pk_add_f32 v[172:173], v[172:173], v[76:77]
    v_pk_add_f32 v[174:175], v[174:175], v[78:79]
    v_pk_add_f32 v[172:173], v[172:173], v[80:81]
    s_waitcnt lgkmcnt(4)
    v_mfma_f32_32x32x16_bf16 v[220:235], v[148:151], v[112:115], v[220:235]
    ds_read_b128 v[140:143], v4 offset:12288
    v_pk_add_f32 v[174:175], v[174:175], v[82:83]
    v_pk_add_f32 v[172:173], v[172:173], v[84:85]
    v_mfma_f32_32x32x16_bf16 v[236:251], v[152:155], v[112:115], v[236:251]
    ds_read_b128 v[144:147], v4 offset:13312
    v_pk_add_f32 v[174:175], v[174:175], v[86:87]
    v_pk_add_f32 v[172:173], v[172:173], v[88:89]
    v_pk_add_f32 v[174:175], v[174:175], v[90:91]
    s_waitcnt lgkmcnt(4)
    v_mfma_f32_32x32x16_bf16 v[76:91], v[124:127], v[28:31], v[156:171]
    ds_read_b128 v[148:151], v4 offset:14336
    v_exp_f32 v100, v100
    v_mfma_f32_32x32x16_bf16 v[76:91], v[128:131], v[32:35], v[76:91]
    ds_read_b128 v[152:155], v4 offset:15360
    v_exp_f32 v101, v101
    v_exp_f32 v102, v102
    s_waitcnt lgkmcnt(4)
    v_mfma_f32_32x32x16_bf16 v[76:91], v[132:135], v[36:39], v[76:91]
    ds_read_b128 v[124:127], v6 offset:8192
    v_exp_f32 v103, v103
    v_mfma_f32_32x32x16_bf16 v[76:91], v[136:139], v[40:43], v[76:91]
    ds_read_b128 v[128:131], v6 offset:9216
    v_exp_f32 v104, v104
    v_exp_f32 v105, v105
    s_waitcnt lgkmcnt(4)
    v_mfma_f32_32x32x16_bf16 v[76:91], v[140:143], v[44:47], v[76:91]
    ds_read_b128 v[132:135], v6 offset:10240
    s_add_u32 m0, s29, s32
    s_add_u32 s29, s29, 16384
    buffer_load_dwordx4 v11, s[16:19], s35 offen lds
    v_exp_f32 v106, v106
    v_mfma_f32_32x32x16_bf16 v[76:91], v[144:147], v[48:51], v[76:91]
    ds_read_b128 v[136:139], v6 offset:11264
    v_exp_f32 v107, v107
    v_cvt_pk_bf16_f32 v120, v100, v101
    s_waitcnt lgkmcnt(4)
    v_mfma_f32_32x32x16_bf16 v[76:91], v[148:151], v[52:55], v[76:91]
    ds_read_b128 v[140:143], v6 offset:12288
    v_cvt_pk_bf16_f32 v121, v102, v103
    v_mfma_f32_32x32x16_bf16 v[76:91], v[152:155], v[56:59], v[76:91]
    ds_read_b128 v[144:147], v6 offset:13312
    v_cvt_pk_bf16_f32 v122, v104, v105
    v_cvt_pk_bf16_f32 v123, v106, v107
    s_waitcnt lgkmcnt(4)
    v_mfma_f32_32x32x16_bf16 v[188:203], v[124:127], v[116:119], v[188:203]
    ds_read_b128 v[148:151], v6 offset:14336
    v_pk_add_f32 v[172:173], v[172:173], v[92:93]
    v_pk_add_f32 v[174:175], v[174:175], v[94:95]
    v_pk_add_f32 v[172:173], v[172:173], v[96:97]
    v_mfma_f32_32x32x16_bf16 v[204:219], v[128:131], v[116:119], v[204:219]
    ds_read_b128 v[152:155], v6 offset:15360
    v_pk_add_f32 v[174:175], v[174:175], v[98:99]
    v_pk_add_f32 v[172:173], v[172:173], v[100:101]
    v_pk_add_f32 v[174:175], v[174:175], v[102:103]
    s_waitcnt lgkmcnt(4)
    v_mfma_f32_32x32x16_bf16 v[220:235], v[132:135], v[116:119], v[220:235]
    ds_read_b128 v[124:127], v5 offset:0
    v_pk_add_f32 v[172:173], v[172:173], v[104:105]
    v_pk_add_f32 v[174:175], v[174:175], v[106:107]
    v_mfma_f32_32x32x16_bf16 v[236:251], v[136:139], v[116:119], v[236:251]
    ds_read_b128 v[128:131], v5 offset:1024
    buffer_load_dwordx4 v11, s[16:19], s35 offen offset:1024 lds
    s_cmp_eq_u32 s29, 114688
    s_cselect_b32 s29, 65536, s29
    s_add_u32 s35, s35, 16384
    s_waitcnt lgkmcnt(4)
    v_mfma_f32_32x32x16_bf16 v[188:203], v[140:143], v[120:123], v[188:203]
    ds_read_b128 v[132:135], v5 offset:2048
    v_mfma_f32_32x32x16_bf16 v[204:219], v[144:147], v[120:123], v[204:219]
    ds_read_b128 v[136:139], v5 offset:3072
    s_waitcnt lgkmcnt(4)
    v_mfma_f32_32x32x16_bf16 v[220:235], v[148:151], v[120:123], v[220:235]
    ds_read_b128 v[140:143], v5 offset:4096
    v_mfma_f32_32x32x16_bf16 v[236:251], v[152:155], v[120:123], v[236:251]
    ds_read_b128 v[144:147], v5 offset:5120
    s_nop 7
    s_add_u32 s33, s25, 1
    s_lshl_b32 s33, s33, 6
    v_subrev_u32 v12, s33, v7
    v_cmp_gt_i32 s[60:61], 0, v12
    v_cmp_gt_i32 s[62:63], 1, v12
    v_cmp_gt_i32 s[64:65], 2, v12
    v_cmp_gt_i32 s[66:67], 3, v12
    s_nop 1
    v_cndmask_b32 v60, v60, v10, s[60:61]
    v_cndmask_b32 v61, v61, v10, s[62:63]
    v_cndmask_b32 v62, v62, v10, s[64:65]
    v_cndmask_b32 v63, v63, v10, s[66:67]
    v_cmp_gt_i32 s[60:61], 8, v12
    v_cmp_gt_i32 s[62:63], 9, v12
    v_cmp_gt_i32 s[64:65], 10, v12
    v_cmp_gt_i32 s[66:67], 11, v12
    s_nop 1
    v_cndmask_b32 v64, v64, v10, s[60:61]
    v_cndmask_b32 v65, v65, v10, s[62:63]
    v_cndmask_b32 v66, v66, v10, s[64:65]
    v_cndmask_b32 v67, v67, v10, s[66:67]
    v_cmp_gt_i32 s[60:61], 16, v12
    v_cmp_gt_i32 s[62:63], 17, v12
    v_cmp_gt_i32 s[64:65], 18, v12
    v_cmp_gt_i32 s[66:67], 19, v12
    s_nop 1
    v_cndmask_b32 v68, v68, v10, s[60:61]
    v_cndmask_b32 v69, v69, v10, s[62:63]
    v_cndmask_b32 v70, v70, v10, s[64:65]
    v_cndmask_b32 v71, v71, v10, s[66:67]
    v_cmp_gt_i32 s[60:61], 24, v12
    v_cmp_gt_i32 s[62:63], 25, v12
    v_cmp_gt_i32 s[64:65], 26, v12
    v_cmp_gt_i32 s[66:67], 27, v12
    s_nop 1
    v_cndmask_b32 v72, v72, v10, s[60:61]
    v_cndmask_b32 v73, v73, v10, s[62:63]
    v_cndmask_b32 v74, v74, v10, s[64:65]
    v_cndmask_b32 v75, v75, v10, s[66:67]
    v_cmp_gt_i32 s[60:61], 32, v12
    v_cmp_gt_i32 s[62:63], 33, v12
    v_cmp_gt_i32 s[64:65], 34, v12
    v_cmp_gt_i32 s[66:67], 35, v12
    s_nop 1
    v_cndmask_b32 v76, v76, v10, s[60:61]
    v_cndmask_b32 v77, v77, v10, s[62:63]
    v_cndmask_b32 v78, v78, v10, s[64:65]
    v_cndmask_b32 v79, v79, v10, s[66:67]
    v_cmp_gt_i32 s[60:61], 40, v12
    v_cmp_gt_i32 s[62:63], 41, v12
    v_cmp_gt_i32 s[64:65], 42, v12
    v_cmp_gt_i32 s[66:67], 43, v12
    s_nop 1
    v_cndmask_b32 v80, v80, v10, s[60:61]
    v_cndmask_b32 v81, v81, v10, s[62:63]
    v_cndmask_b32 v82, v82, v10, s[64:65]
    v_cndmask_b32 v83, v83, v10, s[66:67]
    v_cmp_gt_i32 s[60:61], 48, v12
    v_cmp_gt_i32 s[62:63], 49, v12
    v_cmp_gt_i32 s[64:65], 50, v12
    v_cmp_gt_i32 s[66:67], 51, v12
    s_nop 1
    v_cndmask_b32 v84, v84, v10, s[60:61]
    v_cndmask_b32 v85, v85, v10, s[62:63]
    v_cndmask_b32 v86, v86, v10, s[64:65]
    v_cndmask_b32 v87, v87, v10, s[66:67]
    v_cmp_gt_i32 s[60:61], 56, v12
    v_cmp_gt_i32 s[62:63], 57, v12
    v_cmp_gt_i32 s[64:65], 58, v12
    v_cmp_gt_i32 s[66:67], 59, v12
    s_nop 1
    v_cndmask_b32 v88, v88, v10, s[60:61]
    v_cndmask_b32 v89, v89, v10, s[62:63]
    v_cndmask_b32 v90, v90, v10, s[64:65]
    v_cndmask_b32 v91, v91, v10, s[66:67]
    v_max3_f32 v20, v60, v61, v62
    v_max3_f32 v20, v20, v63, v64
    v_max3_f32 v20, v20, v65, v66
    v_max3_f32 v20, v20, v67, v68
    v_max3_f32 v20, v20, v69, v70
    v_max3_f32 v20, v20, v71, v72
    v_max3_f32 v20, v20, v73, v74
    v_max_f32 v20, v20, v75
    v_max3_f32 v12, v20, v76, v77
    v_max3_f32 v12, v12, v78, v79
    v_max3_f32 v12, v12, v80, v81
    v_max3_f32 v12, v12, v82, v83
    v_max3_f32 v12, v12, v84, v85
    v_max3_f32 v12, v12, v86, v87
    v_max3_f32 v12, v12, v88, v89
    v_max3_f32 v12, v12, v90, v91
    v_cmp_gt_f32 vcc, v12, v21
    s_nop 4
    s_cbranch_vccz K2_NRB21
    s_nop 15
    v_mov_b32 v13, v12
    s_nop 1
    v_permlane32_swap_b32 v12, v13
    s_nop 1
    v_max_f32 v12, v12, v13
    v_max_f32 v12, 0, v12
    v_sub_f32 v13, 0, v12
    v_exp_f32 v13, v13
    v_sub_f32 v60, v60, v12
    v_sub_f32 v76, v76, v12
    v_sub_f32 v156, v156, v12
    v_sub_f32 v61, v61, v12
    v_sub_f32 v77, v77, v12
    v_sub_f32 v157, v157, v12
    v_sub_f32 v62, v62, v12
    v_sub_f32 v78, v78, v12
    v_sub_f32 v158, v158, v12
    v_sub_f32 v63, v63, v12
    v_sub_f32 v79, v79, v12
    v_sub_f32 v159, v159, v12
    v_sub_f32 v64, v64, v12
    v_sub_f32 v80, v80, v12
    v_sub_f32 v160, v160, v12
    v_sub_f32 v65, v65, v12
    v_sub_f32 v81, v81, v12
    v_sub_f32 v161, v161, v12
    v_sub_f32 v66, v66, v12
    v_sub_f32 v82, v82, v12
    v_sub_f32 v162, v162, v12
    v_sub_f32 v67, v67, v12
    v_sub_f32 v83, v83, v12
    v_sub_f32 v163, v163, v12
    v_sub_f32 v68, v68, v12
    v_sub_f32 v84, v84, v12
    v_sub_f32 v164, v164, v12
    v_sub_f32 v69, v69, v12
    v_sub_f32 v85, v85, v12
    v_sub_f32 v165, v165, v12
    v_sub_f32 v70, v70, v12
    v_sub_f32 v86, v86, v12
    v_sub_f32 v166, v166, v12
    v_sub_f32 v71, v71, v12
    v_sub_f32 v87, v87, v12
    v_sub_f32 v167, v167, v12
    v_sub_f32 v72, v72, v12
    v_sub_f32 v88, v88, v12
    v_sub_f32 v168, v168, v12
    v_sub_f32 v73, v73, v12
    v_sub_f32 v89, v89, v12
    v_sub_f32 v169, v169, v12
    v_sub_f32 v74, v74, v12
    v_sub_f32 v90, v90, v12
    v_sub_f32 v170, v170, v12
    v_sub_f32 v75, v75, v12
    v_sub_f32 v91, v91, v12
    v_sub_f32 v171, v171, v12
    v_mul_f32 v172, v172, v13
    v_mul_f32 v173, v173, v13
    v_mul_f32 v174, v174, v13
    v_mul_f32 v175, v175, v13
    v_mul_f32 v188, v188, v13
    v_mul_f32 v189, v189, v13
    v_mul_f32 v190, v190, v13
    v_mul_f32 v191, v191, v13
    v_mul_f32 v192, v192, v13
    v_mul_f32 v193, v193, v13
    v_mul_f32 v194, v194, v13
    v_mul_f32 v195, v195, v13
    v_mul_f32 v196, v196, v13
    v_mul_f32 v197, v197, v13
    v_mul_f32 v198, v198, v13
    v_mul_f32 v199, v199, v13
    v_mul_f32 v200, v200, v13
    v_mul_f32 v201, v201, v13
    v_mul_f32 v202, v202, v13
    v_mul_f32 v203, v203, v13
    v_mul_f32 v204, v204, v13
    v_mul_f32 v205, v205, v13
    v_mul_f32 v206, v206, v13
    v_mul_f32 v207, v207, v13
    v_mul_f32 v208, v208, v13
    v_mul_f32 v209, v209, v13
    v_mul_f32 v210, v210, v13
    v_mul_f32 v211, v211, v13
    v_mul_f32 v212, v212, v13
    v_mul_f32 v213, v213, v13
    v_mul_f32 v214, v214, v13
    v_mul_f32 v215, v215, v13
    v_mul_f32 v216, v216, v13
    v_mul_f32 v217, v217, v13
    v_mul_f32 v218, v218, v13
    v_mul_f32 v219, v219, v13
    v_mul_f32 v220, v220, v13
    v_mul_f32 v221, v221, v13
    v_mul_f32 v222, v222, v13
    v_mul_f32 v223, v223, v13
    v_mul_f32 v224, v224, v13
    v_mul_f32 v225, v225, v13
    v_mul_f32 v226, v226, v13
    v_mul_f32 v227, v227, v13
    v_mul_f32 v228, v228, v13
    v_mul_f32 v229, v229, v13
    v_mul_f32 v230, v230, v13
    v_mul_f32 v231, v231, v13
    v_mul_f32 v232, v232, v13
    v_mul_f32 v233, v233, v13
    v_mul_f32 v234, v234, v13
    v_mul_f32 v235, v235, v13
    v_mul_f32 v236, v236, v13
    v_mul_f32 v237, v237, v13
    v_mul_f32 v238, v238, v13
    v_mul_f32 v239, v239, v13
    v_mul_f32 v240, v240, v13
    v_mul_f32 v241, v241, v13
    v_mul_f32 v242, v242, v13
    v_mul_f32 v243, v243, v13
    v_mul_f32 v244, v244, v13
    v_mul_f32 v245, v245, v13
    v_mul_f32 v246, v246, v13
    v_mul_f32 v247, v247, v13
    v_mul_f32 v248, v248, v13
    v_mul_f32 v249, v249, v13
    v_mul_f32 v250, v250, v13
    v_mul_f32 v251, v251, v13
    s_nop 1
K2_NRB21:
    s_add_u32 s26, s26, 16384
    s_and_b32 s26, s26, 0xffff
    s_add_u32 s27, s27, 16384
    s_cmp_eq_u32 s27, 114688
    s_cselect_b32 s27, 65536, s27
    s_add_u32 s25, s25, 1
    s_branch K2_IT0
K2_FIN2:
    s_add_u32 m0, s28, s32
    s_add_u32 s28, s28, 16384
    buffer_load_dwordx4 v11, s[16:19], s34 offen lds
    buffer_load_dwordx4 v11, s[16:19], s34 offen offset:1024 lds
    s_and_b32 s28, s28, 0xffff
    s_add_u32 s34, s34, 16384
    s_add_u32 m0, s29, s32
    s_add_u32 s29, s29, 16384
    buffer_load_dwordx4 v11, s[16:19], s35 offen lds
    buffer_load_dwordx4 v11, s[16:19], s35 offen offset:1024 lds
    s_cmp_eq_u32 s29, 114688
    s_cselect_b32 s29, 65536, s29
    s_add_u32 s35, s35, 16384
    s_waitcnt lgkmcnt(0)
    v_exp_f32 v76, v76
    v_exp_f32 v77, v77
    v_exp_f32 v78, v78
    v_exp_f32 v79, v79
    v_exp_f32 v80, v80
    v_exp_f32 v81, v81
    v_exp_f32 v82, v82
    v_exp_f32 v83, v83
    v_cvt_pk_bf16_f32 v108, v76, v77
    v_pk_add_f32 v[172:173], v[172:173], v[76:77]
    v_cvt_pk_bf16_f32 v109, v78, v79
    v_pk_add_f32 v[174:175], v[174:175], v[78:79]
    v_cvt_pk_bf16_f32 v110, v80, v81
    v_pk_add_f32 v[172:173], v[172:173], v[80:81]
    v_cvt_pk_bf16_f32 v111, v82, v83
    v_pk_add_f32 v[174:175], v[174:175], v[82:83]
    v_exp_f32 v84, v84
    v_exp_f32 v85, v85
    v_exp_f32 v86, v86
    v_exp_f32 v87, v87
    v_exp_f32 v88, v88
    v_exp_f32 v89, v89
    v_exp_f32 v90, v90
    v_exp_f32 v91, v91
    v_cvt_pk_bf16_f32 v112, v84, v85
    v_pk_add_f32 v[172:173], v[172:173], v[84:85]
    v_cvt_pk_bf16_f32 v113, v86, v87
    v_pk_add_f32 v[174:175], v[174:175], v[86:87]
    v_cvt_pk_bf16_f32 v114, v88, v89
    v_pk_add_f32 v[172:173], v[172:173], v[88:89]
    v_cvt_pk_bf16_f32 v115, v90, v91
    v_pk_add_f32 v[174:175], v[174:175], v[90:91]
    v_exp_f32 v92, v92
    v_exp_f32 v93, v93
    v_exp_f32 v94, v94
    v_exp_f32 v95, v95
    v_exp_f32 v96, v96
    v_exp_f32 v97, v97
    v_exp_f32 v98, v98
    v_exp_f32 v99, v99
    v_cvt_pk_bf16_f32 v116, v92, v93
    v_pk_add_f32 v[172:173], v[172:173], v[92:93]
    v_cvt_pk_bf16_f32 v117, v94, v95
    v_pk_add_f32 v[174:175], v[174:175], v[94:95]
    v_cvt_pk_bf16_f32 v118, v96, v97
    v_pk_add_f32 v[172:173], v[172:173], v[96:97]
    v_cvt_pk_bf16_f32 v119, v98, v99
    v_pk_add_f32 v[174:175], v[174:175], v[98:99]
    v_exp_f32 v100, v100
    v_exp_f32 v101, v101
    v_exp_f32 v102, v102
    v_exp_f32 v103, v103
    v_exp_f32 v104, v104
    v_exp_f32 v105, v105
    v_exp_f32 v106, v106
    v_exp_f32 v107, v107
    v_cvt_pk_bf16_f32 v120, v100, v101
    v_pk_add_f32 v[172:173], v[172:173], v[100:101]
    v_cvt_pk_bf16_f32 v121, v102, v103
    v_pk_add_f32 v[174:175], v[174:175], v[102:103]
    v_cvt_pk_bf16_f32 v122, v104, v105
    v_pk_add_f32 v[172:173], v[172:173], v[104:105]
    v_cvt_pk_bf16_f32 v123, v106, v107
    v_pk_add_f32 v[174:175], v[174:175], v[106:107]
    ds_read_b128 v[124:127], v6 offset:0
    ds_read_b128 v[128:131], v6 offset:1024
    ds_read_b128 v[132:135], v6 offset:2048
    ds_read_b128 v[136:139], v6 offset:3072
    ds_read_b128 v[140:143], v6 offset:4096
    ds_read_b128 v[144:147], v6 offset:5120
    ds_read_b128 v[148:151], v6 offset:6144
    ds_read_b128 v[152:155], v6 offset:7168
    s_waitcnt lgkmcnt(7)
    v_mfma_f32_32x32x16_bf16 v[188:203], v[124:127], v[108:111], v[188:203]
    s_waitcnt lgkmcnt(6)
    v_mfma_f32_32x32x16_bf16 v[204:219], v[128:131], v[108:111], v[204:219]
    s_waitcnt lgkmcnt(5)
    v_mfma_f32_32x32x16_bf16 v[220:235], v[132:135], v[108:111], v[220:235]
    s_waitcnt lgkmcnt(4)
    v_mfma_f32_32x32x16_bf16 v[236:251], v[136:139], v[108:111], v[236:251]
    s_waitcnt lgkmcnt(3)
    v_mfma_f32_32x32x16_bf16 v[188:203], v[140:143], v[112:115], v[188:203]
    s_waitcnt lgkmcnt(2)
    v_mfma_f32_32x32x16_bf16 v[204:219], v[144:147], v[112:115], v[204:219]
    s_waitcnt lgkmcnt(1)
    v_mfma_f32_32x32x16_bf16 v[220:235], v[148:151], v[112:115], v[220:235]
    s_waitcnt lgkmcnt(0)
    v_mfma_f32_32x32x16_bf16 v[236:251], v[152:155], v[112:115], v[236:251]
    ds_read_b128 v[124:127], v6 offset:8192
    ds_read_b128 v[128:131], v6 offset:9216
    ds_read_b128 v[132:135], v6 offset:10240
    ds_read_b128 v[136:139], v6 offset:11264
    ds_read_b128 v[140:143], v6 offset:12288
    ds_read_b128 v[144:147], v6 offset:13312
    ds_read_b128 v[148:151], v6 offset:14336
    ds_read_b128 v[152:155], v6 offset:15360
    s_waitcnt lgkmcnt(7)
    v_mfma_f32_32x32x16_bf16 v[188:203], v[124:127], v[116:119], v[188:203]
    s_waitcnt lgkmcnt(6)
    v_mfma_f32_32x32x16_bf16 v[204:219], v[128:131], v[116:119], v[204:219]
    s_waitcnt lgkmcnt(5)
    v_mfma_f32_32x32x16_bf16 v[220:235], v[132:135], v[116:119], v[220:235]
    s_waitcnt lgkmcnt(4)
    v_mfma_f32_32x32x16_bf16 v[236:251], v[136:139], v[116:119], v[236:251]
    s_waitcnt lgkmcnt(3)
    v_mfma_f32_32x32x16_bf16 v[188:203], v[140:143], v[120:123], v[188:203]
    s_waitcnt lgkmcnt(2)
    v_mfma_f32_32x32x16_bf16 v[204:219], v[144:147], v[120:123], v[204:219]
    s_waitcnt lgkmcnt(1)
    v_mfma_f32_32x32x16_bf16 v[220:235], v[148:151], v[120:123], v[220:235]
    s_waitcnt lgkmcnt(0)
    v_mfma_f32_32x32x16_bf16 v[236:251], v[152:155], v[120:123], v[236:251]
    v_add_f32 v172, v172, v173
    v_add_f32 v174, v174, v175
    v_add_f32 v172, v172, v174
    v_mov_b32 v173, v172
    s_nop 1
    v_permlane32_swap_b32 v172, v173
    s_nop 1
    v_add_f32 v172, v172, v173
    s_nop 15
    v_rcp_f32 v12, v172
    s_nop 0
    v_mul_f32 v188, v188, v12
    v_mul_f32 v189, v189, v12
    v_mul_f32 v190, v190, v12
    v_mul_f32 v191, v191, v12
    v_mul_f32 v192, v192, v12
    v_mul_f32 v193, v193, v12
    v_mul_f32 v194, v194, v12
    v_mul_f32 v195, v195, v12
    v_mul_f32 v196, v196, v12
    v_mul_f32 v197, v197, v12
    v_mul_f32 v198, v198, v12
    v_mul_f32 v199, v199, v12
    v_mul_f32 v200, v200, v12
    v_mul_f32 v201, v201, v12
    v_mul_f32 v202, v202, v12
    v_mul_f32 v203, v203, v12
    v_mul_f32 v204, v204, v12
    v_mul_f32 v205, v205, v12
    v_mul_f32 v206, v206, v12
    v_mul_f32 v207, v207, v12
    v_mul_f32 v208, v208, v12
    v_mul_f32 v209, v209, v12
    v_mul_f32 v210, v210, v12
    v_mul_f32 v211, v211, v12
    v_mul_f32 v212, v212, v12
    v_mul_f32 v213, v213, v12
    v_mul_f32 v214, v214, v12
    v_mul_f32 v215, v215, v12
    v_mul_f32 v216, v216, v12
    v_mul_f32 v217, v217, v12
    v_mul_f32 v218, v218, v12
    v_mul_f32 v219, v219, v12
    v_mul_f32 v220, v220, v12
    v_mul_f32 v221, v221, v12
    v_mul_f32 v222, v222, v12
    v_mul_f32 v223, v223, v12
    v_mul_f32 v224, v224, v12
    v_mul_f32 v225, v225, v12
    v_mul_f32 v226, v226, v12
    v_mul_f32 v227, v227, v12
    v_mul_f32 v228, v228, v12
    v_mul_f32 v229, v229, v12
    v_mul_f32 v230, v230, v12
    v_mul_f32 v231, v231, v12
    v_mul_f32 v232, v232, v12
    v_mul_f32 v233, v233, v12
    v_mul_f32 v234, v234, v12
    v_mul_f32 v235, v235, v12
    v_mul_f32 v236, v236, v12
    v_mul_f32 v237, v237, v12
    v_mul_f32 v238, v238, v12
    v_mul_f32 v239, v239, v12
    v_mul_f32 v240, v240, v12
    v_mul_f32 v241, v241, v12
    v_mul_f32 v242, v242, v12
    v_mul_f32 v243, v243, v12
    v_mul_f32 v244, v244, v12
    v_mul_f32 v245, v245, v12
    v_mul_f32 v246, v246, v12
    v_mul_f32 v247, v247, v12
    v_mul_f32 v248, v248, v12
    v_mul_f32 v249, v249, v12
    v_mul_f32 v250, v250, v12
    v_mul_f32 v251, v251, v12
    s_lshl_b32 s33, s31, 5
    s_add_u32 s33, s33, s21
    s_lshl_b32 s33, s33, 13
    s_add_u32 s36, s33, 50331648
    s_add_u32 s37, s36, 4096
    v_cvt_pk_bf16_f32 v60, v188, v189
    v_cvt_pk_bf16_f32 v61, v190, v191
    v_cvt_pk_bf16_f32 v62, v192, v193
    v_cvt_pk_bf16_f32 v63, v194, v195
    buffer_store_dwordx4 v[60:63], v2, s[16:19], s36 offen offset:0 sc1
    v_cvt_pk_bf16_f32 v64, v196, v197
    v_cvt_pk_bf16_f32 v65, v198, v199
    v_cvt_pk_bf16_f32 v66, v200, v201
    v_cvt_pk_bf16_f32 v67, v202, v203
    buffer_store_dwordx4 v[64:67], v2, s[16:19], s36 offen offset:1024 sc1
    v_cvt_pk_bf16_f32 v68, v204, v205
    v_cvt_pk_bf16_f32 v69, v206, v207
    v_cvt_pk_bf16_f32 v70, v208, v209
    v_cvt_pk_bf16_f32 v71, v210, v211
    buffer_store_dwordx4 v[68:71], v2, s[16:19], s36 offen offset:2048 sc1
    v_cvt_pk_bf16_f32 v72, v212, v213
    v_cvt_pk_bf16_f32 v73, v214, v215
    v_cvt_pk_bf16_f32 v74, v216, v217
    v_cvt_pk_bf16_f32 v75, v218, v219
    buffer_store_dwordx4 v[72:75], v2, s[16:19], s36 offen offset:3072 sc1
    v_cvt_pk_bf16_f32 v76, v220, v221
    v_cvt_pk_bf16_f32 v77, v222, v223
    v_cvt_pk_bf16_f32 v78, v224, v225
    v_cvt_pk_bf16_f32 v79, v226, v227
    buffer_store_dwordx4 v[76:79], v2, s[16:19], s37 offen offset:0 sc1
    v_cvt_pk_bf16_f32 v80, v228, v229
    v_cvt_pk_bf16_f32 v81, v230, v231
    v_cvt_pk_bf16_f32 v82, v232, v233
    v_cvt_pk_bf16_f32 v83, v234, v235
    buffer_store_dwordx4 v[80:83], v2, s[16:19], s37 offen offset:1024 sc1
    v_cvt_pk_bf16_f32 v84, v236, v237
    v_cvt_pk_bf16_f32 v85, v238, v239
    v_cvt_pk_bf16_f32 v86, v240, v241
    v_cvt_pk_bf16_f32 v87, v242, v243
    buffer_store_dwordx4 v[84:87], v2, s[16:19], s37 offen offset:2048 sc1
    v_cvt_pk_bf16_f32 v88, v244, v245
    v_cvt_pk_bf16_f32 v89, v246, v247
    v_cvt_pk_bf16_f32 v90, v248, v249
    v_cvt_pk_bf16_f32 v91, v250, v251
    buffer_store_dwordx4 v[88:91], v2, s[16:19], s37 offen offset:3072 sc1
    s_branch K2_POST
K2_B2W:
    s_mov_b32 s43, 1
    s_lshl_b32 s38, s21, 12
    s_add_u32 s38, s38, 71303168
    s_sub_u32 s41, s22, 5
    s_lshl_b32 s41, s41, 2
    s_add_u32 s41, s41, s20
    s_lshl_b32 s41, s41, 3
    s_lshl_b32 s39, s21, 6
    s_add_u32 s39, s39, s41
    s_lshl_b32 s39, s39, 11
    s_add_u32 s39, s39, 67108864
    s_lshl_b32 s40, s41, 5
    s_add_u32 s40, s40, s21
    s_lshl_b32 s40, s40, 10
    s_add_u32 s40, s40, 73400320
    s_and_b32 s33, s21, 1
    s_cmp_eq_u32 s33, 1
    s_cselect_b64 s[60:61], -1, 0
    v_mov_b32 v16, 0x358637bd
    s_add_u32 s25, s25, 1
    s_waitcnt vmcnt(12)
    s_barrier
    s_add_u32 m0, s28, s32
    s_add_u32 s28, s28, 16384
    buffer_load_dwordx4 v11, s[16:19], s34 offen lds
    buffer_load_dwordx4 v11, s[16:19], s34 offen offset:1024 lds
    s_and_b32 s28, s28, 0xffff
    s_add_u32 s34, s34, 16384
    s_add_u32 m0, s29, s32
    s_add_u32 s29, s29, 16384
    buffer_load_dwordx4 v11, s[16:19], s35 offen lds
    buffer_load_dwordx4 v11, s[16:19], s35 offen offset:1024 lds
    s_cmp_eq_u32 s29, 114688
    s_cselect_b32 s29, 65536, s29
    s_add_u32 s35, s35, 16384
    s_waitcnt vmcnt(4)
    s_add_u32 s33, s38, 0
    buffer_load_dwordx4 v[64:67], v2, s[16:19], s33 offen offset:0
    s_add_u32 s33, s38, 131072
    buffer_load_dwordx4 v[68:71], v2, s[16:19], s33 offen offset:0
    s_add_u32 s33, s38, 262144
    buffer_load_dwordx4 v[72:75], v2, s[16:19], s33 offen offset:0
    s_add_u32 s33, s38, 393216
    buffer_load_dwordx4 v[76:79], v2, s[16:19], s33 offen offset:0
    s_add_u32 s33, s38, 524288
    buffer_load_dwordx4 v[80:83], v2, s[16:19], s33 offen offset:0
    s_add_u32 s33, s38, 655360
    buffer_load_dwordx4 v[84:87], v2, s[16:19], s33 offen offset:0
    s_add_u32 s33, s38, 786432
    buffer_load_dwordx4 v[88:91], v2, s[16:19], s33 offen offset:0
    s_add_u32 s33, s38, 917504
    buffer_load_dwordx4 v[92:95], v2, s[16:19], s33 offen offset:0
    s_add_u32 s33, s38, 1048576
    buffer_load_dwordx4 v[96:99], v2, s[16:19], s33 offen offset:0
    s_add_u32 s33, s38, 1179648
    buffer_load_dwordx4 v[100:103], v2, s[16:19], s33 offen offset:0
    s_add_u32 s33, s38, 1310720
    buffer_load_dwordx4 v[104:107], v2, s[16:19], s33 offen offset:0
    s_add_u32 s33, s38, 1441792
    buffer_load_dwordx4 v[108:111], v2, s[16:19], s33 offen offset:0
    s_add_u32 s33, s38, 1572864
    buffer_load_dwordx4 v[112:115], v2, s[16:19], s33 offen offset:0
    s_add_u32 s33, s38, 1703936
    buffer_load_dwordx4 v[116:119], v2, s[16:19], s33 offen offset:0
    s_add_u32 s33, s38, 1835008
    buffer_load_dwordx4 v[120:123], v2, s[16:19], s33 offen offset:0
    s_add_u32 s33, s38, 1966080
    buffer_load_dwordx4 v[124:127], v2, s[16:19], s33 offen offset:0
    s_add_u32 s33, s38, 0
    buffer_load_dwordx4 v[128:131], v2, s[16:19], s33 offen offset:1024
    s_add_u32 s33, s38, 131072
    buffer_load_dwordx4 v[132:135], v2, s[16:19], s33 offen offset:1024
    s_add_u32 s33, s38, 262144
    buffer_load_dwordx4 v[136:139], v2, s[16:19], s33 offen offset:1024
    s_add_u32 s33, s38, 393216
    buffer_load_dwordx4 v[140:143], v2, s[16:19], s33 offen offset:1024
    s_add_u32 s33, s38, 524288
    buffer_load_dwordx4 v[144:147], v2, s[16:19], s33 offen offset:1024
    s_add_u32 s33, s38, 655360
    buffer_load_dwordx4 v[148:151], v2, s[16:19], s33 offen offset:1024
    s_add_u32 s33, s38, 786432
    buffer_load_dwordx4 v[152:155], v2, s[16:19], s33 offen offset:1024
    s_add_u32 s33, s38, 917504
    buffer_load_dwordx4 v[156:159], v2, s[16:19], s33 offen offset:1024
    s_add_u32 s33, s38, 1048576
    buffer_load_dwordx4 v[160:163], v2, s[16:19], s33 offen offset:1024
    s_add_u32 s33, s38, 1179648
    buffer_load_dwordx4 v[164:167], v2, s[16:19], s33 offen offset:1024
    s_add_u32 s33, s38, 1310720
    buffer_load_dwordx4 v[168:171], v2, s[16:19], s33 offen offset:1024
    s_add_u32 s33, s38, 1441792
    buffer_load_dwordx4 v[172:175], v2, s[16:19], s33 offen offset:1024
    s_add_u32 s33, s38, 1572864
    buffer_load_dwordx4 v[176:179], v2, s[16:19], s33 offen offset:1024
    s_add_u32 s33, s38, 1703936
    buffer_load_dwordx4 v[180:183], v2, s[16:19], s33 offen offset:1024
    s_add_u32 s33, s38, 1835008
    buffer_load_dwordx4 v[184:187], v2, s[16:19], s33 offen offset:1024
    s_add_u32 s33, s38, 1966080
    buffer_load_dwordx4 v[188:191], v2, s[16:19], s33 offen offset:1024
    s_add_u32 s25, s25, 1
    s_waitcnt vmcnt(36)
    s_barrier
    s_add_u32 m0, s28, s32
    s_add_u32 s28, s28, 16384
    buffer_load_dwordx4 v11, s[16:19], s34 offen lds
    buffer_load_dwordx4 v11, s[16:19], s34 offen offset:1024 lds
    s_and_b32 s28, s28, 0xffff
    s_add_u32 s34, s34, 16384
    s_add_u32 m0, s29, s32
    s_add_u32 s29, s29, 16384
    buffer_load_dwordx4 v11, s[16:19], s35 offen lds
    buffer_load_dwordx4 v11, s[16:19], s35 offen offset:1024 lds
    s_cmp_eq_u32 s29, 114688
    s_cselect_b32 s29, 65536, s29
    s_add_u32 s35, s35, 16384
    s_waitcnt vmcnt(4)
    v_pk_add_f32 v[24:25], v[64:65], v[68:69]
    v_pk_add_f32 v[26:27], v[66:67], v[70:71]
    v_pk_add_f32 v[24:25], v[24:25], v[72:73]
    v_pk_add_f32 v[26:27], v[26:27], v[74:75]
    v_pk_add_f32 v[24:25], v[24:25], v[76:77]
    v_pk_add_f32 v[26:27], v[26:27], v[78:79]
    v_pk_add_f32 v[24:25], v[24:25], v[80:81]
    v_pk_add_f32 v[26:27], v[26:27], v[82:83]
    v_pk_add_f32 v[24:25], v[24:25], v[84:85]
    v_pk_add_f32 v[26:27], v[26:27], v[86:87]
    v_pk_add_f32 v[24:25], v[24:25], v[88:89]
    v_pk_add_f32 v[26:27], v[26:27], v[90:91]
    v_pk_add_f32 v[24:25], v[24:25], v[92:93]
    v_pk_add_f32 v[26:27], v[26:27], v[94:95]
    v_pk_add_f32 v[24:25], v[24:25], v[96:97]
    v_pk_add_f32 v[26:27], v[26:27], v[98:99]
    v_pk_add_f32 v[24:25], v[24:25], v[100:101]
    v_pk_add_f32 v[26:27], v[26:27], v[102:103]
    v_pk_add_f32 v[24:25], v[24:25], v[104:105]
    v_pk_add_f32 v[26:27], v[26:27], v[106:107]
    v_pk_add_f32 v[24:25], v[24:25], v[108:109]
    v_pk_add_f32 v[26:27], v[26:27], v[110:111]
    v_pk_add_f32 v[24:25], v[24:25], v[112:113]
    v_pk_add_f32 v[26:27], v[26:27], v[114:115]
    v_pk_add_f32 v[24:25], v[24:25], v[116:117]
    v_pk_add_f32 v[26:27], v[26:27], v[118:119]
    v_pk_add_f32 v[24:25], v[24:25], v[120:121]
    v_pk_add_f32 v[26:27], v[26:27], v[122:123]
    v_pk_add_f32 v[24:25], v[24:25], v[124:125]
    v_pk_add_f32 v[26:27], v[26:27], v[126:127]
    v_pk_add_f32 v[28:29], v[128:129], v[132:133]
    v_pk_add_f32 v[30:31], v[130:131], v[134:135]
    v_pk_add_f32 v[28:29], v[28:29], v[136:137]
    v_pk_add_f32 v[30:31], v[30:31], v[138:139]
    v_pk_add_f32 v[28:29], v[28:29], v[140:141]
    v_pk_add_f32 v[30:31], v[30:31], v[142:143]
    v_pk_add_f32 v[28:29], v[28:29], v[144:145]
    v_pk_add_f32 v[30:31], v[30:31], v[146:147]
    v_pk_add_f32 v[28:29], v[28:29], v[148:149]
    v_pk_add_f32 v[30:31], v[30:31], v[150:151]
    v_pk_add_f32 v[28:29], v[28:29], v[152:153]
    v_pk_add_f32 v[30:31], v[30:31], v[154:155]
    v_pk_add_f32 v[28:29], v[28:29], v[156:157]
    v_pk_add_f32 v[30:31], v[30:31], v[158:159]
    v_pk_add_f32 v[28:29], v[28:29], v[160:161]
    v_pk_add_f32 v[30:31], v[30:31], v[162:163]
    v_pk_add_f32 v[28:29], v[28:29], v[164:165]
    v_pk_add_f32 v[30:31], v[30:31], v[166:167]
    v_pk_add_f32 v[28:29], v[28:29], v[168:169]
    v_pk_add_f32 v[30:31], v[30:31], v[170:171]
    v_pk_add_f32 v[28:29], v[28:29], v[172:173]
    v_pk_add_f32 v[30:31], v[30:31], v[174:175]
    v_pk_add_f32 v[28:29], v[28:29], v[176:177]
    v_pk_add_f32 v[30:31], v[30:31], v[178:179]
    v_pk_add_f32 v[28:29], v[28:29], v[180:181]
    v_pk_add_f32 v[30:31], v[30:31], v[182:183]
    v_pk_add_f32 v[28:29], v[28:29], v[184:185]
    v_pk_add_f32 v[30:31], v[30:31], v[186:187]
    v_pk_add_f32 v[28:29], v[28:29], v[188:189]
    v_pk_add_f32 v[30:31], v[30:31], v[190:191]
    s_add_u32 s33, s38, 0
    buffer_load_dwordx4 v[64:67], v2, s[16:19], s33 offen offset:2048
    s_add_u32 s33, s38, 131072
    buffer_load_dwordx4 v[68:71], v2, s[16:19], s33 offen offset:2048
    s_add_u32 s33, s38, 262144
    buffer_load_dwordx4 v[72:75], v2, s[16:19], s33 offen offset:2048
    s_add_u32 s33, s38, 393216
    buffer_load_dwordx4 v[76:79], v2, s[16:19], s33 offen offset:2048
    s_add_u32 s33, s38, 524288
    buffer_load_dwordx4 v[80:83], v2, s[16:19], s33 offen offset:2048
    s_add_u32 s33, s38, 655360
    buffer_load_dwordx4 v[84:87], v2, s[16:19], s33 offen offset:2048
    s_add_u32 s33, s38, 786432
    buffer_load_dwordx4 v[88:91], v2, s[16:19], s33 offen offset:2048
    s_add_u32 s33, s38, 917504
    buffer_load_dwordx4 v[92:95], v2, s[16:19], s33 offen offset:2048
    s_add_u32 s33, s38, 1048576
    buffer_load_dwordx4 v[96:99], v2, s[16:19], s33 offen offset:2048
    s_add_u32 s33, s38, 1179648
    buffer_load_dwordx4 v[100:103], v2, s[16:19], s33 offen offset:2048
    s_add_u32 s33, s38, 1310720
    buffer_load_dwordx4 v[104:107], v2, s[16:19], s33 offen offset:2048
    s_add_u32 s33, s38, 1441792
    buffer_load_dwordx4 v[108:111], v2, s[16:19], s33 offen offset:2048
    s_add_u32 s33, s38, 1572864
    buffer_load_dwordx4 v[112:115], v2, s[16:19], s33 offen offset:2048
    s_add_u32 s33, s38, 1703936
    buffer_load_dwordx4 v[116:119], v2, s[16:19], s33 offen offset:2048
    s_add_u32 s33, s38, 1835008
    buffer_load_dwordx4 v[120:123], v2, s[16:19], s33 offen offset:2048
    s_add_u32 s33, s38, 1966080
    buffer_load_dwordx4 v[124:127], v2, s[16:19], s33 offen offset:2048
    s_add_u32 s33, s38, 0
    buffer_load_dwordx4 v[128:131], v2, s[16:19], s33 offen offset:3072
    s_add_u32 s33, s38, 131072
    buffer_load_dwordx4 v[132:135], v2, s[16:19], s33 offen offset:3072
    s_add_u32 s33, s38, 262144
    buffer_load_dwordx4 v[136:139], v2, s[16:19], s33 offen offset:3072
    s_add_u32 s33, s38, 393216
    buffer_load_dwordx4 v[140:143], v2, s[16:19], s33 offen offset:3072
    s_add_u32 s33, s38, 524288
    buffer_load_dwordx4 v[144:147], v2, s[16:19], s33 offen offset:3072
    s_add_u32 s33, s38, 655360
    buffer_load_dwordx4 v[148:151], v2, s[16:19], s33 offen offset:3072
    s_add_u32 s33, s38, 786432
    buffer_load_dwordx4 v[152:155], v2, s[16:19], s33 offen offset:3072
    s_add_u32 s33, s38, 917504
    buffer_load_dwordx4 v[156:159], v2, s[16:19], s33 offen offset:3072
    s_add_u32 s33, s38, 1048576
    buffer_load_dwordx4 v[160:163], v2, s[16:19], s33 offen offset:3072
    s_add_u32 s33, s38, 1179648
    buffer_load_dwordx4 v[164:167], v2, s[16:19], s33 offen offset:3072
    s_add_u32 s33, s38, 1310720
    buffer_load_dwordx4 v[168:171], v2, s[16:19], s33 offen offset:3072
    s_add_u32 s33, s38, 1441792
    buffer_load_dwordx4 v[172:175], v2, s[16:19], s33 offen offset:3072
    s_add_u32 s33, s38, 1572864
    buffer_load_dwordx4 v[176:179], v2, s[16:19], s33 offen offset:3072
    s_add_u32 s33, s38, 1703936
    buffer_load_dwordx4 v[180:183], v2, s[16:19], s33 offen offset:3072
    s_add_u32 s33, s38, 1835008
    buffer_load_dwordx4 v[184:187], v2, s[16:19], s33 offen offset:3072
    s_add_u32 s33, s38, 1966080
    buffer_load_dwordx4 v[188:191], v2, s[16:19], s33 offen offset:3072
    s_add_u32 s25, s25, 1
    s_waitcnt vmcnt(36)
    s_barrier
    s_add_u32 m0, s28, s32
    s_add_u32 s28, s28, 16384
    buffer_load_dwordx4 v11, s[16:19], s34 offen lds
    buffer_load_dwordx4 v11, s[16:19], s34 offen offset:1024 lds
    s_and_b32 s28, s28, 0xffff
    s_add_u32 s34, s34, 16384
    s_add_u32 m0, s29, s32
    s_add_u32 s29, s29, 16384
    buffer_load_dwordx4 v11, s[16:19], s35 offen lds
    buffer_load_dwordx4 v11, s[16:19], s35 offen offset:1024 lds
    s_cmp_eq_u32 s29, 114688
    s_cselect_b32 s29, 65536, s29
    s_add_u32 s35, s35, 16384
    s_waitcnt vmcnt(4)
    v_pk_add_f32 v[32:33], v[64:65], v[68:69]
    v_pk_add_f32 v[34:35], v[66:67], v[70:71]
    v_pk_add_f32 v[32:33], v[32:33], v[72:73]
    v_pk_add_f32 v[34:35], v[34:35], v[74:75]
    v_pk_add_f32 v[32:33], v[32:33], v[76:77]
    v_pk_add_f32 v[34:35], v[34:35], v[78:79]
    v_pk_add_f32 v[32:33], v[32:33], v[80:81]
    v_pk_add_f32 v[34:35], v[34:35], v[82:83]
    v_pk_add_f32 v[32:33], v[32:33], v[84:85]
    v_pk_add_f32 v[34:35], v[34:35], v[86:87]
    v_pk_add_f32 v[32:33], v[32:33], v[88:89]
    v_pk_add_f32 v[34:35], v[34:35], v[90:91]
    v_pk_add_f32 v[32:33], v[32:33], v[92:93]
    v_pk_add_f32 v[34:35], v[34:35], v[94:95]
    v_pk_add_f32 v[32:33], v[32:33], v[96:97]
    v_pk_add_f32 v[34:35], v[34:35], v[98:99]
    v_pk_add_f32 v[32:33], v[32:33], v[100:101]
    v_pk_add_f32 v[34:35], v[34:35], v[102:103]
    v_pk_add_f32 v[32:33], v[32:33], v[104:105]
    v_pk_add_f32 v[34:35], v[34:35], v[106:107]
    v_pk_add_f32 v[32:33], v[32:33], v[108:109]
    v_pk_add_f32 v[34:35], v[34:35], v[110:111]
    v_pk_add_f32 v[32:33], v[32:33], v[112:113]
    v_pk_add_f32 v[34:35], v[34:35], v[114:115]
    v_pk_add_f32 v[32:33], v[32:33], v[116:117]
    v_pk_add_f32 v[34:35], v[34:35], v[118:119]
    v_pk_add_f32 v[32:33], v[32:33], v[120:121]
    v_pk_add_f32 v[34:35], v[34:35], v[122:123]
    v_pk_add_f32 v[32:33], v[32:33], v[124:125]
    v_pk_add_f32 v[34:35], v[34:35], v[126:127]
    v_pk_add_f32 v[36:37], v[128:129], v[132:133]
    v_pk_add_f32 v[38:39], v[130:131], v[134:135]
    v_pk_add_f32 v[36:37], v[36:37], v[136:137]
    v_pk_add_f32 v[38:39], v[38:39], v[138:139]
    v_pk_add_f32 v[36:37], v[36:37], v[140:141]
    v_pk_add_f32 v[38:39], v[38:39], v[142:143]
    v_pk_add_f32 v[36:37], v[36:37], v[144:145]
    v_pk_add_f32 v[38:39], v[38:39], v[146:147]
    v_pk_add_f32 v[36:37], v[36:37], v[148:149]
    v_pk_add_f32 v[38:39], v[38:39], v[150:151]
    v_pk_add_f32 v[36:37], v[36:37], v[152:153]
    v_pk_add_f32 v[38:39], v[38:39], v[154:155]
    v_pk_add_f32 v[36:37], v[36:37], v[156:157]
    v_pk_add_f32 v[38:39], v[38:39], v[158:159]
    v_pk_add_f32 v[36:37], v[36:37], v[160:161]
    v_pk_add_f32 v[38:39], v[38:39], v[162:163]
    v_pk_add_f32 v[36:37], v[36:37], v[164:165]
    v_pk_add_f32 v[38:39], v[38:39], v[166:167]
    v_pk_add_f32 v[36:37], v[36:37], v[168:169]
    v_pk_add_f32 v[38:39], v[38:39], v[170:171]
    v_pk_add_f32 v[36:37], v[36:37], v[172:173]
    v_pk_add_f32 v[38:39], v[38:39], v[174:175]
    v_pk_add_f32 v[36:37], v[36:37], v[176:177]
    v_pk_add_f32 v[38:39], v[38:39], v[178:179]
    v_pk_add_f32 v[36:37], v[36:37], v[180:181]
    v_pk_add_f32 v[38:39], v[38:39], v[182:183]
    v_pk_add_f32 v[36:37], v[36:37], v[184:185]
    v_pk_add_f32 v[38:39], v[38:39], v[186:187]
    v_pk_add_f32 v[36:37], v[36:37], v[188:189]
    v_pk_add_f32 v[38:39], v[38:39], v[190:191]
    v_cvt_pk_bf16_f32 v40, v24, v25
    v_cvt_pk_bf16_f32 v41, v26, v27
    v_cvt_pk_bf16_f32 v42, v28, v29
    v_cvt_pk_bf16_f32 v43, v30, v31
    v_cvt_pk_bf16_f32 v44, v32, v33
    v_cvt_pk_bf16_f32 v45, v34, v35
    v_cvt_pk_bf16_f32 v46, v36, v37
    v_cvt_pk_bf16_f32 v47, v38, v39
    s_add_u32 s33, s39, 0
    buffer_load_dwordx4 v[64:67], v2, s[16:19], s33 offen
    buffer_load_dwordx4 v[68:71], v2, s[16:19], s33 offen offset:1024
    s_add_u32 s33, s39, 2048
    buffer_load_dwordx4 v[72:75], v2, s[16:19], s33 offen
    buffer_load_dwordx4 v[76:79], v2, s[16:19], s33 offen offset:1024
    s_add_u32 s33, s39, 4096
    buffer_load_dwordx4 v[80:83], v2, s[16:19], s33 offen
    buffer_load_dwordx4 v[84:87], v2, s[16:19], s33 offen offset:1024
    s_add_u32 s33, s39, 6144
    buffer_load_dwordx4 v[88:91], v2, s[16:19], s33 offen
    buffer_load_dwordx4 v[92:95], v2, s[16:19], s33 offen offset:1024
    s_add_u32 s25, s25, 1
    s_waitcnt vmcnt(16)
    s_barrier
    s_add_u32 m0, s28, s32
    s_add_u32 s28, s28, 16384
    buffer_load_dwordx4 v11, s[16:19], s34 offen lds
    buffer_load_dwordx4 v11, s[16:19], s34 offen offset:1024 lds
    s_and_b32 s28, s28, 0xffff
    s_add_u32 s34, s34, 16384
    s_add_u32 m0, s29, s32
    s_add_u32 s29, s29, 16384
    buffer_load_dwordx4 v11, s[16:19], s35 offen lds
    buffer_load_dwordx4 v11, s[16:19], s35 offen offset:1024 lds
    s_cmp_eq_u32 s29, 114688
    s_cselect_b32 s29, 65536, s29
    s_add_u32 s35, s35, 16384
    s_waitcnt vmcnt(4)
    v_mfma_f32_32x32x16_bf16 v[128:143], v[40:43], v[64:67], 0
    v_mfma_f32_32x32x16_bf16 v[128:143], v[44:47], v[68:71], v[128:143]
    v_mfma_f32_32x32x16_bf16 v[144:159], v[40:43], v[72:75], 0
    v_mfma_f32_32x32x16_bf16 v[144:159], v[44:47], v[76:79], v[144:159]
    v_mfma_f32_32x32x16_bf16 v[160:175], v[40:43], v[80:83], 0
    v_mfma_f32_32x32x16_bf16 v[160:175], v[44:47], v[84:87], v[160:175]
    v_mfma_f32_32x32x16_bf16 v[176:191], v[40:43], v[88:91], 0
    v_mfma_f32_32x32x16_bf16 v[176:191], v[44:47], v[92:95], v[176:191]
    s_nop 15
    v_cndmask_b32 v12, v136, v128, s[60:61]
    v_cndmask_b32 v128, v128, v136, s[60:61]
    v_cndmask_b32 v129, v129, v137, s[60:61]
    v_cndmask_b32 v130, v130, v138, s[60:61]
    v_cndmask_b32 v131, v131, v139, s[60:61]
    v_cndmask_b32 v132, v132, v140, s[60:61]
    v_cndmask_b32 v133, v133, v141, s[60:61]
    v_cndmask_b32 v134, v134, v142, s[60:61]
    v_cndmask_b32 v135, v135, v143, s[60:61]
    v_cvt_pk_bf16_f32 v12, v12, v12
    v_lshlrev_b32 v12, 16, v12
    v_add_f32 v12, v12, v16
    v_cvt_pk_bf16_f32 v12, v12, v12
    v_lshlrev_b32 v12, 16, v12
    v_rcp_f32 v12, v12
    v_cvt_pk_bf16_f32 v128, v128, v128
    v_lshlrev_b32 v128, 16, v128
    v_cvt_pk_bf16_f32 v129, v129, v129
    v_lshlrev_b32 v129, 16, v129
    v_cvt_pk_bf16_f32 v130, v130, v130
    v_lshlrev_b32 v130, 16, v130
    v_cvt_pk_bf16_f32 v131, v131, v131
    v_lshlrev_b32 v131, 16, v131
    v_cvt_pk_bf16_f32 v132, v132, v132
    v_lshlrev_b32 v132, 16, v132
    v_cvt_pk_bf16_f32 v133, v133, v133
    v_lshlrev_b32 v133, 16, v133
    v_cvt_pk_bf16_f32 v134, v134, v134
    v_lshlrev_b32 v134, 16, v134
    v_cvt_pk_bf16_f32 v135, v135, v135
    v_lshlrev_b32 v135, 16, v135
    v_mul_f32 v128, v128, v12
    v_mul_f32 v129, v129, v12
    v_mul_f32 v130, v130, v12
    v_mul_f32 v131, v131, v12
    v_mul_f32 v132, v132, v12
    v_mul_f32 v133, v133, v12
    v_mul_f32 v134, v134, v12
    v_mul_f32 v135, v135, v12
    v_cvt_pk_bf16_f32 v192, v128, v129
    v_cvt_pk_bf16_f32 v193, v130, v131
    v_cvt_pk_bf16_f32 v194, v132, v133
    v_cvt_pk_bf16_f32 v195, v134, v135
    s_add_u32 s33, s40, 0
    buffer_store_dwordx4 v[192:195], v2, s[16:19], s33 offen sc1
    v_cndmask_b32 v12, v152, v144, s[60:61]
    v_cndmask_b32 v144, v144, v152, s[60:61]
    v_cndmask_b32 v145, v145, v153, s[60:61]
    v_cndmask_b32 v146, v146, v154, s[60:61]
    v_cndmask_b32 v147, v147, v155, s[60:61]
    v_cndmask_b32 v148, v148, v156, s[60:61]
    v_cndmask_b32 v149, v149, v157, s[60:61]
    v_cndmask_b32 v150, v150, v158, s[60:61]
    v_cndmask_b32 v151, v151, v159, s[60:61]
    v_cvt_pk_bf16_f32 v12, v12, v12
    v_lshlrev_b32 v12, 16, v12
    v_add_f32 v12, v12, v16
    v_cvt_pk_bf16_f32 v12, v12, v12
    v_lshlrev_b32 v12, 16, v12
    v_rcp_f32 v12, v12
    v_cvt_pk_bf16_f32 v144, v144, v144
    v_lshlrev_b32 v144, 16, v144
    v_cvt_pk_bf16_f32 v145, v145, v145
    v_lshlrev_b32 v145, 16, v145
    v_cvt_pk_bf16_f32 v146, v146, v146
    v_lshlrev_b32 v146, 16, v146
    v_cvt_pk_bf16_f32 v147, v147, v147
    v_lshlrev_b32 v147, 16, v147
    v_cvt_pk_bf16_f32 v148, v148, v148
    v_lshlrev_b32 v148, 16, v148
    v_cvt_pk_bf16_f32 v149, v149, v149
    v_lshlrev_b32 v149, 16, v149
    v_cvt_pk_bf16_f32 v150, v150, v150
    v_lshlrev_b32 v150, 16, v150
    v_cvt_pk_bf16_f32 v151, v151, v151
    v_lshlrev_b32 v151, 16, v151
    v_mul_f32 v144, v144, v12
    v_mul_f32 v145, v145, v12
    v_mul_f32 v146, v146, v12
    v_mul_f32 v147, v147, v12
    v_mul_f32 v148, v148, v12
    v_mul_f32 v149, v149, v12
    v_mul_f32 v150, v150, v12
    v_mul_f32 v151, v151, v12
    v_cvt_pk_bf16_f32 v196, v144, v145
    v_cvt_pk_bf16_f32 v197, v146, v147
    v_cvt_pk_bf16_f32 v198, v148, v149
    v_cvt_pk_bf16_f32 v199, v150, v151
    s_add_u32 s33, s40, 32768
    buffer_store_dwordx4 v[196:199], v2, s[16:19], s33 offen sc1
    v_cndmask_b32 v12, v168, v160, s[60:61]
    v_cndmask_b32 v160, v160, v168, s[60:61]
    v_cndmask_b32 v161, v161, v169, s[60:61]
    v_cndmask_b32 v162, v162, v170, s[60:61]
    v_cndmask_b32 v163, v163, v171, s[60:61]
    v_cndmask_b32 v164, v164, v172, s[60:61]
    v_cndmask_b32 v165, v165, v173, s[60:61]
    v_cndmask_b32 v166, v166, v174, s[60:61]
    v_cndmask_b32 v167, v167, v175, s[60:61]
    v_cvt_pk_bf16_f32 v12, v12, v12
    v_lshlrev_b32 v12, 16, v12
    v_add_f32 v12, v12, v16
    v_cvt_pk_bf16_f32 v12, v12, v12
    v_lshlrev_b32 v12, 16, v12
    v_rcp_f32 v12, v12
    v_cvt_pk_bf16_f32 v160, v160, v160
    v_lshlrev_b32 v160, 16, v160
    v_cvt_pk_bf16_f32 v161, v161, v161
    v_lshlrev_b32 v161, 16, v161
    v_cvt_pk_bf16_f32 v162, v162, v162
    v_lshlrev_b32 v162, 16, v162
    v_cvt_pk_bf16_f32 v163, v163, v163
    v_lshlrev_b32 v163, 16, v163
    v_cvt_pk_bf16_f32 v164, v164, v164
    v_lshlrev_b32 v164, 16, v164
    v_cvt_pk_bf16_f32 v165, v165, v165
    v_lshlrev_b32 v165, 16, v165
    v_cvt_pk_bf16_f32 v166, v166, v166
    v_lshlrev_b32 v166, 16, v166
    v_cvt_pk_bf16_f32 v167, v167, v167
    v_lshlrev_b32 v167, 16, v167
    v_mul_f32 v160, v160, v12
    v_mul_f32 v161, v161, v12
    v_mul_f32 v162, v162, v12
    v_mul_f32 v163, v163, v12
    v_mul_f32 v164, v164, v12
    v_mul_f32 v165, v165, v12
    v_mul_f32 v166, v166, v12
    v_mul_f32 v167, v167, v12
    v_cvt_pk_bf16_f32 v200, v160, v161
    v_cvt_pk_bf16_f32 v201, v162, v163
    v_cvt_pk_bf16_f32 v202, v164, v165
    v_cvt_pk_bf16_f32 v203, v166, v167
    s_add_u32 s33, s40, 65536
    buffer_store_dwordx4 v[200:203], v2, s[16:19], s33 offen sc1
    v_cndmask_b32 v12, v184, v176, s[60:61]
    v_cndmask_b32 v176, v176, v184, s[60:61]
    v_cndmask_b32 v177, v177, v185, s[60:61]
    v_cndmask_b32 v178, v178, v186, s[60:61]
    v_cndmask_b32 v179, v179, v187, s[60:61]
    v_cndmask_b32 v180, v180, v188, s[60:61]
    v_cndmask_b32 v181, v181, v189, s[60:61]
    v_cndmask_b32 v182, v182, v190, s[60:61]
    v_cndmask_b32 v183, v183, v191, s[60:61]
    v_cvt_pk_bf16_f32 v12, v12, v12
    v_lshlrev_b32 v12, 16, v12
    v_add_f32 v12, v12, v16
    v_cvt_pk_bf16_f32 v12, v12, v12
    v_lshlrev_b32 v12, 16, v12
    v_rcp_f32 v12, v12
    v_cvt_pk_bf16_f32 v176, v176, v176
    v_lshlrev_b32 v176, 16, v176
    v_cvt_pk_bf16_f32 v177, v177, v177
    v_lshlrev_b32 v177, 16, v177
    v_cvt_pk_bf16_f32 v178, v178, v178
    v_lshlrev_b32 v178, 16, v178
    v_cvt_pk_bf16_f32 v179, v179, v179
    v_lshlrev_b32 v179, 16, v179
    v_cvt_pk_bf16_f32 v180, v180, v180
    v_lshlrev_b32 v180, 16, v180
    v_cvt_pk_bf16_f32 v181, v181, v181
    v_lshlrev_b32 v181, 16, v181
    v_cvt_pk_bf16_f32 v182, v182, v182
    v_lshlrev_b32 v182, 16, v182
    v_cvt_pk_bf16_f32 v183, v183, v183
    v_lshlrev_b32 v183, 16, v183
    v_mul_f32 v176, v176, v12
    v_mul_f32 v177, v177, v12
    v_mul_f32 v178, v178, v12
    v_mul_f32 v179, v179, v12
    v_mul_f32 v180, v180, v12
    v_mul_f32 v181, v181, v12
    v_mul_f32 v182, v182, v12
    v_mul_f32 v183, v183, v12
    v_cvt_pk_bf16_f32 v204, v176, v177
    v_cvt_pk_bf16_f32 v205, v178, v179
    v_cvt_pk_bf16_f32 v206, v180, v181
    v_cvt_pk_bf16_f32 v207, v182, v183
    s_add_u32 s33, s40, 98304
    buffer_store_dwordx4 v[204:207], v2, s[16:19], s33 offen sc1
    s_add_u32 s33, s39, 8192
    buffer_load_dwordx4 v[64:67], v2, s[16:19], s33 offen
    buffer_load_dwordx4 v[68:71], v2, s[16:19], s33 offen offset:1024
    s_add_u32 s33, s39, 10240
    buffer_load_dwordx4 v[72:75], v2, s[16:19], s33 offen
    buffer_load_dwordx4 v[76:79], v2, s[16:19], s33 offen offset:1024
    s_add_u32 s33, s39, 12288
    buffer_load_dwordx4 v[80:83], v2, s[16:19], s33 offen
    buffer_load_dwordx4 v[84:87], v2, s[16:19], s33 offen offset:1024
    s_add_u32 s33, s39, 14336
    buffer_load_dwordx4 v[88:91], v2, s[16:19], s33 offen
    buffer_load_dwordx4 v[92:95], v2, s[16:19], s33 offen offset:1024
    s_add_u32 s25, s25, 1
    s_waitcnt vmcnt(16)
    s_barrier
    s_add_u32 m0, s28, s32
    s_add_u32 s28, s28, 16384
    buffer_load_dwordx4 v11, s[16:19], s34 offen lds
    buffer_load_dwordx4 v11, s[16:19], s34 offen offset:1024 lds
    s_and_b32 s28, s28, 0xffff
    s_add_u32 s34, s34, 16384
    s_add_u32 m0, s29, s32
    s_add_u32 s29, s29, 16384
    buffer_load_dwordx4 v11, s[16:19], s35 offen lds
    buffer_load_dwordx4 v11, s[16:19], s35 offen offset:1024 lds
    s_cmp_eq_u32 s29, 114688
    s_cselect_b32 s29, 65536, s29
    s_add_u32 s35, s35, 16384
    s_waitcnt vmcnt(4)
    v_mfma_f32_32x32x16_bf16 v[128:143], v[40:43], v[64:67], 0
    v_mfma_f32_32x32x16_bf16 v[128:143], v[44:47], v[68:71], v[128:143]
    v_mfma_f32_32x32x16_bf16 v[144:159], v[40:43], v[72:75], 0
    v_mfma_f32_32x32x16_bf16 v[144:159], v[44:47], v[76:79], v[144:159]
    v_mfma_f32_32x32x16_bf16 v[160:175], v[40:43], v[80:83], 0
    v_mfma_f32_32x32x16_bf16 v[160:175], v[44:47], v[84:87], v[160:175]
    v_mfma_f32_32x32x16_bf16 v[176:191], v[40:43], v[88:91], 0
    v_mfma_f32_32x32x16_bf16 v[176:191], v[44:47], v[92:95], v[176:191]
    s_nop 15
    v_cndmask_b32 v12, v136, v128, s[60:61]
    v_cndmask_b32 v128, v128, v136, s[60:61]
    v_cndmask_b32 v129, v129, v137, s[60:61]
    v_cndmask_b32 v130, v130, v138, s[60:61]
    v_cndmask_b32 v131, v131, v139, s[60:61]
    v_cndmask_b32 v132, v132, v140, s[60:61]
    v_cndmask_b32 v133, v133, v141, s[60:61]
    v_cndmask_b32 v134, v134, v142, s[60:61]
    v_cndmask_b32 v135, v135, v143, s[60:61]
    v_cvt_pk_bf16_f32 v12, v12, v12
    v_lshlrev_b32 v12, 16, v12
    v_add_f32 v12, v12, v16
    v_cvt_pk_bf16_f32 v12, v12, v12
    v_lshlrev_b32 v12, 16, v12
    v_rcp_f32 v12, v12
    v_cvt_pk_bf16_f32 v128, v128, v128
    v_lshlrev_b32 v128, 16, v128
    v_cvt_pk_bf16_f32 v129, v129, v129
    v_lshlrev_b32 v129, 16, v129
    v_cvt_pk_bf16_f32 v130, v130, v130
    v_lshlrev_b32 v130, 16, v130
    v_cvt_pk_bf16_f32 v131, v131, v131
    v_lshlrev_b32 v131, 16, v131
    v_cvt_pk_bf16_f32 v132, v132, v132
    v_lshlrev_b32 v132, 16, v132
    v_cvt_pk_bf16_f32 v133, v133, v133
    v_lshlrev_b32 v133, 16, v133
    v_cvt_pk_bf16_f32 v134, v134, v134
    v_lshlrev_b32 v134, 16, v134
    v_cvt_pk_bf16_f32 v135, v135, v135
    v_lshlrev_b32 v135, 16, v135
    v_mul_f32 v128, v128, v12
    v_mul_f32 v129, v129, v12
    v_mul_f32 v130, v130, v12
    v_mul_f32 v131, v131, v12
    v_mul_f32 v132, v132, v12
    v_mul_f32 v133, v133, v12
    v_mul_f32 v134, v134, v12
    v_mul_f32 v135, v135, v12
    v_cvt_pk_bf16_f32 v192, v128, v129
    v_cvt_pk_bf16_f32 v193, v130, v131
    v_cvt_pk_bf16_f32 v194, v132, v133
    v_cvt_pk_bf16_f32 v195, v134, v135
    s_add_u32 s33, s40, 131072
    buffer_store_dwordx4 v[192:195], v2, s[16:19], s33 offen sc1
    v_cndmask_b32 v12, v152, v144, s[60:61]
    v_cndmask_b32 v144, v144, v152, s[60:61]
    v_cndmask_b32 v145, v145, v153, s[60:61]
    v_cndmask_b32 v146, v146, v154, s[60:61]
    v_cndmask_b32 v147, v147, v155, s[60:61]
    v_cndmask_b32 v148, v148, v156, s[60:61]
    v_cndmask_b32 v149, v149, v157, s[60:61]
    v_cndmask_b32 v150, v150, v158, s[60:61]
    v_cndmask_b32 v151, v151, v159, s[60:61]
    v_cvt_pk_bf16_f32 v12, v12, v12
    v_lshlrev_b32 v12, 16, v12
    v_add_f32 v12, v12, v16
    v_cvt_pk_bf16_f32 v12, v12, v12
    v_lshlrev_b32 v12, 16, v12
    v_rcp_f32 v12, v12
    v_cvt_pk_bf16_f32 v144, v144, v144
    v_lshlrev_b32 v144, 16, v144
    v_cvt_pk_bf16_f32 v145, v145, v145
    v_lshlrev_b32 v145, 16, v145
    v_cvt_pk_bf16_f32 v146, v146, v146
    v_lshlrev_b32 v146, 16, v146
    v_cvt_pk_bf16_f32 v147, v147, v147
    v_lshlrev_b32 v147, 16, v147
    v_cvt_pk_bf16_f32 v148, v148, v148
    v_lshlrev_b32 v148, 16, v148
    v_cvt_pk_bf16_f32 v149, v149, v149
    v_lshlrev_b32 v149, 16, v149
    v_cvt_pk_bf16_f32 v150, v150, v150
    v_lshlrev_b32 v150, 16, v150
    v_cvt_pk_bf16_f32 v151, v151, v151
    v_lshlrev_b32 v151, 16, v151
    v_mul_f32 v144, v144, v12
    v_mul_f32 v145, v145, v12
    v_mul_f32 v146, v146, v12
    v_mul_f32 v147, v147, v12
    v_mul_f32 v148, v148, v12
    v_mul_f32 v149, v149, v12
    v_mul_f32 v150, v150, v12
    v_mul_f32 v151, v151, v12
    v_cvt_pk_bf16_f32 v196, v144, v145
    v_cvt_pk_bf16_f32 v197, v146, v147
    v_cvt_pk_bf16_f32 v198, v148, v149
    v_cvt_pk_bf16_f32 v199, v150, v151
    s_add_u32 s33, s40, 163840
    buffer_store_dwordx4 v[196:199], v2, s[16:19], s33 offen sc1
    v_cndmask_b32 v12, v168, v160, s[60:61]
    v_cndmask_b32 v160, v160, v168, s[60:61]
    v_cndmask_b32 v161, v161, v169, s[60:61]
    v_cndmask_b32 v162, v162, v170, s[60:61]
    v_cndmask_b32 v163, v163, v171, s[60:61]
    v_cndmask_b32 v164, v164, v172, s[60:61]
    v_cndmask_b32 v165, v165, v173, s[60:61]
    v_cndmask_b32 v166, v166, v174, s[60:61]
    v_cndmask_b32 v167, v167, v175, s[60:61]
    v_cvt_pk_bf16_f32 v12, v12, v12
    v_lshlrev_b32 v12, 16, v12
    v_add_f32 v12, v12, v16
    v_cvt_pk_bf16_f32 v12, v12, v12
    v_lshlrev_b32 v12, 16, v12
    v_rcp_f32 v12, v12
    v_cvt_pk_bf16_f32 v160, v160, v160
    v_lshlrev_b32 v160, 16, v160
    v_cvt_pk_bf16_f32 v161, v161, v161
    v_lshlrev_b32 v161, 16, v161
    v_cvt_pk_bf16_f32 v162, v162, v162
    v_lshlrev_b32 v162, 16, v162
    v_cvt_pk_bf16_f32 v163, v163, v163
    v_lshlrev_b32 v163, 16, v163
    v_cvt_pk_bf16_f32 v164, v164, v164
    v_lshlrev_b32 v164, 16, v164
    v_cvt_pk_bf16_f32 v165, v165, v165
    v_lshlrev_b32 v165, 16, v165
    v_cvt_pk_bf16_f32 v166, v166, v166
    v_lshlrev_b32 v166, 16, v166
    v_cvt_pk_bf16_f32 v167, v167, v167
    v_lshlrev_b32 v167, 16, v167
    v_mul_f32 v160, v160, v12
    v_mul_f32 v161, v161, v12
    v_mul_f32 v162, v162, v12
    v_mul_f32 v163, v163, v12
    v_mul_f32 v164, v164, v12
    v_mul_f32 v165, v165, v12
    v_mul_f32 v166, v166, v12
    v_mul_f32 v167, v167, v12
    v_cvt_pk_bf16_f32 v200, v160, v161
    v_cvt_pk_bf16_f32 v201, v162, v163
    v_cvt_pk_bf16_f32 v202, v164, v165
    v_cvt_pk_bf16_f32 v203, v166, v167
    s_add_u32 s33, s40, 196608
    buffer_store_dwordx4 v[200:203], v2, s[16:19], s33 offen sc1
    v_cndmask_b32 v12, v184, v176, s[60:61]
    v_cndmask_b32 v176, v176, v184, s[60:61]
    v_cndmask_b32 v177, v177, v185, s[60:61]
    v_cndmask_b32 v178, v178, v186, s[60:61]
    v_cndmask_b32 v179, v179, v187, s[60:61]
    v_cndmask_b32 v180, v180, v188, s[60:61]
    v_cndmask_b32 v181, v181, v189, s[60:61]
    v_cndmask_b32 v182, v182, v190, s[60:61]
    v_cndmask_b32 v183, v183, v191, s[60:61]
    v_cvt_pk_bf16_f32 v12, v12, v12
    v_lshlrev_b32 v12, 16, v12
    v_add_f32 v12, v12, v16
    v_cvt_pk_bf16_f32 v12, v12, v12
    v_lshlrev_b32 v12, 16, v12
    v_rcp_f32 v12, v12
    v_cvt_pk_bf16_f32 v176, v176, v176
    v_lshlrev_b32 v176, 16, v176
    v_cvt_pk_bf16_f32 v177, v177, v177
    v_lshlrev_b32 v177, 16, v177
    v_cvt_pk_bf16_f32 v178, v178, v178
    v_lshlrev_b32 v178, 16, v178
    v_cvt_pk_bf16_f32 v179, v179, v179
    v_lshlrev_b32 v179, 16, v179
    v_cvt_pk_bf16_f32 v180, v180, v180
    v_lshlrev_b32 v180, 16, v180
    v_cvt_pk_bf16_f32 v181, v181, v181
    v_lshlrev_b32 v181, 16, v181
    v_cvt_pk_bf16_f32 v182, v182, v182
    v_lshlrev_b32 v182, 16, v182
    v_cvt_pk_bf16_f32 v183, v183, v183
    v_lshlrev_b32 v183, 16, v183
    v_mul_f32 v176, v176, v12
    v_mul_f32 v177, v177, v12
    v_mul_f32 v178, v178, v12
    v_mul_f32 v179, v179, v12
    v_mul_f32 v180, v180, v12
    v_mul_f32 v181, v181, v12
    v_mul_f32 v182, v182, v12
    v_mul_f32 v183, v183, v12
    v_cvt_pk_bf16_f32 v204, v176, v177
    v_cvt_pk_bf16_f32 v205, v178, v179
    v_cvt_pk_bf16_f32 v206, v180, v181
    v_cvt_pk_bf16_f32 v207, v182, v183
    s_add_u32 s33, s40, 229376
    buffer_store_dwordx4 v[204:207], v2, s[16:19], s33 offen sc1
    s_branch K2_IDLE
K2_POST:
    s_cmp_ge_u32 s20, 4
    s_cbranch_scc1 K2_IDLE
    s_sub_u32 s33, s22, 5
    s_cmp_lt_u32 s33, 2
    s_cbranch_scc1 K2_B2W
    s_cmp_gt_u32 s22, 4
    s_cbranch_scc1 K2_IDLE
    s_cmp_eq_u32 s22, 4
    s_cbranch_scc1 K2_WT4
    v_lshlrev_b32 v21, 7, v0
    s_lshl_b32 s33, s2, 15
    buffer_load_dword v20, v21, s[8:11], s33 offen
    s_branch K2_IDLE
K2_WT4:
    v_lshlrev_b32 v21, 6, v0
    s_and_b32 s33, s2, 31
    s_lshl_b32 s33, s33, 14
    buffer_load_dword v20, v21, s[12:15], s33 offen
K2_IDLE:
    s_add_u32 s25, s25, 1
    s_cmp_ge_u32 s25, s24
    s_cbranch_scc1 K2_DONE
    s_cmp_lg_u32 s42, 0
    s_cbranch_scc1 K2_W4
    s_waitcnt vmcnt(8)
    s_branch K2_W5
K2_W4:
    s_waitcnt vmcnt(4)
K2_W5:
    s_barrier
    s_cmp_lg_u32 s42, 0
    s_cbranch_scc1 K2_SGA
    s_waitcnt vmcnt(0)
    s_lshr_b32 s33, s31, 2
    s_lshl_b32 s33, s33, 8
    s_add_u32 s33, s33, 77594752
    v_mov_b32 v12, 0
    v_mov_b32 v13, 1
    s_mov_b64 exec, 1
    buffer_atomic_add v13, v12, s[16:19], s33 offen sc1
    s_cmp_eq_u32 s43, 0
    s_cbranch_scc1 K2_SHA
    s_mov_b32 s33, 77598848
    buffer_atomic_add v13, v12, s[16:19], s33 offen sc1
K2_SHA:
    s_mov_b64 exec, -1
    s_mov_b32 s42, 1
K2_SGA:
    s_add_u32 m0, s28, s32
    s_add_u32 s28, s28, 16384
    buffer_load_dwordx4 v11, s[16:19], s34 offen lds
    buffer_load_dwordx4 v11, s[16:19], s34 offen offset:1024 lds
    s_and_b32 s28, s28, 0xffff
    s_add_u32 s34, s34, 16384
    s_add_u32 m0, s29, s32
    s_add_u32 s29, s29, 16384
    buffer_load_dwordx4 v11, s[16:19], s35 offen lds
    buffer_load_dwordx4 v11, s[16:19], s35 offen offset:1024 lds
    s_cmp_eq_u32 s29, 114688
    s_cselect_b32 s29, 65536, s29
    s_add_u32 s35, s35, 16384
    s_branch K2_IDLE
K2_DONE:
    s_cmp_lg_u32 s42, 0
    s_cbranch_scc1 K2_SGB
    s_waitcnt vmcnt(0)
    s_lshr_b32 s33, s31, 2
    s_lshl_b32 s33, s33, 8
    s_add_u32 s33, s33, 77594752
    v_mov_b32 v12, 0
    v_mov_b32 v13, 1
    s_mov_b64 exec, 1
    buffer_atomic_add v13, v12, s[16:19], s33 offen sc1
    s_cmp_eq_u32 s43, 0
    s_cbranch_scc1 K2_SHB
    s_mov_b32 s33, 77598848
    buffer_atomic_add v13, v12, s[16:19], s33 offen sc1
K2_SHB:
    s_mov_b64 exec, -1
    s_mov_b32 s42, 1
K2_SGB:
    s_branch K3_ENTRY
K2_EXIT:
    s_endpgm
K3_ENTRY:
    v_lshrrev_b32 v1, 6, v0
    v_and_b32 v3, 63, v0
    v_readfirstlane_b32 s20, v1
    v_lshlrev_b32 v2, 4, v3
    s_bfe_u32 s23, s2, 0x20001
    s_and_b32 s30, s2, 1
    s_lshr_b32 s31, s2, 5
    s_lshl_b32 s31, s31, 1
    s_add_u32 s30, s30, s31
    s_sub_u32 s21, 15, s30
    s_bfe_u32 s22, s2, 0x20003
    s_lshl_b32 s24, s22, 4
    s_add_u32 s24, s24, s21
    s_lshl_b32 s25, s20, 11
    s_lshl_b32 s30, s21, 2
    s_lshr_b32 s31, s20, 1
    s_add_u32 s30, s30, s31
    s_and_b32 s31, s20, 1
    s_lshl_b32 s31, s31, 11
    s_lshl_b32 s32, s30, 18
    s_add_u32 s32, s32, s31
    s_mul_i32 s33, s23, 77824
    s_add_u32 s32, s32, s33
    s_add_u32 s26, s32, 50331648
    s_lshl_b32 s32, s30, 15
    s_add_u32 s32, s32, s31
    s_add_u32 s28, s32, 73400320
    s_lshl_b32 s29, s20, 13
    s_mul_i32 s33, s23, 1245184
    s_add_u32 s27, s33, s29
    v_lshrrev_b32 v14, 4, v3
    v_bfe_u32 v15, v3, 2, 2
    v_xor_b32 v16, v14, v15
    v_lshlrev_b32 v16, 6, v16
    v_lshl_add_u32 v16, v14, 10, v16
    v_and_b32 v17, 3, v3
    v_lshl_add_u32 v16, v17, 4, v16
    s_lshl_b32 s30, s22, 8
    v_add_u32 v4, s30, v16
    s_mov_b32 s64, s88
    s_and_b32 s65, s89, 0xffff
    s_mov_b32 s66, 2097152
    s_mov_b32 s67, 0x00020000
    s_mov_b32 s49, s26
    s_mov_b32 s50, s27
    s_cmp_eq_u32 s23, 3
    s_cselect_b32 s51, 7, 19
    s_mov_b32 s48, s21
    s_cmp_ge_u32 s48, s51
    s_cselect_b32 s30, s51, 0
    s_sub_u32 s48, s48, s30
    s_cmp_ge_u32 s48, s51
    s_cselect_b32 s30, s51, 0
    s_sub_u32 s48, s48, s30
    s_cmp_ge_u32 s48, s51
    s_cselect_b32 s30, s51, 0
    s_sub_u32 s48, s48, s30
    s_lshl_b32 s55, s21, 8
    s_add_u32 s55, s55, 77594752
    v_mov_b32 v22, 0
    v_mov_b32 v23, 0
    s_waitcnt vmcnt(0)
    s_cmp_lg_u32 s20, 0
    s_cbranch_scc1 K3_NP0
    s_mov_b64 exec, 1
    buffer_atomic_or v23, v22, s[16:19], s55 offen sc0 sc1
    s_mov_b64 exec, -1
K3_NP0:
    s_barrier
    s_lshl_b32 s30, s48, 12
    s_add_u32 s26, s49, s30
    s_lshl_b32 s30, s48, 16
    s_add_u32 s27, s50, s30
    s_add_u32 s48, s48, 1
    s_cmp_eq_u32 s48, s51
    s_cselect_b32 s48, 0, s48
    s_add_u32 s30, s27, 4096
    s_add_u32 m0, s25, 16384
    s_nop 0
    buffer_load_dwordx4 v4, s[8:11], s27 offen lds
    s_add_u32 m0, s25, 17408
    s_nop 0
    buffer_load_dwordx4 v4, s[8:11], s30 offen lds
    s_mov_b32 s52, s26
    s_lshl_b32 s30, s48, 12
    s_add_u32 s26, s49, s30
    s_lshl_b32 s30, s48, 16
    s_add_u32 s27, s50, s30
    s_add_u32 s48, s48, 1
    s_cmp_eq_u32 s48, s51
    s_cselect_b32 s48, 0, s48
    s_add_u32 s30, s27, 4096
    s_add_u32 m0, s25, 49152
    s_nop 0
    buffer_load_dwordx4 v4, s[8:11], s27 offen lds
    s_add_u32 m0, s25, 50176
    s_nop 0
    buffer_load_dwordx4 v4, s[8:11], s30 offen lds
    s_mov_b32 s53, s26
    s_lshl_b32 s30, s48, 12
    s_add_u32 s26, s49, s30
    s_lshl_b32 s30, s48, 16
    s_add_u32 s27, s50, s30
    s_add_u32 s48, s48, 1
    s_cmp_eq_u32 s48, s51
    s_cselect_b32 s48, 0, s48
    s_add_u32 s30, s27, 4096
    s_add_u32 m0, s25, 81920
    s_nop 0
    buffer_load_dwordx4 v4, s[8:11], s27 offen lds
    s_add_u32 m0, s25, 82944
    s_nop 0
    buffer_load_dwordx4 v4, s[8:11], s30 offen lds
    s_mov_b32 s54, s26
    s_cmp_lg_u32 s20, 0
    s_cbranch_scc1 K3_GO0
    s_mov_b32 s30, s55
    s_mov_b32 s31, 0
    s_mov_b32 s33, 128
    s_waitcnt vmcnt(6)
    s_branch K3_CHK0
K3_SPIN0:
    v_mov_b32 v23, 0
    s_mov_b64 exec, 1
    buffer_atomic_or v23, v22, s[16:19], s30 offen sc0 sc1
    s_mov_b64 exec, -1
    s_waitcnt vmcnt(0)
K3_CHK0:
    v_readfirstlane_b32 s32, v23
    s_cmp_ge_u32 s32, s33
    s_cbranch_scc1 K3_NX0
    s_sleep 4
    s_add_u32 s31, s31, 1
    s_cmp_lt_u32 s31, 0x40000
    s_cbranch_scc1 K3_SPIN0
K3_NX0:
    s_cmp_lg_u32 s23, 3
    s_cbranch_scc1 K3_GO0
    s_cmp_eq_u32 s33, 256
    s_cbranch_scc1 K3_GO0
    s_mov_b32 s33, 256
    s_mov_b32 s30, 77598848
    s_branch K3_SPIN0
K3_GO0:
    s_barrier
    s_add_u32 m0, s25, 0
    s_nop 0
    buffer_load_dwordx4 v2, s[16:19], s52 offen lds
    buffer_load_dwordx4 v2, s[16:19], s52 offen offset:1024 lds
    s_add_u32 m0, s25, 32768
    s_nop 0
    buffer_load_dwordx4 v2, s[16:19], s53 offen lds
    buffer_load_dwordx4 v2, s[16:19], s53 offen offset:1024 lds
    s_add_u32 m0, s25, 65536
    s_nop 0
    buffer_load_dwordx4 v2, s[16:19], s54 offen lds
    buffer_load_dwordx4 v2, s[16:19], s54 offen offset:1024 lds
    s_lshr_b32 s34, s20, 2
    s_bfe_u32 s35, s20, 0x10001
    s_and_b32 s36, s20, 1
    s_xor_b32 s30, s34, 0
    s_lshl_b32 s31, s35, 1
    s_add_u32 s30, s30, s31
    s_lshl_b32 s30, s30, 2
    s_lshl_b32 s31, s34, 1
    s_add_u32 s30, s30, s31
    s_lshl_b32 s30, s30, 10
    v_add_u32 v6, s30, v2
    v_add_u32 v7, 0x10000, v6
    s_xor_b32 s30, s34, 1
    s_lshl_b32 s31, s35, 1
    s_add_u32 s30, s30, s31
    s_lshl_b32 s30, s30, 2
    s_lshl_b32 s31, s34, 1
    s_add_u32 s30, s30, s31
    s_lshl_b32 s30, s30, 10
    v_add_u32 v8, s30, v2
    v_add_u32 v9, 0x10000, v8
    v_lshrrev_b32 v14, 5, v3
    v_lshl_add_u32 v14, v14, 2, v15
    v_lshlrev_b32 v14, 8, v14
    v_bfe_u32 v16, v3, 4, 1
    v_lshl_add_u32 v14, v16, 5, v14
    v_lshl_add_u32 v14, v17, 3, v14
    s_lshl_b32 s30, s34, 13
    s_add_u32 s30, s30, 16384
    v_add_u32 v14, s30, v14
    s_lshl_b32 s30, s36, 1
    s_add_u32 s30, s30, 0
    v_xor_b32 v16, s30, v15
    v_lshl_add_u32 v10, v16, 6, v14
    v_add_u32 v11, 0x10000, v10
    s_lshl_b32 s30, s36, 1
    s_add_u32 s30, s30, 1
    v_xor_b32 v16, s30, v15
    v_lshl_add_u32 v12, v16, 6, v14
    v_add_u32 v13, 0x10000, v12
    s_cmp_eq_u32 s23, 3
    s_cbranch_scc1 K3_FIN
    s_waitcnt vmcnt(4)
    s_barrier
    ds_read_b128 v[32:35], v6 offset:0
    ds_read_b128 v[36:39], v8 offset:0
    ds_read_b64_tr_b16 v[40:41], v10 offset:0
    ds_read_b64_tr_b16 v[42:43], v10 offset:2048
    ds_read_b64_tr_b16 v[44:45], v12 offset:0
    ds_read_b64_tr_b16 v[46:47], v12 offset:2048
    ds_read_b128 v[48:51], v6 offset:1024
    ds_read_b128 v[52:55], v8 offset:1024
    ds_read_b64_tr_b16 v[56:57], v10 offset:4096
    ds_read_b64_tr_b16 v[58:59], v10 offset:6144
    ds_read_b64_tr_b16 v[60:61], v12 offset:4096
    ds_read_b64_tr_b16 v[62:63], v12 offset:6144
    s_waitcnt lgkmcnt(6)
    v_mfma_f32_32x32x16_bf16 v[64:79], v[40:43], v[32:35], 0
    v_mfma_f32_32x32x16_bf16 v[80:95], v[44:47], v[32:35], 0
    s_lshl_b32 s30, s48, 12
    s_add_u32 s26, s49, s30
    s_lshl_b32 s30, s48, 16
    s_add_u32 s27, s50, s30
    s_add_u32 s48, s48, 1
    s_cmp_eq_u32 s48, s51
    s_cselect_b32 s48, 0, s48
    s_add_u32 m0, s25, 98304
    s_add_u32 s30, s27, 4096
    buffer_load_dwordx4 v2, s[16:19], s26 offen lds
    v_mfma_f32_32x32x16_bf16 v[96:111], v[40:43], v[36:39], 0
    v_mfma_f32_32x32x16_bf16 v[112:127], v[44:47], v[36:39], 0
    buffer_load_dwordx4 v2, s[16:19], s26 offen offset:1024 lds
    s_waitcnt lgkmcnt(0)
    v_mfma_f32_32x32x16_bf16 v[64:79], v[56:59], v[48:51], v[64:79]
    v_mfma_f32_32x32x16_bf16 v[80:95], v[60:63], v[48:51], v[80:95]
    s_add_u32 m0, s25, 114688
    s_nop 0
    buffer_load_dwordx4 v4, s[8:11], s27 offen lds
    v_mfma_f32_32x32x16_bf16 v[96:111], v[56:59], v[52:55], v[96:111]
    v_mfma_f32_32x32x16_bf16 v[112:127], v[60:63], v[52:55], v[112:127]
    s_add_u32 m0, s25, 115712
    s_nop 0
    buffer_load_dwordx4 v4, s[8:11], s30 offen lds
    s_waitcnt vmcnt(6)
    s_barrier
    ds_read_b128 v[32:35], v6 offset:32768
    ds_read_b128 v[36:39], v8 offset:32768
    ds_read_b64_tr_b16 v[40:41], v10 offset:32768
    ds_read_b64_tr_b16 v[42:43], v10 offset:34816
    ds_read_b64_tr_b16 v[44:45], v12 offset:32768
    ds_read_b64_tr_b16 v[46:47], v12 offset:34816
    ds_read_b128 v[48:51], v6 offset:33792
    ds_read_b128 v[52:55], v8 offset:33792
    ds_read_b64_tr_b16 v[56:57], v10 offset:36864
    ds_read_b64_tr_b16 v[58:59], v10 offset:38912
    ds_read_b64_tr_b16 v[60:61], v12 offset:36864
    ds_read_b64_tr_b16 v[62:63], v12 offset:38912
    s_waitcnt lgkmcnt(6)
    v_mfma_f32_32x32x16_bf16 v[64:79], v[40:43], v[32:35], v[64:79]
    v_mfma_f32_32x32x16_bf16 v[80:95], v[44:47], v[32:35], v[80:95]
    s_lshl_b32 s30, s48, 12
    s_add_u32 s26, s49, s30
    s_lshl_b32 s30, s48, 16
    s_add_u32 s27, s50, s30
    s_add_u32 s48, s48, 1
    s_cmp_eq_u32 s48, s51
    s_cselect_b32 s48, 0, s48
    s_add_u32 m0, s25, 0
    s_add_u32 s30, s27, 4096
    buffer_load_dwordx4 v2, s[16:19], s26 offen lds
    v_mfma_f32_32x32x16_bf16 v[96:111], v[40:43], v[36:39], v[96:111]
    v_mfma_f32_32x32x16_bf16 v[112:127], v[44:47], v[36:39], v[112:127]
    buffer_load_dwordx4 v2, s[16:19], s26 offen offset:1024 lds
    s_waitcnt lgkmcnt(0)
    v_mfma_f32_32x32x16_bf16 v[64:79], v[56:59], v[48:51], v[64:79]
    v_mfma_f32_32x32x16_bf16 v[80:95], v[60:63], v[48:51], v[80:95]
    s_add_u32 m0, s25, 16384
    s_nop 0
    buffer_load_dwordx4 v4, s[8:11], s27 offen lds
    v_mfma_f32_32x32x16_bf16 v[96:111], v[56:59], v[52:55], v[96:111]
    v_mfma_f32_32x32x16_bf16 v[112:127], v[60:63], v[52:55], v[112:127]
    s_add_u32 m0, s25, 17408
    s_nop 0
    buffer_load_dwordx4 v4, s[8:11], s30 offen lds
    s_waitcnt vmcnt(8)
    s_barrier
    ds_read_b128 v[32:35], v7 offset:0
    ds_read_b128 v[36:39], v9 offset:0
    ds_read_b64_tr_b16 v[40:41], v11 offset:0
    ds_read_b64_tr_b16 v[42:43], v11 offset:2048
    ds_read_b64_tr_b16 v[44:45], v13 offset:0
    ds_read_b64_tr_b16 v[46:47], v13 offset:2048
    ds_read_b128 v[48:51], v7 offset:1024
    ds_read_b128 v[52:55], v9 offset:1024
    ds_read_b64_tr_b16 v[56:57], v11 offset:4096
    ds_read_b64_tr_b16 v[58:59], v11 offset:6144
    ds_read_b64_tr_b16 v[60:61], v13 offset:4096
    ds_read_b64_tr_b16 v[62:63], v13 offset:6144
    s_waitcnt lgkmcnt(6)
    v_mfma_f32_32x32x16_bf16 v[64:79], v[40:43], v[32:35], v[64:79]
    v_mfma_f32_32x32x16_bf16 v[80:95], v[44:47], v[32:35], v[80:95]
    s_lshl_b32 s30, s48, 12
    s_add_u32 s26, s49, s30
    s_lshl_b32 s30, s48, 16
    s_add_u32 s27, s50, s30
    s_add_u32 s48, s48, 1
    s_cmp_eq_u32 s48, s51
    s_cselect_b32 s48, 0, s48
    s_add_u32 m0, s25, 32768
    s_add_u32 s30, s27, 4096
    buffer_load_dwordx4 v2, s[16:19], s26 offen lds
    v_mfma_f32_32x32x16_bf16 v[96:111], v[40:43], v[36:39], v[96:111]
    v_mfma_f32_32x32x16_bf16 v[112:127], v[44:47], v[36:39], v[112:127]
    buffer_load_dwordx4 v2, s[16:19], s26 offen offset:1024 lds
    s_waitcnt lgkmcnt(0)
    v_mfma_f32_32x32x16_bf16 v[64:79], v[56:59], v[48:51], v[64:79]
    v_mfma_f32_32x32x16_bf16 v[80:95], v[60:63], v[48:51], v[80:95]
    s_add_u32 m0, s25, 49152
    s_nop 0
    buffer_load_dwordx4 v4, s[8:11], s27 offen lds
    v_mfma_f32_32x32x16_bf16 v[96:111], v[56:59], v[52:55], v[96:111]
    v_mfma_f32_32x32x16_bf16 v[112:127], v[60:63], v[52:55], v[112:127]
    s_add_u32 m0, s25, 50176
    s_nop 0
    buffer_load_dwordx4 v4, s[8:11], s30 offen lds
    s_waitcnt vmcnt(8)
    s_barrier
    ds_read_b128 v[32:35], v7 offset:32768
    ds_read_b128 v[36:39], v9 offset:32768
    ds_read_b64_tr_b16 v[40:41], v11 offset:32768
    ds_read_b64_tr_b16 v[42:43], v11 offset:34816
    ds_read_b64_tr_b16 v[44:45], v13 offset:32768
    ds_read_b64_tr_b16 v[46:47], v13 offset:34816
    ds_read_b128 v[48:51], v7 offset:33792
    ds_read_b128 v[52:55], v9 offset:33792
    ds_read_b64_tr_b16 v[56:57], v11 offset:36864
    ds_read_b64_tr_b16 v[58:59], v11 offset:38912
    ds_read_b64_tr_b16 v[60:61], v13 offset:36864
    ds_read_b64_tr_b16 v[62:63], v13 offset:38912
    s_waitcnt lgkmcnt(6)
    v_mfma_f32_32x32x16_bf16 v[64:79], v[40:43], v[32:35], v[64:79]
    v_mfma_f32_32x32x16_bf16 v[80:95], v[44:47], v[32:35], v[80:95]
    s_lshl_b32 s30, s48, 12
    s_add_u32 s26, s49, s30
    s_lshl_b32 s30, s48, 16
    s_add_u32 s27, s50, s30
    s_add_u32 s48, s48, 1
    s_cmp_eq_u32 s48, s51
    s_cselect_b32 s48, 0, s48
    s_add_u32 m0, s25, 65536
    s_add_u32 s30, s27, 4096
    buffer_load_dwordx4 v2, s[16:19], s26 offen lds
    v_mfma_f32_32x32x16_bf16 v[96:111], v[40:43], v[36:39], v[96:111]
    v_mfma_f32_32x32x16_bf16 v[112:127], v[44:47], v[36:39], v[112:127]
    buffer_load_dwordx4 v2, s[16:19], s26 offen offset:1024 lds
    s_waitcnt lgkmcnt(0)
    v_mfma_f32_32x32x16_bf16 v[64:79], v[56:59], v[48:51], v[64:79]
    v_mfma_f32_32x32x16_bf16 v[80:95], v[60:63], v[48:51], v[80:95]
    s_add_u32 m0, s25, 81920
    s_nop 0
    buffer_load_dwordx4 v4, s[8:11], s27 offen lds
    v_mfma_f32_32x32x16_bf16 v[96:111], v[56:59], v[52:55], v[96:111]
    v_mfma_f32_32x32x16_bf16 v[112:127], v[60:63], v[52:55], v[112:127]
    s_add_u32 m0, s25, 82944
    s_nop 0
    buffer_load_dwordx4 v4, s[8:11], s30 offen lds
    s_waitcnt vmcnt(8)
    s_barrier
    ds_read_b128 v[32:35], v6 offset:0
    ds_read_b128 v[36:39], v8 offset:0
    ds_read_b64_tr_b16 v[40:41], v10 offset:0
    ds_read_b64_tr_b16 v[42:43], v10 offset:2048
    ds_read_b64_tr_b16 v[44:45], v12 offset:0
    ds_read_b64_tr_b16 v[46:47], v12 offset:2048
    ds_read_b128 v[48:51], v6 offset:1024
    ds_read_b128 v[52:55], v8 offset:1024
    ds_read_b64_tr_b16 v[56:57], v10 offset:4096
    ds_read_b64_tr_b16 v[58:59], v10 offset:6144
    ds_read_b64_tr_b16 v[60:61], v12 offset:4096
    ds_read_b64_tr_b16 v[62:63], v12 offset:6144
    s_waitcnt lgkmcnt(6)
    v_mfma_f32_32x32x16_bf16 v[64:79], v[40:43], v[32:35], v[64:79]
    v_mfma_f32_32x32x16_bf16 v[80:95], v[44:47], v[32:35], v[80:95]
    s_lshl_b32 s30, s48, 12
    s_add_u32 s26, s49, s30
    s_lshl_b32 s30, s48, 16
    s_add_u32 s27, s50, s30
    s_add_u32 s48, s48, 1
    s_cmp_eq_u32 s48, s51
    s_cselect_b32 s48, 0, s48
    s_add_u32 m0, s25, 98304
    s_add_u32 s30, s27, 4096
    buffer_load_dwordx4 v2, s[16:19], s26 offen lds
    v_mfma_f32_32x32x16_bf16 v[96:111], v[40:43], v[36:39], v[96:111]
    v_mfma_f32_32x32x16_bf16 v[112:127], v[44:47], v[36:39], v[112:127]
    buffer_load_dwordx4 v2, s[16:19], s26 offen offset:1024 lds
    s_waitcnt lgkmcnt(0)
    v_mfma_f32_32x32x16_bf16 v[64:79], v[56:59], v[48:51], v[64:79]
    v_mfma_f32_32x32x16_bf16 v[80:95], v[60:63], v[48:51], v[80:95]
    s_add_u32 m0, s25, 114688
    s_nop 0
    buffer_load_dwordx4 v4, s[8:11], s27 offen lds
    v_mfma_f32_32x32x16_bf16 v[96:111], v[56:59], v[52:55], v[96:111]
    v_mfma_f32_32x32x16_bf16 v[112:127], v[60:63], v[52:55], v[112:127]
    s_add_u32 m0, s25, 115712
    s_nop 0
    buffer_load_dwordx4 v4, s[8:11], s30 offen lds
    s_waitcnt vmcnt(8)
    s_barrier
    ds_read_b128 v[32:35], v6 offset:32768
    ds_read_b128 v[36:39], v8 offset:32768
    ds_read_b64_tr_b16 v[40:41], v10 offset:32768
    ds_read_b64_tr_b16 v[42:43], v10 offset:34816
    ds_read_b64_tr_b16 v[44:45], v12 offset:32768
    ds_read_b64_tr_b16 v[46:47], v12 offset:34816
    ds_read_b128 v[48:51], v6 offset:33792
    ds_read_b128 v[52:55], v8 offset:33792
    ds_read_b64_tr_b16 v[56:57], v10 offset:36864
    ds_read_b64_tr_b16 v[58:59], v10 offset:38912
    ds_read_b64_tr_b16 v[60:61], v12 offset:36864
    ds_read_b64_tr_b16 v[62:63], v12 offset:38912
    s_waitcnt lgkmcnt(6)
    v_mfma_f32_32x32x16_bf16 v[64:79], v[40:43], v[32:35], v[64:79]
    v_mfma_f32_32x32x16_bf16 v[80:95], v[44:47], v[32:35], v[80:95]
    s_lshl_b32 s30, s48, 12
    s_add_u32 s26, s49, s30
    s_lshl_b32 s30, s48, 16
    s_add_u32 s27, s50, s30
    s_add_u32 s48, s48, 1
    s_cmp_eq_u32 s48, s51
    s_cselect_b32 s48, 0, s48
    s_add_u32 m0, s25, 0
    s_add_u32 s30, s27, 4096
    buffer_load_dwordx4 v2, s[16:19], s26 offen lds
    v_mfma_f32_32x32x16_bf16 v[96:111], v[40:43], v[36:39], v[96:111]
    v_mfma_f32_32x32x16_bf16 v[112:127], v[44:47], v[36:39], v[112:127]
    buffer_load_dwordx4 v2, s[16:19], s26 offen offset:1024 lds
    s_waitcnt lgkmcnt(0)
    v_mfma_f32_32x32x16_bf16 v[64:79], v[56:59], v[48:51], v[64:79]
    v_mfma_f32_32x32x16_bf16 v[80:95], v[60:63], v[48:51], v[80:95]
    s_add_u32 m0, s25, 16384
    s_nop 0
    buffer_load_dwordx4 v4, s[8:11], s27 offen lds
    v_mfma_f32_32x32x16_bf16 v[96:111], v[56:59], v[52:55], v[96:111]
    v_mfma_f32_32x32x16_bf16 v[112:127], v[60:63], v[52:55], v[112:127]
    s_add_u32 m0, s25, 17408
    s_nop 0
    buffer_load_dwordx4 v4, s[8:11], s30 offen lds
    s_waitcnt vmcnt(8)
    s_barrier
    ds_read_b128 v[32:35], v7 offset:0
    ds_read_b128 v[36:39], v9 offset:0
    ds_read_b64_tr_b16 v[40:41], v11 offset:0
    ds_read_b64_tr_b16 v[42:43], v11 offset:2048
    ds_read_b64_tr_b16 v[44:45], v13 offset:0
    ds_read_b64_tr_b16 v[46:47], v13 offset:2048
    ds_read_b128 v[48:51], v7 offset:1024
    ds_read_b128 v[52:55], v9 offset:1024
    ds_read_b64_tr_b16 v[56:57], v11 offset:4096
    ds_read_b64_tr_b16 v[58:59], v11 offset:6144
    ds_read_b64_tr_b16 v[60:61], v13 offset:4096
    ds_read_b64_tr_b16 v[62:63], v13 offset:6144
    s_waitcnt lgkmcnt(6)
    v_mfma_f32_32x32x16_bf16 v[64:79], v[40:43], v[32:35], v[64:79]
    v_mfma_f32_32x32x16_bf16 v[80:95], v[44:47], v[32:35], v[80:95]
    s_lshl_b32 s30, s48, 12
    s_add_u32 s26, s49, s30
    s_lshl_b32 s30, s48, 16
    s_add_u32 s27, s50, s30
    s_add_u32 s48, s48, 1
    s_cmp_eq_u32 s48, s51
    s_cselect_b32 s48, 0, s48
    s_add_u32 m0, s25, 32768
    s_add_u32 s30, s27, 4096
    buffer_load_dwordx4 v2, s[16:19], s26 offen lds
    v_mfma_f32_32x32x16_bf16 v[96:111], v[40:43], v[36:39], v[96:111]
    v_mfma_f32_32x32x16_bf16 v[112:127], v[44:47], v[36:39], v[112:127]
    buffer_load_dwordx4 v2, s[16:19], s26 offen offset:1024 lds
    s_waitcnt lgkmcnt(0)
    v_mfma_f32_32x32x16_bf16 v[64:79], v[56:59], v[48:51], v[64:79]
    v_mfma_f32_32x32x16_bf16 v[80:95], v[60:63], v[48:51], v[80:95]
    s_add_u32 m0, s25, 49152
    s_nop 0
    buffer_load_dwordx4 v4, s[8:11], s27 offen lds
    v_mfma_f32_32x32x16_bf16 v[96:111], v[56:59], v[52:55], v[96:111]
    v_mfma_f32_32x32x16_bf16 v[112:127], v[60:63], v[52:55], v[112:127]
    s_add_u32 m0, s25, 50176
    s_nop 0
    buffer_load_dwordx4 v4, s[8:11], s30 offen lds
    s_waitcnt vmcnt(8)
    s_barrier
    ds_read_b128 v[32:35], v7 offset:32768
    ds_read_b128 v[36:39], v9 offset:32768
    ds_read_b64_tr_b16 v[40:41], v11 offset:32768
    ds_read_b64_tr_b16 v[42:43], v11 offset:34816
    ds_read_b64_tr_b16 v[44:45], v13 offset:32768
    ds_read_b64_tr_b16 v[46:47], v13 offset:34816
    ds_read_b128 v[48:51], v7 offset:33792
    ds_read_b128 v[52:55], v9 offset:33792
    ds_read_b64_tr_b16 v[56:57], v11 offset:36864
    ds_read_b64_tr_b16 v[58:59], v11 offset:38912
    ds_read_b64_tr_b16 v[60:61], v13 offset:36864
    ds_read_b64_tr_b16 v[62:63], v13 offset:38912
    s_waitcnt lgkmcnt(6)
    v_mfma_f32_32x32x16_bf16 v[64:79], v[40:43], v[32:35], v[64:79]
    v_mfma_f32_32x32x16_bf16 v[80:95], v[44:47], v[32:35], v[80:95]
    s_lshl_b32 s30, s48, 12
    s_add_u32 s26, s49, s30
    s_lshl_b32 s30, s48, 16
    s_add_u32 s27, s50, s30
    s_add_u32 s48, s48, 1
    s_cmp_eq_u32 s48, s51
    s_cselect_b32 s48, 0, s48
    s_add_u32 m0, s25, 65536
    s_add_u32 s30, s27, 4096
    buffer_load_dwordx4 v2, s[16:19], s26 offen lds
    v_mfma_f32_32x32x16_bf16 v[96:111], v[40:43], v[36:39], v[96:111]
    v_mfma_f32_32x32x16_bf16 v[112:127], v[44:47], v[36:39], v[112:127]
    buffer_load_dwordx4 v2, s[16:19], s26 offen offset:1024 lds
    s_waitcnt lgkmcnt(0)
    v_mfma_f32_32x32x16_bf16 v[64:79], v[56:59], v[48:51], v[64:79]
    v_mfma_f32_32x32x16_bf16 v[80:95], v[60:63], v[48:51], v[80:95]
    s_add_u32 m0, s25, 81920
    s_nop 0
    buffer_load_dwordx4 v4, s[8:11], s27 offen lds
    v_mfma_f32_32x32x16_bf16 v[96:111], v[56:59], v[52:55], v[96:111]
    v_mfma_f32_32x32x16_bf16 v[112:127], v[60:63], v[52:55], v[112:127]
    s_add_u32 m0, s25, 82944
    s_nop 0
    buffer_load_dwordx4 v4, s[8:11], s30 offen lds
    s_waitcnt vmcnt(8)
    s_barrier
    ds_read_b128 v[32:35], v6 offset:0
    ds_read_b128 v[36:39], v8 offset:0
    ds_read_b64_tr_b16 v[40:41], v10 offset:0
    ds_read_b64_tr_b16 v[42:43], v10 offset:2048
    ds_read_b64_tr_b16 v[44:45], v12 offset:0
    ds_read_b64_tr_b16 v[46:47], v12 offset:2048
    ds_read_b128 v[48:51], v6 offset:1024
    ds_read_b128 v[52:55], v8 offset:1024
    ds_read_b64_tr_b16 v[56:57], v10 offset:4096
    ds_read_b64_tr_b16 v[58:59], v10 offset:6144
    ds_read_b64_tr_b16 v[60:61], v12 offset:4096
    ds_read_b64_tr_b16 v[62:63], v12 offset:6144
    s_waitcnt lgkmcnt(6)
    v_mfma_f32_32x32x16_bf16 v[64:79], v[40:43], v[32:35], v[64:79]
    v_mfma_f32_32x32x16_bf16 v[80:95], v[44:47], v[32:35], v[80:95]
    s_lshl_b32 s30, s48, 12
    s_add_u32 s26, s49, s30
    s_lshl_b32 s30, s48, 16
    s_add_u32 s27, s50, s30
    s_add_u32 s48, s48, 1
    s_cmp_eq_u32 s48, s51
    s_cselect_b32 s48, 0, s48
    s_add_u32 m0, s25, 98304
    s_add_u32 s30, s27, 4096
    buffer_load_dwordx4 v2, s[16:19], s26 offen lds
    v_mfma_f32_32x32x16_bf16 v[96:111], v[40:43], v[36:39], v[96:111]
    v_mfma_f32_32x32x16_bf16 v[112:127], v[44:47], v[36:39], v[112:127]
    buffer_load_dwordx4 v2, s[16:19], s26 offen offset:1024 lds
    s_waitcnt lgkmcnt(0)
    v_mfma_f32_32x32x16_bf16 v[64:79], v[56:59], v[48:51], v[64:79]
    v_mfma_f32_32x32x16_bf16 v[80:95], v[60:63], v[48:51], v[80:95]
    s_add_u32 m0, s25, 114688
    s_nop 0
    buffer_load_dwordx4 v4, s[8:11], s27 offen lds
    v_mfma_f32_32x32x16_bf16 v[96:111], v[56:59], v[52:55], v[96:111]
    v_mfma_f32_32x32x16_bf16 v[112:127], v[60:63], v[52:55], v[112:127]
    s_add_u32 m0, s25, 115712
    s_nop 0
    buffer_load_dwordx4 v4, s[8:11], s30 offen lds
    s_waitcnt vmcnt(8)
    s_barrier
    ds_read_b128 v[32:35], v6 offset:32768
    ds_read_b128 v[36:39], v8 offset:32768
    ds_read_b64_tr_b16 v[40:41], v10 offset:32768
    ds_read_b64_tr_b16 v[42:43], v10 offset:34816
    ds_read_b64_tr_b16 v[44:45], v12 offset:32768
    ds_read_b64_tr_b16 v[46:47], v12 offset:34816
    ds_read_b128 v[48:51], v6 offset:33792
    ds_read_b128 v[52:55], v8 offset:33792
    ds_read_b64_tr_b16 v[56:57], v10 offset:36864
    ds_read_b64_tr_b16 v[58:59], v10 offset:38912
    ds_read_b64_tr_b16 v[60:61], v12 offset:36864
    ds_read_b64_tr_b16 v[62:63], v12 offset:38912
    s_waitcnt lgkmcnt(6)
    v_mfma_f32_32x32x16_bf16 v[64:79], v[40:43], v[32:35], v[64:79]
    v_mfma_f32_32x32x16_bf16 v[80:95], v[44:47], v[32:35], v[80:95]
    s_lshl_b32 s30, s48, 12
    s_add_u32 s26, s49, s30
    s_lshl_b32 s30, s48, 16
    s_add_u32 s27, s50, s30
    s_add_u32 s48, s48, 1
    s_cmp_eq_u32 s48, s51
    s_cselect_b32 s48, 0, s48
    s_add_u32 m0, s25, 0
    s_add_u32 s30, s27, 4096
    buffer_load_dwordx4 v2, s[16:19], s26 offen lds
    v_mfma_f32_32x32x16_bf16 v[96:111], v[40:43], v[36:39], v[96:111]
    v_mfma_f32_32x32x16_bf16 v[112:127], v[44:47], v[36:39], v[112:127]
    buffer_load_dwordx4 v2, s[16:19], s26 offen offset:1024 lds
    s_waitcnt lgkmcnt(0)
    v_mfma_f32_32x32x16_bf16 v[64:79], v[56:59], v[48:51], v[64:79]
    v_mfma_f32_32x32x16_bf16 v[80:95], v[60:63], v[48:51], v[80:95]
    s_add_u32 m0, s25, 16384
    s_nop 0
    buffer_load_dwordx4 v4, s[8:11], s27 offen lds
    v_mfma_f32_32x32x16_bf16 v[96:111], v[56:59], v[52:55], v[96:111]
    v_mfma_f32_32x32x16_bf16 v[112:127], v[60:63], v[52:55], v[112:127]
    s_add_u32 m0, s25, 17408
    s_nop 0
    buffer_load_dwordx4 v4, s[8:11], s30 offen lds
    s_waitcnt vmcnt(8)
    s_barrier
    ds_read_b128 v[32:35], v7 offset:0
    ds_read_b128 v[36:39], v9 offset:0
    ds_read_b64_tr_b16 v[40:41], v11 offset:0
    ds_read_b64_tr_b16 v[42:43], v11 offset:2048
    ds_read_b64_tr_b16 v[44:45], v13 offset:0
    ds_read_b64_tr_b16 v[46:47], v13 offset:2048
    ds_read_b128 v[48:51], v7 offset:1024
    ds_read_b128 v[52:55], v9 offset:1024
    ds_read_b64_tr_b16 v[56:57], v11 offset:4096
    ds_read_b64_tr_b16 v[58:59], v11 offset:6144
    ds_read_b64_tr_b16 v[60:61], v13 offset:4096
    ds_read_b64_tr_b16 v[62:63], v13 offset:6144
    s_waitcnt lgkmcnt(6)
    v_mfma_f32_32x32x16_bf16 v[64:79], v[40:43], v[32:35], v[64:79]
    v_mfma_f32_32x32x16_bf16 v[80:95], v[44:47], v[32:35], v[80:95]
    s_lshl_b32 s30, s48, 12
    s_add_u32 s26, s49, s30
    s_lshl_b32 s30, s48, 16
    s_add_u32 s27, s50, s30
    s_add_u32 s48, s48, 1
    s_cmp_eq_u32 s48, s51
    s_cselect_b32 s48, 0, s48
    s_add_u32 m0, s25, 32768
    s_add_u32 s30, s27, 4096
    buffer_load_dwordx4 v2, s[16:19], s26 offen lds
    v_mfma_f32_32x32x16_bf16 v[96:111], v[40:43], v[36:39], v[96:111]
    v_mfma_f32_32x32x16_bf16 v[112:127], v[44:47], v[36:39], v[112:127]
    buffer_load_dwordx4 v2, s[16:19], s26 offen offset:1024 lds
    s_waitcnt lgkmcnt(0)
    v_mfma_f32_32x32x16_bf16 v[64:79], v[56:59], v[48:51], v[64:79]
    v_mfma_f32_32x32x16_bf16 v[80:95], v[60:63], v[48:51], v[80:95]
    s_add_u32 m0, s25, 49152
    s_nop 0
    buffer_load_dwordx4 v4, s[8:11], s27 offen lds
    v_mfma_f32_32x32x16_bf16 v[96:111], v[56:59], v[52:55], v[96:111]
    v_mfma_f32_32x32x16_bf16 v[112:127], v[60:63], v[52:55], v[112:127]
    s_add_u32 m0, s25, 50176
    s_nop 0
    buffer_load_dwordx4 v4, s[8:11], s30 offen lds
    s_waitcnt vmcnt(8)
    s_barrier
    ds_read_b128 v[32:35], v7 offset:32768
    ds_read_b128 v[36:39], v9 offset:32768
    ds_read_b64_tr_b16 v[40:41], v11 offset:32768
    ds_read_b64_tr_b16 v[42:43], v11 offset:34816
    ds_read_b64_tr_b16 v[44:45], v13 offset:32768
    ds_read_b64_tr_b16 v[46:47], v13 offset:34816
    ds_read_b128 v[48:51], v7 offset:33792
    ds_read_b128 v[52:55], v9 offset:33792
    ds_read_b64_tr_b16 v[56:57], v11 offset:36864
    ds_read_b64_tr_b16 v[58:59], v11 offset:38912
    ds_read_b64_tr_b16 v[60:61], v13 offset:36864
    ds_read_b64_tr_b16 v[62:63], v13 offset:38912
    s_waitcnt lgkmcnt(6)
    v_mfma_f32_32x32x16_bf16 v[64:79], v[40:43], v[32:35], v[64:79]
    v_mfma_f32_32x32x16_bf16 v[80:95], v[44:47], v[32:35], v[80:95]
    s_lshl_b32 s30, s48, 12
    s_add_u32 s26, s49, s30
    s_lshl_b32 s30, s48, 16
    s_add_u32 s27, s50, s30
    s_add_u32 s48, s48, 1
    s_cmp_eq_u32 s48, s51
    s_cselect_b32 s48, 0, s48
    s_add_u32 m0, s25, 65536
    s_add_u32 s30, s27, 4096
    buffer_load_dwordx4 v2, s[16:19], s26 offen lds
    v_mfma_f32_32x32x16_bf16 v[96:111], v[40:43], v[36:39], v[96:111]
    v_mfma_f32_32x32x16_bf16 v[112:127], v[44:47], v[36:39], v[112:127]
    buffer_load_dwordx4 v2, s[16:19], s26 offen offset:1024 lds
    s_waitcnt lgkmcnt(0)
    v_mfma_f32_32x32x16_bf16 v[64:79], v[56:59], v[48:51], v[64:79]
    v_mfma_f32_32x32x16_bf16 v[80:95], v[60:63], v[48:51], v[80:95]
    s_add_u32 m0, s25, 81920
    s_nop 0
    buffer_load_dwordx4 v4, s[8:11], s27 offen lds
    v_mfma_f32_32x32x16_bf16 v[96:111], v[56:59], v[52:55], v[96:111]
    v_mfma_f32_32x32x16_bf16 v[112:127], v[60:63], v[52:55], v[112:127]
    s_add_u32 m0, s25, 82944
    s_nop 0
    buffer_load_dwordx4 v4, s[8:11], s30 offen lds
    s_waitcnt vmcnt(8)
    s_barrier
    ds_read_b128 v[32:35], v6 offset:0
    ds_read_b128 v[36:39], v8 offset:0
    ds_read_b64_tr_b16 v[40:41], v10 offset:0
    ds_read_b64_tr_b16 v[42:43], v10 offset:2048
    ds_read_b64_tr_b16 v[44:45], v12 offset:0
    ds_read_b64_tr_b16 v[46:47], v12 offset:2048
    ds_read_b128 v[48:51], v6 offset:1024
    ds_read_b128 v[52:55], v8 offset:1024
    ds_read_b64_tr_b16 v[56:57], v10 offset:4096
    ds_read_b64_tr_b16 v[58:59], v10 offset:6144
    ds_read_b64_tr_b16 v[60:61], v12 offset:4096
    ds_read_b64_tr_b16 v[62:63], v12 offset:6144
    s_waitcnt lgkmcnt(6)
    v_mfma_f32_32x32x16_bf16 v[64:79], v[40:43], v[32:35], v[64:79]
    v_mfma_f32_32x32x16_bf16 v[80:95], v[44:47], v[32:35], v[80:95]
    s_lshl_b32 s30, s48, 12
    s_add_u32 s26, s49, s30
    s_lshl_b32 s30, s48, 16
    s_add_u32 s27, s50, s30
    s_add_u32 s48, s48, 1
    s_cmp_eq_u32 s48, s51
    s_cselect_b32 s48, 0, s48
    s_add_u32 m0, s25, 98304
    s_add_u32 s30, s27, 4096
    buffer_load_dwordx4 v2, s[16:19], s26 offen lds
    v_mfma_f32_32x32x16_bf16 v[96:111], v[40:43], v[36:39], v[96:111]
    v_mfma_f32_32x32x16_bf16 v[112:127], v[44:47], v[36:39], v[112:127]
    buffer_load_dwordx4 v2, s[16:19], s26 offen offset:1024 lds
    s_waitcnt lgkmcnt(0)
    v_mfma_f32_32x32x16_bf16 v[64:79], v[56:59], v[48:51], v[64:79]
    v_mfma_f32_32x32x16_bf16 v[80:95], v[60:63], v[48:51], v[80:95]
    s_add_u32 m0, s25, 114688
    s_nop 0
    buffer_load_dwordx4 v4, s[8:11], s27 offen lds
    v_mfma_f32_32x32x16_bf16 v[96:111], v[56:59], v[52:55], v[96:111]
    v_mfma_f32_32x32x16_bf16 v[112:127], v[60:63], v[52:55], v[112:127]
    s_add_u32 m0, s25, 115712
    s_nop 0
    buffer_load_dwordx4 v4, s[8:11], s30 offen lds
    s_waitcnt vmcnt(8)
    s_barrier
    ds_read_b128 v[32:35], v6 offset:32768
    ds_read_b128 v[36:39], v8 offset:32768
    ds_read_b64_tr_b16 v[40:41], v10 offset:32768
    ds_read_b64_tr_b16 v[42:43], v10 offset:34816
    ds_read_b64_tr_b16 v[44:45], v12 offset:32768
    ds_read_b64_tr_b16 v[46:47], v12 offset:34816
    ds_read_b128 v[48:51], v6 offset:33792
    ds_read_b128 v[52:55], v8 offset:33792
    ds_read_b64_tr_b16 v[56:57], v10 offset:36864
    ds_read_b64_tr_b16 v[58:59], v10 offset:38912
    ds_read_b64_tr_b16 v[60:61], v12 offset:36864
    ds_read_b64_tr_b16 v[62:63], v12 offset:38912
    s_waitcnt lgkmcnt(6)
    v_mfma_f32_32x32x16_bf16 v[64:79], v[40:43], v[32:35], v[64:79]
    v_mfma_f32_32x32x16_bf16 v[80:95], v[44:47], v[32:35], v[80:95]
    s_lshl_b32 s30, s48, 12
    s_add_u32 s26, s49, s30
    s_lshl_b32 s30, s48, 16
    s_add_u32 s27, s50, s30
    s_add_u32 s48, s48, 1
    s_cmp_eq_u32 s48, s51
    s_cselect_b32 s48, 0, s48
    s_add_u32 m0, s25, 0
    s_add_u32 s30, s27, 4096
    buffer_load_dwordx4 v2, s[16:19], s26 offen lds
    v_mfma_f32_32x32x16_bf16 v[96:111], v[40:43], v[36:39], v[96:111]
    v_mfma_f32_32x32x16_bf16 v[112:127], v[44:47], v[36:39], v[112:127]
    buffer_load_dwordx4 v2, s[16:19], s26 offen offset:1024 lds
    s_waitcnt lgkmcnt(0)
    v_mfma_f32_32x32x16_bf16 v[64:79], v[56:59], v[48:51], v[64:79]
    v_mfma_f32_32x32x16_bf16 v[80:95], v[60:63], v[48:51], v[80:95]
    s_add_u32 m0, s25, 16384
    s_nop 0
    buffer_load_dwordx4 v4, s[8:11], s27 offen lds
    v_mfma_f32_32x32x16_bf16 v[96:111], v[56:59], v[52:55], v[96:111]
    v_mfma_f32_32x32x16_bf16 v[112:127], v[60:63], v[52:55], v[112:127]
    s_add_u32 m0, s25, 17408
    s_nop 0
    buffer_load_dwordx4 v4, s[8:11], s30 offen lds
    s_waitcnt vmcnt(8)
    s_barrier
    ds_read_b128 v[32:35], v7 offset:0
    ds_read_b128 v[36:39], v9 offset:0
    ds_read_b64_tr_b16 v[40:41], v11 offset:0
    ds_read_b64_tr_b16 v[42:43], v11 offset:2048
    ds_read_b64_tr_b16 v[44:45], v13 offset:0
    ds_read_b64_tr_b16 v[46:47], v13 offset:2048
    ds_read_b128 v[48:51], v7 offset:1024
    ds_read_b128 v[52:55], v9 offset:1024
    ds_read_b64_tr_b16 v[56:57], v11 offset:4096
    ds_read_b64_tr_b16 v[58:59], v11 offset:6144
    ds_read_b64_tr_b16 v[60:61], v13 offset:4096
    ds_read_b64_tr_b16 v[62:63], v13 offset:6144
    s_waitcnt lgkmcnt(6)
    v_mfma_f32_32x32x16_bf16 v[64:79], v[40:43], v[32:35], v[64:79]
    v_mfma_f32_32x32x16_bf16 v[80:95], v[44:47], v[32:35], v[80:95]
    s_lshl_b32 s30, s48, 12
    s_add_u32 s26, s49, s30
    s_lshl_b32 s30, s48, 16
    s_add_u32 s27, s50, s30
    s_add_u32 s48, s48, 1
    s_cmp_eq_u32 s48, s51
    s_cselect_b32 s48, 0, s48
    s_add_u32 m0, s25, 32768
    s_add_u32 s30, s27, 4096
    buffer_load_dwordx4 v2, s[16:19], s26 offen lds
    v_mfma_f32_32x32x16_bf16 v[96:111], v[40:43], v[36:39], v[96:111]
    v_mfma_f32_32x32x16_bf16 v[112:127], v[44:47], v[36:39], v[112:127]
    buffer_load_dwordx4 v2, s[16:19], s26 offen offset:1024 lds
    s_waitcnt lgkmcnt(0)
    v_mfma_f32_32x32x16_bf16 v[64:79], v[56:59], v[48:51], v[64:79]
    v_mfma_f32_32x32x16_bf16 v[80:95], v[60:63], v[48:51], v[80:95]
    s_add_u32 m0, s25, 49152
    s_nop 0
    buffer_load_dwordx4 v4, s[8:11], s27 offen lds
    v_mfma_f32_32x32x16_bf16 v[96:111], v[56:59], v[52:55], v[96:111]
    v_mfma_f32_32x32x16_bf16 v[112:127], v[60:63], v[52:55], v[112:127]
    s_add_u32 m0, s25, 50176
    s_nop 0
    buffer_load_dwordx4 v4, s[8:11], s30 offen lds
    s_waitcnt vmcnt(8)
    s_barrier
    ds_read_b128 v[32:35], v7 offset:32768
    ds_read_b128 v[36:39], v9 offset:32768
    ds_read_b64_tr_b16 v[40:41], v11 offset:32768
    ds_read_b64_tr_b16 v[42:43], v11 offset:34816
    ds_read_b64_tr_b16 v[44:45], v13 offset:32768
    ds_read_b64_tr_b16 v[46:47], v13 offset:34816
    ds_read_b128 v[48:51], v7 offset:33792
    ds_read_b128 v[52:55], v9 offset:33792
    ds_read_b64_tr_b16 v[56:57], v11 offset:36864
    ds_read_b64_tr_b16 v[58:59], v11 offset:38912
    ds_read_b64_tr_b16 v[60:61], v13 offset:36864
    ds_read_b64_tr_b16 v[62:63], v13 offset:38912
    s_waitcnt lgkmcnt(6)
    v_mfma_f32_32x32x16_bf16 v[64:79], v[40:43], v[32:35], v[64:79]
    v_mfma_f32_32x32x16_bf16 v[80:95], v[44:47], v[32:35], v[80:95]
    s_lshl_b32 s30, s48, 12
    s_add_u32 s26, s49, s30
    s_lshl_b32 s30, s48, 16
    s_add_u32 s27, s50, s30
    s_add_u32 s48, s48, 1
    s_cmp_eq_u32 s48, s51
    s_cselect_b32 s48, 0, s48
    s_add_u32 m0, s25, 65536
    s_add_u32 s30, s27, 4096
    buffer_load_dwordx4 v2, s[16:19], s26 offen lds
    v_mfma_f32_32x32x16_bf16 v[96:111], v[40:43], v[36:39], v[96:111]
    v_mfma_f32_32x32x16_bf16 v[112:127], v[44:47], v[36:39], v[112:127]
    buffer_load_dwordx4 v2, s[16:19], s26 offen offset:1024 lds
    s_waitcnt lgkmcnt(0)
    v_mfma_f32_32x32x16_bf16 v[64:79], v[56:59], v[48:51], v[64:79]
    v_mfma_f32_32x32x16_bf16 v[80:95], v[60:63], v[48:51], v[80:95]
    s_add_u32 m0, s25, 81920
    s_nop 0
    buffer_load_dwordx4 v4, s[8:11], s27 offen lds
    v_mfma_f32_32x32x16_bf16 v[96:111], v[56:59], v[52:55], v[96:111]
    v_mfma_f32_32x32x16_bf16 v[112:127], v[60:63], v[52:55], v[112:127]
    s_add_u32 m0, s25, 82944
    s_nop 0
    buffer_load_dwordx4 v4, s[8:11], s30 offen lds
    s_waitcnt vmcnt(8)
    s_barrier
    ds_read_b128 v[32:35], v6 offset:0
    ds_read_b128 v[36:39], v8 offset:0
    ds_read_b64_tr_b16 v[40:41], v10 offset:0
    ds_read_b64_tr_b16 v[42:43], v10 offset:2048
    ds_read_b64_tr_b16 v[44:45], v12 offset:0
    ds_read_b64_tr_b16 v[46:47], v12 offset:2048
    ds_read_b128 v[48:51], v6 offset:1024
    ds_read_b128 v[52:55], v8 offset:1024
    ds_read_b64_tr_b16 v[56:57], v10 offset:4096
    ds_read_b64_tr_b16 v[58:59], v10 offset:6144
    ds_read_b64_tr_b16 v[60:61], v12 offset:4096
    ds_read_b64_tr_b16 v[62:63], v12 offset:6144
    s_waitcnt lgkmcnt(6)
    v_mfma_f32_32x32x16_bf16 v[64:79], v[40:43], v[32:35], v[64:79]
    v_mfma_f32_32x32x16_bf16 v[80:95], v[44:47], v[32:35], v[80:95]
    v_mfma_f32_32x32x16_bf16 v[96:111], v[40:43], v[36:39], v[96:111]
    v_mfma_f32_32x32x16_bf16 v[112:127], v[44:47], v[36:39], v[112:127]
    s_waitcnt lgkmcnt(0)
    v_mfma_f32_32x32x16_bf16 v[64:79], v[56:59], v[48:51], v[64:79]
    v_mfma_f32_32x32x16_bf16 v[80:95], v[60:63], v[48:51], v[80:95]
    v_mfma_f32_32x32x16_bf16 v[96:111], v[56:59], v[52:55], v[96:111]
    v_mfma_f32_32x32x16_bf16 v[112:127], v[60:63], v[52:55], v[112:127]
    s_waitcnt vmcnt(4)
    s_barrier
    ds_read_b128 v[32:35], v6 offset:32768
    ds_read_b128 v[36:39], v8 offset:32768
    ds_read_b64_tr_b16 v[40:41], v10 offset:32768
    ds_read_b64_tr_b16 v[42:43], v10 offset:34816
    ds_read_b64_tr_b16 v[44:45], v12 offset:32768
    ds_read_b64_tr_b16 v[46:47], v12 offset:34816
    ds_read_b128 v[48:51], v6 offset:33792
    ds_read_b128 v[52:55], v8 offset:33792
    ds_read_b64_tr_b16 v[56:57], v10 offset:36864
    ds_read_b64_tr_b16 v[58:59], v10 offset:38912
    ds_read_b64_tr_b16 v[60:61], v12 offset:36864
    ds_read_b64_tr_b16 v[62:63], v12 offset:38912
    s_waitcnt lgkmcnt(6)
    v_mfma_f32_32x32x16_bf16 v[64:79], v[40:43], v[32:35], v[64:79]
    v_mfma_f32_32x32x16_bf16 v[80:95], v[44:47], v[32:35], v[80:95]
    v_mfma_f32_32x32x16_bf16 v[96:111], v[40:43], v[36:39], v[96:111]
    v_mfma_f32_32x32x16_bf16 v[112:127], v[44:47], v[36:39], v[112:127]
    s_waitcnt lgkmcnt(0)
    v_mfma_f32_32x32x16_bf16 v[64:79], v[56:59], v[48:51], v[64:79]
    v_mfma_f32_32x32x16_bf16 v[80:95], v[60:63], v[48:51], v[80:95]
    v_mfma_f32_32x32x16_bf16 v[96:111], v[56:59], v[52:55], v[96:111]
    v_mfma_f32_32x32x16_bf16 v[112:127], v[60:63], v[52:55], v[112:127]
    s_waitcnt vmcnt(0)
    s_barrier
    ds_read_b128 v[32:35], v7 offset:0
    ds_read_b128 v[36:39], v9 offset:0
    ds_read_b64_tr_b16 v[40:41], v11 offset:0
    ds_read_b64_tr_b16 v[42:43], v11 offset:2048
    ds_read_b64_tr_b16 v[44:45], v13 offset:0
    ds_read_b64_tr_b16 v[46:47], v13 offset:2048
    ds_read_b128 v[48:51], v7 offset:1024
    ds_read_b128 v[52:55], v9 offset:1024
    ds_read_b64_tr_b16 v[56:57], v11 offset:4096
    ds_read_b64_tr_b16 v[58:59], v11 offset:6144
    ds_read_b64_tr_b16 v[60:61], v13 offset:4096
    ds_read_b64_tr_b16 v[62:63], v13 offset:6144
    s_waitcnt lgkmcnt(6)
    v_mfma_f32_32x32x16_bf16 v[64:79], v[40:43], v[32:35], v[64:79]
    v_mfma_f32_32x32x16_bf16 v[80:95], v[44:47], v[32:35], v[80:95]
    v_mfma_f32_32x32x16_bf16 v[96:111], v[40:43], v[36:39], v[96:111]
    v_mfma_f32_32x32x16_bf16 v[112:127], v[44:47], v[36:39], v[112:127]
    s_waitcnt lgkmcnt(0)
    v_mfma_f32_32x32x16_bf16 v[64:79], v[56:59], v[48:51], v[64:79]
    v_mfma_f32_32x32x16_bf16 v[80:95], v[60:63], v[48:51], v[80:95]
    v_mfma_f32_32x32x16_bf16 v[96:111], v[56:59], v[52:55], v[96:111]
    v_mfma_f32_32x32x16_bf16 v[112:127], v[60:63], v[52:55], v[112:127]
    s_lshl_b32 s30, s35, 1
    s_add_u32 s38, s30, s34
    s_lshl_b32 s37, s38, 5
    s_lshl_b32 s31, s21, 7
    s_add_u32 s30, s37, s31
    s_lshl_b32 s30, s30, 2
    s_add_u32 s30, s30, 76546048
    v_and_b32 v22, 31, v3
    v_lshlrev_b32 v5, 2, v22
    buffer_load_dword v5, v5, s[16:19], s30 offen
    s_barrier
    s_lshl_b32 s30, s20, 13
    v_add_u32 v14, s30, v2
    s_xor_b32 s30, s20, 4
    s_lshl_b32 s30, s30, 13
    v_add_u32 v15, s30, v2
    v_add_u32 v16, 0x10000, v14
    v_add_u32 v17, 0x10000, v15
    s_nop 7
    ds_write_b128 v14, v[96:99] offset:0
    ds_write_b128 v14, v[100:103] offset:1024
    ds_write_b128 v14, v[104:107] offset:2048
    ds_write_b128 v14, v[108:111] offset:3072
    ds_write_b128 v14, v[112:115] offset:4096
    ds_write_b128 v14, v[116:119] offset:5120
    ds_write_b128 v14, v[120:123] offset:6144
    ds_write_b128 v14, v[124:127] offset:7168
    s_waitcnt lgkmcnt(0)
    s_barrier
    ds_read_b128 v[96:99], v15 offset:0
    ds_read_b128 v[100:103], v15 offset:1024
    ds_read_b128 v[104:107], v15 offset:2048
    ds_read_b128 v[108:111], v15 offset:3072
    ds_read_b128 v[112:115], v15 offset:4096
    ds_read_b128 v[116:119], v15 offset:5120
    ds_read_b128 v[120:123], v15 offset:6144
    ds_read_b128 v[124:127], v15 offset:7168
    s_waitcnt lgkmcnt(0)
    v_add_f32 v64, v64, v96
    v_add_f32 v65, v65, v97
    v_add_f32 v66, v66, v98
    v_add_f32 v67, v67, v99
    v_add_f32 v68, v68, v100
    v_add_f32 v69, v69, v101
    v_add_f32 v70, v70, v102
    v_add_f32 v71, v71, v103
    v_add_f32 v72, v72, v104
    v_add_f32 v73, v73, v105
    v_add_f32 v74, v74, v106
    v_add_f32 v75, v75, v107
    v_add_f32 v76, v76, v108
    v_add_f32 v77, v77, v109
    v_add_f32 v78, v78, v110
    v_add_f32 v79, v79, v111
    v_add_f32 v80, v80, v112
    v_add_f32 v81, v81, v113
    v_add_f32 v82, v82, v114
    v_add_f32 v83, v83, v115
    v_add_f32 v84, v84, v116
    v_add_f32 v85, v85, v117
    v_add_f32 v86, v86, v118
    v_add_f32 v87, v87, v119
    v_add_f32 v88, v88, v120
    v_add_f32 v89, v89, v121
    v_add_f32 v90, v90, v122
    v_add_f32 v91, v91, v123
    v_add_f32 v92, v92, v124
    v_add_f32 v93, v93, v125
    v_add_f32 v94, v94, v126
    v_add_f32 v95, v95, v127
    s_lshl_b32 s39, s24, 2
    s_add_u32 s39, s39, s38
    s_lshl_b32 s39, s39, 1
    s_add_u32 s39, s39, s36
    s_lshl_b32 s39, s39, 16
    s_add_u32 s39, s39, 83886080
    s_lshl_b32 s40, s38, 1
    s_add_u32 s40, s40, s36
    s_lshl_b32 s40, s40, 2
    s_lshl_b32 s30, s24, 8
    s_add_u32 s40, s40, s30
    s_add_u32 s40, s40, 77594624
    v_mov_b32 v14, 0
    s_cmp_eq_u32 s38, s23
    s_cbranch_scc1 K3_FZP
    s_lshl_b32 s30, s23, 13
    s_add_u32 s30, s30, s39
    s_add_u32 s31, s30, 4096
    buffer_store_dwordx4 v[64:67], v2, s[16:19], s30 offen offset:0 sc1
    buffer_store_dwordx4 v[68:71], v2, s[16:19], s30 offen offset:1024 sc1
    buffer_store_dwordx4 v[72:75], v2, s[16:19], s30 offen offset:2048 sc1
    buffer_store_dwordx4 v[76:79], v2, s[16:19], s30 offen offset:3072 sc1
    buffer_store_dwordx4 v[80:83], v2, s[16:19], s31 offen offset:0 sc1
    buffer_store_dwordx4 v[84:87], v2, s[16:19], s31 offen offset:1024 sc1
    buffer_store_dwordx4 v[88:91], v2, s[16:19], s31 offen offset:2048 sc1
    buffer_store_dwordx4 v[92:95], v2, s[16:19], s31 offen offset:3072 sc1
    v_mov_b32 v15, 1
    s_waitcnt vmcnt(0)
    s_mov_b64 exec, 1
    buffer_atomic_add v15, v14, s[16:19], s40 offen sc1
    s_mov_b64 exec, -1
    s_endpgm
K3_FZP:
    s_mov_b32 s31, 0
K3_SPINP:
    v_mov_b32 v15, 0
    s_mov_b64 exec, 1
    buffer_atomic_or v15, v14, s[16:19], s40 offen sc0 sc1
    s_mov_b64 exec, -1
    s_waitcnt vmcnt(0)
    v_readfirstlane_b32 s32, v15
    s_cmp_ge_u32 s32, 3
    s_cbranch_scc1 K3_GOP
    s_sleep 4
    s_add_u32 s31, s31, 1
    s_cmp_lt_u32 s31, 0x40000
    s_cbranch_scc1 K3_SPINP
K3_GOP:
    s_add_u32 s30, s23, 1
    s_and_b32 s30, s30, 3
    s_lshl_b32 s30, s30, 13
    s_add_u32 s30, s30, s39
    s_add_u32 s31, s30, 4096
    buffer_load_dwordx4 v[192:195], v2, s[16:19], s30 offen offset:0 sc1
    buffer_load_dwordx4 v[196:199], v2, s[16:19], s30 offen offset:1024 sc1
    buffer_load_dwordx4 v[200:203], v2, s[16:19], s30 offen offset:2048 sc1
    buffer_load_dwordx4 v[204:207], v2, s[16:19], s30 offen offset:3072 sc1
    buffer_load_dwordx4 v[208:211], v2, s[16:19], s31 offen offset:0 sc1
    buffer_load_dwordx4 v[212:215], v2, s[16:19], s31 offen offset:1024 sc1
    buffer_load_dwordx4 v[216:219], v2, s[16:19], s31 offen offset:2048 sc1
    buffer_load_dwordx4 v[220:223], v2, s[16:19], s31 offen offset:3072 sc1
    s_add_u32 s30, s23, 2
    s_and_b32 s30, s30, 3
    s_lshl_b32 s30, s30, 13
    s_add_u32 s30, s30, s39
    s_add_u32 s31, s30, 4096
    buffer_load_dwordx4 v[224:227], v2, s[16:19], s30 offen offset:0 sc1
    buffer_load_dwordx4 v[228:231], v2, s[16:19], s30 offen offset:1024 sc1
    buffer_load_dwordx4 v[232:235], v2, s[16:19], s30 offen offset:2048 sc1
    buffer_load_dwordx4 v[236:239], v2, s[16:19], s30 offen offset:3072 sc1
    buffer_load_dwordx4 v[240:243], v2, s[16:19], s31 offen offset:0 sc1
    buffer_load_dwordx4 v[244:247], v2, s[16:19], s31 offen offset:1024 sc1
    buffer_load_dwordx4 v[248:251], v2, s[16:19], s31 offen offset:2048 sc1
    buffer_load_dwordx4 v[252:255], v2, s[16:19], s31 offen offset:3072 sc1
    s_add_u32 s30, s23, 3
    s_and_b32 s30, s30, 3
    s_lshl_b32 s30, s30, 13
    s_add_u32 s30, s30, s39
    s_add_u32 s31, s30, 4096
    buffer_load_dwordx4 v[96:99], v2, s[16:19], s30 offen offset:0 sc1
    buffer_load_dwordx4 v[100:103], v2, s[16:19], s30 offen offset:1024 sc1
    buffer_load_dwordx4 v[104:107], v2, s[16:19], s30 offen offset:2048 sc1
    buffer_load_dwordx4 v[108:111], v2, s[16:19], s30 offen offset:3072 sc1
    buffer_load_dwordx4 v[112:115], v2, s[16:19], s31 offen offset:0 sc1
    buffer_load_dwordx4 v[116:119], v2, s[16:19], s31 offen offset:1024 sc1
    buffer_load_dwordx4 v[120:123], v2, s[16:19], s31 offen offset:2048 sc1
    buffer_load_dwordx4 v[124:127], v2, s[16:19], s31 offen offset:3072 sc1
    s_add_u32 s30, s39, 32768
    buffer_load_dwordx4 v[160:163], v2, s[16:19], s30 offen offset:0 sc1
    buffer_load_dwordx4 v[164:167], v2, s[16:19], s30 offen offset:1024 sc1
    buffer_load_dwordx4 v[168:171], v2, s[16:19], s30 offen offset:2048 sc1
    buffer_load_dwordx4 v[172:175], v2, s[16:19], s30 offen offset:3072 sc1
    s_xor_b32 s30, s20, 4
    s_lshl_b32 s30, s30, 13
    v_mul_u32_u24 v22, 144, v22
    v_lshrrev_b32 v23, 5, v3
    v_lshl_add_u32 v22, v23, 3, v22
    v_add_u32 v22, s30, v22
    v_lshrrev_b32 v14, 3, v3
    v_and_b32 v15, 7, v3
    v_mul_u32_u24 v16, 144, v14
    v_lshl_add_u32 v16, v15, 4, v16
    v_add_u32 v16, s30, v16
    v_lshlrev_b32 v17, 10, v14
    v_lshl_add_u32 v17, v15, 4, v17
    s_lshl_b32 s30, s21, 17
    s_lshl_b32 s31, s22, 8
    s_add_u32 s30, s30, s31
    s_lshl_b32 s31, s37, 10
    s_add_u32 s30, s30, s31
    s_lshl_b32 s31, s36, 7
    s_add_u32 s30, s30, s31
    s_waitcnt vmcnt(0)
    v_lshlrev_b32 v128, 16, v160
    v_and_b32 v129, 0xffff0000, v160
    v_lshlrev_b32 v130, 16, v161
    v_and_b32 v131, 0xffff0000, v161
    v_lshlrev_b32 v132, 16, v162
    v_and_b32 v133, 0xffff0000, v162
    v_lshlrev_b32 v134, 16, v163
    v_and_b32 v135, 0xffff0000, v163
    v_lshlrev_b32 v136, 16, v164
    v_and_b32 v137, 0xffff0000, v164
    v_lshlrev_b32 v138, 16, v165
    v_and_b32 v139, 0xffff0000, v165
    v_lshlrev_b32 v140, 16, v166
    v_and_b32 v141, 0xffff0000, v166
    v_lshlrev_b32 v142, 16, v167
    v_and_b32 v143, 0xffff0000, v167
    v_lshlrev_b32 v144, 16, v168
    v_and_b32 v145, 0xffff0000, v168
    v_lshlrev_b32 v146, 16, v169
    v_and_b32 v147, 0xffff0000, v169
    v_lshlrev_b32 v148, 16, v170
    v_and_b32 v149, 0xffff0000, v170
    v_lshlrev_b32 v150, 16, v171
    v_and_b32 v151, 0xffff0000, v171
    v_lshlrev_b32 v152, 16, v172
    v_and_b32 v153, 0xffff0000, v172
    v_lshlrev_b32 v154, 16, v173
    v_and_b32 v155, 0xffff0000, v173
    v_lshlrev_b32 v156, 16, v174
    v_and_b32 v157, 0xffff0000, v174
    v_lshlrev_b32 v158, 16, v175
    v_and_b32 v159, 0xffff0000, v175
    v_add_f32 v192, v192, v224
    v_add_f32 v64, v64, v96
    v_add_f32 v64, v64, v192
    v_cvt_pk_bf16_f32 v64, v64, v64
    v_lshlrev_b32 v64, 16, v64
    v_mul_f32 v64, v64, v5
    v_cvt_pk_bf16_f32 v64, v64, v64
    v_lshlrev_b32 v64, 16, v64
    v_add_f32 v64, v64, v128
    v_add_f32 v193, v193, v225
    v_add_f32 v65, v65, v97
    v_add_f32 v65, v65, v193
    v_cvt_pk_bf16_f32 v65, v65, v65
    v_lshlrev_b32 v65, 16, v65
    v_mul_f32 v65, v65, v5
    v_cvt_pk_bf16_f32 v65, v65, v65
    v_lshlrev_b32 v65, 16, v65
    v_add_f32 v65, v65, v129
    v_add_f32 v194, v194, v226
    v_add_f32 v66, v66, v98
    v_add_f32 v66, v66, v194
    v_cvt_pk_bf16_f32 v66, v66, v66
    v_lshlrev_b32 v66, 16, v66
    v_mul_f32 v66, v66, v5
    v_cvt_pk_bf16_f32 v66, v66, v66
    v_lshlrev_b32 v66, 16, v66
    v_add_f32 v66, v66, v130
    v_add_f32 v195, v195, v227
    v_add_f32 v67, v67, v99
    v_add_f32 v67, v67, v195
    v_cvt_pk_bf16_f32 v67, v67, v67
    v_lshlrev_b32 v67, 16, v67
    v_mul_f32 v67, v67, v5
    v_cvt_pk_bf16_f32 v67, v67, v67
    v_lshlrev_b32 v67, 16, v67
    v_add_f32 v67, v67, v131
    v_add_f32 v196, v196, v228
    v_add_f32 v68, v68, v100
    v_add_f32 v68, v68, v196
    v_cvt_pk_bf16_f32 v68, v68, v68
    v_lshlrev_b32 v68, 16, v68
    v_mul_f32 v68, v68, v5
    v_cvt_pk_bf16_f32 v68, v68, v68
    v_lshlrev_b32 v68, 16, v68
    v_add_f32 v68, v68, v132
    v_add_f32 v197, v197, v229
    v_add_f32 v69, v69, v101
    v_add_f32 v69, v69, v197
    v_cvt_pk_bf16_f32 v69, v69, v69
    v_lshlrev_b32 v69, 16, v69
    v_mul_f32 v69, v69, v5
    v_cvt_pk_bf16_f32 v69, v69, v69
    v_lshlrev_b32 v69, 16, v69
    v_add_f32 v69, v69, v133
    v_add_f32 v198, v198, v230
    v_add_f32 v70, v70, v102
    v_add_f32 v70, v70, v198
    v_cvt_pk_bf16_f32 v70, v70, v70
    v_lshlrev_b32 v70, 16, v70
    v_mul_f32 v70, v70, v5
    v_cvt_pk_bf16_f32 v70, v70, v70
    v_lshlrev_b32 v70, 16, v70
    v_add_f32 v70, v70, v134
    v_add_f32 v199, v199, v231
    v_add_f32 v71, v71, v103
    v_add_f32 v71, v71, v199
    v_cvt_pk_bf16_f32 v71, v71, v71
    v_lshlrev_b32 v71, 16, v71
    v_mul_f32 v71, v71, v5
    v_cvt_pk_bf16_f32 v71, v71, v71
    v_lshlrev_b32 v71, 16, v71
    v_add_f32 v71, v71, v135
    v_add_f32 v200, v200, v232
    v_add_f32 v72, v72, v104
    v_add_f32 v72, v72, v200
    v_cvt_pk_bf16_f32 v72, v72, v72
    v_lshlrev_b32 v72, 16, v72
    v_mul_f32 v72, v72, v5
    v_cvt_pk_bf16_f32 v72, v72, v72
    v_lshlrev_b32 v72, 16, v72
    v_add_f32 v72, v72, v136
    v_add_f32 v201, v201, v233
    v_add_f32 v73, v73, v105
    v_add_f32 v73, v73, v201
    v_cvt_pk_bf16_f32 v73, v73, v73
    v_lshlrev_b32 v73, 16, v73
    v_mul_f32 v73, v73, v5
    v_cvt_pk_bf16_f32 v73, v73, v73
    v_lshlrev_b32 v73, 16, v73
    v_add_f32 v73, v73, v137
    v_add_f32 v202, v202, v234
    v_add_f32 v74, v74, v106
    v_add_f32 v74, v74, v202
    v_cvt_pk_bf16_f32 v74, v74, v74
    v_lshlrev_b32 v74, 16, v74
    v_mul_f32 v74, v74, v5
    v_cvt_pk_bf16_f32 v74, v74, v74
    v_lshlrev_b32 v74, 16, v74
    v_add_f32 v74, v74, v138
    v_add_f32 v203, v203, v235
    v_add_f32 v75, v75, v107
    v_add_f32 v75, v75, v203
    v_cvt_pk_bf16_f32 v75, v75, v75
    v_lshlrev_b32 v75, 16, v75
    v_mul_f32 v75, v75, v5
    v_cvt_pk_bf16_f32 v75, v75, v75
    v_lshlrev_b32 v75, 16, v75
    v_add_f32 v75, v75, v139
    v_add_f32 v204, v204, v236
    v_add_f32 v76, v76, v108
    v_add_f32 v76, v76, v204
    v_cvt_pk_bf16_f32 v76, v76, v76
    v_lshlrev_b32 v76, 16, v76
    v_mul_f32 v76, v76, v5
    v_cvt_pk_bf16_f32 v76, v76, v76
    v_lshlrev_b32 v76, 16, v76
    v_add_f32 v76, v76, v140
    v_add_f32 v205, v205, v237
    v_add_f32 v77, v77, v109
    v_add_f32 v77, v77, v205
    v_cvt_pk_bf16_f32 v77, v77, v77
    v_lshlrev_b32 v77, 16, v77
    v_mul_f32 v77, v77, v5
    v_cvt_pk_bf16_f32 v77, v77, v77
    v_lshlrev_b32 v77, 16, v77
    v_add_f32 v77, v77, v141
    v_add_f32 v206, v206, v238
    v_add_f32 v78, v78, v110
    v_add_f32 v78, v78, v206
    v_cvt_pk_bf16_f32 v78, v78, v78
    v_lshlrev_b32 v78, 16, v78
    v_mul_f32 v78, v78, v5
    v_cvt_pk_bf16_f32 v78, v78, v78
    v_lshlrev_b32 v78, 16, v78
    v_add_f32 v78, v78, v142
    v_add_f32 v207, v207, v239
    v_add_f32 v79, v79, v111
    v_add_f32 v79, v79, v207
    v_cvt_pk_bf16_f32 v79, v79, v79
    v_lshlrev_b32 v79, 16, v79
    v_mul_f32 v79, v79, v5
    v_cvt_pk_bf16_f32 v79, v79, v79
    v_lshlrev_b32 v79, 16, v79
    v_add_f32 v79, v79, v143
    v_add_f32 v208, v208, v240
    v_add_f32 v80, v80, v112
    v_add_f32 v80, v80, v208
    v_cvt_pk_bf16_f32 v80, v80, v80
    v_lshlrev_b32 v80, 16, v80
    v_mul_f32 v80, v80, v5
    v_cvt_pk_bf16_f32 v80, v80, v80
    v_lshlrev_b32 v80, 16, v80
    v_add_f32 v80, v80, v144
    v_add_f32 v209, v209, v241
    v_add_f32 v81, v81, v113
    v_add_f32 v81, v81, v209
    v_cvt_pk_bf16_f32 v81, v81, v81
    v_lshlrev_b32 v81, 16, v81
    v_mul_f32 v81, v81, v5
    v_cvt_pk_bf16_f32 v81, v81, v81
    v_lshlrev_b32 v81, 16, v81
    v_add_f32 v81, v81, v145
    v_add_f32 v210, v210, v242
    v_add_f32 v82, v82, v114
    v_add_f32 v82, v82, v210
    v_cvt_pk_bf16_f32 v82, v82, v82
    v_lshlrev_b32 v82, 16, v82
    v_mul_f32 v82, v82, v5
    v_cvt_pk_bf16_f32 v82, v82, v82
    v_lshlrev_b32 v82, 16, v82
    v_add_f32 v82, v82, v146
    v_add_f32 v211, v211, v243
    v_add_f32 v83, v83, v115
    v_add_f32 v83, v83, v211
    v_cvt_pk_bf16_f32 v83, v83, v83
    v_lshlrev_b32 v83, 16, v83
    v_mul_f32 v83, v83, v5
    v_cvt_pk_bf16_f32 v83, v83, v83
    v_lshlrev_b32 v83, 16, v83
    v_add_f32 v83, v83, v147
    v_add_f32 v212, v212, v244
    v_add_f32 v84, v84, v116
    v_add_f32 v84, v84, v212
    v_cvt_pk_bf16_f32 v84, v84, v84
    v_lshlrev_b32 v84, 16, v84
    v_mul_f32 v84, v84, v5
    v_cvt_pk_bf16_f32 v84, v84, v84
    v_lshlrev_b32 v84, 16, v84
    v_add_f32 v84, v84, v148
    v_add_f32 v213, v213, v245
    v_add_f32 v85, v85, v117
    v_add_f32 v85, v85, v213
    v_cvt_pk_bf16_f32 v85, v85, v85
    v_lshlrev_b32 v85, 16, v85
    v_mul_f32 v85, v85, v5
    v_cvt_pk_bf16_f32 v85, v85, v85
    v_lshlrev_b32 v85, 16, v85
    v_add_f32 v85, v85, v149
    v_add_f32 v214, v214, v246
    v_add_f32 v86, v86, v118
    v_add_f32 v86, v86, v214
    v_cvt_pk_bf16_f32 v86, v86, v86
    v_lshlrev_b32 v86, 16, v86
    v_mul_f32 v86, v86, v5
    v_cvt_pk_bf16_f32 v86, v86, v86
    v_lshlrev_b32 v86, 16, v86
    v_add_f32 v86, v86, v150
    v_add_f32 v215, v215, v247
    v_add_f32 v87, v87, v119
    v_add_f32 v87, v87, v215
    v_cvt_pk_bf16_f32 v87, v87, v87
    v_lshlrev_b32 v87, 16, v87
    v_mul_f32 v87, v87, v5
    v_cvt_pk_bf16_f32 v87, v87, v87
    v_lshlrev_b32 v87, 16, v87
    v_add_f32 v87, v87, v151
    v_add_f32 v216, v216, v248
    v_add_f32 v88, v88, v120
    v_add_f32 v88, v88, v216
    v_cvt_pk_bf16_f32 v88, v88, v88
    v_lshlrev_b32 v88, 16, v88
    v_mul_f32 v88, v88, v5
    v_cvt_pk_bf16_f32 v88, v88, v88
    v_lshlrev_b32 v88, 16, v88
    v_add_f32 v88, v88, v152
    v_add_f32 v217, v217, v249
    v_add_f32 v89, v89, v121
    v_add_f32 v89, v89, v217
    v_cvt_pk_bf16_f32 v89, v89, v89
    v_lshlrev_b32 v89, 16, v89
    v_mul_f32 v89, v89, v5
    v_cvt_pk_bf16_f32 v89, v89, v89
    v_lshlrev_b32 v89, 16, v89
    v_add_f32 v89, v89, v153
    v_add_f32 v218, v218, v250
    v_add_f32 v90, v90, v122
    v_add_f32 v90, v90, v218
    v_cvt_pk_bf16_f32 v90, v90, v90
    v_lshlrev_b32 v90, 16, v90
    v_mul_f32 v90, v90, v5
    v_cvt_pk_bf16_f32 v90, v90, v90
    v_lshlrev_b32 v90, 16, v90
    v_add_f32 v90, v90, v154
    v_add_f32 v219, v219, v251
    v_add_f32 v91, v91, v123
    v_add_f32 v91, v91, v219
    v_cvt_pk_bf16_f32 v91, v91, v91
    v_lshlrev_b32 v91, 16, v91
    v_mul_f32 v91, v91, v5
    v_cvt_pk_bf16_f32 v91, v91, v91
    v_lshlrev_b32 v91, 16, v91
    v_add_f32 v91, v91, v155
    v_add_f32 v220, v220, v252
    v_add_f32 v92, v92, v124
    v_add_f32 v92, v92, v220
    v_cvt_pk_bf16_f32 v92, v92, v92
    v_lshlrev_b32 v92, 16, v92
    v_mul_f32 v92, v92, v5
    v_cvt_pk_bf16_f32 v92, v92, v92
    v_lshlrev_b32 v92, 16, v92
    v_add_f32 v92, v92, v156
    v_add_f32 v221, v221, v253
    v_add_f32 v93, v93, v125
    v_add_f32 v93, v93, v221
    v_cvt_pk_bf16_f32 v93, v93, v93
    v_lshlrev_b32 v93, 16, v93
    v_mul_f32 v93, v93, v5
    v_cvt_pk_bf16_f32 v93, v93, v93
    v_lshlrev_b32 v93, 16, v93
    v_add_f32 v93, v93, v157
    v_add_f32 v222, v222, v254
    v_add_f32 v94, v94, v126
    v_add_f32 v94, v94, v222
    v_cvt_pk_bf16_f32 v94, v94, v94
    v_lshlrev_b32 v94, 16, v94
    v_mul_f32 v94, v94, v5
    v_cvt_pk_bf16_f32 v94, v94, v94
    v_lshlrev_b32 v94, 16, v94
    v_add_f32 v94, v94, v158
    v_add_f32 v223, v223, v255
    v_add_f32 v95, v95, v127
    v_add_f32 v95, v95, v223
    v_cvt_pk_bf16_f32 v95, v95, v95
    v_lshlrev_b32 v95, 16, v95
    v_mul_f32 v95, v95, v5
    v_cvt_pk_bf16_f32 v95, v95, v95
    v_lshlrev_b32 v95, 16, v95
    v_add_f32 v95, v95, v159
    v_cvt_pk_bf16_f32 v192, v64, v65
    v_cvt_pk_bf16_f32 v193, v66, v67
    ds_write_b64 v22, v[192:193] offset:0
    v_cvt_pk_bf16_f32 v194, v68, v69
    v_cvt_pk_bf16_f32 v195, v70, v71
    ds_write_b64 v22, v[194:195] offset:16
    v_cvt_pk_bf16_f32 v196, v72, v73
    v_cvt_pk_bf16_f32 v197, v74, v75
    ds_write_b64 v22, v[196:197] offset:32
    v_cvt_pk_bf16_f32 v198, v76, v77
    v_cvt_pk_bf16_f32 v199, v78, v79
    ds_write_b64 v22, v[198:199] offset:48
    v_cvt_pk_bf16_f32 v200, v80, v81
    v_cvt_pk_bf16_f32 v201, v82, v83
    ds_write_b64 v22, v[200:201] offset:64
    v_cvt_pk_bf16_f32 v202, v84, v85
    v_cvt_pk_bf16_f32 v203, v86, v87
    ds_write_b64 v22, v[202:203] offset:80
    v_cvt_pk_bf16_f32 v204, v88, v89
    v_cvt_pk_bf16_f32 v205, v90, v91
    ds_write_b64 v22, v[204:205] offset:96
    v_cvt_pk_bf16_f32 v206, v92, v93
    v_cvt_pk_bf16_f32 v207, v94, v95
    ds_write_b64 v22, v[206:207] offset:112
    s_waitcnt lgkmcnt(0)
    ds_read_b128 v[32:35], v16 offset:0
    ds_read_b128 v[36:39], v16 offset:1152
    ds_read_b128 v[40:43], v16 offset:2304
    ds_read_b128 v[44:47], v16 offset:3456
    s_waitcnt lgkmcnt(3)
    s_add_u32 s31, s30, 0
    buffer_store_dwordx4 v[32:35], v17, s[64:67], s31 offen
    s_waitcnt lgkmcnt(2)
    s_add_u32 s31, s30, 8192
    buffer_store_dwordx4 v[36:39], v17, s[64:67], s31 offen
    s_waitcnt lgkmcnt(1)
    s_add_u32 s31, s30, 16384
    buffer_store_dwordx4 v[40:43], v17, s[64:67], s31 offen
    s_waitcnt lgkmcnt(0)
    s_add_u32 s31, s30, 24576
    buffer_store_dwordx4 v[44:47], v17, s[64:67], s31 offen
    s_endpgm
K3_FIN:
    s_waitcnt vmcnt(4)
    s_barrier
    ds_read_b128 v[32:35], v6 offset:0
    ds_read_b128 v[36:39], v8 offset:0
    ds_read_b64_tr_b16 v[40:41], v10 offset:0
    ds_read_b64_tr_b16 v[42:43], v10 offset:2048
    ds_read_b64_tr_b16 v[44:45], v12 offset:0
    ds_read_b64_tr_b16 v[46:47], v12 offset:2048
    ds_read_b128 v[48:51], v6 offset:1024
    ds_read_b128 v[52:55], v8 offset:1024
    ds_read_b64_tr_b16 v[56:57], v10 offset:4096
    ds_read_b64_tr_b16 v[58:59], v10 offset:6144
    ds_read_b64_tr_b16 v[60:61], v12 offset:4096
    ds_read_b64_tr_b16 v[62:63], v12 offset:6144
    s_waitcnt lgkmcnt(6)
    v_mfma_f32_32x32x16_bf16 v[64:79], v[40:43], v[32:35], 0
    v_mfma_f32_32x32x16_bf16 v[80:95], v[44:47], v[32:35], 0
    s_lshl_b32 s30, s48, 12
    s_add_u32 s26, s49, s30
    s_lshl_b32 s30, s48, 16
    s_add_u32 s27, s50, s30
    s_add_u32 s48, s48, 1
    s_cmp_eq_u32 s48, s51
    s_cselect_b32 s48, 0, s48
    s_add_u32 m0, s25, 98304
    s_add_u32 s30, s27, 4096
    buffer_load_dwordx4 v2, s[16:19], s26 offen lds
    v_mfma_f32_32x32x16_bf16 v[96:111], v[40:43], v[36:39], 0
    v_mfma_f32_32x32x16_bf16 v[112:127], v[44:47], v[36:39], 0
    buffer_load_dwordx4 v2, s[16:19], s26 offen offset:1024 lds
    s_waitcnt lgkmcnt(0)
    v_mfma_f32_32x32x16_bf16 v[64:79], v[56:59], v[48:51], v[64:79]
    v_mfma_f32_32x32x16_bf16 v[80:95], v[60:63], v[48:51], v[80:95]
    s_add_u32 m0, s25, 114688
    s_nop 0
    buffer_load_dwordx4 v4, s[8:11], s27 offen lds
    v_mfma_f32_32x32x16_bf16 v[96:111], v[56:59], v[52:55], v[96:111]
    v_mfma_f32_32x32x16_bf16 v[112:127], v[60:63], v[52:55], v[112:127]
    s_add_u32 m0, s25, 115712
    s_nop 0
    buffer_load_dwordx4 v4, s[8:11], s30 offen lds
    s_waitcnt vmcnt(6)
    s_barrier
    ds_read_b128 v[32:35], v6 offset:32768
    ds_read_b128 v[36:39], v8 offset:32768
    ds_read_b64_tr_b16 v[40:41], v10 offset:32768
    ds_read_b64_tr_b16 v[42:43], v10 offset:34816
    ds_read_b64_tr_b16 v[44:45], v12 offset:32768
    ds_read_b64_tr_b16 v[46:47], v12 offset:34816
    ds_read_b128 v[48:51], v6 offset:33792
    ds_read_b128 v[52:55], v8 offset:33792
    ds_read_b64_tr_b16 v[56:57], v10 offset:36864
    ds_read_b64_tr_b16 v[58:59], v10 offset:38912
    ds_read_b64_tr_b16 v[60:61], v12 offset:36864
    ds_read_b64_tr_b16 v[62:63], v12 offset:38912
    s_waitcnt lgkmcnt(6)
    v_mfma_f32_32x32x16_bf16 v[64:79], v[40:43], v[32:35], v[64:79]
    v_mfma_f32_32x32x16_bf16 v[80:95], v[44:47], v[32:35], v[80:95]
    s_lshl_b32 s30, s48, 12
    s_add_u32 s26, s49, s30
    s_lshl_b32 s30, s48, 16
    s_add_u32 s27, s50, s30
    s_add_u32 s48, s48, 1
    s_cmp_eq_u32 s48, s51
    s_cselect_b32 s48, 0, s48
    s_add_u32 m0, s25, 0
    s_add_u32 s30, s27, 4096
    buffer_load_dwordx4 v2, s[16:19], s26 offen lds
    v_mfma_f32_32x32x16_bf16 v[96:111], v[40:43], v[36:39], v[96:111]
    v_mfma_f32_32x32x16_bf16 v[112:127], v[44:47], v[36:39], v[112:127]
    buffer_load_dwordx4 v2, s[16:19], s26 offen offset:1024 lds
    s_waitcnt lgkmcnt(0)
    v_mfma_f32_32x32x16_bf16 v[64:79], v[56:59], v[48:51], v[64:79]
    v_mfma_f32_32x32x16_bf16 v[80:95], v[60:63], v[48:51], v[80:95]
    s_add_u32 m0, s25, 16384
    s_nop 0
    buffer_load_dwordx4 v4, s[8:11], s27 offen lds
    v_mfma_f32_32x32x16_bf16 v[96:111], v[56:59], v[52:55], v[96:111]
    v_mfma_f32_32x32x16_bf16 v[112:127], v[60:63], v[52:55], v[112:127]
    s_add_u32 m0, s25, 17408
    s_nop 0
    buffer_load_dwordx4 v4, s[8:11], s30 offen lds
    s_waitcnt vmcnt(8)
    s_barrier
    ds_read_b128 v[32:35], v7 offset:0
    ds_read_b128 v[36:39], v9 offset:0
    ds_read_b64_tr_b16 v[40:41], v11 offset:0
    ds_read_b64_tr_b16 v[42:43], v11 offset:2048
    ds_read_b64_tr_b16 v[44:45], v13 offset:0
    ds_read_b64_tr_b16 v[46:47], v13 offset:2048
    ds_read_b128 v[48:51], v7 offset:1024
    ds_read_b128 v[52:55], v9 offset:1024
    ds_read_b64_tr_b16 v[56:57], v11 offset:4096
    ds_read_b64_tr_b16 v[58:59], v11 offset:6144
    ds_read_b64_tr_b16 v[60:61], v13 offset:4096
    ds_read_b64_tr_b16 v[62:63], v13 offset:6144
    s_waitcnt lgkmcnt(6)
    v_mfma_f32_32x32x16_bf16 v[64:79], v[40:43], v[32:35], v[64:79]
    v_mfma_f32_32x32x16_bf16 v[80:95], v[44:47], v[32:35], v[80:95]
    s_lshl_b32 s30, s48, 12
    s_add_u32 s26, s49, s30
    s_lshl_b32 s30, s48, 16
    s_add_u32 s27, s50, s30
    s_add_u32 s48, s48, 1
    s_cmp_eq_u32 s48, s51
    s_cselect_b32 s48, 0, s48
    s_add_u32 m0, s25, 32768
    s_add_u32 s30, s27, 4096
    buffer_load_dwordx4 v2, s[16:19], s26 offen lds
    v_mfma_f32_32x32x16_bf16 v[96:111], v[40:43], v[36:39], v[96:111]
    v_mfma_f32_32x32x16_bf16 v[112:127], v[44:47], v[36:39], v[112:127]
    buffer_load_dwordx4 v2, s[16:19], s26 offen offset:1024 lds
    s_waitcnt lgkmcnt(0)
    v_mfma_f32_32x32x16_bf16 v[64:79], v[56:59], v[48:51], v[64:79]
    v_mfma_f32_32x32x16_bf16 v[80:95], v[60:63], v[48:51], v[80:95]
    s_add_u32 m0, s25, 49152
    s_nop 0
    buffer_load_dwordx4 v4, s[8:11], s27 offen lds
    v_mfma_f32_32x32x16_bf16 v[96:111], v[56:59], v[52:55], v[96:111]
    v_mfma_f32_32x32x16_bf16 v[112:127], v[60:63], v[52:55], v[112:127]
    s_add_u32 m0, s25, 50176
    s_nop 0
    buffer_load_dwordx4 v4, s[8:11], s30 offen lds
    s_waitcnt vmcnt(8)
    s_barrier
    ds_read_b128 v[32:35], v7 offset:32768
    ds_read_b128 v[36:39], v9 offset:32768
    ds_read_b64_tr_b16 v[40:41], v11 offset:32768
    ds_read_b64_tr_b16 v[42:43], v11 offset:34816
    ds_read_b64_tr_b16 v[44:45], v13 offset:32768
    ds_read_b64_tr_b16 v[46:47], v13 offset:34816
    ds_read_b128 v[48:51], v7 offset:33792
    ds_read_b128 v[52:55], v9 offset:33792
    ds_read_b64_tr_b16 v[56:57], v11 offset:36864
    ds_read_b64_tr_b16 v[58:59], v11 offset:38912
    ds_read_b64_tr_b16 v[60:61], v13 offset:36864
    ds_read_b64_tr_b16 v[62:63], v13 offset:38912
    s_waitcnt lgkmcnt(6)
    v_mfma_f32_32x32x16_bf16 v[64:79], v[40:43], v[32:35], v[64:79]
    v_mfma_f32_32x32x16_bf16 v[80:95], v[44:47], v[32:35], v[80:95]
    s_lshl_b32 s30, s48, 12
    s_add_u32 s26, s49, s30
    s_lshl_b32 s30, s48, 16
    s_add_u32 s27, s50, s30
    s_add_u32 s48, s48, 1
    s_cmp_eq_u32 s48, s51
    s_cselect_b32 s48, 0, s48
    s_add_u32 m0, s25, 65536
    s_add_u32 s30, s27, 4096
    buffer_load_dwordx4 v2, s[16:19], s26 offen lds
    v_mfma_f32_32x32x16_bf16 v[96:111], v[40:43], v[36:39], v[96:111]
    v_mfma_f32_32x32x16_bf16 v[112:127], v[44:47], v[36:39], v[112:127]
    buffer_load_dwordx4 v2, s[16:19], s26 offen offset:1024 lds
    s_waitcnt lgkmcnt(0)
    v_mfma_f32_32x32x16_bf16 v[64:79], v[56:59], v[48:51], v[64:79]
    v_mfma_f32_32x32x16_bf16 v[80:95], v[60:63], v[48:51], v[80:95]
    s_add_u32 m0, s25, 81920
    s_nop 0
    buffer_load_dwordx4 v4, s[8:11], s27 offen lds
    v_mfma_f32_32x32x16_bf16 v[96:111], v[56:59], v[52:55], v[96:111]
    v_mfma_f32_32x32x16_bf16 v[112:127], v[60:63], v[52:55], v[112:127]
    s_add_u32 m0, s25, 82944
    s_nop 0
    buffer_load_dwordx4 v4, s[8:11], s30 offen lds
    s_waitcnt vmcnt(8)
    s_barrier
    ds_read_b128 v[32:35], v6 offset:0
    ds_read_b128 v[36:39], v8 offset:0
    ds_read_b64_tr_b16 v[40:41], v10 offset:0
    ds_read_b64_tr_b16 v[42:43], v10 offset:2048
    ds_read_b64_tr_b16 v[44:45], v12 offset:0
    ds_read_b64_tr_b16 v[46:47], v12 offset:2048
    ds_read_b128 v[48:51], v6 offset:1024
    ds_read_b128 v[52:55], v8 offset:1024
    ds_read_b64_tr_b16 v[56:57], v10 offset:4096
    ds_read_b64_tr_b16 v[58:59], v10 offset:6144
    ds_read_b64_tr_b16 v[60:61], v12 offset:4096
    ds_read_b64_tr_b16 v[62:63], v12 offset:6144
    s_waitcnt lgkmcnt(6)
    v_mfma_f32_32x32x16_bf16 v[64:79], v[40:43], v[32:35], v[64:79]
    v_mfma_f32_32x32x16_bf16 v[80:95], v[44:47], v[32:35], v[80:95]
    s_mov_b32 s49, s28
    s_mov_b32 s50, s29
    s_and_b32 s48, s48, 7
    s_mov_b32 s51, 8
    s_lshl_b32 s30, s48, 12
    s_add_u32 s26, s49, s30
    s_lshl_b32 s30, s48, 16
    s_add_u32 s27, s50, s30
    s_add_u32 s48, s48, 1
    s_cmp_eq_u32 s48, s51
    s_cselect_b32 s48, 0, s48
    s_add_u32 m0, s25, 98304
    s_add_u32 s30, s27, 4096
    buffer_load_dwordx4 v2, s[16:19], s26 offen lds
    v_mfma_f32_32x32x16_bf16 v[96:111], v[40:43], v[36:39], v[96:111]
    v_mfma_f32_32x32x16_bf16 v[112:127], v[44:47], v[36:39], v[112:127]
    buffer_load_dwordx4 v2, s[16:19], s26 offen offset:1024 lds
    s_waitcnt lgkmcnt(0)
    v_mfma_f32_32x32x16_bf16 v[64:79], v[56:59], v[48:51], v[64:79]
    v_mfma_f32_32x32x16_bf16 v[80:95], v[60:63], v[48:51], v[80:95]
    s_add_u32 m0, s25, 114688
    s_nop 0
    buffer_load_dwordx4 v4, s[12:15], s27 offen lds
    v_mfma_f32_32x32x16_bf16 v[96:111], v[56:59], v[52:55], v[96:111]
    v_mfma_f32_32x32x16_bf16 v[112:127], v[60:63], v[52:55], v[112:127]
    s_add_u32 m0, s25, 115712
    s_nop 0
    buffer_load_dwordx4 v4, s[12:15], s30 offen lds
    s_waitcnt vmcnt(8)
    s_barrier
    ds_read_b128 v[32:35], v6 offset:32768
    ds_read_b128 v[36:39], v8 offset:32768
    ds_read_b64_tr_b16 v[40:41], v10 offset:32768
    ds_read_b64_tr_b16 v[42:43], v10 offset:34816
    ds_read_b64_tr_b16 v[44:45], v12 offset:32768
    ds_read_b64_tr_b16 v[46:47], v12 offset:34816
    ds_read_b128 v[48:51], v6 offset:33792
    ds_read_b128 v[52:55], v8 offset:33792
    ds_read_b64_tr_b16 v[56:57], v10 offset:36864
    ds_read_b64_tr_b16 v[58:59], v10 offset:38912
    ds_read_b64_tr_b16 v[60:61], v12 offset:36864
    ds_read_b64_tr_b16 v[62:63], v12 offset:38912
    s_waitcnt lgkmcnt(6)
    v_mfma_f32_32x32x16_bf16 v[64:79], v[40:43], v[32:35], v[64:79]
    v_mfma_f32_32x32x16_bf16 v[80:95], v[44:47], v[32:35], v[80:95]
    s_lshl_b32 s30, s48, 12
    s_add_u32 s26, s49, s30
    s_lshl_b32 s30, s48, 16
    s_add_u32 s27, s50, s30
    s_add_u32 s48, s48, 1
    s_cmp_eq_u32 s48, s51
    s_cselect_b32 s48, 0, s48
    s_add_u32 m0, s25, 0
    s_add_u32 s30, s27, 4096
    buffer_load_dwordx4 v2, s[16:19], s26 offen lds
    v_mfma_f32_32x32x16_bf16 v[96:111], v[40:43], v[36:39], v[96:111]
    v_mfma_f32_32x32x16_bf16 v[112:127], v[44:47], v[36:39], v[112:127]
    buffer_load_dwordx4 v2, s[16:19], s26 offen offset:1024 lds
    s_waitcnt lgkmcnt(0)
    v_mfma_f32_32x32x16_bf16 v[64:79], v[56:59], v[48:51], v[64:79]
    v_mfma_f32_32x32x16_bf16 v[80:95], v[60:63], v[48:51], v[80:95]
    s_add_u32 m0, s25, 16384
    s_nop 0
    buffer_load_dwordx4 v4, s[12:15], s27 offen lds
    v_mfma_f32_32x32x16_bf16 v[96:111], v[56:59], v[52:55], v[96:111]
    v_mfma_f32_32x32x16_bf16 v[112:127], v[60:63], v[52:55], v[112:127]
    s_add_u32 m0, s25, 17408
    s_nop 0
    buffer_load_dwordx4 v4, s[12:15], s30 offen lds
    s_waitcnt vmcnt(8)
    s_barrier
    ds_read_b128 v[32:35], v7 offset:0
    ds_read_b128 v[36:39], v9 offset:0
    ds_read_b64_tr_b16 v[40:41], v11 offset:0
    ds_read_b64_tr_b16 v[42:43], v11 offset:2048
    ds_read_b64_tr_b16 v[44:45], v13 offset:0
    ds_read_b64_tr_b16 v[46:47], v13 offset:2048
    ds_read_b128 v[48:51], v7 offset:1024
    ds_read_b128 v[52:55], v9 offset:1024
    ds_read_b64_tr_b16 v[56:57], v11 offset:4096
    ds_read_b64_tr_b16 v[58:59], v11 offset:6144
    ds_read_b64_tr_b16 v[60:61], v13 offset:4096
    ds_read_b64_tr_b16 v[62:63], v13 offset:6144
    s_waitcnt lgkmcnt(6)
    v_mfma_f32_32x32x16_bf16 v[64:79], v[40:43], v[32:35], v[64:79]
    v_mfma_f32_32x32x16_bf16 v[80:95], v[44:47], v[32:35], v[80:95]
    s_lshl_b32 s30, s48, 12
    s_add_u32 s26, s49, s30
    s_lshl_b32 s30, s48, 16
    s_add_u32 s27, s50, s30
    s_add_u32 s48, s48, 1
    s_cmp_eq_u32 s48, s51
    s_cselect_b32 s48, 0, s48
    s_add_u32 m0, s25, 32768
    s_add_u32 s30, s27, 4096
    buffer_load_dwordx4 v2, s[16:19], s26 offen lds
    v_mfma_f32_32x32x16_bf16 v[96:111], v[40:43], v[36:39], v[96:111]
    v_mfma_f32_32x32x16_bf16 v[112:127], v[44:47], v[36:39], v[112:127]
    buffer_load_dwordx4 v2, s[16:19], s26 offen offset:1024 lds
    s_waitcnt lgkmcnt(0)
    v_mfma_f32_32x32x16_bf16 v[64:79], v[56:59], v[48:51], v[64:79]
    v_mfma_f32_32x32x16_bf16 v[80:95], v[60:63], v[48:51], v[80:95]
    s_add_u32 m0, s25, 49152
    s_nop 0
    buffer_load_dwordx4 v4, s[12:15], s27 offen lds
    v_mfma_f32_32x32x16_bf16 v[96:111], v[56:59], v[52:55], v[96:111]
    v_mfma_f32_32x32x16_bf16 v[112:127], v[60:63], v[52:55], v[112:127]
    s_add_u32 m0, s25, 50176
    s_nop 0
    buffer_load_dwordx4 v4, s[12:15], s30 offen lds
    s_waitcnt vmcnt(8)
    s_barrier
    ds_read_b128 v[32:35], v7 offset:32768
    ds_read_b128 v[36:39], v9 offset:32768
    ds_read_b64_tr_b16 v[40:41], v11 offset:32768
    ds_read_b64_tr_b16 v[42:43], v11 offset:34816
    ds_read_b64_tr_b16 v[44:45], v13 offset:32768
    ds_read_b64_tr_b16 v[46:47], v13 offset:34816
    ds_read_b128 v[48:51], v7 offset:33792
    ds_read_b128 v[52:55], v9 offset:33792
    ds_read_b64_tr_b16 v[56:57], v11 offset:36864
    ds_read_b64_tr_b16 v[58:59], v11 offset:38912
    ds_read_b64_tr_b16 v[60:61], v13 offset:36864
    ds_read_b64_tr_b16 v[62:63], v13 offset:38912
    s_waitcnt lgkmcnt(6)
    v_mfma_f32_32x32x16_bf16 v[128:143], v[40:43], v[32:35], 0
    v_mfma_f32_32x32x16_bf16 v[144:159], v[44:47], v[32:35], 0
    s_lshl_b32 s30, s48, 12
    s_add_u32 s26, s49, s30
    s_lshl_b32 s30, s48, 16
    s_add_u32 s27, s50, s30
    s_add_u32 s48, s48, 1
    s_cmp_eq_u32 s48, s51
    s_cselect_b32 s48, 0, s48
    s_add_u32 m0, s25, 65536
    s_add_u32 s30, s27, 4096
    buffer_load_dwordx4 v2, s[16:19], s26 offen lds
    v_mfma_f32_32x32x16_bf16 v[160:175], v[40:43], v[36:39], 0
    v_mfma_f32_32x32x16_bf16 v[176:191], v[44:47], v[36:39], 0
    buffer_load_dwordx4 v2, s[16:19], s26 offen offset:1024 lds
    s_waitcnt lgkmcnt(0)
    v_mfma_f32_32x32x16_bf16 v[128:143], v[56:59], v[48:51], v[128:143]
    v_mfma_f32_32x32x16_bf16 v[144:159], v[60:63], v[48:51], v[144:159]
    s_add_u32 m0, s25, 81920
    s_nop 0
    buffer_load_dwordx4 v4, s[12:15], s27 offen lds
    v_mfma_f32_32x32x16_bf16 v[160:175], v[56:59], v[52:55], v[160:175]
    v_mfma_f32_32x32x16_bf16 v[176:191], v[60:63], v[52:55], v[176:191]
    s_add_u32 m0, s25, 82944
    s_nop 0
    buffer_load_dwordx4 v4, s[12:15], s30 offen lds
    s_waitcnt vmcnt(8)
    s_barrier
    ds_read_b128 v[32:35], v6 offset:0
    ds_read_b128 v[36:39], v8 offset:0
    ds_read_b64_tr_b16 v[40:41], v10 offset:0
    ds_read_b64_tr_b16 v[42:43], v10 offset:2048
    ds_read_b64_tr_b16 v[44:45], v12 offset:0
    ds_read_b64_tr_b16 v[46:47], v12 offset:2048
    ds_read_b128 v[48:51], v6 offset:1024
    ds_read_b128 v[52:55], v8 offset:1024
    ds_read_b64_tr_b16 v[56:57], v10 offset:4096
    ds_read_b64_tr_b16 v[58:59], v10 offset:6144
    ds_read_b64_tr_b16 v[60:61], v12 offset:4096
    ds_read_b64_tr_b16 v[62:63], v12 offset:6144
    s_waitcnt lgkmcnt(6)
    v_mfma_f32_32x32x16_bf16 v[128:143], v[40:43], v[32:35], v[128:143]
    v_mfma_f32_32x32x16_bf16 v[144:159], v[44:47], v[32:35], v[144:159]
    s_lshl_b32 s30, s48, 12
    s_add_u32 s26, s49, s30
    s_lshl_b32 s30, s48, 16
    s_add_u32 s27, s50, s30
    s_add_u32 s48, s48, 1
    s_cmp_eq_u32 s48, s51
    s_cselect_b32 s48, 0, s48
    s_add_u32 m0, s25, 98304
    s_add_u32 s30, s27, 4096
    buffer_load_dwordx4 v2, s[16:19], s26 offen lds
    v_mfma_f32_32x32x16_bf16 v[160:175], v[40:43], v[36:39], v[160:175]
    v_mfma_f32_32x32x16_bf16 v[176:191], v[44:47], v[36:39], v[176:191]
    buffer_load_dwordx4 v2, s[16:19], s26 offen offset:1024 lds
    s_waitcnt lgkmcnt(0)
    v_mfma_f32_32x32x16_bf16 v[128:143], v[56:59], v[48:51], v[128:143]
    v_mfma_f32_32x32x16_bf16 v[144:159], v[60:63], v[48:51], v[144:159]
    s_add_u32 m0, s25, 114688
    s_nop 0
    buffer_load_dwordx4 v4, s[12:15], s27 offen lds
    v_mfma_f32_32x32x16_bf16 v[160:175], v[56:59], v[52:55], v[160:175]
    v_mfma_f32_32x32x16_bf16 v[176:191], v[60:63], v[52:55], v[176:191]
    s_add_u32 m0, s25, 115712
    s_nop 0
    buffer_load_dwordx4 v4, s[12:15], s30 offen lds
    s_waitcnt vmcnt(8)
    s_barrier
    ds_read_b128 v[32:35], v6 offset:32768
    ds_read_b128 v[36:39], v8 offset:32768
    ds_read_b64_tr_b16 v[40:41], v10 offset:32768
    ds_read_b64_tr_b16 v[42:43], v10 offset:34816
    ds_read_b64_tr_b16 v[44:45], v12 offset:32768
    ds_read_b64_tr_b16 v[46:47], v12 offset:34816
    ds_read_b128 v[48:51], v6 offset:33792
    ds_read_b128 v[52:55], v8 offset:33792
    ds_read_b64_tr_b16 v[56:57], v10 offset:36864
    ds_read_b64_tr_b16 v[58:59], v10 offset:38912
    ds_read_b64_tr_b16 v[60:61], v12 offset:36864
    ds_read_b64_tr_b16 v[62:63], v12 offset:38912
    s_waitcnt lgkmcnt(6)
    v_mfma_f32_32x32x16_bf16 v[128:143], v[40:43], v[32:35], v[128:143]
    v_mfma_f32_32x32x16_bf16 v[144:159], v[44:47], v[32:35], v[144:159]
    s_lshl_b32 s30, s48, 12
    s_add_u32 s26, s49, s30
    s_lshl_b32 s30, s48, 16
    s_add_u32 s27, s50, s30
    s_add_u32 s48, s48, 1
    s_cmp_eq_u32 s48, s51
    s_cselect_b32 s48, 0, s48
    s_add_u32 m0, s25, 0
    s_add_u32 s30, s27, 4096
    buffer_load_dwordx4 v2, s[16:19], s26 offen lds
    v_mfma_f32_32x32x16_bf16 v[160:175], v[40:43], v[36:39], v[160:175]
    v_mfma_f32_32x32x16_bf16 v[176:191], v[44:47], v[36:39], v[176:191]
    buffer_load_dwordx4 v2, s[16:19], s26 offen offset:1024 lds
    s_waitcnt lgkmcnt(0)
    v_mfma_f32_32x32x16_bf16 v[128:143], v[56:59], v[48:51], v[128:143]
    v_mfma_f32_32x32x16_bf16 v[144:159], v[60:63], v[48:51], v[144:159]
    s_add_u32 m0, s25, 16384
    s_nop 0
    buffer_load_dwordx4 v4, s[12:15], s27 offen lds
    v_mfma_f32_32x32x16_bf16 v[160:175], v[56:59], v[52:55], v[160:175]
    v_mfma_f32_32x32x16_bf16 v[176:191], v[60:63], v[52:55], v[176:191]
    s_add_u32 m0, s25, 17408
    s_nop 0
    buffer_load_dwordx4 v4, s[12:15], s30 offen lds
    s_waitcnt vmcnt(8)
    s_barrier
    ds_read_b128 v[32:35], v7 offset:0
    ds_read_b128 v[36:39], v9 offset:0
    ds_read_b64_tr_b16 v[40:41], v11 offset:0
    ds_read_b64_tr_b16 v[42:43], v11 offset:2048
    ds_read_b64_tr_b16 v[44:45], v13 offset:0
    ds_read_b64_tr_b16 v[46:47], v13 offset:2048
    ds_read_b128 v[48:51], v7 offset:1024
    ds_read_b128 v[52:55], v9 offset:1024
    ds_read_b64_tr_b16 v[56:57], v11 offset:4096
    ds_read_b64_tr_b16 v[58:59], v11 offset:6144
    ds_read_b64_tr_b16 v[60:61], v13 offset:4096
    ds_read_b64_tr_b16 v[62:63], v13 offset:6144
    s_waitcnt lgkmcnt(6)
    v_mfma_f32_32x32x16_bf16 v[128:143], v[40:43], v[32:35], v[128:143]
    v_mfma_f32_32x32x16_bf16 v[144:159], v[44:47], v[32:35], v[144:159]
    s_lshl_b32 s30, s48, 12
    s_add_u32 s26, s49, s30
    s_lshl_b32 s30, s48, 16
    s_add_u32 s27, s50, s30
    s_add_u32 s48, s48, 1
    s_cmp_eq_u32 s48, s51
    s_cselect_b32 s48, 0, s48
    s_add_u32 m0, s25, 32768
    s_add_u32 s30, s27, 4096
    buffer_load_dwordx4 v2, s[16:19], s26 offen lds
    v_mfma_f32_32x32x16_bf16 v[160:175], v[40:43], v[36:39], v[160:175]
    v_mfma_f32_32x32x16_bf16 v[176:191], v[44:47], v[36:39], v[176:191]
    buffer_load_dwordx4 v2, s[16:19], s26 offen offset:1024 lds
    s_waitcnt lgkmcnt(0)
    v_mfma_f32_32x32x16_bf16 v[128:143], v[56:59], v[48:51], v[128:143]
    v_mfma_f32_32x32x16_bf16 v[144:159], v[60:63], v[48:51], v[144:159]
    s_add_u32 m0, s25, 49152
    s_nop 0
    buffer_load_dwordx4 v4, s[12:15], s27 offen lds
    v_mfma_f32_32x32x16_bf16 v[160:175], v[56:59], v[52:55], v[160:175]
    v_mfma_f32_32x32x16_bf16 v[176:191], v[60:63], v[52:55], v[176:191]
    s_add_u32 m0, s25, 50176
    s_nop 0
    buffer_load_dwordx4 v4, s[12:15], s30 offen lds
    s_waitcnt vmcnt(8)
    s_barrier
    ds_read_b128 v[32:35], v7 offset:32768
    ds_read_b128 v[36:39], v9 offset:32768
    ds_read_b64_tr_b16 v[40:41], v11 offset:32768
    ds_read_b64_tr_b16 v[42:43], v11 offset:34816
    ds_read_b64_tr_b16 v[44:45], v13 offset:32768
    ds_read_b64_tr_b16 v[46:47], v13 offset:34816
    ds_read_b128 v[48:51], v7 offset:33792
    ds_read_b128 v[52:55], v9 offset:33792
    ds_read_b64_tr_b16 v[56:57], v11 offset:36864
    ds_read_b64_tr_b16 v[58:59], v11 offset:38912
    ds_read_b64_tr_b16 v[60:61], v13 offset:36864
    ds_read_b64_tr_b16 v[62:63], v13 offset:38912
    s_waitcnt lgkmcnt(6)
    v_mfma_f32_32x32x16_bf16 v[128:143], v[40:43], v[32:35], v[128:143]
    v_mfma_f32_32x32x16_bf16 v[144:159], v[44:47], v[32:35], v[144:159]
    s_lshl_b32 s30, s48, 12
    s_add_u32 s26, s49, s30
    s_lshl_b32 s30, s48, 16
    s_add_u32 s27, s50, s30
    s_add_u32 s48, s48, 1
    s_cmp_eq_u32 s48, s51
    s_cselect_b32 s48, 0, s48
    s_add_u32 m0, s25, 65536
    s_add_u32 s30, s27, 4096
    buffer_load_dwordx4 v2, s[16:19], s26 offen lds
    v_mfma_f32_32x32x16_bf16 v[160:175], v[40:43], v[36:39], v[160:175]
    v_mfma_f32_32x32x16_bf16 v[176:191], v[44:47], v[36:39], v[176:191]
    buffer_load_dwordx4 v2, s[16:19], s26 offen offset:1024 lds
    s_waitcnt lgkmcnt(0)
    v_mfma_f32_32x32x16_bf16 v[128:143], v[56:59], v[48:51], v[128:143]
    v_mfma_f32_32x32x16_bf16 v[144:159], v[60:63], v[48:51], v[144:159]
    s_add_u32 m0, s25, 81920
    s_nop 0
    buffer_load_dwordx4 v4, s[12:15], s27 offen lds
    v_mfma_f32_32x32x16_bf16 v[160:175], v[56:59], v[52:55], v[160:175]
    v_mfma_f32_32x32x16_bf16 v[176:191], v[60:63], v[52:55], v[176:191]
    s_add_u32 m0, s25, 82944
    s_nop 0
    buffer_load_dwordx4 v4, s[12:15], s30 offen lds
    s_waitcnt vmcnt(8)
    s_barrier
    ds_read_b128 v[32:35], v6 offset:0
    ds_read_b128 v[36:39], v8 offset:0
    ds_read_b64_tr_b16 v[40:41], v10 offset:0
    ds_read_b64_tr_b16 v[42:43], v10 offset:2048
    ds_read_b64_tr_b16 v[44:45], v12 offset:0
    ds_read_b64_tr_b16 v[46:47], v12 offset:2048
    ds_read_b128 v[48:51], v6 offset:1024
    ds_read_b128 v[52:55], v8 offset:1024
    ds_read_b64_tr_b16 v[56:57], v10 offset:4096
    ds_read_b64_tr_b16 v[58:59], v10 offset:6144
    ds_read_b64_tr_b16 v[60:61], v12 offset:4096
    ds_read_b64_tr_b16 v[62:63], v12 offset:6144
    s_waitcnt lgkmcnt(6)
    v_mfma_f32_32x32x16_bf16 v[128:143], v[40:43], v[32:35], v[128:143]
    v_mfma_f32_32x32x16_bf16 v[144:159], v[44:47], v[32:35], v[144:159]
    v_mfma_f32_32x32x16_bf16 v[160:175], v[40:43], v[36:39], v[160:175]
    v_mfma_f32_32x32x16_bf16 v[176:191], v[44:47], v[36:39], v[176:191]
    s_waitcnt lgkmcnt(0)
    v_mfma_f32_32x32x16_bf16 v[128:143], v[56:59], v[48:51], v[128:143]
    v_mfma_f32_32x32x16_bf16 v[144:159], v[60:63], v[48:51], v[144:159]
    v_mfma_f32_32x32x16_bf16 v[160:175], v[56:59], v[52:55], v[160:175]
    v_mfma_f32_32x32x16_bf16 v[176:191], v[60:63], v[52:55], v[176:191]
    s_waitcnt vmcnt(4)
    s_barrier
    ds_read_b128 v[32:35], v6 offset:32768
    ds_read_b128 v[36:39], v8 offset:32768
    ds_read_b64_tr_b16 v[40:41], v10 offset:32768
    ds_read_b64_tr_b16 v[42:43], v10 offset:34816
    ds_read_b64_tr_b16 v[44:45], v12 offset:32768
    ds_read_b64_tr_b16 v[46:47], v12 offset:34816
    ds_read_b128 v[48:51], v6 offset:33792
    ds_read_b128 v[52:55], v8 offset:33792
    ds_read_b64_tr_b16 v[56:57], v10 offset:36864
    ds_read_b64_tr_b16 v[58:59], v10 offset:38912
    ds_read_b64_tr_b16 v[60:61], v12 offset:36864
    ds_read_b64_tr_b16 v[62:63], v12 offset:38912
    s_waitcnt lgkmcnt(6)
    v_mfma_f32_32x32x16_bf16 v[128:143], v[40:43], v[32:35], v[128:143]
    v_mfma_f32_32x32x16_bf16 v[144:159], v[44:47], v[32:35], v[144:159]
    v_mfma_f32_32x32x16_bf16 v[160:175], v[40:43], v[36:39], v[160:175]
    v_mfma_f32_32x32x16_bf16 v[176:191], v[44:47], v[36:39], v[176:191]
    s_waitcnt lgkmcnt(0)
    v_mfma_f32_32x32x16_bf16 v[128:143], v[56:59], v[48:51], v[128:143]
    v_mfma_f32_32x32x16_bf16 v[144:159], v[60:63], v[48:51], v[144:159]
    v_mfma_f32_32x32x16_bf16 v[160:175], v[56:59], v[52:55], v[160:175]
    v_mfma_f32_32x32x16_bf16 v[176:191], v[60:63], v[52:55], v[176:191]
    s_waitcnt vmcnt(0)
    s_barrier
    ds_read_b128 v[32:35], v7 offset:0
    ds_read_b128 v[36:39], v9 offset:0
    ds_read_b64_tr_b16 v[40:41], v11 offset:0
    ds_read_b64_tr_b16 v[42:43], v11 offset:2048
    ds_read_b64_tr_b16 v[44:45], v13 offset:0
    ds_read_b64_tr_b16 v[46:47], v13 offset:2048
    ds_read_b128 v[48:51], v7 offset:1024
    ds_read_b128 v[52:55], v9 offset:1024
    ds_read_b64_tr_b16 v[56:57], v11 offset:4096
    ds_read_b64_tr_b16 v[58:59], v11 offset:6144
    ds_read_b64_tr_b16 v[60:61], v13 offset:4096
    ds_read_b64_tr_b16 v[62:63], v13 offset:6144
    s_waitcnt lgkmcnt(6)
    v_mfma_f32_32x32x16_bf16 v[128:143], v[40:43], v[32:35], v[128:143]
    v_mfma_f32_32x32x16_bf16 v[144:159], v[44:47], v[32:35], v[144:159]
    v_mfma_f32_32x32x16_bf16 v[160:175], v[40:43], v[36:39], v[160:175]
    v_mfma_f32_32x32x16_bf16 v[176:191], v[44:47], v[36:39], v[176:191]
    s_waitcnt lgkmcnt(0)
    v_mfma_f32_32x32x16_bf16 v[128:143], v[56:59], v[48:51], v[128:143]
    v_mfma_f32_32x32x16_bf16 v[144:159], v[60:63], v[48:51], v[144:159]
    v_mfma_f32_32x32x16_bf16 v[160:175], v[56:59], v[52:55], v[160:175]
    v_mfma_f32_32x32x16_bf16 v[176:191], v[60:63], v[52:55], v[176:191]
    s_lshl_b32 s30, s35, 1
    s_add_u32 s38, s30, s34
    s_lshl_b32 s37, s38, 5
    s_lshl_b32 s31, s21, 7
    s_add_u32 s30, s37, s31
    s_lshl_b32 s30, s30, 2
    s_add_u32 s30, s30, 76546048
    v_and_b32 v22, 31, v3
    v_lshlrev_b32 v5, 2, v22
    buffer_load_dword v5, v5, s[16:19], s30 offen
    s_barrier
    s_lshl_b32 s30, s20, 13
    v_add_u32 v14, s30, v2
    s_xor_b32 s30, s20, 4
    s_lshl_b32 s30, s30, 13
    v_add_u32 v15, s30, v2
    v_add_u32 v16, 0x10000, v14
    v_add_u32 v17, 0x10000, v15
    s_nop 7
    ds_write_b128 v14, v[96:99] offset:0
    ds_write_b128 v14, v[100:103] offset:1024
    ds_write_b128 v14, v[104:107] offset:2048
    ds_write_b128 v14, v[108:111] offset:3072
    ds_write_b128 v14, v[112:115] offset:4096
    ds_write_b128 v14, v[116:119] offset:5120
    ds_write_b128 v14, v[120:123] offset:6144
    ds_write_b128 v14, v[124:127] offset:7168
    ds_write_b128 v16, v[160:163] offset:0
    ds_write_b128 v16, v[164:167] offset:1024
    ds_write_b128 v16, v[168:171] offset:2048
    ds_write_b128 v16, v[172:175] offset:3072
    ds_write_b128 v16, v[176:179] offset:4096
    ds_write_b128 v16, v[180:183] offset:5120
    ds_write_b128 v16, v[184:187] offset:6144
    ds_write_b128 v16, v[188:191] offset:7168
    s_waitcnt lgkmcnt(0)
    s_barrier
    ds_read_b128 v[96:99], v15 offset:0
    ds_read_b128 v[100:103], v15 offset:1024
    ds_read_b128 v[104:107], v15 offset:2048
    ds_read_b128 v[108:111], v15 offset:3072
    ds_read_b128 v[112:115], v15 offset:4096
    ds_read_b128 v[116:119], v15 offset:5120
    ds_read_b128 v[120:123], v15 offset:6144
    ds_read_b128 v[124:127], v15 offset:7168
    ds_read_b128 v[160:163], v17 offset:0
    ds_read_b128 v[164:167], v17 offset:1024
    ds_read_b128 v[168:171], v17 offset:2048
    ds_read_b128 v[172:175], v17 offset:3072
    ds_read_b128 v[176:179], v17 offset:4096
    ds_read_b128 v[180:183], v17 offset:5120
    ds_read_b128 v[184:187], v17 offset:6144
    ds_read_b128 v[188:191], v17 offset:7168
    s_waitcnt lgkmcnt(0)
    v_add_f32 v64, v64, v96
    v_add_f32 v65, v65, v97
    v_add_f32 v66, v66, v98
    v_add_f32 v67, v67, v99
    v_add_f32 v68, v68, v100
    v_add_f32 v69, v69, v101
    v_add_f32 v70, v70, v102
    v_add_f32 v71, v71, v103
    v_add_f32 v72, v72, v104
    v_add_f32 v73, v73, v105
    v_add_f32 v74, v74, v106
    v_add_f32 v75, v75, v107
    v_add_f32 v76, v76, v108
    v_add_f32 v77, v77, v109
    v_add_f32 v78, v78, v110
    v_add_f32 v79, v79, v111
    v_add_f32 v80, v80, v112
    v_add_f32 v81, v81, v113
    v_add_f32 v82, v82, v114
    v_add_f32 v83, v83, v115
    v_add_f32 v84, v84, v116
    v_add_f32 v85, v85, v117
    v_add_f32 v86, v86, v118
    v_add_f32 v87, v87, v119
    v_add_f32 v88, v88, v120
    v_add_f32 v89, v89, v121
    v_add_f32 v90, v90, v122
    v_add_f32 v91, v91, v123
    v_add_f32 v92, v92, v124
    v_add_f32 v93, v93, v125
    v_add_f32 v94, v94, v126
    v_add_f32 v95, v95, v127
    v_add_f32 v128, v128, v160
    v_add_f32 v129, v129, v161
    v_add_f32 v130, v130, v162
    v_add_f32 v131, v131, v163
    v_add_f32 v132, v132, v164
    v_add_f32 v133, v133, v165
    v_add_f32 v134, v134, v166
    v_add_f32 v135, v135, v167
    v_add_f32 v136, v136, v168
    v_add_f32 v137, v137, v169
    v_add_f32 v138, v138, v170
    v_add_f32 v139, v139, v171
    v_add_f32 v140, v140, v172
    v_add_f32 v141, v141, v173
    v_add_f32 v142, v142, v174
    v_add_f32 v143, v143, v175
    v_add_f32 v144, v144, v176
    v_add_f32 v145, v145, v177
    v_add_f32 v146, v146, v178
    v_add_f32 v147, v147, v179
    v_add_f32 v148, v148, v180
    v_add_f32 v149, v149, v181
    v_add_f32 v150, v150, v182
    v_add_f32 v151, v151, v183
    v_add_f32 v152, v152, v184
    v_add_f32 v153, v153, v185
    v_add_f32 v154, v154, v186
    v_add_f32 v155, v155, v187
    v_add_f32 v156, v156, v188
    v_add_f32 v157, v157, v189
    v_add_f32 v158, v158, v190
    v_add_f32 v159, v159, v191
    s_lshl_b32 s39, s24, 2
    s_add_u32 s39, s39, s38
    s_lshl_b32 s39, s39, 1
    s_add_u32 s39, s39, s36
    s_lshl_b32 s39, s39, 16
    s_add_u32 s39, s39, 83886080
    s_lshl_b32 s40, s38, 1
    s_add_u32 s40, s40, s36
    s_lshl_b32 s40, s40, 2
    s_lshl_b32 s30, s24, 8
    s_add_u32 s40, s40, s30
    s_add_u32 s40, s40, 77594624
    v_mov_b32 v14, 0
    s_cmp_eq_u32 s38, s23
    s_cbranch_scc1 K3_FZF
    s_lshl_b32 s30, s23, 13
    s_add_u32 s30, s30, s39
    s_add_u32 s31, s30, 4096
    buffer_store_dwordx4 v[64:67], v2, s[16:19], s30 offen offset:0 sc1
    buffer_store_dwordx4 v[68:71], v2, s[16:19], s30 offen offset:1024 sc1
    buffer_store_dwordx4 v[72:75], v2, s[16:19], s30 offen offset:2048 sc1
    buffer_store_dwordx4 v[76:79], v2, s[16:19], s30 offen offset:3072 sc1
    buffer_store_dwordx4 v[80:83], v2, s[16:19], s31 offen offset:0 sc1
    buffer_store_dwordx4 v[84:87], v2, s[16:19], s31 offen offset:1024 sc1
    buffer_store_dwordx4 v[88:91], v2, s[16:19], s31 offen offset:2048 sc1
    buffer_store_dwordx4 v[92:95], v2, s[16:19], s31 offen offset:3072 sc1
    s_waitcnt vmcnt(8)
    v_sub_f32 v20, 1.0, v5
    v_cvt_pk_bf16_f32 v20, v20, v20
    v_lshlrev_b32 v20, 16, v20
    v_cvt_pk_bf16_f32 v128, v128, v128
    v_lshlrev_b32 v128, 16, v128
    v_mul_f32 v128, v128, v20
    v_cvt_pk_bf16_f32 v128, v128, v128
    v_lshlrev_b32 v128, 16, v128
    v_cvt_pk_bf16_f32 v129, v129, v129
    v_lshlrev_b32 v129, 16, v129
    v_mul_f32 v129, v129, v20
    v_cvt_pk_bf16_f32 v129, v129, v129
    v_lshlrev_b32 v129, 16, v129
    v_cvt_pk_bf16_f32 v130, v130, v130
    v_lshlrev_b32 v130, 16, v130
    v_mul_f32 v130, v130, v20
    v_cvt_pk_bf16_f32 v130, v130, v130
    v_lshlrev_b32 v130, 16, v130
    v_cvt_pk_bf16_f32 v131, v131, v131
    v_lshlrev_b32 v131, 16, v131
    v_mul_f32 v131, v131, v20
    v_cvt_pk_bf16_f32 v131, v131, v131
    v_lshlrev_b32 v131, 16, v131
    v_cvt_pk_bf16_f32 v132, v132, v132
    v_lshlrev_b32 v132, 16, v132
    v_mul_f32 v132, v132, v20
    v_cvt_pk_bf16_f32 v132, v132, v132
    v_lshlrev_b32 v132, 16, v132
    v_cvt_pk_bf16_f32 v133, v133, v133
    v_lshlrev_b32 v133, 16, v133
    v_mul_f32 v133, v133, v20
    v_cvt_pk_bf16_f32 v133, v133, v133
    v_lshlrev_b32 v133, 16, v133
    v_cvt_pk_bf16_f32 v134, v134, v134
    v_lshlrev_b32 v134, 16, v134
    v_mul_f32 v134, v134, v20
    v_cvt_pk_bf16_f32 v134, v134, v134
    v_lshlrev_b32 v134, 16, v134
    v_cvt_pk_bf16_f32 v135, v135, v135
    v_lshlrev_b32 v135, 16, v135
    v_mul_f32 v135, v135, v20
    v_cvt_pk_bf16_f32 v135, v135, v135
    v_lshlrev_b32 v135, 16, v135
    v_cvt_pk_bf16_f32 v136, v136, v136
    v_lshlrev_b32 v136, 16, v136
    v_mul_f32 v136, v136, v20
    v_cvt_pk_bf16_f32 v136, v136, v136
    v_lshlrev_b32 v136, 16, v136
    v_cvt_pk_bf16_f32 v137, v137, v137
    v_lshlrev_b32 v137, 16, v137
    v_mul_f32 v137, v137, v20
    v_cvt_pk_bf16_f32 v137, v137, v137
    v_lshlrev_b32 v137, 16, v137
    v_cvt_pk_bf16_f32 v138, v138, v138
    v_lshlrev_b32 v138, 16, v138
    v_mul_f32 v138, v138, v20
    v_cvt_pk_bf16_f32 v138, v138, v138
    v_lshlrev_b32 v138, 16, v138
    v_cvt_pk_bf16_f32 v139, v139, v139
    v_lshlrev_b32 v139, 16, v139
    v_mul_f32 v139, v139, v20
    v_cvt_pk_bf16_f32 v139, v139, v139
    v_lshlrev_b32 v139, 16, v139
    v_cvt_pk_bf16_f32 v140, v140, v140
    v_lshlrev_b32 v140, 16, v140
    v_mul_f32 v140, v140, v20
    v_cvt_pk_bf16_f32 v140, v140, v140
    v_lshlrev_b32 v140, 16, v140
    v_cvt_pk_bf16_f32 v141, v141, v141
    v_lshlrev_b32 v141, 16, v141
    v_mul_f32 v141, v141, v20
    v_cvt_pk_bf16_f32 v141, v141, v141
    v_lshlrev_b32 v141, 16, v141
    v_cvt_pk_bf16_f32 v142, v142, v142
    v_lshlrev_b32 v142, 16, v142
    v_mul_f32 v142, v142, v20
    v_cvt_pk_bf16_f32 v142, v142, v142
    v_lshlrev_b32 v142, 16, v142
    v_cvt_pk_bf16_f32 v143, v143, v143
    v_lshlrev_b32 v143, 16, v143
    v_mul_f32 v143, v143, v20
    v_cvt_pk_bf16_f32 v143, v143, v143
    v_lshlrev_b32 v143, 16, v143
    v_cvt_pk_bf16_f32 v144, v144, v144
    v_lshlrev_b32 v144, 16, v144
    v_mul_f32 v144, v144, v20
    v_cvt_pk_bf16_f32 v144, v144, v144
    v_lshlrev_b32 v144, 16, v144
    v_cvt_pk_bf16_f32 v145, v145, v145
    v_lshlrev_b32 v145, 16, v145
    v_mul_f32 v145, v145, v20
    v_cvt_pk_bf16_f32 v145, v145, v145
    v_lshlrev_b32 v145, 16, v145
    v_cvt_pk_bf16_f32 v146, v146, v146
    v_lshlrev_b32 v146, 16, v146
    v_mul_f32 v146, v146, v20
    v_cvt_pk_bf16_f32 v146, v146, v146
    v_lshlrev_b32 v146, 16, v146
    v_cvt_pk_bf16_f32 v147, v147, v147
    v_lshlrev_b32 v147, 16, v147
    v_mul_f32 v147, v147, v20
    v_cvt_pk_bf16_f32 v147, v147, v147
    v_lshlrev_b32 v147, 16, v147
    v_cvt_pk_bf16_f32 v148, v148, v148
    v_lshlrev_b32 v148, 16, v148
    v_mul_f32 v148, v148, v20
    v_cvt_pk_bf16_f32 v148, v148, v148
    v_lshlrev_b32 v148, 16, v148
    v_cvt_pk_bf16_f32 v149, v149, v149
    v_lshlrev_b32 v149, 16, v149
    v_mul_f32 v149, v149, v20
    v_cvt_pk_bf16_f32 v149, v149, v149
    v_lshlrev_b32 v149, 16, v149
    v_cvt_pk_bf16_f32 v150, v150, v150
    v_lshlrev_b32 v150, 16, v150
    v_mul_f32 v150, v150, v20
    v_cvt_pk_bf16_f32 v150, v150, v150
    v_lshlrev_b32 v150, 16, v150
    v_cvt_pk_bf16_f32 v151, v151, v151
    v_lshlrev_b32 v151, 16, v151
    v_mul_f32 v151, v151, v20
    v_cvt_pk_bf16_f32 v151, v151, v151
    v_lshlrev_b32 v151, 16, v151
    v_cvt_pk_bf16_f32 v152, v152, v152
    v_lshlrev_b32 v152, 16, v152
    v_mul_f32 v152, v152, v20
    v_cvt_pk_bf16_f32 v152, v152, v152
    v_lshlrev_b32 v152, 16, v152
    v_cvt_pk_bf16_f32 v153, v153, v153
    v_lshlrev_b32 v153, 16, v153
    v_mul_f32 v153, v153, v20
    v_cvt_pk_bf16_f32 v153, v153, v153
    v_lshlrev_b32 v153, 16, v153
    v_cvt_pk_bf16_f32 v154, v154, v154
    v_lshlrev_b32 v154, 16, v154
    v_mul_f32 v154, v154, v20
    v_cvt_pk_bf16_f32 v154, v154, v154
    v_lshlrev_b32 v154, 16, v154
    v_cvt_pk_bf16_f32 v155, v155, v155
    v_lshlrev_b32 v155, 16, v155
    v_mul_f32 v155, v155, v20
    v_cvt_pk_bf16_f32 v155, v155, v155
    v_lshlrev_b32 v155, 16, v155
    v_cvt_pk_bf16_f32 v156, v156, v156
    v_lshlrev_b32 v156, 16, v156
    v_mul_f32 v156, v156, v20
    v_cvt_pk_bf16_f32 v156, v156, v156
    v_lshlrev_b32 v156, 16, v156
    v_cvt_pk_bf16_f32 v157, v157, v157
    v_lshlrev_b32 v157, 16, v157
    v_mul_f32 v157, v157, v20
    v_cvt_pk_bf16_f32 v157, v157, v157
    v_lshlrev_b32 v157, 16, v157
    v_cvt_pk_bf16_f32 v158, v158, v158
    v_lshlrev_b32 v158, 16, v158
    v_mul_f32 v158, v158, v20
    v_cvt_pk_bf16_f32 v158, v158, v158
    v_lshlrev_b32 v158, 16, v158
    v_cvt_pk_bf16_f32 v159, v159, v159
    v_lshlrev_b32 v159, 16, v159
    v_mul_f32 v159, v159, v20
    v_cvt_pk_bf16_f32 v159, v159, v159
    v_lshlrev_b32 v159, 16, v159
    s_add_u32 s30, s39, 32768
    v_cvt_pk_bf16_f32 v160, v128, v129
    v_cvt_pk_bf16_f32 v161, v130, v131
    v_cvt_pk_bf16_f32 v162, v132, v133
    v_cvt_pk_bf16_f32 v163, v134, v135
    buffer_store_dwordx4 v[160:163], v2, s[16:19], s30 offen offset:0 sc1
    v_cvt_pk_bf16_f32 v164, v136, v137
    v_cvt_pk_bf16_f32 v165, v138, v139
    v_cvt_pk_bf16_f32 v166, v140, v141
    v_cvt_pk_bf16_f32 v167, v142, v143
    buffer_store_dwordx4 v[164:167], v2, s[16:19], s30 offen offset:1024 sc1
    v_cvt_pk_bf16_f32 v168, v144, v145
    v_cvt_pk_bf16_f32 v169, v146, v147
    v_cvt_pk_bf16_f32 v170, v148, v149
    v_cvt_pk_bf16_f32 v171, v150, v151
    buffer_store_dwordx4 v[168:171], v2, s[16:19], s30 offen offset:2048 sc1
    v_cvt_pk_bf16_f32 v172, v152, v153
    v_cvt_pk_bf16_f32 v173, v154, v155
    v_cvt_pk_bf16_f32 v174, v156, v157
    v_cvt_pk_bf16_f32 v175, v158, v159
    buffer_store_dwordx4 v[172:175], v2, s[16:19], s30 offen offset:3072 sc1
    v_mov_b32 v15, 1
    s_waitcnt vmcnt(0)
    s_mov_b64 exec, 1
    buffer_atomic_add v15, v14, s[16:19], s40 offen sc1
    s_mov_b64 exec, -1
    s_endpgm
K3_FZF:
    s_mov_b32 s31, 0
K3_SPINF:
    v_mov_b32 v15, 0
    s_mov_b64 exec, 1
    buffer_atomic_or v15, v14, s[16:19], s40 offen sc0 sc1
    s_mov_b64 exec, -1
    s_waitcnt vmcnt(0)
    v_readfirstlane_b32 s32, v15
    s_cmp_ge_u32 s32, 3
    s_cbranch_scc1 K3_GOF
    s_sleep 4
    s_add_u32 s31, s31, 1
    s_cmp_lt_u32 s31, 0x40000
    s_cbranch_scc1 K3_SPINF
K3_GOF:
    s_add_u32 s30, s23, 1
    s_and_b32 s30, s30, 3
    s_lshl_b32 s30, s30, 13
    s_add_u32 s30, s30, s39
    s_add_u32 s31, s30, 4096
    buffer_load_dwordx4 v[192:195], v2, s[16:19], s30 offen offset:0 sc1
    buffer_load_dwordx4 v[196:199], v2, s[16:19], s30 offen offset:1024 sc1
    buffer_load_dwordx4 v[200:203], v2, s[16:19], s30 offen offset:2048 sc1
    buffer_load_dwordx4 v[204:207], v2, s[16:19], s30 offen offset:3072 sc1
    buffer_load_dwordx4 v[208:211], v2, s[16:19], s31 offen offset:0 sc1
    buffer_load_dwordx4 v[212:215], v2, s[16:19], s31 offen offset:1024 sc1
    buffer_load_dwordx4 v[216:219], v2, s[16:19], s31 offen offset:2048 sc1
    buffer_load_dwordx4 v[220:223], v2, s[16:19], s31 offen offset:3072 sc1
    s_add_u32 s30, s23, 2
    s_and_b32 s30, s30, 3
    s_lshl_b32 s30, s30, 13
    s_add_u32 s30, s30, s39
    s_add_u32 s31, s30, 4096
    buffer_load_dwordx4 v[224:227], v2, s[16:19], s30 offen offset:0 sc1
    buffer_load_dwordx4 v[228:231], v2, s[16:19], s30 offen offset:1024 sc1
    buffer_load_dwordx4 v[232:235], v2, s[16:19], s30 offen offset:2048 sc1
    buffer_load_dwordx4 v[236:239], v2, s[16:19], s30 offen offset:3072 sc1
    buffer_load_dwordx4 v[240:243], v2, s[16:19], s31 offen offset:0 sc1
    buffer_load_dwordx4 v[244:247], v2, s[16:19], s31 offen offset:1024 sc1
    buffer_load_dwordx4 v[248:251], v2, s[16:19], s31 offen offset:2048 sc1
    buffer_load_dwordx4 v[252:255], v2, s[16:19], s31 offen offset:3072 sc1
    s_add_u32 s30, s23, 3
    s_and_b32 s30, s30, 3
    s_lshl_b32 s30, s30, 13
    s_add_u32 s30, s30, s39
    s_add_u32 s31, s30, 4096
    buffer_load_dwordx4 v[96:99], v2, s[16:19], s30 offen offset:0 sc1
    buffer_load_dwordx4 v[100:103], v2, s[16:19], s30 offen offset:1024 sc1
    buffer_load_dwordx4 v[104:107], v2, s[16:19], s30 offen offset:2048 sc1
    buffer_load_dwordx4 v[108:111], v2, s[16:19], s30 offen offset:3072 sc1
    buffer_load_dwordx4 v[112:115], v2, s[16:19], s31 offen offset:0 sc1
    buffer_load_dwordx4 v[116:119], v2, s[16:19], s31 offen offset:1024 sc1
    buffer_load_dwordx4 v[120:123], v2, s[16:19], s31 offen offset:2048 sc1
    buffer_load_dwordx4 v[124:127], v2, s[16:19], s31 offen offset:3072 sc1
    s_waitcnt vmcnt(24)
    v_sub_f32 v20, 1.0, v5
    v_cvt_pk_bf16_f32 v20, v20, v20
    v_lshlrev_b32 v20, 16, v20
    v_cvt_pk_bf16_f32 v128, v128, v128
    v_lshlrev_b32 v128, 16, v128
    v_mul_f32 v128, v128, v20
    v_cvt_pk_bf16_f32 v128, v128, v128
    v_lshlrev_b32 v128, 16, v128
    v_cvt_pk_bf16_f32 v129, v129, v129
    v_lshlrev_b32 v129, 16, v129
    v_mul_f32 v129, v129, v20
    v_cvt_pk_bf16_f32 v129, v129, v129
    v_lshlrev_b32 v129, 16, v129
    v_cvt_pk_bf16_f32 v130, v130, v130
    v_lshlrev_b32 v130, 16, v130
    v_mul_f32 v130, v130, v20
    v_cvt_pk_bf16_f32 v130, v130, v130
    v_lshlrev_b32 v130, 16, v130
    v_cvt_pk_bf16_f32 v131, v131, v131
    v_lshlrev_b32 v131, 16, v131
    v_mul_f32 v131, v131, v20
    v_cvt_pk_bf16_f32 v131, v131, v131
    v_lshlrev_b32 v131, 16, v131
    v_cvt_pk_bf16_f32 v132, v132, v132
    v_lshlrev_b32 v132, 16, v132
    v_mul_f32 v132, v132, v20
    v_cvt_pk_bf16_f32 v132, v132, v132
    v_lshlrev_b32 v132, 16, v132
    v_cvt_pk_bf16_f32 v133, v133, v133
    v_lshlrev_b32 v133, 16, v133
    v_mul_f32 v133, v133, v20
    v_cvt_pk_bf16_f32 v133, v133, v133
    v_lshlrev_b32 v133, 16, v133
    v_cvt_pk_bf16_f32 v134, v134, v134
    v_lshlrev_b32 v134, 16, v134
    v_mul_f32 v134, v134, v20
    v_cvt_pk_bf16_f32 v134, v134, v134
    v_lshlrev_b32 v134, 16, v134
    v_cvt_pk_bf16_f32 v135, v135, v135
    v_lshlrev_b32 v135, 16, v135
    v_mul_f32 v135, v135, v20
    v_cvt_pk_bf16_f32 v135, v135, v135
    v_lshlrev_b32 v135, 16, v135
    v_cvt_pk_bf16_f32 v136, v136, v136
    v_lshlrev_b32 v136, 16, v136
    v_mul_f32 v136, v136, v20
    v_cvt_pk_bf16_f32 v136, v136, v136
    v_lshlrev_b32 v136, 16, v136
    v_cvt_pk_bf16_f32 v137, v137, v137
    v_lshlrev_b32 v137, 16, v137
    v_mul_f32 v137, v137, v20
    v_cvt_pk_bf16_f32 v137, v137, v137
    v_lshlrev_b32 v137, 16, v137
    v_cvt_pk_bf16_f32 v138, v138, v138
    v_lshlrev_b32 v138, 16, v138
    v_mul_f32 v138, v138, v20
    v_cvt_pk_bf16_f32 v138, v138, v138
    v_lshlrev_b32 v138, 16, v138
    v_cvt_pk_bf16_f32 v139, v139, v139
    v_lshlrev_b32 v139, 16, v139
    v_mul_f32 v139, v139, v20
    v_cvt_pk_bf16_f32 v139, v139, v139
    v_lshlrev_b32 v139, 16, v139
    v_cvt_pk_bf16_f32 v140, v140, v140
    v_lshlrev_b32 v140, 16, v140
    v_mul_f32 v140, v140, v20
    v_cvt_pk_bf16_f32 v140, v140, v140
    v_lshlrev_b32 v140, 16, v140
    v_cvt_pk_bf16_f32 v141, v141, v141
    v_lshlrev_b32 v141, 16, v141
    v_mul_f32 v141, v141, v20
    v_cvt_pk_bf16_f32 v141, v141, v141
    v_lshlrev_b32 v141, 16, v141
    v_cvt_pk_bf16_f32 v142, v142, v142
    v_lshlrev_b32 v142, 16, v142
    v_mul_f32 v142, v142, v20
    v_cvt_pk_bf16_f32 v142, v142, v142
    v_lshlrev_b32 v142, 16, v142
    v_cvt_pk_bf16_f32 v143, v143, v143
    v_lshlrev_b32 v143, 16, v143
    v_mul_f32 v143, v143, v20
    v_cvt_pk_bf16_f32 v143, v143, v143
    v_lshlrev_b32 v143, 16, v143
    v_cvt_pk_bf16_f32 v144, v144, v144
    v_lshlrev_b32 v144, 16, v144
    v_mul_f32 v144, v144, v20
    v_cvt_pk_bf16_f32 v144, v144, v144
    v_lshlrev_b32 v144, 16, v144
    v_cvt_pk_bf16_f32 v145, v145, v145
    v_lshlrev_b32 v145, 16, v145
    v_mul_f32 v145, v145, v20
    v_cvt_pk_bf16_f32 v145, v145, v145
    v_lshlrev_b32 v145, 16, v145
    v_cvt_pk_bf16_f32 v146, v146, v146
    v_lshlrev_b32 v146, 16, v146
    v_mul_f32 v146, v146, v20
    v_cvt_pk_bf16_f32 v146, v146, v146
    v_lshlrev_b32 v146, 16, v146
    v_cvt_pk_bf16_f32 v147, v147, v147
    v_lshlrev_b32 v147, 16, v147
    v_mul_f32 v147, v147, v20
    v_cvt_pk_bf16_f32 v147, v147, v147
    v_lshlrev_b32 v147, 16, v147
    v_cvt_pk_bf16_f32 v148, v148, v148
    v_lshlrev_b32 v148, 16, v148
    v_mul_f32 v148, v148, v20
    v_cvt_pk_bf16_f32 v148, v148, v148
    v_lshlrev_b32 v148, 16, v148
    v_cvt_pk_bf16_f32 v149, v149, v149
    v_lshlrev_b32 v149, 16, v149
    v_mul_f32 v149, v149, v20
    v_cvt_pk_bf16_f32 v149, v149, v149
    v_lshlrev_b32 v149, 16, v149
    v_cvt_pk_bf16_f32 v150, v150, v150
    v_lshlrev_b32 v150, 16, v150
    v_mul_f32 v150, v150, v20
    v_cvt_pk_bf16_f32 v150, v150, v150
    v_lshlrev_b32 v150, 16, v150
    v_cvt_pk_bf16_f32 v151, v151, v151
    v_lshlrev_b32 v151, 16, v151
    v_mul_f32 v151, v151, v20
    v_cvt_pk_bf16_f32 v151, v151, v151
    v_lshlrev_b32 v151, 16, v151
    v_cvt_pk_bf16_f32 v152, v152, v152
    v_lshlrev_b32 v152, 16, v152
    v_mul_f32 v152, v152, v20
    v_cvt_pk_bf16_f32 v152, v152, v152
    v_lshlrev_b32 v152, 16, v152
    v_cvt_pk_bf16_f32 v153, v153, v153
    v_lshlrev_b32 v153, 16, v153
    v_mul_f32 v153, v153, v20
    v_cvt_pk_bf16_f32 v153, v153, v153
    v_lshlrev_b32 v153, 16, v153
    v_cvt_pk_bf16_f32 v154, v154, v154
    v_lshlrev_b32 v154, 16, v154
    v_mul_f32 v154, v154, v20
    v_cvt_pk_bf16_f32 v154, v154, v154
    v_lshlrev_b32 v154, 16, v154
    v_cvt_pk_bf16_f32 v155, v155, v155
    v_lshlrev_b32 v155, 16, v155
    v_mul_f32 v155, v155, v20
    v_cvt_pk_bf16_f32 v155, v155, v155
    v_lshlrev_b32 v155, 16, v155
    v_cvt_pk_bf16_f32 v156, v156, v156
    v_lshlrev_b32 v156, 16, v156
    v_mul_f32 v156, v156, v20
    v_cvt_pk_bf16_f32 v156, v156, v156
    v_lshlrev_b32 v156, 16, v156
    v_cvt_pk_bf16_f32 v157, v157, v157
    v_lshlrev_b32 v157, 16, v157
    v_mul_f32 v157, v157, v20
    v_cvt_pk_bf16_f32 v157, v157, v157
    v_lshlrev_b32 v157, 16, v157
    v_cvt_pk_bf16_f32 v158, v158, v158
    v_lshlrev_b32 v158, 16, v158
    v_mul_f32 v158, v158, v20
    v_cvt_pk_bf16_f32 v158, v158, v158
    v_lshlrev_b32 v158, 16, v158
    v_cvt_pk_bf16_f32 v159, v159, v159
    v_lshlrev_b32 v159, 16, v159
    v_mul_f32 v159, v159, v20
    v_cvt_pk_bf16_f32 v159, v159, v159
    v_lshlrev_b32 v159, 16, v159
    s_xor_b32 s30, s20, 4
    s_lshl_b32 s30, s30, 13
    v_mul_u32_u24 v22, 144, v22
    v_lshrrev_b32 v23, 5, v3
    v_lshl_add_u32 v22, v23, 3, v22
    v_add_u32 v22, s30, v22
    v_lshrrev_b32 v14, 3, v3
    v_and_b32 v15, 7, v3
    v_mul_u32_u24 v16, 144, v14
    v_lshl_add_u32 v16, v15, 4, v16
    v_add_u32 v16, s30, v16
    v_lshlrev_b32 v17, 10, v14
    v_lshl_add_u32 v17, v15, 4, v17
    s_lshl_b32 s30, s21, 17
    s_lshl_b32 s31, s22, 8
    s_add_u32 s30, s30, s31
    s_lshl_b32 s31, s37, 10
    s_add_u32 s30, s30, s31
    s_lshl_b32 s31, s36, 7
    s_add_u32 s30, s30, s31
    s_waitcnt vmcnt(0)
    v_add_f32 v192, v192, v224
    v_add_f32 v64, v64, v96
    v_add_f32 v64, v64, v192
    v_cvt_pk_bf16_f32 v64, v64, v64
    v_lshlrev_b32 v64, 16, v64
    v_mul_f32 v64, v64, v5
    v_cvt_pk_bf16_f32 v64, v64, v64
    v_lshlrev_b32 v64, 16, v64
    v_add_f32 v64, v64, v128
    v_add_f32 v193, v193, v225
    v_add_f32 v65, v65, v97
    v_add_f32 v65, v65, v193
    v_cvt_pk_bf16_f32 v65, v65, v65
    v_lshlrev_b32 v65, 16, v65
    v_mul_f32 v65, v65, v5
    v_cvt_pk_bf16_f32 v65, v65, v65
    v_lshlrev_b32 v65, 16, v65
    v_add_f32 v65, v65, v129
    v_add_f32 v194, v194, v226
    v_add_f32 v66, v66, v98
    v_add_f32 v66, v66, v194
    v_cvt_pk_bf16_f32 v66, v66, v66
    v_lshlrev_b32 v66, 16, v66
    v_mul_f32 v66, v66, v5
    v_cvt_pk_bf16_f32 v66, v66, v66
    v_lshlrev_b32 v66, 16, v66
    v_add_f32 v66, v66, v130
    v_add_f32 v195, v195, v227
    v_add_f32 v67, v67, v99
    v_add_f32 v67, v67, v195
    v_cvt_pk_bf16_f32 v67, v67, v67
    v_lshlrev_b32 v67, 16, v67
    v_mul_f32 v67, v67, v5
    v_cvt_pk_bf16_f32 v67, v67, v67
    v_lshlrev_b32 v67, 16, v67
    v_add_f32 v67, v67, v131
    v_add_f32 v196, v196, v228
    v_add_f32 v68, v68, v100
    v_add_f32 v68, v68, v196
    v_cvt_pk_bf16_f32 v68, v68, v68
    v_lshlrev_b32 v68, 16, v68
    v_mul_f32 v68, v68, v5
    v_cvt_pk_bf16_f32 v68, v68, v68
    v_lshlrev_b32 v68, 16, v68
    v_add_f32 v68, v68, v132
    v_add_f32 v197, v197, v229
    v_add_f32 v69, v69, v101
    v_add_f32 v69, v69, v197
    v_cvt_pk_bf16_f32 v69, v69, v69
    v_lshlrev_b32 v69, 16, v69
    v_mul_f32 v69, v69, v5
    v_cvt_pk_bf16_f32 v69, v69, v69
    v_lshlrev_b32 v69, 16, v69
    v_add_f32 v69, v69, v133
    v_add_f32 v198, v198, v230
    v_add_f32 v70, v70, v102
    v_add_f32 v70, v70, v198
    v_cvt_pk_bf16_f32 v70, v70, v70
    v_lshlrev_b32 v70, 16, v70
    v_mul_f32 v70, v70, v5
    v_cvt_pk_bf16_f32 v70, v70, v70
    v_lshlrev_b32 v70, 16, v70
    v_add_f32 v70, v70, v134
    v_add_f32 v199, v199, v231
    v_add_f32 v71, v71, v103
    v_add_f32 v71, v71, v199
    v_cvt_pk_bf16_f32 v71, v71, v71
    v_lshlrev_b32 v71, 16, v71
    v_mul_f32 v71, v71, v5
    v_cvt_pk_bf16_f32 v71, v71, v71
    v_lshlrev_b32 v71, 16, v71
    v_add_f32 v71, v71, v135
    v_add_f32 v200, v200, v232
    v_add_f32 v72, v72, v104
    v_add_f32 v72, v72, v200
    v_cvt_pk_bf16_f32 v72, v72, v72
    v_lshlrev_b32 v72, 16, v72
    v_mul_f32 v72, v72, v5
    v_cvt_pk_bf16_f32 v72, v72, v72
    v_lshlrev_b32 v72, 16, v72
    v_add_f32 v72, v72, v136
    v_add_f32 v201, v201, v233
    v_add_f32 v73, v73, v105
    v_add_f32 v73, v73, v201
    v_cvt_pk_bf16_f32 v73, v73, v73
    v_lshlrev_b32 v73, 16, v73
    v_mul_f32 v73, v73, v5
    v_cvt_pk_bf16_f32 v73, v73, v73
    v_lshlrev_b32 v73, 16, v73
    v_add_f32 v73, v73, v137
    v_add_f32 v202, v202, v234
    v_add_f32 v74, v74, v106
    v_add_f32 v74, v74, v202
    v_cvt_pk_bf16_f32 v74, v74, v74
    v_lshlrev_b32 v74, 16, v74
    v_mul_f32 v74, v74, v5
    v_cvt_pk_bf16_f32 v74, v74, v74
    v_lshlrev_b32 v74, 16, v74
    v_add_f32 v74, v74, v138
    v_add_f32 v203, v203, v235
    v_add_f32 v75, v75, v107
    v_add_f32 v75, v75, v203
    v_cvt_pk_bf16_f32 v75, v75, v75
    v_lshlrev_b32 v75, 16, v75
    v_mul_f32 v75, v75, v5
    v_cvt_pk_bf16_f32 v75, v75, v75
    v_lshlrev_b32 v75, 16, v75
    v_add_f32 v75, v75, v139
    v_add_f32 v204, v204, v236
    v_add_f32 v76, v76, v108
    v_add_f32 v76, v76, v204
    v_cvt_pk_bf16_f32 v76, v76, v76
    v_lshlrev_b32 v76, 16, v76
    v_mul_f32 v76, v76, v5
    v_cvt_pk_bf16_f32 v76, v76, v76
    v_lshlrev_b32 v76, 16, v76
    v_add_f32 v76, v76, v140
    v_add_f32 v205, v205, v237
    v_add_f32 v77, v77, v109
    v_add_f32 v77, v77, v205
    v_cvt_pk_bf16_f32 v77, v77, v77
    v_lshlrev_b32 v77, 16, v77
    v_mul_f32 v77, v77, v5
    v_cvt_pk_bf16_f32 v77, v77, v77
    v_lshlrev_b32 v77, 16, v77
    v_add_f32 v77, v77, v141
    v_add_f32 v206, v206, v238
    v_add_f32 v78, v78, v110
    v_add_f32 v78, v78, v206
    v_cvt_pk_bf16_f32 v78, v78, v78
    v_lshlrev_b32 v78, 16, v78
    v_mul_f32 v78, v78, v5
    v_cvt_pk_bf16_f32 v78, v78, v78
    v_lshlrev_b32 v78, 16, v78
    v_add_f32 v78, v78, v142
    v_add_f32 v207, v207, v239
    v_add_f32 v79, v79, v111
    v_add_f32 v79, v79, v207
    v_cvt_pk_bf16_f32 v79, v79, v79
    v_lshlrev_b32 v79, 16, v79
    v_mul_f32 v79, v79, v5
    v_cvt_pk_bf16_f32 v79, v79, v79
    v_lshlrev_b32 v79, 16, v79
    v_add_f32 v79, v79, v143
    v_add_f32 v208, v208, v240
    v_add_f32 v80, v80, v112
    v_add_f32 v80, v80, v208
    v_cvt_pk_bf16_f32 v80, v80, v80
    v_lshlrev_b32 v80, 16, v80
    v_mul_f32 v80, v80, v5
    v_cvt_pk_bf16_f32 v80, v80, v80
    v_lshlrev_b32 v80, 16, v80
    v_add_f32 v80, v80, v144
    v_add_f32 v209, v209, v241
    v_add_f32 v81, v81, v113
    v_add_f32 v81, v81, v209
    v_cvt_pk_bf16_f32 v81, v81, v81
    v_lshlrev_b32 v81, 16, v81
    v_mul_f32 v81, v81, v5
    v_cvt_pk_bf16_f32 v81, v81, v81
    v_lshlrev_b32 v81, 16, v81
    v_add_f32 v81, v81, v145
    v_add_f32 v210, v210, v242
    v_add_f32 v82, v82, v114
    v_add_f32 v82, v82, v210
    v_cvt_pk_bf16_f32 v82, v82, v82
    v_lshlrev_b32 v82, 16, v82
    v_mul_f32 v82, v82, v5
    v_cvt_pk_bf16_f32 v82, v82, v82
    v_lshlrev_b32 v82, 16, v82
    v_add_f32 v82, v82, v146
    v_add_f32 v211, v211, v243
    v_add_f32 v83, v83, v115
    v_add_f32 v83, v83, v211
    v_cvt_pk_bf16_f32 v83, v83, v83
    v_lshlrev_b32 v83, 16, v83
    v_mul_f32 v83, v83, v5
    v_cvt_pk_bf16_f32 v83, v83, v83
    v_lshlrev_b32 v83, 16, v83
    v_add_f32 v83, v83, v147
    v_add_f32 v212, v212, v244
    v_add_f32 v84, v84, v116
    v_add_f32 v84, v84, v212
    v_cvt_pk_bf16_f32 v84, v84, v84
    v_lshlrev_b32 v84, 16, v84
    v_mul_f32 v84, v84, v5
    v_cvt_pk_bf16_f32 v84, v84, v84
    v_lshlrev_b32 v84, 16, v84
    v_add_f32 v84, v84, v148
    v_add_f32 v213, v213, v245
    v_add_f32 v85, v85, v117
    v_add_f32 v85, v85, v213
    v_cvt_pk_bf16_f32 v85, v85, v85
    v_lshlrev_b32 v85, 16, v85
    v_mul_f32 v85, v85, v5
    v_cvt_pk_bf16_f32 v85, v85, v85
    v_lshlrev_b32 v85, 16, v85
    v_add_f32 v85, v85, v149
    v_add_f32 v214, v214, v246
    v_add_f32 v86, v86, v118
    v_add_f32 v86, v86, v214
    v_cvt_pk_bf16_f32 v86, v86, v86
    v_lshlrev_b32 v86, 16, v86
    v_mul_f32 v86, v86, v5
    v_cvt_pk_bf16_f32 v86, v86, v86
    v_lshlrev_b32 v86, 16, v86
    v_add_f32 v86, v86, v150
    v_add_f32 v215, v215, v247
    v_add_f32 v87, v87, v119
    v_add_f32 v87, v87, v215
    v_cvt_pk_bf16_f32 v87, v87, v87
    v_lshlrev_b32 v87, 16, v87
    v_mul_f32 v87, v87, v5
    v_cvt_pk_bf16_f32 v87, v87, v87
    v_lshlrev_b32 v87, 16, v87
    v_add_f32 v87, v87, v151
    v_add_f32 v216, v216, v248
    v_add_f32 v88, v88, v120
    v_add_f32 v88, v88, v216
    v_cvt_pk_bf16_f32 v88, v88, v88
    v_lshlrev_b32 v88, 16, v88
    v_mul_f32 v88, v88, v5
    v_cvt_pk_bf16_f32 v88, v88, v88
    v_lshlrev_b32 v88, 16, v88
    v_add_f32 v88, v88, v152
    v_add_f32 v217, v217, v249
    v_add_f32 v89, v89, v121
    v_add_f32 v89, v89, v217
    v_cvt_pk_bf16_f32 v89, v89, v89
    v_lshlrev_b32 v89, 16, v89
    v_mul_f32 v89, v89, v5
    v_cvt_pk_bf16_f32 v89, v89, v89
    v_lshlrev_b32 v89, 16, v89
    v_add_f32 v89, v89, v153
    v_add_f32 v218, v218, v250
    v_add_f32 v90, v90, v122
    v_add_f32 v90, v90, v218
    v_cvt_pk_bf16_f32 v90, v90, v90
    v_lshlrev_b32 v90, 16, v90
    v_mul_f32 v90, v90, v5
    v_cvt_pk_bf16_f32 v90, v90, v90
    v_lshlrev_b32 v90, 16, v90
    v_add_f32 v90, v90, v154
    v_add_f32 v219, v219, v251
    v_add_f32 v91, v91, v123
    v_add_f32 v91, v91, v219
    v_cvt_pk_bf16_f32 v91, v91, v91
    v_lshlrev_b32 v91, 16, v91
    v_mul_f32 v91, v91, v5
    v_cvt_pk_bf16_f32 v91, v91, v91
    v_lshlrev_b32 v91, 16, v91
    v_add_f32 v91, v91, v155
    v_add_f32 v220, v220, v252
    v_add_f32 v92, v92, v124
    v_add_f32 v92, v92, v220
    v_cvt_pk_bf16_f32 v92, v92, v92
    v_lshlrev_b32 v92, 16, v92
    v_mul_f32 v92, v92, v5
    v_cvt_pk_bf16_f32 v92, v92, v92
    v_lshlrev_b32 v92, 16, v92
    v_add_f32 v92, v92, v156
    v_add_f32 v221, v221, v253
    v_add_f32 v93, v93, v125
    v_add_f32 v93, v93, v221
    v_cvt_pk_bf16_f32 v93, v93, v93
    v_lshlrev_b32 v93, 16, v93
    v_mul_f32 v93, v93, v5
    v_cvt_pk_bf16_f32 v93, v93, v93
    v_lshlrev_b32 v93, 16, v93
    v_add_f32 v93, v93, v157
    v_add_f32 v222, v222, v254
    v_add_f32 v94, v94, v126
    v_add_f32 v94, v94, v222
    v_cvt_pk_bf16_f32 v94, v94, v94
    v_lshlrev_b32 v94, 16, v94
    v_mul_f32 v94, v94, v5
    v_cvt_pk_bf16_f32 v94, v94, v94
    v_lshlrev_b32 v94, 16, v94
    v_add_f32 v94, v94, v158
    v_add_f32 v223, v223, v255
    v_add_f32 v95, v95, v127
    v_add_f32 v95, v95, v223
    v_cvt_pk_bf16_f32 v95, v95, v95
    v_lshlrev_b32 v95, 16, v95
    v_mul_f32 v95, v95, v5
    v_cvt_pk_bf16_f32 v95, v95, v95
    v_lshlrev_b32 v95, 16, v95
    v_add_f32 v95, v95, v159
    v_cvt_pk_bf16_f32 v192, v64, v65
    v_cvt_pk_bf16_f32 v193, v66, v67
    ds_write_b64 v22, v[192:193] offset:0
    v_cvt_pk_bf16_f32 v194, v68, v69
    v_cvt_pk_bf16_f32 v195, v70, v71
    ds_write_b64 v22, v[194:195] offset:16
    v_cvt_pk_bf16_f32 v196, v72, v73
    v_cvt_pk_bf16_f32 v197, v74, v75
    ds_write_b64 v22, v[196:197] offset:32
    v_cvt_pk_bf16_f32 v198, v76, v77
    v_cvt_pk_bf16_f32 v199, v78, v79
    ds_write_b64 v22, v[198:199] offset:48
    v_cvt_pk_bf16_f32 v200, v80, v81
    v_cvt_pk_bf16_f32 v201, v82, v83
    ds_write_b64 v22, v[200:201] offset:64
    v_cvt_pk_bf16_f32 v202, v84, v85
    v_cvt_pk_bf16_f32 v203, v86, v87
    ds_write_b64 v22, v[202:203] offset:80
    v_cvt_pk_bf16_f32 v204, v88, v89
    v_cvt_pk_bf16_f32 v205, v90, v91
    ds_write_b64 v22, v[204:205] offset:96
    v_cvt_pk_bf16_f32 v206, v92, v93
    v_cvt_pk_bf16_f32 v207, v94, v95
    ds_write_b64 v22, v[206:207] offset:112
    s_waitcnt lgkmcnt(0)
    ds_read_b128 v[32:35], v16 offset:0
    ds_read_b128 v[36:39], v16 offset:1152
    ds_read_b128 v[40:43], v16 offset:2304
    ds_read_b128 v[44:47], v16 offset:3456
    s_waitcnt lgkmcnt(3)
    s_add_u32 s31, s30, 0
    buffer_store_dwordx4 v[32:35], v17, s[64:67], s31 offen
    s_waitcnt lgkmcnt(2)
    s_add_u32 s31, s30, 8192
    buffer_store_dwordx4 v[36:39], v17, s[64:67], s31 offen
    s_waitcnt lgkmcnt(1)
    s_add_u32 s31, s30, 16384
    buffer_store_dwordx4 v[40:43], v17, s[64:67], s31 offen
    s_waitcnt lgkmcnt(0)
    s_add_u32 s31, s30, 24576
    buffer_store_dwordx4 v[44:47], v17, s[64:67], s31 offen
    s_endpgm
.section .rodata,"a"
.p2align 6
.amdhsa_kernel attn_kernel
  .amdhsa_next_free_vgpr 256
  .amdhsa_next_free_sgpr 102
  .amdhsa_accum_offset 256
  .amdhsa_group_segment_fixed_size 0
  .amdhsa_kernarg_size 112
  .amdhsa_user_sgpr_count 2
  .amdhsa_user_sgpr_kernarg_segment_ptr 1
  .amdhsa_system_sgpr_workgroup_id_x 1
.end_amdhsa_kernel
```
